```python
import torch

def _softmax(x, axis=-1):
    return torch.softmax(x, dim=axis)
def _gelu(x):
    return torch.nn.functional.gelu(x, approximate="tanh")
def _silu(x):
    return torch.nn.functional.silu(x)
def _sigmoid(x):
    return torch.sigmoid(x)
def _layernorm(x, axis=-1, eps=1e-5):
    m = x.mean(dim=axis, keepdim=True)
    v = x.var(dim=axis, keepdim=True, unbiased=False)
    return (x - m) / torch.sqrt(v + eps)
def _scatter_add(tgt, idx, src, axis=0):
    return tgt.clone().index_add_(axis, idx, src)
def _segment_sum(src, seg, n):
    out = torch.zeros((n,) + src.shape[1:], dtype=src.dtype)
    return out.index_add_(0, seg, src)
def _pad(x, pw):
    flat = tuple(v for pair in reversed(pw) for v in pair)
    return torch.nn.functional.pad(x, flat)

kernel_name = 'gated_mix__linear_kernel_hedgehog__dense_activation_silu__prompt'

def setup_inputs():

    _w = (lambda a: (lambda t: t.to(torch.bfloat16) if t.is_floating_point() else t)(torch.as_tensor(a)))
    def _A_setup():
        B, S, D, H = 1, 2048, 640, 32
        Dh = D // H
        return {
            "x": _w((lambda *s: torch.randn(*s, dtype=torch.bfloat16) * 0.1)(B, S, D)),
            "wqkv": _w((lambda *s: torch.randn(*s, dtype=torch.bfloat16) * 0.8)(D, 3 * D)),
            "w_phi": _w((lambda *s: torch.randn(*s, dtype=torch.bfloat16) * 0.8)(H, Dh, Dh) * (Dh ** -0.5)),
            "wo": _w((lambda *s: torch.randn(*s, dtype=torch.bfloat16) * 0.2)(D, D)),
        }
    _A_in = _A_setup()

    def _B_setup():
        B, S, D, F = 1, 2048, 640, 1728
        return {
            "x": _w((lambda *s: torch.randn(*s, dtype=torch.bfloat16) * 0.1)(B, S, D)),
            "w1": _w((lambda *s: torch.randn(*s, dtype=torch.bfloat16) * 3.2)(D, F) * (D ** -0.5)),
            "w2": _w((lambda *s: torch.randn(*s, dtype=torch.bfloat16) * 3.2)(F, D) * (F ** -0.5)),
        }
    _B_in = _B_setup()

    return {
        "A_x": _A_in["x"],
        "A_wqkv": _A_in["wqkv"],
        "A_w_phi": _A_in["w_phi"],
        "A_wo": _A_in["wo"],
        "B_x": _B_in["x"],
        "B_w1": _B_in["w1"],
        "B_w2": _B_in["w2"],
        "gate_w": _w((lambda *s: torch.randn(*s, dtype=torch.bfloat16) * 0.1)(640) * 16.0),
    }

def reference(A_x, A_wqkv, A_w_phi, A_wo, B_x, B_w1, B_w2, gate_w):
    def _A_ref(x, wqkv, w_phi, wo):
        B, S, D = x.shape
        H = 32; Dh = D // H
        qkv = (lambda x, *d: x.permute(*d))((x @ wqkv).reshape(B, S, 3, H, Dh), 2, 0, 3, 1, 4)
        q, k, v = qkv[0], qkv[1], qkv[2]
        pq = torch.einsum("bhsd,hdf->bhsf", q, w_phi)
        pk = torch.einsum("bhsd,hdf->bhsf", k, w_phi)
        phi_q = torch.concatenate([_softmax(pq, axis=-1), _softmax(-pq, axis=-1)], axis=-1)
        phi_k = torch.concatenate([_softmax(pk, axis=-1), _softmax(-pk, axis=-1)], axis=-1)
        kv = torch.einsum("bhsf,bhsd->bhfd", phi_k, v)
        z  = torch.einsum("bhsf->bhf", phi_k)
        num = torch.einsum("bhqf,bhfd->bhqd", phi_q, kv)
        den = torch.einsum("bhqf,bhf->bhq", phi_q, z)[..., None] + 1e-6
        o = num / den
        return (lambda x, *d: x.permute(*d))(o, 0, 2, 1, 3).reshape(B, S, D) @ wo

    def _B_ref(x, w1, w2):
        h = torch.einsum("bsd,df->bsf", x, w1)
        h = _silu(h)
        out = torch.einsum("bsf,fd->bsd", h, w2)
        return out

    x = A_x
    g = _sigmoid((x * gate_w).sum(-1, keepdims=True))
    a = _A_ref(x, A_wqkv, A_w_phi, A_wo)
    b = _B_ref(x, B_w1, B_w2)
    return g * a + (1 - g) * b
```

```asm
; @launch grid=(256,1,1) block=(512,1,1) lds=163840
.amdgcn_target "amdgcn-amd-amdhsa--gfx950"
.text
.globl gated_mix__linear_kernel_hedgehog__dense_activation_silu__prompt_kernel
.p2align 8
.type gated_mix__linear_kernel_hedgehog__dense_activation_silu__prompt_kernel,@function
gated_mix__linear_kernel_hedgehog__dense_activation_silu__prompt_kernel:
    s_cmp_ge_u32 s2, 256
    s_cbranch_scc1 L_EXIT
    s_load_dwordx16 s[4:19], s[0:1], 0
    s_load_dwordx2 s[22:23], s[0:1], 80
    v_and_b32 v1, 63, v0
    v_lshrrev_b32 v2, 6, v0
    s_nop 0
    v_readfirstlane_b32 s44, v2
    s_and_b32 s56, s2, 7
    s_lshr_b32 s57, s2, 3
    s_and_b32 s58, s56, 1
    s_and_b32 s59, s57, 7
    s_lshl_b32 s46, s58, 3
    s_add_u32 s46, s46, s59
    s_lshr_b32 s60, s57, 3
    s_lshr_b32 s61, s56, 1
    s_lshl_b32 s51, s61, 2
    s_add_u32 s51, s51, s60
    s_lshl_b32 s47, s61, 1
    s_and_b32 s48, s60, 1
    s_add_u32 s47, s47, s48
    s_lshl_b32 s48, s58, 4
    s_and_b32 s49, s61, 1
    s_lshl_b32 s49, s49, 3
    s_add_u32 s48, s48, s49
    s_add_u32 s48, s48, s59
    s_lshr_b32 s49, s56, 2
    s_lshl_b32 s49, s49, 2
    s_add_u32 s49, s49, s60
    s_and_b32 s46, s57, 3
    s_lshl2_add_u32 s46, s61, s46
    s_bfe_u32 s47, s57, 0x20002
    s_lshl2_add_u32 s47, s58, s47
    s_lshl3_add_u32 s48, s61, s59
    s_lshl2_add_u32 s49, s58, s60
    s_mov_b32 s59, s61
    s_and_b32 s45, s44, 3
    s_mov_b32 s62, 0x3fb8aa3b
    s_mov_b32 s63, 0xbfb8aa3b
    v_lshlrev_b32 v2, 4, v1
    v_lshrrev_b32 v4, 3, v1
    v_mul_u32_u24 v4, 1280, v4
    s_and_b32 s52, s44, 1
    s_lshl_b32 s52, s52, 2
    v_lshrrev_b32 v5, 4, v1
    v_add_u32 v5, s52, v5
    v_and_b32 v6, 7, v1
    v_xor_b32 v5, v5, v6
    v_lshl_add_u32 v3, v5, 4, v4
    s_lshl_b32 s52, s46, 4
    s_add_u32 s52, s52, s44
    s_mul_i32 s52, s52, 10240
    s_lshl_b32 s54, s44, 10
    s_lshl1_add_u32 s21, s60, s59
    s_mul_i32 s82, s21, 5
    s_lshr_b32 s82, s82, 2
    s_add_u32 s82, s60, s59
    s_and_b32 s82, s82, 1
    s_mul_i32 s82, s82, 5
    s_sub_u32 s20, s82, 10
    s_cmp_ge_u32 s82, 10
    s_cselect_b32 s82, s20, s82
    s_sub_u32 s20, 10, s82
    s_lshl_b32 s20, -1, s20
    s_lshl_b32 s56, s82, 7
    s_add_u32 s52, s52, s56
    s_lshr_b32 s60, s60, 1
    s_lshr_b32 s59, s44, 2
    s_lshl1_add_u32 s83, s60, s59
    s_waitcnt lgkmcnt(0)
    s_mov_b32 s13, s21
    s_add_u32 s56, s22, 0xd2d800
    s_addc_u32 s57, s23, 0
    s_load_dword s50, s[56:57], 0
    s_mov_b32 s24, s4
    s_and_b32 s25, s5, 0xffff
    s_mov_b32 s26, 0x280000
    s_mov_b32 s27, 0x20000
    s_mov_b32 s32, s22
    s_and_b32 s33, s23, 0xffff
    s_mov_b32 s34, 0xd2d900
    s_mov_b32 s35, 0x20000
    s_cmp_eq_u32 s83, 1
    s_cbranch_scc1 L_X1
    s_cmp_eq_u32 s83, 2
    s_cbranch_scc1 L_Y0
    s_cmp_eq_u32 s83, 3
    s_cbranch_scc1 L_Y1
L_X0:
    s_mov_b32 s28, s6
    s_and_b32 s29, s7, 0xffff
    s_mov_b32 s30, 0x258000
    s_mov_b32 s31, 0x20000
    s_mul_i32 s53, s45, 61440
    s_mul_i32 s56, s47, 160
    s_add_u32 s53, s53, s56
    s_add_u32 s53, s53, 1280
    s_mul_i32 s56, s82, 245760
    s_add_u32 s53, s53, s56
    s_mul_i32 s55, s45, 2560
    v_add_u32 v13, 0, v1
    v_mul_u32_u24 v14, 6554, v13
    v_lshrrev_b32 v14, 16, v14
    v_mul_u32_u24 v15, 10, v14
    v_sub_u32 v13, v13, v15
    v_and_b32 v15, 0x13, v14
    v_and_b32 v4, 4, v14
    v_lshl_or_b32 v15, v4, 1, v15
    v_bfe_u32 v4, v14, 3, 1
    v_lshl_or_b32 v15, v4, 2, v15
    v_mul_u32_u24 v15, 3840, v15
    v_lshl_add_u32 v4, v13, 4, v15
    v_add_u32 v13, 64, v1
    v_mul_u32_u24 v14, 6554, v13
    v_lshrrev_b32 v14, 16, v14
    v_mul_u32_u24 v15, 10, v14
    v_sub_u32 v13, v13, v15
    v_and_b32 v15, 0x13, v14
    v_and_b32 v5, 4, v14
    v_lshl_or_b32 v15, v5, 1, v15
    v_bfe_u32 v5, v14, 3, 1
    v_lshl_or_b32 v15, v5, 2, v15
    v_mul_u32_u24 v15, 3840, v15
    v_lshl_add_u32 v5, v13, 4, v15
    v_add_u32 v13, 128, v1
    v_mul_u32_u24 v14, 6554, v13
    v_lshrrev_b32 v14, 16, v14
    v_mul_u32_u24 v15, 10, v14
    v_sub_u32 v13, v13, v15
    v_and_b32 v15, 0x13, v14
    v_and_b32 v6, 4, v14
    v_lshl_or_b32 v15, v6, 1, v15
    v_bfe_u32 v6, v14, 3, 1
    v_lshl_or_b32 v15, v6, 2, v15
    v_mul_u32_u24 v15, 3840, v15
    v_lshl_add_u32 v6, v13, 4, v15
    s_bitcmp1_b32 s20, 0
    s_cselect_b32 s21, 0x500, 0
    s_sub_u32 s21, s52, s21
    s_add_u32 m0, s54, 0x0
    s_add_u32 s56, s21, 0x0
    buffer_load_dwordx4 v3, s[24:27], s56 offen lds
    s_add_u32 m0, s54, 0x2000
    s_add_u32 s56, s21, 0x14000
    buffer_load_dwordx4 v3, s[24:27], s56 offen lds
    s_bitcmp1_b32 s20, 0
    s_cselect_b32 s12, 0x258000, 0
    s_sub_u32 s12, s53, s12
    s_add_u32 m0, s55, 0x4000
    s_add_u32 s56, s12, 0x0
    buffer_load_dwordx4 v4, s[28:31], s56 offen lds
    s_add_u32 m0, s55, 0x4400
    s_add_u32 s56, s12, 0x0
    buffer_load_dwordx4 v5, s[28:31], s56 offen lds
    s_add_u32 m0, s55, 0x4800
    s_add_u32 s56, s12, 0x0
    s_mov_b32 exec_hi, 0
    buffer_load_dwordx4 v6, s[28:31], s56 offen lds
    s_mov_b32 exec_hi, -1
    s_barrier
    s_bitcmp1_b32 s20, 1
    s_cselect_b32 s21, 0x500, 0
    s_sub_u32 s21, s52, s21
    s_add_u32 m0, s54, 0x9000
    s_add_u32 s56, s21, 0x80
    buffer_load_dwordx4 v3, s[24:27], s56 offen lds
    s_add_u32 m0, s54, 0xb000
    s_add_u32 s56, s21, 0x14080
    buffer_load_dwordx4 v3, s[24:27], s56 offen lds
    s_bitcmp1_b32 s20, 1
    s_cselect_b32 s12, 0x258000, 0
    s_sub_u32 s12, s53, s12
    s_add_u32 m0, s55, 0xd000
    s_add_u32 s56, s12, 0x3c000
    buffer_load_dwordx4 v4, s[28:31], s56 offen lds
    s_add_u32 m0, s55, 0xd400
    s_add_u32 s56, s12, 0x3c000
    buffer_load_dwordx4 v5, s[28:31], s56 offen lds
    s_add_u32 m0, s55, 0xd800
    s_add_u32 s56, s12, 0x3c000
    s_mov_b32 exec_hi, 0
    buffer_load_dwordx4 v6, s[28:31], s56 offen lds
    s_mov_b32 exec_hi, -1
    v_and_b32 v13, 15, v1
    v_bfe_u32 v14, v1, 1, 3
    v_lshrrev_b32 v15, 4, v1
    v_xor_b32 v14, v14, v15
    v_lshlrev_b32 v13, 7, v13
    v_lshl_add_u32 v7, v14, 4, v13
    s_lshl_b32 s56, s45, 12
    v_add_u32 v7, s56, v7
    v_xor_b32 v8, 64, v7
    s_mov_b32 s40, s8
    s_and_b32 s41, s9, 0xffff
    s_mov_b32 s42, 0x6400
    s_mov_b32 s43, 0x20000
    s_mul_i32 s57, s47, 3200
    s_lshl_b32 s56, s45, 10
    s_add_u32 s57, s57, s56
    s_add_u32 m0, s56, 0x26400
    s_nop 0
    buffer_load_dwordx4 v2, s[40:43], s57 offen lds
    s_mul_i32 s76, s49, 74
    s_add_u32 s76, s76, s45
    s_mul_i32 s76, s76, 5120
    s_add_u32 s76, s76, 0x940000
    s_mov_b32 s77, 0xd28000
    s_mul_i32 s78, s45, 5120
    s_mul_i32 s74, s48, 74
    s_add_u32 s74, s74, s45
    s_lshl_b32 s74, s74, 12
    s_lshl_b32 s75, s48, 9
    s_add_u32 s75, s75, 0xd29000
    s_lshr_b32 s79, s2, 3
    s_lshr_b32 s56, s2, 6
    s_add_u32 s79, s79, s56
    s_mul_i32 s56, s49, 5
    s_add_u32 s57, s56, 4
    s_lshr_b32 s56, s56, 3
    s_lshr_b32 s57, s57, 3
    s_lshl_b32 s56, s56, 9
    s_lshl_b32 s57, s57, 9
    v_mov_b32 v176, s56
    v_mov_b32 v177, s57
    v_cmp_gt_u32 vcc, 32, v1
    s_nop 1
    v_cndmask_b32 v176, v177, v176, vcc
    v_and_b32 v177, 31, v1
    v_lshl_add_u32 v176, v177, 4, v176
    v_mov_b32 v178, 0x7ff00000
    v_cmp_gt_u32 vcc, 19, v177
    s_nop 1
    v_cndmask_b32 v175, v178, v176, vcc
    v_lshrrev_b32 v13, 5, v1
    v_lshlrev_b32 v13, 4, v13
    v_bfe_u32 v14, v1, 2, 3
    v_add_u32 v13, v13, v14
    v_mul_u32_u24 v13, 160, v13
    v_add_u32 v13, 0x4000, v13
    v_and_b32 v14, 3, v1
    v_mul_u32_u24 v14, 40, v14
    v_add_u32 v9, v13, v14
    s_waitcnt lgkmcnt(0)
    s_mul_i32 s50, s50, 0x9e3779b1
    s_add_u32 s50, s50, 0x7f4a7c15
    s_mov_b32 s51, s50
    s_waitcnt vmcnt(6)
    s_barrier
    ds_read_b128 v[96:99], v7 offset:0
    ds_read_b128 v[100:103], v7 offset:2048
    ds_read_b64_tr_b16 v[56:57], v9 offset:0
    ds_read_b64_tr_b16 v[58:59], v9 offset:1280
    ds_read_b64_tr_b16 v[60:61], v9 offset:8
    ds_read_b64_tr_b16 v[62:63], v9 offset:1288
    ds_read_b64_tr_b16 v[64:65], v9 offset:16
    ds_read_b64_tr_b16 v[66:67], v9 offset:1296
    ds_read_b64_tr_b16 v[68:69], v9 offset:24
    ds_read_b64_tr_b16 v[70:71], v9 offset:1304
    ds_read_b64_tr_b16 v[72:73], v9 offset:32
    ds_read_b64_tr_b16 v[74:75], v9 offset:1312
    s_waitcnt lgkmcnt(0)
    v_mfma_f32_16x16x32_bf16 v[16:19], v[56:59], v[96:99], 0
    ds_read_b128 v[104:107], v8 offset:0
    ds_read_b128 v[108:111], v8 offset:2048
    s_bitcmp1_b32 s20, 2
    s_cselect_b32 s21, 0x500, 0
    s_sub_u32 s21, s52, s21
    s_add_u32 m0, s54, 0x12000
    s_add_u32 s56, s21, 0x100
    buffer_load_dwordx4 v3, s[24:27], s56 offen lds
    v_mfma_f32_16x16x32_bf16 v[20:23], v[56:59], v[100:103], 0
    ds_read_b64_tr_b16 v[76:77], v9 offset:5120
    ds_read_b64_tr_b16 v[78:79], v9 offset:6400
    s_add_u32 m0, s54, 0x14000
    s_add_u32 s56, s21, 0x14100
    buffer_load_dwordx4 v3, s[24:27], s56 offen lds
    v_mfma_f32_16x16x32_bf16 v[24:27], v[60:63], v[96:99], 0
    ds_read_b64_tr_b16 v[80:81], v9 offset:5128
    ds_read_b64_tr_b16 v[82:83], v9 offset:6408
    s_bitcmp1_b32 s20, 2
    s_cselect_b32 s12, 0x258000, 0
    s_sub_u32 s12, s53, s12
    s_add_u32 m0, s55, 0x16000
    s_add_u32 s56, s12, 0x78000
    buffer_load_dwordx4 v4, s[28:31], s56 offen lds
    v_mfma_f32_16x16x32_bf16 v[28:31], v[60:63], v[100:103], 0
    ds_read_b64_tr_b16 v[84:85], v9 offset:5136
    ds_read_b64_tr_b16 v[86:87], v9 offset:6416
    s_add_u32 m0, s55, 0x16400
    s_add_u32 s56, s12, 0x78000
    buffer_load_dwordx4 v5, s[28:31], s56 offen lds
    v_mfma_f32_16x16x32_bf16 v[32:35], v[64:67], v[96:99], 0
    ds_read_b64_tr_b16 v[88:89], v9 offset:5144
    ds_read_b64_tr_b16 v[90:91], v9 offset:6424
    s_add_u32 m0, s55, 0x16800
    s_add_u32 s56, s12, 0x78000
    s_mov_b32 exec_hi, 0
    buffer_load_dwordx4 v6, s[28:31], s56 offen lds
    s_mov_b32 exec_hi, -1
    v_mfma_f32_16x16x32_bf16 v[36:39], v[64:67], v[100:103], 0
    ds_read_b64_tr_b16 v[92:93], v9 offset:5152
    ds_read_b64_tr_b16 v[94:95], v9 offset:6432
    v_mfma_f32_16x16x32_bf16 v[40:43], v[68:71], v[96:99], 0
    v_mfma_f32_16x16x32_bf16 v[44:47], v[68:71], v[100:103], 0
    v_mfma_f32_16x16x32_bf16 v[48:51], v[72:75], v[96:99], 0
    v_mfma_f32_16x16x32_bf16 v[52:55], v[72:75], v[100:103], 0
    s_waitcnt lgkmcnt(0)
    s_waitcnt vmcnt(6)
    s_barrier
    v_mfma_f32_16x16x32_bf16 v[16:19], v[76:79], v[104:107], v[16:19]
    ds_read_b128 v[96:99], v7 offset:36864
    ds_read_b128 v[100:103], v7 offset:38912
    s_bitcmp1_b32 s20, 3
    s_cselect_b32 s21, 0x500, 0
    s_sub_u32 s21, s52, s21
    s_add_u32 m0, s54, 0x1b000
    s_add_u32 s56, s21, 0x180
    buffer_load_dwordx4 v3, s[24:27], s56 offen lds
    v_mfma_f32_16x16x32_bf16 v[20:23], v[76:79], v[108:111], v[20:23]
    ds_read_b64_tr_b16 v[56:57], v9 offset:36864
    ds_read_b64_tr_b16 v[58:59], v9 offset:38144
    s_add_u32 m0, s54, 0x1d000
    s_add_u32 s56, s21, 0x14180
    buffer_load_dwordx4 v3, s[24:27], s56 offen lds
    v_mfma_f32_16x16x32_bf16 v[24:27], v[80:83], v[104:107], v[24:27]
    ds_read_b64_tr_b16 v[60:61], v9 offset:36872
    ds_read_b64_tr_b16 v[62:63], v9 offset:38152
    v_mfma_f32_16x16x32_bf16 v[28:31], v[80:83], v[108:111], v[28:31]
    ds_read_b64_tr_b16 v[64:65], v9 offset:36880
    ds_read_b64_tr_b16 v[66:67], v9 offset:38160
    v_mfma_f32_16x16x32_bf16 v[32:35], v[84:87], v[104:107], v[32:35]
    ds_read_b64_tr_b16 v[68:69], v9 offset:36888
    ds_read_b64_tr_b16 v[70:71], v9 offset:38168
    v_mfma_f32_16x16x32_bf16 v[36:39], v[84:87], v[108:111], v[36:39]
    ds_read_b64_tr_b16 v[72:73], v9 offset:36896
    ds_read_b64_tr_b16 v[74:75], v9 offset:38176
    v_mfma_f32_16x16x32_bf16 v[40:43], v[88:91], v[104:107], v[40:43]
    v_mfma_f32_16x16x32_bf16 v[44:47], v[88:91], v[108:111], v[44:47]
    v_mfma_f32_16x16x32_bf16 v[48:51], v[92:95], v[104:107], v[48:51]
    v_mfma_f32_16x16x32_bf16 v[52:55], v[92:95], v[108:111], v[52:55]
    s_waitcnt lgkmcnt(0)
    v_mfma_f32_16x16x32_bf16 v[16:19], v[56:59], v[96:99], v[16:19]
    ds_read_b128 v[104:107], v8 offset:36864
    ds_read_b128 v[108:111], v8 offset:38912
    s_bitcmp1_b32 s20, 3
    s_cselect_b32 s12, 0x258000, 0
    s_sub_u32 s12, s53, s12
    s_add_u32 m0, s55, 0x1f000
    s_add_u32 s56, s12, 0xb4000
    buffer_load_dwordx4 v4, s[28:31], s56 offen lds
    v_mfma_f32_16x16x32_bf16 v[20:23], v[56:59], v[100:103], v[20:23]
    ds_read_b64_tr_b16 v[76:77], v9 offset:41984
    ds_read_b64_tr_b16 v[78:79], v9 offset:43264
    s_add_u32 m0, s55, 0x1f400
    s_add_u32 s56, s12, 0xb4000
    buffer_load_dwordx4 v5, s[28:31], s56 offen lds
    v_mfma_f32_16x16x32_bf16 v[24:27], v[60:63], v[96:99], v[24:27]
    ds_read_b64_tr_b16 v[80:81], v9 offset:41992
    ds_read_b64_tr_b16 v[82:83], v9 offset:43272
    s_add_u32 m0, s55, 0x1f800
    s_add_u32 s56, s12, 0xb4000
    s_mov_b32 exec_hi, 0
    buffer_load_dwordx4 v6, s[28:31], s56 offen lds
    s_mov_b32 exec_hi, -1
    v_mfma_f32_16x16x32_bf16 v[28:31], v[60:63], v[100:103], v[28:31]
    ds_read_b64_tr_b16 v[84:85], v9 offset:42000
    ds_read_b64_tr_b16 v[86:87], v9 offset:43280
    v_mfma_f32_16x16x32_bf16 v[32:35], v[64:67], v[96:99], v[32:35]
    ds_read_b64_tr_b16 v[88:89], v9 offset:42008
    ds_read_b64_tr_b16 v[90:91], v9 offset:43288
    v_mfma_f32_16x16x32_bf16 v[36:39], v[64:67], v[100:103], v[36:39]
    ds_read_b64_tr_b16 v[92:93], v9 offset:42016
    ds_read_b64_tr_b16 v[94:95], v9 offset:43296
    v_mfma_f32_16x16x32_bf16 v[40:43], v[68:71], v[96:99], v[40:43]
    v_mfma_f32_16x16x32_bf16 v[44:47], v[68:71], v[100:103], v[44:47]
    v_mfma_f32_16x16x32_bf16 v[48:51], v[72:75], v[96:99], v[48:51]
    v_mfma_f32_16x16x32_bf16 v[52:55], v[72:75], v[100:103], v[52:55]
    s_waitcnt lgkmcnt(0)
    s_waitcnt vmcnt(5)
    s_barrier
    v_mfma_f32_16x16x32_bf16 v[16:19], v[76:79], v[104:107], v[16:19]
    v_add_u32 v7, 0x12000, v7
    v_add_u32 v8, 0x12000, v8
    ds_read_b128 v[96:99], v7 offset:0
    ds_read_b128 v[100:103], v7 offset:2048
    s_bitcmp1_b32 s20, 4
    s_cselect_b32 s21, 0x500, 0
    s_sub_u32 s21, s52, s21
    s_add_u32 m0, s54, 0x0
    s_add_u32 s56, s21, 0x200
    buffer_load_dwordx4 v3, s[24:27], s56 offen lds
    v_mfma_f32_16x16x32_bf16 v[20:23], v[76:79], v[108:111], v[20:23]
    v_add_u32 v9, 0x12000, v9
    ds_read_b64_tr_b16 v[56:57], v9 offset:0
    ds_read_b64_tr_b16 v[58:59], v9 offset:1280
    s_add_u32 m0, s54, 0x2000
    s_add_u32 s56, s21, 0x14200
    buffer_load_dwordx4 v3, s[24:27], s56 offen lds
    v_mfma_f32_16x16x32_bf16 v[24:27], v[80:83], v[104:107], v[24:27]
    ds_read_b64_tr_b16 v[60:61], v9 offset:8
    ds_read_b64_tr_b16 v[62:63], v9 offset:1288
    v_mfma_f32_16x16x32_bf16 v[28:31], v[80:83], v[108:111], v[28:31]
    ds_read_b64_tr_b16 v[64:65], v9 offset:16
    ds_read_b64_tr_b16 v[66:67], v9 offset:1296
    v_mfma_f32_16x16x32_bf16 v[32:35], v[84:87], v[104:107], v[32:35]
    ds_read_b64_tr_b16 v[68:69], v9 offset:24
    ds_read_b64_tr_b16 v[70:71], v9 offset:1304
    v_mfma_f32_16x16x32_bf16 v[36:39], v[84:87], v[108:111], v[36:39]
    ds_read_b64_tr_b16 v[72:73], v9 offset:32
    ds_read_b64_tr_b16 v[74:75], v9 offset:1312
    v_mfma_f32_16x16x32_bf16 v[40:43], v[88:91], v[104:107], v[40:43]
    v_mfma_f32_16x16x32_bf16 v[44:47], v[88:91], v[108:111], v[44:47]
    v_mfma_f32_16x16x32_bf16 v[48:51], v[92:95], v[104:107], v[48:51]
    v_mfma_f32_16x16x32_bf16 v[52:55], v[92:95], v[108:111], v[52:55]
    s_waitcnt lgkmcnt(0)
    v_mfma_f32_16x16x32_bf16 v[16:19], v[56:59], v[96:99], v[16:19]
    ds_read_b128 v[104:107], v8 offset:0
    ds_read_b128 v[108:111], v8 offset:2048
    s_bitcmp1_b32 s20, 4
    s_cselect_b32 s12, 0x258000, 0
    s_sub_u32 s12, s53, s12
    s_add_u32 m0, s55, 0x4000
    s_add_u32 s56, s12, 0xf0000
    buffer_load_dwordx4 v4, s[28:31], s56 offen lds
    v_mfma_f32_16x16x32_bf16 v[20:23], v[56:59], v[100:103], v[20:23]
    ds_read_b64_tr_b16 v[76:77], v9 offset:5120
    ds_read_b64_tr_b16 v[78:79], v9 offset:6400
    s_add_u32 m0, s55, 0x4400
    s_add_u32 s56, s12, 0xf0000
    buffer_load_dwordx4 v5, s[28:31], s56 offen lds
    v_mfma_f32_16x16x32_bf16 v[24:27], v[60:63], v[96:99], v[24:27]
    ds_read_b64_tr_b16 v[80:81], v9 offset:5128
    ds_read_b64_tr_b16 v[82:83], v9 offset:6408
    s_add_u32 m0, s55, 0x4800
    s_add_u32 s56, s12, 0xf0000
    s_mov_b32 exec_hi, 0
    buffer_load_dwordx4 v6, s[28:31], s56 offen lds
    s_mov_b32 exec_hi, -1
    v_mfma_f32_16x16x32_bf16 v[28:31], v[60:63], v[100:103], v[28:31]
    ds_read_b64_tr_b16 v[84:85], v9 offset:5136
    ds_read_b64_tr_b16 v[86:87], v9 offset:6416
    v_mfma_f32_16x16x32_bf16 v[32:35], v[64:67], v[96:99], v[32:35]
    ds_read_b64_tr_b16 v[88:89], v9 offset:5144
    ds_read_b64_tr_b16 v[90:91], v9 offset:6424
    v_mfma_f32_16x16x32_bf16 v[36:39], v[64:67], v[100:103], v[36:39]
    ds_read_b64_tr_b16 v[92:93], v9 offset:5152
    ds_read_b64_tr_b16 v[94:95], v9 offset:6432
    v_mfma_f32_16x16x32_bf16 v[40:43], v[68:71], v[96:99], v[40:43]
    v_mfma_f32_16x16x32_bf16 v[44:47], v[68:71], v[100:103], v[44:47]
    v_mfma_f32_16x16x32_bf16 v[48:51], v[72:75], v[96:99], v[48:51]
    v_mfma_f32_16x16x32_bf16 v[52:55], v[72:75], v[100:103], v[52:55]
    s_waitcnt lgkmcnt(0)
    s_waitcnt vmcnt(5)
    s_barrier
    v_mfma_f32_16x16x32_bf16 v[16:19], v[76:79], v[104:107], v[16:19]
    ds_read_b128 v[96:99], v7 offset:36864
    ds_read_b128 v[100:103], v7 offset:38912
    s_bitcmp1_b32 s20, 5
    s_cselect_b32 s21, 0x500, 0
    s_sub_u32 s21, s52, s21
    s_add_u32 m0, s54, 0x9000
    s_add_u32 s56, s21, 0x280
    buffer_load_dwordx4 v3, s[24:27], s56 offen lds
    v_mfma_f32_16x16x32_bf16 v[20:23], v[76:79], v[108:111], v[20:23]
    ds_read_b64_tr_b16 v[56:57], v9 offset:36864
    ds_read_b64_tr_b16 v[58:59], v9 offset:38144
    s_add_u32 m0, s54, 0xb000
    s_add_u32 s56, s21, 0x14280
    buffer_load_dwordx4 v3, s[24:27], s56 offen lds
    v_mfma_f32_16x16x32_bf16 v[24:27], v[80:83], v[104:107], v[24:27]
    ds_read_b64_tr_b16 v[60:61], v9 offset:36872
    ds_read_b64_tr_b16 v[62:63], v9 offset:38152
    v_mfma_f32_16x16x32_bf16 v[28:31], v[80:83], v[108:111], v[28:31]
    ds_read_b64_tr_b16 v[64:65], v9 offset:36880
    ds_read_b64_tr_b16 v[66:67], v9 offset:38160
    v_mfma_f32_16x16x32_bf16 v[32:35], v[84:87], v[104:107], v[32:35]
    ds_read_b64_tr_b16 v[68:69], v9 offset:36888
    ds_read_b64_tr_b16 v[70:71], v9 offset:38168
    v_mfma_f32_16x16x32_bf16 v[36:39], v[84:87], v[108:111], v[36:39]
    ds_read_b64_tr_b16 v[72:73], v9 offset:36896
    ds_read_b64_tr_b16 v[74:75], v9 offset:38176
    v_mfma_f32_16x16x32_bf16 v[40:43], v[88:91], v[104:107], v[40:43]
    v_mfma_f32_16x16x32_bf16 v[44:47], v[88:91], v[108:111], v[44:47]
    v_mfma_f32_16x16x32_bf16 v[48:51], v[92:95], v[104:107], v[48:51]
    v_mfma_f32_16x16x32_bf16 v[52:55], v[92:95], v[108:111], v[52:55]
    s_waitcnt lgkmcnt(0)
    v_mfma_f32_16x16x32_bf16 v[16:19], v[56:59], v[96:99], v[16:19]
    ds_read_b128 v[104:107], v8 offset:36864
    ds_read_b128 v[108:111], v8 offset:38912
    s_bitcmp1_b32 s20, 5
    s_cselect_b32 s12, 0x258000, 0
    s_sub_u32 s12, s53, s12
    s_add_u32 m0, s55, 0xd000
    s_add_u32 s56, s12, 0x12c000
    buffer_load_dwordx4 v4, s[28:31], s56 offen lds
    v_mfma_f32_16x16x32_bf16 v[20:23], v[56:59], v[100:103], v[20:23]
    ds_read_b64_tr_b16 v[76:77], v9 offset:41984
    ds_read_b64_tr_b16 v[78:79], v9 offset:43264
    s_add_u32 m0, s55, 0xd400
    s_add_u32 s56, s12, 0x12c000
    buffer_load_dwordx4 v5, s[28:31], s56 offen lds
    v_mfma_f32_16x16x32_bf16 v[24:27], v[60:63], v[96:99], v[24:27]
    ds_read_b64_tr_b16 v[80:81], v9 offset:41992
    ds_read_b64_tr_b16 v[82:83], v9 offset:43272
    s_add_u32 m0, s55, 0xd800
    s_add_u32 s56, s12, 0x12c000
    s_mov_b32 exec_hi, 0
    buffer_load_dwordx4 v6, s[28:31], s56 offen lds
    s_mov_b32 exec_hi, -1
    v_mfma_f32_16x16x32_bf16 v[28:31], v[60:63], v[100:103], v[28:31]
    ds_read_b64_tr_b16 v[84:85], v9 offset:42000
    ds_read_b64_tr_b16 v[86:87], v9 offset:43280
    v_mfma_f32_16x16x32_bf16 v[32:35], v[64:67], v[96:99], v[32:35]
    ds_read_b64_tr_b16 v[88:89], v9 offset:42008
    ds_read_b64_tr_b16 v[90:91], v9 offset:43288
    v_mfma_f32_16x16x32_bf16 v[36:39], v[64:67], v[100:103], v[36:39]
    ds_read_b64_tr_b16 v[92:93], v9 offset:42016
    ds_read_b64_tr_b16 v[94:95], v9 offset:43296
    v_mfma_f32_16x16x32_bf16 v[40:43], v[68:71], v[96:99], v[40:43]
    v_mfma_f32_16x16x32_bf16 v[44:47], v[68:71], v[100:103], v[44:47]
    v_mfma_f32_16x16x32_bf16 v[48:51], v[72:75], v[96:99], v[48:51]
    v_mfma_f32_16x16x32_bf16 v[52:55], v[72:75], v[100:103], v[52:55]
    s_waitcnt lgkmcnt(0)
    s_waitcnt vmcnt(5)
    s_barrier
    v_mfma_f32_16x16x32_bf16 v[16:19], v[76:79], v[104:107], v[16:19]
    v_add_u32 v7, 0xfffee000, v7
    v_add_u32 v8, 0xfffee000, v8
    ds_read_b128 v[96:99], v7 offset:0
    ds_read_b128 v[100:103], v7 offset:2048
    s_bitcmp1_b32 s20, 6
    s_cselect_b32 s21, 0x500, 0
    s_sub_u32 s21, s52, s21
    s_add_u32 m0, s54, 0x12000
    s_add_u32 s56, s21, 0x300
    buffer_load_dwordx4 v3, s[24:27], s56 offen lds
    v_mfma_f32_16x16x32_bf16 v[20:23], v[76:79], v[108:111], v[20:23]
    v_add_u32 v9, 0xfffee000, v9
    ds_read_b64_tr_b16 v[56:57], v9 offset:0
    ds_read_b64_tr_b16 v[58:59], v9 offset:1280
    s_add_u32 m0, s54, 0x14000
    s_add_u32 s56, s21, 0x14300
    buffer_load_dwordx4 v3, s[24:27], s56 offen lds
    v_mfma_f32_16x16x32_bf16 v[24:27], v[80:83], v[104:107], v[24:27]
    ds_read_b64_tr_b16 v[60:61], v9 offset:8
    ds_read_b64_tr_b16 v[62:63], v9 offset:1288
    v_mfma_f32_16x16x32_bf16 v[28:31], v[80:83], v[108:111], v[28:31]
    ds_read_b64_tr_b16 v[64:65], v9 offset:16
    ds_read_b64_tr_b16 v[66:67], v9 offset:1296
    v_mfma_f32_16x16x32_bf16 v[32:35], v[84:87], v[104:107], v[32:35]
    ds_read_b64_tr_b16 v[68:69], v9 offset:24
    ds_read_b64_tr_b16 v[70:71], v9 offset:1304
    v_mfma_f32_16x16x32_bf16 v[36:39], v[84:87], v[108:111], v[36:39]
    ds_read_b64_tr_b16 v[72:73], v9 offset:32
    ds_read_b64_tr_b16 v[74:75], v9 offset:1312
    v_mfma_f32_16x16x32_bf16 v[40:43], v[88:91], v[104:107], v[40:43]
    v_mfma_f32_16x16x32_bf16 v[44:47], v[88:91], v[108:111], v[44:47]
    v_mfma_f32_16x16x32_bf16 v[48:51], v[92:95], v[104:107], v[48:51]
    v_mfma_f32_16x16x32_bf16 v[52:55], v[92:95], v[108:111], v[52:55]
    s_waitcnt lgkmcnt(0)
    v_mfma_f32_16x16x32_bf16 v[16:19], v[56:59], v[96:99], v[16:19]
    ds_read_b128 v[104:107], v8 offset:0
    ds_read_b128 v[108:111], v8 offset:2048
    s_bitcmp1_b32 s20, 6
    s_cselect_b32 s12, 0x258000, 0
    s_sub_u32 s12, s53, s12
    s_add_u32 m0, s55, 0x16000
    s_add_u32 s56, s12, 0x168000
    buffer_load_dwordx4 v4, s[28:31], s56 offen lds
    v_mfma_f32_16x16x32_bf16 v[20:23], v[56:59], v[100:103], v[20:23]
    ds_read_b64_tr_b16 v[76:77], v9 offset:5120
    ds_read_b64_tr_b16 v[78:79], v9 offset:6400
    s_add_u32 m0, s55, 0x16400
    s_add_u32 s56, s12, 0x168000
    buffer_load_dwordx4 v5, s[28:31], s56 offen lds
    v_mfma_f32_16x16x32_bf16 v[24:27], v[60:63], v[96:99], v[24:27]
    ds_read_b64_tr_b16 v[80:81], v9 offset:5128
    ds_read_b64_tr_b16 v[82:83], v9 offset:6408
    s_add_u32 m0, s55, 0x16800
    s_add_u32 s56, s12, 0x168000
    s_mov_b32 exec_hi, 0
    buffer_load_dwordx4 v6, s[28:31], s56 offen lds
    s_mov_b32 exec_hi, -1
    v_mfma_f32_16x16x32_bf16 v[28:31], v[60:63], v[100:103], v[28:31]
    ds_read_b64_tr_b16 v[84:85], v9 offset:5136
    ds_read_b64_tr_b16 v[86:87], v9 offset:6416
    v_mfma_f32_16x16x32_bf16 v[32:35], v[64:67], v[96:99], v[32:35]
    ds_read_b64_tr_b16 v[88:89], v9 offset:5144
    ds_read_b64_tr_b16 v[90:91], v9 offset:6424
    v_mfma_f32_16x16x32_bf16 v[36:39], v[64:67], v[100:103], v[36:39]
    ds_read_b64_tr_b16 v[92:93], v9 offset:5152
    ds_read_b64_tr_b16 v[94:95], v9 offset:6432
    v_mfma_f32_16x16x32_bf16 v[40:43], v[68:71], v[96:99], v[40:43]
    v_mfma_f32_16x16x32_bf16 v[44:47], v[68:71], v[100:103], v[44:47]
    v_mfma_f32_16x16x32_bf16 v[48:51], v[72:75], v[96:99], v[48:51]
    v_mfma_f32_16x16x32_bf16 v[52:55], v[72:75], v[100:103], v[52:55]
    s_waitcnt lgkmcnt(0)
    s_waitcnt vmcnt(5)
    s_barrier
    v_mfma_f32_16x16x32_bf16 v[16:19], v[76:79], v[104:107], v[16:19]
    ds_read_b128 v[96:99], v7 offset:36864
    ds_read_b128 v[100:103], v7 offset:38912
    s_bitcmp1_b32 s20, 7
    s_cselect_b32 s21, 0x500, 0
    s_sub_u32 s21, s52, s21
    s_add_u32 m0, s54, 0x1b000
    s_add_u32 s56, s21, 0x380
    buffer_load_dwordx4 v3, s[24:27], s56 offen lds
    v_mfma_f32_16x16x32_bf16 v[20:23], v[76:79], v[108:111], v[20:23]
    ds_read_b64_tr_b16 v[56:57], v9 offset:36864
    ds_read_b64_tr_b16 v[58:59], v9 offset:38144
    s_add_u32 m0, s54, 0x1d000
    s_add_u32 s56, s21, 0x14380
    buffer_load_dwordx4 v3, s[24:27], s56 offen lds
    v_mfma_f32_16x16x32_bf16 v[24:27], v[80:83], v[104:107], v[24:27]
    ds_read_b64_tr_b16 v[60:61], v9 offset:36872
    ds_read_b64_tr_b16 v[62:63], v9 offset:38152
    v_mfma_f32_16x16x32_bf16 v[28:31], v[80:83], v[108:111], v[28:31]
    ds_read_b64_tr_b16 v[64:65], v9 offset:36880
    ds_read_b64_tr_b16 v[66:67], v9 offset:38160
    v_mfma_f32_16x16x32_bf16 v[32:35], v[84:87], v[104:107], v[32:35]
    ds_read_b64_tr_b16 v[68:69], v9 offset:36888
    ds_read_b64_tr_b16 v[70:71], v9 offset:38168
    v_mfma_f32_16x16x32_bf16 v[36:39], v[84:87], v[108:111], v[36:39]
    ds_read_b64_tr_b16 v[72:73], v9 offset:36896
    ds_read_b64_tr_b16 v[74:75], v9 offset:38176
    v_mfma_f32_16x16x32_bf16 v[40:43], v[88:91], v[104:107], v[40:43]
    v_mfma_f32_16x16x32_bf16 v[44:47], v[88:91], v[108:111], v[44:47]
    v_mfma_f32_16x16x32_bf16 v[48:51], v[92:95], v[104:107], v[48:51]
    v_mfma_f32_16x16x32_bf16 v[52:55], v[92:95], v[108:111], v[52:55]
    s_waitcnt lgkmcnt(0)
    v_mfma_f32_16x16x32_bf16 v[16:19], v[56:59], v[96:99], v[16:19]
    ds_read_b128 v[104:107], v8 offset:36864
    ds_read_b128 v[108:111], v8 offset:38912
    s_bitcmp1_b32 s20, 7
    s_cselect_b32 s12, 0x258000, 0
    s_sub_u32 s12, s53, s12
    s_add_u32 m0, s55, 0x1f000
    s_add_u32 s56, s12, 0x1a4000
    buffer_load_dwordx4 v4, s[28:31], s56 offen lds
    v_mfma_f32_16x16x32_bf16 v[20:23], v[56:59], v[100:103], v[20:23]
    ds_read_b64_tr_b16 v[76:77], v9 offset:41984
    ds_read_b64_tr_b16 v[78:79], v9 offset:43264
    s_add_u32 m0, s55, 0x1f400
    s_add_u32 s56, s12, 0x1a4000
    buffer_load_dwordx4 v5, s[28:31], s56 offen lds
    v_mfma_f32_16x16x32_bf16 v[24:27], v[60:63], v[96:99], v[24:27]
    ds_read_b64_tr_b16 v[80:81], v9 offset:41992
    ds_read_b64_tr_b16 v[82:83], v9 offset:43272
    s_add_u32 m0, s55, 0x1f800
    s_add_u32 s56, s12, 0x1a4000
    s_mov_b32 exec_hi, 0
    buffer_load_dwordx4 v6, s[28:31], s56 offen lds
    s_mov_b32 exec_hi, -1
    v_mfma_f32_16x16x32_bf16 v[28:31], v[60:63], v[100:103], v[28:31]
    ds_read_b64_tr_b16 v[84:85], v9 offset:42000
    ds_read_b64_tr_b16 v[86:87], v9 offset:43280
    v_mfma_f32_16x16x32_bf16 v[32:35], v[64:67], v[96:99], v[32:35]
    ds_read_b64_tr_b16 v[88:89], v9 offset:42008
    ds_read_b64_tr_b16 v[90:91], v9 offset:43288
    v_mfma_f32_16x16x32_bf16 v[36:39], v[64:67], v[100:103], v[36:39]
    ds_read_b64_tr_b16 v[92:93], v9 offset:42016
    ds_read_b64_tr_b16 v[94:95], v9 offset:43296
    v_mfma_f32_16x16x32_bf16 v[40:43], v[68:71], v[96:99], v[40:43]
    v_mfma_f32_16x16x32_bf16 v[44:47], v[68:71], v[100:103], v[44:47]
    v_mfma_f32_16x16x32_bf16 v[48:51], v[72:75], v[96:99], v[48:51]
    v_mfma_f32_16x16x32_bf16 v[52:55], v[72:75], v[100:103], v[52:55]
    s_waitcnt lgkmcnt(0)
    s_waitcnt vmcnt(5)
    s_barrier
    v_mfma_f32_16x16x32_bf16 v[16:19], v[76:79], v[104:107], v[16:19]
    v_add_u32 v7, 0x12000, v7
    v_add_u32 v8, 0x12000, v8
    ds_read_b128 v[96:99], v7 offset:0
    ds_read_b128 v[100:103], v7 offset:2048
    s_bitcmp1_b32 s20, 8
    s_cselect_b32 s21, 0x500, 0
    s_sub_u32 s21, s52, s21
    s_add_u32 m0, s54, 0x0
    s_add_u32 s56, s21, 0x400
    buffer_load_dwordx4 v3, s[24:27], s56 offen lds
    v_mfma_f32_16x16x32_bf16 v[20:23], v[76:79], v[108:111], v[20:23]
    v_add_u32 v9, 0x12000, v9
    ds_read_b64_tr_b16 v[56:57], v9 offset:0
    ds_read_b64_tr_b16 v[58:59], v9 offset:1280
    s_add_u32 m0, s54, 0x2000
    s_add_u32 s56, s21, 0x14400
    buffer_load_dwordx4 v3, s[24:27], s56 offen lds
    v_mfma_f32_16x16x32_bf16 v[24:27], v[80:83], v[104:107], v[24:27]
    ds_read_b64_tr_b16 v[60:61], v9 offset:8
    ds_read_b64_tr_b16 v[62:63], v9 offset:1288
    v_mfma_f32_16x16x32_bf16 v[28:31], v[80:83], v[108:111], v[28:31]
    ds_read_b64_tr_b16 v[64:65], v9 offset:16
    ds_read_b64_tr_b16 v[66:67], v9 offset:1296
    v_mfma_f32_16x16x32_bf16 v[32:35], v[84:87], v[104:107], v[32:35]
    ds_read_b64_tr_b16 v[68:69], v9 offset:24
    ds_read_b64_tr_b16 v[70:71], v9 offset:1304
    v_mfma_f32_16x16x32_bf16 v[36:39], v[84:87], v[108:111], v[36:39]
    ds_read_b64_tr_b16 v[72:73], v9 offset:32
    ds_read_b64_tr_b16 v[74:75], v9 offset:1312
    v_mfma_f32_16x16x32_bf16 v[40:43], v[88:91], v[104:107], v[40:43]
    v_mfma_f32_16x16x32_bf16 v[44:47], v[88:91], v[108:111], v[44:47]
    v_mfma_f32_16x16x32_bf16 v[48:51], v[92:95], v[104:107], v[48:51]
    v_mfma_f32_16x16x32_bf16 v[52:55], v[92:95], v[108:111], v[52:55]
    s_waitcnt lgkmcnt(0)
    v_mfma_f32_16x16x32_bf16 v[16:19], v[56:59], v[96:99], v[16:19]
    ds_read_b128 v[104:107], v8 offset:0
    ds_read_b128 v[108:111], v8 offset:2048
    s_bitcmp1_b32 s20, 8
    s_cselect_b32 s12, 0x258000, 0
    s_sub_u32 s12, s53, s12
    s_add_u32 m0, s55, 0x4000
    s_add_u32 s56, s12, 0x1e0000
    buffer_load_dwordx4 v4, s[28:31], s56 offen lds
    v_mfma_f32_16x16x32_bf16 v[20:23], v[56:59], v[100:103], v[20:23]
    ds_read_b64_tr_b16 v[76:77], v9 offset:5120
    ds_read_b64_tr_b16 v[78:79], v9 offset:6400
    s_add_u32 m0, s55, 0x4400
    s_add_u32 s56, s12, 0x1e0000
    buffer_load_dwordx4 v5, s[28:31], s56 offen lds
    v_mfma_f32_16x16x32_bf16 v[24:27], v[60:63], v[96:99], v[24:27]
    ds_read_b64_tr_b16 v[80:81], v9 offset:5128
    ds_read_b64_tr_b16 v[82:83], v9 offset:6408
    s_add_u32 m0, s55, 0x4800
    s_add_u32 s56, s12, 0x1e0000
    s_mov_b32 exec_hi, 0
    buffer_load_dwordx4 v6, s[28:31], s56 offen lds
    s_mov_b32 exec_hi, -1
    v_mfma_f32_16x16x32_bf16 v[28:31], v[60:63], v[100:103], v[28:31]
    ds_read_b64_tr_b16 v[84:85], v9 offset:5136
    ds_read_b64_tr_b16 v[86:87], v9 offset:6416
    v_mfma_f32_16x16x32_bf16 v[32:35], v[64:67], v[96:99], v[32:35]
    ds_read_b64_tr_b16 v[88:89], v9 offset:5144
    ds_read_b64_tr_b16 v[90:91], v9 offset:6424
    v_mfma_f32_16x16x32_bf16 v[36:39], v[64:67], v[100:103], v[36:39]
    ds_read_b64_tr_b16 v[92:93], v9 offset:5152
    ds_read_b64_tr_b16 v[94:95], v9 offset:6432
    v_mfma_f32_16x16x32_bf16 v[40:43], v[68:71], v[96:99], v[40:43]
    v_mfma_f32_16x16x32_bf16 v[44:47], v[68:71], v[100:103], v[44:47]
    v_mfma_f32_16x16x32_bf16 v[48:51], v[72:75], v[96:99], v[48:51]
    v_mfma_f32_16x16x32_bf16 v[52:55], v[72:75], v[100:103], v[52:55]
    s_waitcnt lgkmcnt(0)
    s_waitcnt vmcnt(5)
    s_barrier
    v_mfma_f32_16x16x32_bf16 v[16:19], v[76:79], v[104:107], v[16:19]
    ds_read_b128 v[96:99], v7 offset:36864
    ds_read_b128 v[100:103], v7 offset:38912
    s_bitcmp1_b32 s20, 9
    s_cselect_b32 s21, 0x500, 0
    s_sub_u32 s21, s52, s21
    s_add_u32 m0, s54, 0x9000
    s_add_u32 s56, s21, 0x480
    buffer_load_dwordx4 v3, s[24:27], s56 offen lds
    v_mfma_f32_16x16x32_bf16 v[20:23], v[76:79], v[108:111], v[20:23]
    ds_read_b64_tr_b16 v[56:57], v9 offset:36864
    ds_read_b64_tr_b16 v[58:59], v9 offset:38144
    s_add_u32 m0, s54, 0xb000
    s_add_u32 s56, s21, 0x14480
    buffer_load_dwordx4 v3, s[24:27], s56 offen lds
    v_mfma_f32_16x16x32_bf16 v[24:27], v[80:83], v[104:107], v[24:27]
    ds_read_b64_tr_b16 v[60:61], v9 offset:36872
    ds_read_b64_tr_b16 v[62:63], v9 offset:38152
    v_mfma_f32_16x16x32_bf16 v[28:31], v[80:83], v[108:111], v[28:31]
    ds_read_b64_tr_b16 v[64:65], v9 offset:36880
    ds_read_b64_tr_b16 v[66:67], v9 offset:38160
    v_mfma_f32_16x16x32_bf16 v[32:35], v[84:87], v[104:107], v[32:35]
    ds_read_b64_tr_b16 v[68:69], v9 offset:36888
    ds_read_b64_tr_b16 v[70:71], v9 offset:38168
    v_mfma_f32_16x16x32_bf16 v[36:39], v[84:87], v[108:111], v[36:39]
    ds_read_b64_tr_b16 v[72:73], v9 offset:36896
    ds_read_b64_tr_b16 v[74:75], v9 offset:38176
    v_mfma_f32_16x16x32_bf16 v[40:43], v[88:91], v[104:107], v[40:43]
    v_mfma_f32_16x16x32_bf16 v[44:47], v[88:91], v[108:111], v[44:47]
    v_mfma_f32_16x16x32_bf16 v[48:51], v[92:95], v[104:107], v[48:51]
    v_mfma_f32_16x16x32_bf16 v[52:55], v[92:95], v[108:111], v[52:55]
    s_waitcnt lgkmcnt(0)
    v_mfma_f32_16x16x32_bf16 v[16:19], v[56:59], v[96:99], v[16:19]
    ds_read_b128 v[104:107], v8 offset:36864
    ds_read_b128 v[108:111], v8 offset:38912
    s_bitcmp1_b32 s20, 9
    s_cselect_b32 s12, 0x258000, 0
    s_sub_u32 s12, s53, s12
    s_add_u32 m0, s55, 0xd000
    s_add_u32 s56, s12, 0x21c000
    buffer_load_dwordx4 v4, s[28:31], s56 offen lds
    v_mfma_f32_16x16x32_bf16 v[20:23], v[56:59], v[100:103], v[20:23]
    ds_read_b64_tr_b16 v[76:77], v9 offset:41984
    ds_read_b64_tr_b16 v[78:79], v9 offset:43264
    s_add_u32 m0, s55, 0xd400
    s_add_u32 s56, s12, 0x21c000
    buffer_load_dwordx4 v5, s[28:31], s56 offen lds
    v_mfma_f32_16x16x32_bf16 v[24:27], v[60:63], v[96:99], v[24:27]
    ds_read_b64_tr_b16 v[80:81], v9 offset:41992
    ds_read_b64_tr_b16 v[82:83], v9 offset:43272
    s_add_u32 m0, s55, 0xd800
    s_add_u32 s56, s12, 0x21c000
    s_mov_b32 exec_hi, 0
    buffer_load_dwordx4 v6, s[28:31], s56 offen lds
    s_mov_b32 exec_hi, -1
    v_mfma_f32_16x16x32_bf16 v[28:31], v[60:63], v[100:103], v[28:31]
    ds_read_b64_tr_b16 v[84:85], v9 offset:42000
    ds_read_b64_tr_b16 v[86:87], v9 offset:43280
    v_mfma_f32_16x16x32_bf16 v[32:35], v[64:67], v[96:99], v[32:35]
    ds_read_b64_tr_b16 v[88:89], v9 offset:42008
    ds_read_b64_tr_b16 v[90:91], v9 offset:43288
    v_mfma_f32_16x16x32_bf16 v[36:39], v[64:67], v[100:103], v[36:39]
    ds_read_b64_tr_b16 v[92:93], v9 offset:42016
    ds_read_b64_tr_b16 v[94:95], v9 offset:43296
    v_mfma_f32_16x16x32_bf16 v[40:43], v[68:71], v[96:99], v[40:43]
    v_mfma_f32_16x16x32_bf16 v[44:47], v[68:71], v[100:103], v[44:47]
    v_mfma_f32_16x16x32_bf16 v[48:51], v[72:75], v[96:99], v[48:51]
    v_mfma_f32_16x16x32_bf16 v[52:55], v[72:75], v[100:103], v[52:55]
    s_waitcnt lgkmcnt(0)
    s_waitcnt vmcnt(5)
    s_barrier
    v_mfma_f32_16x16x32_bf16 v[16:19], v[76:79], v[104:107], v[16:19]
    v_add_u32 v7, 0xfffee000, v7
    v_add_u32 v8, 0xfffee000, v8
    ds_read_b128 v[96:99], v7 offset:0
    ds_read_b128 v[100:103], v7 offset:2048
    v_mfma_f32_16x16x32_bf16 v[20:23], v[76:79], v[108:111], v[20:23]
    v_add_u32 v9, 0xfffee000, v9
    ds_read_b64_tr_b16 v[56:57], v9 offset:0
    ds_read_b64_tr_b16 v[58:59], v9 offset:1280
    v_mfma_f32_16x16x32_bf16 v[24:27], v[80:83], v[104:107], v[24:27]
    ds_read_b64_tr_b16 v[60:61], v9 offset:8
    ds_read_b64_tr_b16 v[62:63], v9 offset:1288
    v_mfma_f32_16x16x32_bf16 v[28:31], v[80:83], v[108:111], v[28:31]
    ds_read_b64_tr_b16 v[64:65], v9 offset:16
    ds_read_b64_tr_b16 v[66:67], v9 offset:1296
    v_mfma_f32_16x16x32_bf16 v[32:35], v[84:87], v[104:107], v[32:35]
    ds_read_b64_tr_b16 v[68:69], v9 offset:24
    ds_read_b64_tr_b16 v[70:71], v9 offset:1304
    v_mfma_f32_16x16x32_bf16 v[36:39], v[84:87], v[108:111], v[36:39]
    ds_read_b64_tr_b16 v[72:73], v9 offset:32
    ds_read_b64_tr_b16 v[74:75], v9 offset:1312
    v_mfma_f32_16x16x32_bf16 v[40:43], v[88:91], v[104:107], v[40:43]
    v_mfma_f32_16x16x32_bf16 v[44:47], v[88:91], v[108:111], v[44:47]
    v_mfma_f32_16x16x32_bf16 v[48:51], v[92:95], v[104:107], v[48:51]
    v_mfma_f32_16x16x32_bf16 v[52:55], v[92:95], v[108:111], v[52:55]
    s_waitcnt lgkmcnt(0)
    v_mfma_f32_16x16x32_bf16 v[16:19], v[56:59], v[96:99], v[16:19]
    ds_read_b128 v[104:107], v8 offset:0
    ds_read_b128 v[108:111], v8 offset:2048
    s_load_dwordx2 s[20:21], s[0:1], 64
    v_mfma_f32_16x16x32_bf16 v[20:23], v[56:59], v[100:103], v[20:23]
    ds_read_b64_tr_b16 v[76:77], v9 offset:5120
    ds_read_b64_tr_b16 v[78:79], v9 offset:6400
    v_mfma_f32_16x16x32_bf16 v[24:27], v[60:63], v[96:99], v[24:27]
    ds_read_b64_tr_b16 v[80:81], v9 offset:5128
    ds_read_b64_tr_b16 v[82:83], v9 offset:6408
    v_mfma_f32_16x16x32_bf16 v[28:31], v[60:63], v[100:103], v[28:31]
    ds_read_b64_tr_b16 v[84:85], v9 offset:5136
    ds_read_b64_tr_b16 v[86:87], v9 offset:6416
    v_mfma_f32_16x16x32_bf16 v[32:35], v[64:67], v[96:99], v[32:35]
    ds_read_b64_tr_b16 v[88:89], v9 offset:5144
    ds_read_b64_tr_b16 v[90:91], v9 offset:6424
    v_mfma_f32_16x16x32_bf16 v[36:39], v[64:67], v[100:103], v[36:39]
    ds_read_b64_tr_b16 v[92:93], v9 offset:5152
    ds_read_b64_tr_b16 v[94:95], v9 offset:6432
    v_mfma_f32_16x16x32_bf16 v[40:43], v[68:71], v[96:99], v[40:43]
    v_mfma_f32_16x16x32_bf16 v[44:47], v[68:71], v[100:103], v[44:47]
    v_mfma_f32_16x16x32_bf16 v[48:51], v[72:75], v[96:99], v[48:51]
    v_mfma_f32_16x16x32_bf16 v[52:55], v[72:75], v[100:103], v[52:55]
    s_waitcnt lgkmcnt(0)
    s_waitcnt vmcnt(0)
    s_barrier
    v_mfma_f32_16x16x32_bf16 v[16:19], v[76:79], v[104:107], v[16:19]
    ds_read_b128 v[96:99], v7 offset:36864
    ds_read_b128 v[100:103], v7 offset:38912
    v_mfma_f32_16x16x32_bf16 v[20:23], v[76:79], v[108:111], v[20:23]
    ds_read_b64_tr_b16 v[56:57], v9 offset:36864
    ds_read_b64_tr_b16 v[58:59], v9 offset:38144
    v_mfma_f32_16x16x32_bf16 v[24:27], v[80:83], v[104:107], v[24:27]
    ds_read_b64_tr_b16 v[60:61], v9 offset:36872
    ds_read_b64_tr_b16 v[62:63], v9 offset:38152
    v_mfma_f32_16x16x32_bf16 v[28:31], v[80:83], v[108:111], v[28:31]
    ds_read_b64_tr_b16 v[64:65], v9 offset:36880
    ds_read_b64_tr_b16 v[66:67], v9 offset:38160
    v_mfma_f32_16x16x32_bf16 v[32:35], v[84:87], v[104:107], v[32:35]
    ds_read_b64_tr_b16 v[68:69], v9 offset:36888
    ds_read_b64_tr_b16 v[70:71], v9 offset:38168
    v_mfma_f32_16x16x32_bf16 v[36:39], v[84:87], v[108:111], v[36:39]
    ds_read_b64_tr_b16 v[72:73], v9 offset:36896
    ds_read_b64_tr_b16 v[74:75], v9 offset:38176
    v_mfma_f32_16x16x32_bf16 v[40:43], v[88:91], v[104:107], v[40:43]
    v_mfma_f32_16x16x32_bf16 v[44:47], v[88:91], v[108:111], v[44:47]
    v_mfma_f32_16x16x32_bf16 v[48:51], v[92:95], v[104:107], v[48:51]
    v_mfma_f32_16x16x32_bf16 v[52:55], v[92:95], v[108:111], v[52:55]
    s_waitcnt lgkmcnt(0)
    v_mfma_f32_16x16x32_bf16 v[16:19], v[56:59], v[96:99], v[16:19]
    ds_read_b128 v[104:107], v8 offset:36864
    ds_read_b128 v[108:111], v8 offset:38912
    buffer_load_dwordx4 v[176:179], v175, s[32:35], s77 offen offset:0 sc1
    v_mfma_f32_16x16x32_bf16 v[20:23], v[56:59], v[100:103], v[20:23]
    ds_read_b64_tr_b16 v[76:77], v9 offset:41984
    ds_read_b64_tr_b16 v[78:79], v9 offset:43264
    v_mfma_f32_16x16x32_bf16 v[24:27], v[60:63], v[96:99], v[24:27]
    ds_read_b64_tr_b16 v[80:81], v9 offset:41992
    ds_read_b64_tr_b16 v[82:83], v9 offset:43272
    v_mfma_f32_16x16x32_bf16 v[28:31], v[60:63], v[100:103], v[28:31]
    ds_read_b64_tr_b16 v[84:85], v9 offset:42000
    ds_read_b64_tr_b16 v[86:87], v9 offset:43280
    v_mfma_f32_16x16x32_bf16 v[32:35], v[64:67], v[96:99], v[32:35]
    ds_read_b64_tr_b16 v[88:89], v9 offset:42008
    ds_read_b64_tr_b16 v[90:91], v9 offset:43288
    v_mfma_f32_16x16x32_bf16 v[36:39], v[64:67], v[100:103], v[36:39]
    ds_read_b64_tr_b16 v[92:93], v9 offset:42016
    ds_read_b64_tr_b16 v[94:95], v9 offset:43296
    v_mfma_f32_16x16x32_bf16 v[40:43], v[68:71], v[96:99], v[40:43]
    v_mfma_f32_16x16x32_bf16 v[44:47], v[68:71], v[100:103], v[44:47]
    v_mfma_f32_16x16x32_bf16 v[48:51], v[72:75], v[96:99], v[48:51]
    v_mfma_f32_16x16x32_bf16 v[52:55], v[72:75], v[100:103], v[52:55]
    s_waitcnt lgkmcnt(0)
    s_barrier
    v_mfma_f32_16x16x32_bf16 v[16:19], v[76:79], v[104:107], v[16:19]
    v_and_b32 v173, 3, v1
    v_lshrrev_b32 v174, 4, v1
    v_cmp_eq_u32 vcc, v173, v174
    v_mul_u32_u24 v173, 800, v173
    v_bfe_u32 v174, v1, 2, 2
    v_mfma_f32_16x16x32_bf16 v[20:23], v[76:79], v[108:111], v[20:23]
    v_mul_u32_u24 v174, 40, v174
    v_add_u32 v173, v173, v174
    v_add_u32 v173, 0x26400, v173
    v_mov_b32 v174, 0x27400
    v_cndmask_b32 v172, v174, v173, vcc
    v_mfma_f32_16x16x32_bf16 v[24:27], v[80:83], v[104:107], v[24:27]
    ds_read_b64_tr_b16 v[112:113], v172 offset:0
    ds_read_b64_tr_b16 v[114:115], v172 offset:160
    ds_read_b64_tr_b16 v[116:117], v172 offset:320
    ds_read_b64_tr_b16 v[118:119], v172 offset:480
    ds_read_b64_tr_b16 v[120:121], v172 offset:640
    v_mfma_f32_16x16x32_bf16 v[28:31], v[80:83], v[108:111], v[28:31]
    v_mov_b32 v122, 0
    v_mov_b32 v123, 0
    ds_read_b64_tr_b16 v[124:125], v172 offset:8
    ds_read_b64_tr_b16 v[126:127], v172 offset:168
    ds_read_b64_tr_b16 v[128:129], v172 offset:328
    ds_read_b64_tr_b16 v[130:131], v172 offset:488
    v_mfma_f32_16x16x32_bf16 v[32:35], v[84:87], v[104:107], v[32:35]
    ds_read_b64_tr_b16 v[132:133], v172 offset:648
    v_mov_b32 v134, 0
    v_mov_b32 v135, 0
    ds_read_b64_tr_b16 v[136:137], v172 offset:16
    ds_read_b64_tr_b16 v[138:139], v172 offset:176
    ds_read_b64_tr_b16 v[140:141], v172 offset:336
    v_mfma_f32_16x16x32_bf16 v[36:39], v[84:87], v[108:111], v[36:39]
    ds_read_b64_tr_b16 v[142:143], v172 offset:496
    ds_read_b64_tr_b16 v[144:145], v172 offset:656
    v_mov_b32 v146, 0
    v_mov_b32 v147, 0
    ds_read_b64_tr_b16 v[148:149], v172 offset:24
    ds_read_b64_tr_b16 v[150:151], v172 offset:184
    v_mfma_f32_16x16x32_bf16 v[40:43], v[88:91], v[104:107], v[40:43]
    ds_read_b64_tr_b16 v[152:153], v172 offset:344
    ds_read_b64_tr_b16 v[154:155], v172 offset:504
    ds_read_b64_tr_b16 v[156:157], v172 offset:664
    v_mov_b32 v158, 0
    v_mov_b32 v159, 0
    ds_read_b64_tr_b16 v[160:161], v172 offset:32
    v_mfma_f32_16x16x32_bf16 v[44:47], v[88:91], v[108:111], v[44:47]
    ds_read_b64_tr_b16 v[162:163], v172 offset:192
    ds_read_b64_tr_b16 v[164:165], v172 offset:352
    ds_read_b64_tr_b16 v[166:167], v172 offset:512
    ds_read_b64_tr_b16 v[168:169], v172 offset:672
    v_mfma_f32_16x16x32_bf16 v[48:51], v[92:95], v[104:107], v[48:51]
    v_mov_b32 v170, 0
    v_mov_b32 v171, 0
    s_lshl2_add_u32 s64, s47, s45
    s_lshl4_add_u32 s64, s64, s46
    s_lshl_b32 s64, s64, 11
    s_add_u32 s64, s64, 0xc24000
    v_mov_b32 v244, -1
    v_mov_b32 v245, -1
    v_mfma_f32_16x16x32_bf16 v[52:55], v[92:95], v[108:111], v[52:55]
    v_mov_b32 v246, -1
    v_mov_b32 v247, -1
    buffer_store_dwordx4 v[244:247], v2, s[32:35], s64 offen offset:0 sc1
    buffer_store_dwordx4 v[244:247], v2, s[32:35], s64 offen offset:1024 sc1
    s_setprio 2
    v_and_b32 v3, 15, v1
    v_mul_u32_u24 v3, 352, v3
    v_lshrrev_b32 v4, 4, v1
    v_mul_u32_u24 v4, 80, v4
    s_mul_i32 s56, s45, 11264
    s_add_u32 s56, s56, 0x7000
    v_add3_u32 v3, v3, v4, s56
    v_mov_b32 v5, 0x26000
    v_mov_b32 v6, 1
    v_lshrrev_b32 v7, 2, v1
    v_mul_u32_u24 v7, 352, v7
    v_and_b32 v8, 3, v1
    v_lshl_add_u32 v7, v8, 3, v7
    s_mul_i32 s56, s45, 80
    s_add_u32 s56, s56, 0x7000
    v_add_u32 v7, s56, v7
    s_lshl_b32 s56, s45, 10
    s_add_u32 s56, s56, 0x2000
    v_add_u32 v8, s56, v2
    v_add_u32 v9, 0x3000, v2
    v_cvt_pk_bf16_f32 v80, v16, v17
    v_cvt_pk_bf16_f32 v81, v18, v19
    v_cvt_pk_bf16_f32 v82, v24, v25
    v_cvt_pk_bf16_f32 v83, v26, v27
    v_cvt_pk_bf16_f32 v84, v32, v33
    v_cvt_pk_bf16_f32 v85, v34, v35
    v_cvt_pk_bf16_f32 v86, v40, v41
    v_cvt_pk_bf16_f32 v87, v42, v43
    v_cvt_pk_bf16_f32 v88, v48, v49
    v_cvt_pk_bf16_f32 v89, v50, v51
    v_mov_b32 v90, 0
    v_mov_b32 v91, 0
    v_cvt_pk_bf16_f32 v92, v20, v21
    v_cvt_pk_bf16_f32 v93, v22, v23
    v_cvt_pk_bf16_f32 v94, v28, v29
    v_cvt_pk_bf16_f32 v95, v30, v31
    v_cvt_pk_bf16_f32 v96, v36, v37
    v_cvt_pk_bf16_f32 v97, v38, v39
    v_cvt_pk_bf16_f32 v98, v44, v45
    v_cvt_pk_bf16_f32 v99, v46, v47
    v_cvt_pk_bf16_f32 v100, v52, v53
    v_cvt_pk_bf16_f32 v101, v54, v55
    v_mov_b32 v102, 0
    v_mov_b32 v103, 0
    s_waitcnt lgkmcnt(0)
    v_mfma_f32_16x16x32_bf16 v[16:19], v[112:115], v[80:83], 0
    v_mfma_f32_16x16x32_bf16 v[20:23], v[124:127], v[80:83], 0
    v_mfma_f32_16x16x32_bf16 v[24:27], v[136:139], v[80:83], 0
    v_mfma_f32_16x16x32_bf16 v[28:31], v[148:151], v[80:83], 0
    v_mfma_f32_16x16x32_bf16 v[32:35], v[160:163], v[80:83], 0
    v_mfma_f32_16x16x32_bf16 v[16:19], v[116:119], v[84:87], v[16:19]
    v_mfma_f32_16x16x32_bf16 v[20:23], v[128:131], v[84:87], v[20:23]
    v_mfma_f32_16x16x32_bf16 v[24:27], v[140:143], v[84:87], v[24:27]
    v_mfma_f32_16x16x32_bf16 v[28:31], v[152:155], v[84:87], v[28:31]
    v_mfma_f32_16x16x32_bf16 v[32:35], v[164:167], v[84:87], v[32:35]
    v_mfma_f32_16x16x32_bf16 v[16:19], v[120:123], v[88:91], v[16:19]
    v_mfma_f32_16x16x32_bf16 v[20:23], v[132:135], v[88:91], v[20:23]
    v_mfma_f32_16x16x32_bf16 v[24:27], v[144:147], v[88:91], v[24:27]
    v_mfma_f32_16x16x32_bf16 v[28:31], v[156:159], v[88:91], v[28:31]
    v_mfma_f32_16x16x32_bf16 v[32:35], v[168:171], v[88:91], v[32:35]
    v_mfma_f32_16x16x32_bf16 v[36:39], v[112:115], v[92:95], 0
    v_mfma_f32_16x16x32_bf16 v[40:43], v[124:127], v[92:95], 0
    v_mfma_f32_16x16x32_bf16 v[44:47], v[136:139], v[92:95], 0
    v_mfma_f32_16x16x32_bf16 v[48:51], v[148:151], v[92:95], 0
    v_mfma_f32_16x16x32_bf16 v[52:55], v[160:163], v[92:95], 0
    v_mfma_f32_16x16x32_bf16 v[36:39], v[116:119], v[96:99], v[36:39]
    v_mfma_f32_16x16x32_bf16 v[40:43], v[128:131], v[96:99], v[40:43]
    v_mfma_f32_16x16x32_bf16 v[44:47], v[140:143], v[96:99], v[44:47]
    v_mfma_f32_16x16x32_bf16 v[48:51], v[152:155], v[96:99], v[48:51]
    v_mfma_f32_16x16x32_bf16 v[52:55], v[164:167], v[96:99], v[52:55]
    v_mfma_f32_16x16x32_bf16 v[36:39], v[120:123], v[100:103], v[36:39]
    v_mfma_f32_16x16x32_bf16 v[40:43], v[132:135], v[100:103], v[40:43]
    v_mfma_f32_16x16x32_bf16 v[44:47], v[144:147], v[100:103], v[44:47]
    v_mfma_f32_16x16x32_bf16 v[48:51], v[156:159], v[100:103], v[48:51]
    v_mfma_f32_16x16x32_bf16 v[52:55], v[168:171], v[100:103], v[52:55]
    s_waitcnt vmcnt(2)
    v_cmp_eq_u32 s[58:59], s50, v176
    v_cmp_eq_u32 vcc, s50, v177
    s_nop 1
    s_and_b64 s[58:59], s[58:59], vcc
    v_cmp_eq_u32 vcc, s50, v178
    s_nop 1
    s_and_b64 s[58:59], s[58:59], vcc
    v_cmp_eq_u32 vcc, s50, v179
    s_nop 1
    s_and_b64 s[58:59], s[58:59], vcc
    s_orn2_b32 s58, s58, 0x7ffff
    s_orn2_b32 s59, s59, 0x7ffff
    s_and_b32 s58, s58, s59
    s_cmp_eq_u32 s58, -1
    s_cselect_b32 s80, 1, 0
    s_cselect_b32 s81, s76, 0x7ff00000
    s_add_u32 s61, s79, 0
    s_and_b32 s61, s61, 3
    s_mul_i32 s61, s61, 20480
    s_add_u32 s61, s61, s81
    buffer_load_dwordx4 v[176:179], v2, s[32:35], s61 offen offset:0
    buffer_load_dwordx4 v[180:183], v2, s[32:35], s61 offen offset:1024
    buffer_load_dwordx4 v[184:187], v2, s[32:35], s61 offen offset:2048
    buffer_load_dwordx4 v[188:191], v2, s[32:35], s61 offen offset:3072
    s_add_u32 s61, s61, 4096
    buffer_load_dwordx4 v[192:195], v2, s[32:35], s61 offen offset:0
    s_add_u32 s61, s79, 1
    s_and_b32 s61, s61, 3
    s_mul_i32 s61, s61, 20480
    s_add_u32 s61, s61, s81
    buffer_load_dwordx4 v[196:199], v2, s[32:35], s61 offen offset:0
    buffer_load_dwordx4 v[200:203], v2, s[32:35], s61 offen offset:1024
    v_max3_f32 v124, v16, v17, v18
    v_max3_f32 v125, v19, v20, v21
    v_max3_f32 v124, v124, v22, v23
    v_max3_f32 v125, v125, v24, v25
    v_max3_f32 v124, v124, v26, v27
    v_max3_f32 v125, v125, v28, v29
    v_max3_f32 v124, v124, v30, v31
    v_max3_f32 v125, v125, v32, v33
    v_max3_f32 v124, v124, v34, v35
    v_max_f32 v124, v124, v125
    v_min3_f32 v126, v16, v17, v18
    v_min3_f32 v127, v19, v20, v21
    v_min3_f32 v126, v126, v22, v23
    v_min3_f32 v127, v127, v24, v25
    v_min3_f32 v126, v126, v26, v27
    v_min3_f32 v127, v127, v28, v29
    v_min3_f32 v126, v126, v30, v31
    v_min3_f32 v127, v127, v32, v33
    v_min3_f32 v126, v126, v34, v35
    v_min_f32 v126, v126, v127
    v_mul_f32 v124, s63, v124
    v_mul_f32 v126, s62, v126
    v_pk_fma_f32 v[104:105], v[16:17], s[62:63], v[126:127] op_sel_hi:[1,0,0] neg_lo:[0,1,0] neg_hi:[0,1,0]
    v_pk_fma_f32 v[16:17], v[16:17], s[62:63], v[124:125] op_sel_hi:[1,0,0]
    v_pk_fma_f32 v[106:107], v[18:19], s[62:63], v[126:127] op_sel_hi:[1,0,0] neg_lo:[0,1,0] neg_hi:[0,1,0]
    v_pk_fma_f32 v[18:19], v[18:19], s[62:63], v[124:125] op_sel_hi:[1,0,0]
    v_pk_fma_f32 v[108:109], v[20:21], s[62:63], v[126:127] op_sel_hi:[1,0,0] neg_lo:[0,1,0] neg_hi:[0,1,0]
    v_pk_fma_f32 v[20:21], v[20:21], s[62:63], v[124:125] op_sel_hi:[1,0,0]
    v_pk_fma_f32 v[110:111], v[22:23], s[62:63], v[126:127] op_sel_hi:[1,0,0] neg_lo:[0,1,0] neg_hi:[0,1,0]
    v_pk_fma_f32 v[22:23], v[22:23], s[62:63], v[124:125] op_sel_hi:[1,0,0]
    v_pk_fma_f32 v[112:113], v[24:25], s[62:63], v[126:127] op_sel_hi:[1,0,0] neg_lo:[0,1,0] neg_hi:[0,1,0]
    v_pk_fma_f32 v[24:25], v[24:25], s[62:63], v[124:125] op_sel_hi:[1,0,0]
    v_pk_fma_f32 v[114:115], v[26:27], s[62:63], v[126:127] op_sel_hi:[1,0,0] neg_lo:[0,1,0] neg_hi:[0,1,0]
    v_pk_fma_f32 v[26:27], v[26:27], s[62:63], v[124:125] op_sel_hi:[1,0,0]
    v_pk_fma_f32 v[116:117], v[28:29], s[62:63], v[126:127] op_sel_hi:[1,0,0] neg_lo:[0,1,0] neg_hi:[0,1,0]
    v_pk_fma_f32 v[28:29], v[28:29], s[62:63], v[124:125] op_sel_hi:[1,0,0]
    v_pk_fma_f32 v[118:119], v[30:31], s[62:63], v[126:127] op_sel_hi:[1,0,0] neg_lo:[0,1,0] neg_hi:[0,1,0]
    v_pk_fma_f32 v[30:31], v[30:31], s[62:63], v[124:125] op_sel_hi:[1,0,0]
    v_pk_fma_f32 v[120:121], v[32:33], s[62:63], v[126:127] op_sel_hi:[1,0,0] neg_lo:[0,1,0] neg_hi:[0,1,0]
    v_pk_fma_f32 v[32:33], v[32:33], s[62:63], v[124:125] op_sel_hi:[1,0,0]
    v_pk_fma_f32 v[122:123], v[34:35], s[62:63], v[126:127] op_sel_hi:[1,0,0] neg_lo:[0,1,0] neg_hi:[0,1,0]
    v_pk_fma_f32 v[34:35], v[34:35], s[62:63], v[124:125] op_sel_hi:[1,0,0]
    v_exp_f32 v16, v16
    v_exp_f32 v104, v104
    v_exp_f32 v17, v17
    v_exp_f32 v105, v105
    v_exp_f32 v18, v18
    v_exp_f32 v106, v106
    v_exp_f32 v19, v19
    v_exp_f32 v107, v107
    v_exp_f32 v20, v20
    v_exp_f32 v108, v108
    v_exp_f32 v21, v21
    v_exp_f32 v109, v109
    v_exp_f32 v22, v22
    v_exp_f32 v110, v110
    v_exp_f32 v23, v23
    v_exp_f32 v111, v111
    v_exp_f32 v24, v24
    v_exp_f32 v112, v112
    v_exp_f32 v25, v25
    v_exp_f32 v113, v113
    v_exp_f32 v26, v26
    v_exp_f32 v114, v114
    v_exp_f32 v27, v27
    v_exp_f32 v115, v115
    v_exp_f32 v28, v28
    v_exp_f32 v116, v116
    v_exp_f32 v29, v29
    v_exp_f32 v117, v117
    v_exp_f32 v30, v30
    v_exp_f32 v118, v118
    v_exp_f32 v31, v31
    v_exp_f32 v119, v119
    v_exp_f32 v32, v32
    v_exp_f32 v120, v120
    v_exp_f32 v33, v33
    v_exp_f32 v121, v121
    v_exp_f32 v34, v34
    v_exp_f32 v122, v122
    v_exp_f32 v35, v35
    v_exp_f32 v123, v123
    v_pk_add_f32 v[128:129], v[16:17], v[18:19]
    v_pk_add_f32 v[130:131], v[104:105], v[106:107]
    v_pk_add_f32 v[128:129], v[128:129], v[20:21]
    v_pk_add_f32 v[130:131], v[130:131], v[108:109]
    v_pk_add_f32 v[128:129], v[128:129], v[22:23]
    v_pk_add_f32 v[130:131], v[130:131], v[110:111]
    v_pk_add_f32 v[128:129], v[128:129], v[24:25]
    v_pk_add_f32 v[130:131], v[130:131], v[112:113]
    v_pk_add_f32 v[128:129], v[128:129], v[26:27]
    v_pk_add_f32 v[130:131], v[130:131], v[114:115]
    v_pk_add_f32 v[128:129], v[128:129], v[28:29]
    v_pk_add_f32 v[130:131], v[130:131], v[116:117]
    v_pk_add_f32 v[128:129], v[128:129], v[30:31]
    v_pk_add_f32 v[130:131], v[130:131], v[118:119]
    v_pk_add_f32 v[128:129], v[128:129], v[32:33]
    v_pk_add_f32 v[130:131], v[130:131], v[120:121]
    v_pk_add_f32 v[128:129], v[128:129], v[34:35]
    v_pk_add_f32 v[130:131], v[130:131], v[122:123]
    v_add_f32 v128, v128, v129
    v_add_f32 v130, v130, v131
    v_rcp_f32 v128, v128
    v_rcp_f32 v130, v130
    v_pk_mul_f32 v[16:17], v[16:17], v[128:129] op_sel_hi:[1,0]
    v_pk_mul_f32 v[104:105], v[104:105], v[130:131] op_sel_hi:[1,0]
    v_pk_mul_f32 v[18:19], v[18:19], v[128:129] op_sel_hi:[1,0]
    v_pk_mul_f32 v[106:107], v[106:107], v[130:131] op_sel_hi:[1,0]
    v_pk_mul_f32 v[20:21], v[20:21], v[128:129] op_sel_hi:[1,0]
    v_pk_mul_f32 v[108:109], v[108:109], v[130:131] op_sel_hi:[1,0]
    v_pk_mul_f32 v[22:23], v[22:23], v[128:129] op_sel_hi:[1,0]
    v_pk_mul_f32 v[110:111], v[110:111], v[130:131] op_sel_hi:[1,0]
    v_pk_mul_f32 v[24:25], v[24:25], v[128:129] op_sel_hi:[1,0]
    v_pk_mul_f32 v[112:113], v[112:113], v[130:131] op_sel_hi:[1,0]
    v_pk_mul_f32 v[26:27], v[26:27], v[128:129] op_sel_hi:[1,0]
    v_pk_mul_f32 v[114:115], v[114:115], v[130:131] op_sel_hi:[1,0]
    v_pk_mul_f32 v[28:29], v[28:29], v[128:129] op_sel_hi:[1,0]
    v_pk_mul_f32 v[116:117], v[116:117], v[130:131] op_sel_hi:[1,0]
    v_pk_mul_f32 v[30:31], v[30:31], v[128:129] op_sel_hi:[1,0]
    v_pk_mul_f32 v[118:119], v[118:119], v[130:131] op_sel_hi:[1,0]
    v_pk_mul_f32 v[32:33], v[32:33], v[128:129] op_sel_hi:[1,0]
    v_pk_mul_f32 v[120:121], v[120:121], v[130:131] op_sel_hi:[1,0]
    v_pk_mul_f32 v[34:35], v[34:35], v[128:129] op_sel_hi:[1,0]
    v_pk_mul_f32 v[122:123], v[122:123], v[130:131] op_sel_hi:[1,0]
    v_cvt_pk_bf16_f32 v56, v16, v17
    v_cvt_pk_bf16_f32 v57, v18, v19
    v_cvt_pk_bf16_f32 v58, v20, v21
    v_cvt_pk_bf16_f32 v59, v22, v23
    v_cvt_pk_bf16_f32 v60, v24, v25
    v_cvt_pk_bf16_f32 v61, v26, v27
    v_cvt_pk_bf16_f32 v62, v28, v29
    v_cvt_pk_bf16_f32 v63, v30, v31
    v_cvt_pk_bf16_f32 v64, v32, v33
    v_cvt_pk_bf16_f32 v65, v34, v35
    v_cvt_pk_bf16_f32 v66, v104, v105
    v_cvt_pk_bf16_f32 v67, v106, v107
    v_cvt_pk_bf16_f32 v68, v108, v109
    v_cvt_pk_bf16_f32 v69, v110, v111
    v_cvt_pk_bf16_f32 v70, v112, v113
    v_cvt_pk_bf16_f32 v71, v114, v115
    v_cvt_pk_bf16_f32 v72, v116, v117
    v_cvt_pk_bf16_f32 v73, v118, v119
    v_cvt_pk_bf16_f32 v74, v120, v121
    v_cvt_pk_bf16_f32 v75, v122, v123
    ds_write_b128 v3, v[56:59] offset:0
    ds_write_b128 v3, v[60:63] offset:16
    ds_write_b128 v3, v[64:67] offset:32
    ds_write_b128 v3, v[68:71] offset:48
    ds_write_b128 v3, v[72:75] offset:64
    s_add_u32 s61, s79, 1
    s_and_b32 s61, s61, 3
    s_mul_i32 s61, s61, 20480
    s_add_u32 s61, s61, s81
    buffer_load_dwordx4 v[204:207], v2, s[32:35], s61 offen offset:2048
    buffer_load_dwordx4 v[208:211], v2, s[32:35], s61 offen offset:3072
    s_add_u32 s61, s61, 4096
    buffer_load_dwordx4 v[212:215], v2, s[32:35], s61 offen offset:0
    s_add_u32 s61, s79, 2
    s_and_b32 s61, s61, 3
    s_mul_i32 s61, s61, 20480
    s_add_u32 s61, s61, s81
    buffer_load_dwordx4 v[216:219], v2, s[32:35], s61 offen offset:0
    buffer_load_dwordx4 v[220:223], v2, s[32:35], s61 offen offset:1024
    buffer_load_dwordx4 v[224:227], v2, s[32:35], s61 offen offset:2048
    buffer_load_dwordx4 v[228:231], v2, s[32:35], s61 offen offset:3072
    v_max3_f32 v124, v36, v37, v38
    v_max3_f32 v125, v39, v40, v41
    v_max3_f32 v124, v124, v42, v43
    v_max3_f32 v125, v125, v44, v45
    v_max3_f32 v124, v124, v46, v47
    v_max3_f32 v125, v125, v48, v49
    v_max3_f32 v124, v124, v50, v51
    v_max3_f32 v125, v125, v52, v53
    v_max3_f32 v124, v124, v54, v55
    v_max_f32 v124, v124, v125
    v_min3_f32 v126, v36, v37, v38
    v_min3_f32 v127, v39, v40, v41
    v_min3_f32 v126, v126, v42, v43
    v_min3_f32 v127, v127, v44, v45
    v_min3_f32 v126, v126, v46, v47
    v_min3_f32 v127, v127, v48, v49
    v_min3_f32 v126, v126, v50, v51
    v_min3_f32 v127, v127, v52, v53
    v_min3_f32 v126, v126, v54, v55
    v_min_f32 v126, v126, v127
    v_mul_f32 v124, s63, v124
    v_mul_f32 v126, s62, v126
    v_pk_fma_f32 v[104:105], v[36:37], s[62:63], v[126:127] op_sel_hi:[1,0,0] neg_lo:[0,1,0] neg_hi:[0,1,0]
    v_pk_fma_f32 v[36:37], v[36:37], s[62:63], v[124:125] op_sel_hi:[1,0,0]
    v_pk_fma_f32 v[106:107], v[38:39], s[62:63], v[126:127] op_sel_hi:[1,0,0] neg_lo:[0,1,0] neg_hi:[0,1,0]
    v_pk_fma_f32 v[38:39], v[38:39], s[62:63], v[124:125] op_sel_hi:[1,0,0]
    v_pk_fma_f32 v[108:109], v[40:41], s[62:63], v[126:127] op_sel_hi:[1,0,0] neg_lo:[0,1,0] neg_hi:[0,1,0]
    v_pk_fma_f32 v[40:41], v[40:41], s[62:63], v[124:125] op_sel_hi:[1,0,0]
    v_pk_fma_f32 v[110:111], v[42:43], s[62:63], v[126:127] op_sel_hi:[1,0,0] neg_lo:[0,1,0] neg_hi:[0,1,0]
    v_pk_fma_f32 v[42:43], v[42:43], s[62:63], v[124:125] op_sel_hi:[1,0,0]
    v_pk_fma_f32 v[112:113], v[44:45], s[62:63], v[126:127] op_sel_hi:[1,0,0] neg_lo:[0,1,0] neg_hi:[0,1,0]
    v_pk_fma_f32 v[44:45], v[44:45], s[62:63], v[124:125] op_sel_hi:[1,0,0]
    v_pk_fma_f32 v[114:115], v[46:47], s[62:63], v[126:127] op_sel_hi:[1,0,0] neg_lo:[0,1,0] neg_hi:[0,1,0]
    v_pk_fma_f32 v[46:47], v[46:47], s[62:63], v[124:125] op_sel_hi:[1,0,0]
    v_pk_fma_f32 v[116:117], v[48:49], s[62:63], v[126:127] op_sel_hi:[1,0,0] neg_lo:[0,1,0] neg_hi:[0,1,0]
    v_pk_fma_f32 v[48:49], v[48:49], s[62:63], v[124:125] op_sel_hi:[1,0,0]
    v_pk_fma_f32 v[118:119], v[50:51], s[62:63], v[126:127] op_sel_hi:[1,0,0] neg_lo:[0,1,0] neg_hi:[0,1,0]
    v_pk_fma_f32 v[50:51], v[50:51], s[62:63], v[124:125] op_sel_hi:[1,0,0]
    v_pk_fma_f32 v[120:121], v[52:53], s[62:63], v[126:127] op_sel_hi:[1,0,0] neg_lo:[0,1,0] neg_hi:[0,1,0]
    v_pk_fma_f32 v[52:53], v[52:53], s[62:63], v[124:125] op_sel_hi:[1,0,0]
    v_pk_fma_f32 v[122:123], v[54:55], s[62:63], v[126:127] op_sel_hi:[1,0,0] neg_lo:[0,1,0] neg_hi:[0,1,0]
    v_pk_fma_f32 v[54:55], v[54:55], s[62:63], v[124:125] op_sel_hi:[1,0,0]
    v_exp_f32 v36, v36
    v_exp_f32 v104, v104
    v_exp_f32 v37, v37
    v_exp_f32 v105, v105
    v_exp_f32 v38, v38
    v_exp_f32 v106, v106
    v_exp_f32 v39, v39
    v_exp_f32 v107, v107
    v_exp_f32 v40, v40
    v_exp_f32 v108, v108
    v_exp_f32 v41, v41
    v_exp_f32 v109, v109
    v_exp_f32 v42, v42
    v_exp_f32 v110, v110
    v_exp_f32 v43, v43
    v_exp_f32 v111, v111
    v_exp_f32 v44, v44
    v_exp_f32 v112, v112
    v_exp_f32 v45, v45
    v_exp_f32 v113, v113
    v_exp_f32 v46, v46
    v_exp_f32 v114, v114
    v_exp_f32 v47, v47
    v_exp_f32 v115, v115
    v_exp_f32 v48, v48
    v_exp_f32 v116, v116
    v_exp_f32 v49, v49
    v_exp_f32 v117, v117
    v_exp_f32 v50, v50
    v_exp_f32 v118, v118
    v_exp_f32 v51, v51
    v_exp_f32 v119, v119
    v_exp_f32 v52, v52
    v_exp_f32 v120, v120
    v_exp_f32 v53, v53
    v_exp_f32 v121, v121
    v_exp_f32 v54, v54
    v_exp_f32 v122, v122
    v_exp_f32 v55, v55
    v_exp_f32 v123, v123
    v_pk_add_f32 v[128:129], v[36:37], v[38:39]
    v_pk_add_f32 v[130:131], v[104:105], v[106:107]
    v_pk_add_f32 v[128:129], v[128:129], v[40:41]
    v_pk_add_f32 v[130:131], v[130:131], v[108:109]
    v_pk_add_f32 v[128:129], v[128:129], v[42:43]
    v_pk_add_f32 v[130:131], v[130:131], v[110:111]
    v_pk_add_f32 v[128:129], v[128:129], v[44:45]
    v_pk_add_f32 v[130:131], v[130:131], v[112:113]
    v_pk_add_f32 v[128:129], v[128:129], v[46:47]
    v_pk_add_f32 v[130:131], v[130:131], v[114:115]
    v_pk_add_f32 v[128:129], v[128:129], v[48:49]
    v_pk_add_f32 v[130:131], v[130:131], v[116:117]
    v_pk_add_f32 v[128:129], v[128:129], v[50:51]
    v_pk_add_f32 v[130:131], v[130:131], v[118:119]
    v_pk_add_f32 v[128:129], v[128:129], v[52:53]
    v_pk_add_f32 v[130:131], v[130:131], v[120:121]
    v_pk_add_f32 v[128:129], v[128:129], v[54:55]
    v_pk_add_f32 v[130:131], v[130:131], v[122:123]
    v_add_f32 v128, v128, v129
    v_add_f32 v130, v130, v131
    v_rcp_f32 v128, v128
    v_rcp_f32 v130, v130
    v_pk_mul_f32 v[36:37], v[36:37], v[128:129] op_sel_hi:[1,0]
    v_pk_mul_f32 v[104:105], v[104:105], v[130:131] op_sel_hi:[1,0]
    v_pk_mul_f32 v[38:39], v[38:39], v[128:129] op_sel_hi:[1,0]
    v_pk_mul_f32 v[106:107], v[106:107], v[130:131] op_sel_hi:[1,0]
    v_pk_mul_f32 v[40:41], v[40:41], v[128:129] op_sel_hi:[1,0]
    v_pk_mul_f32 v[108:109], v[108:109], v[130:131] op_sel_hi:[1,0]
    v_pk_mul_f32 v[42:43], v[42:43], v[128:129] op_sel_hi:[1,0]
    v_pk_mul_f32 v[110:111], v[110:111], v[130:131] op_sel_hi:[1,0]
    v_pk_mul_f32 v[44:45], v[44:45], v[128:129] op_sel_hi:[1,0]
    v_pk_mul_f32 v[112:113], v[112:113], v[130:131] op_sel_hi:[1,0]
    v_pk_mul_f32 v[46:47], v[46:47], v[128:129] op_sel_hi:[1,0]
    v_pk_mul_f32 v[114:115], v[114:115], v[130:131] op_sel_hi:[1,0]
    v_pk_mul_f32 v[48:49], v[48:49], v[128:129] op_sel_hi:[1,0]
    v_pk_mul_f32 v[116:117], v[116:117], v[130:131] op_sel_hi:[1,0]
    v_pk_mul_f32 v[50:51], v[50:51], v[128:129] op_sel_hi:[1,0]
    v_pk_mul_f32 v[118:119], v[118:119], v[130:131] op_sel_hi:[1,0]
    v_pk_mul_f32 v[52:53], v[52:53], v[128:129] op_sel_hi:[1,0]
    v_pk_mul_f32 v[120:121], v[120:121], v[130:131] op_sel_hi:[1,0]
    v_pk_mul_f32 v[54:55], v[54:55], v[128:129] op_sel_hi:[1,0]
    v_pk_mul_f32 v[122:123], v[122:123], v[130:131] op_sel_hi:[1,0]
    v_cvt_pk_bf16_f32 v56, v36, v37
    v_cvt_pk_bf16_f32 v57, v38, v39
    v_cvt_pk_bf16_f32 v58, v40, v41
    v_cvt_pk_bf16_f32 v59, v42, v43
    v_cvt_pk_bf16_f32 v60, v44, v45
    v_cvt_pk_bf16_f32 v61, v46, v47
    v_cvt_pk_bf16_f32 v62, v48, v49
    v_cvt_pk_bf16_f32 v63, v50, v51
    v_cvt_pk_bf16_f32 v64, v52, v53
    v_cvt_pk_bf16_f32 v65, v54, v55
    v_cvt_pk_bf16_f32 v66, v104, v105
    v_cvt_pk_bf16_f32 v67, v106, v107
    v_cvt_pk_bf16_f32 v68, v108, v109
    v_cvt_pk_bf16_f32 v69, v110, v111
    v_cvt_pk_bf16_f32 v70, v112, v113
    v_cvt_pk_bf16_f32 v71, v114, v115
    v_cvt_pk_bf16_f32 v72, v116, v117
    v_cvt_pk_bf16_f32 v73, v118, v119
    v_cvt_pk_bf16_f32 v74, v120, v121
    v_cvt_pk_bf16_f32 v75, v122, v123
    ds_write_b128 v3, v[56:59] offset:5632
    ds_write_b128 v3, v[60:63] offset:5648
    ds_write_b128 v3, v[64:67] offset:5664
    ds_write_b128 v3, v[68:71] offset:5680
    ds_write_b128 v3, v[72:75] offset:5696
    s_mov_b64 exec, 1
    ds_add_u32 v5, v6 offset:0
    s_mov_b64 exec, -1
    s_add_u32 s61, s79, 2
    s_and_b32 s61, s61, 3
    s_mul_i32 s61, s61, 20480
    s_add_u32 s61, s61, s81
    s_add_u32 s61, s61, 4096
    buffer_load_dwordx4 v[232:235], v2, s[32:35], s61 offen offset:0
    s_add_u32 s61, s79, 3
    s_and_b32 s61, s61, 3
    s_mul_i32 s61, s61, 20480
    s_add_u32 s61, s61, s81
    buffer_load_dwordx4 v[236:239], v2, s[32:35], s61 offen offset:0
    buffer_load_dwordx4 v[240:243], v2, s[32:35], s61 offen offset:1024
    buffer_load_dwordx4 v[244:247], v2, s[32:35], s61 offen offset:2048
    buffer_load_dwordx4 v[248:251], v2, s[32:35], s61 offen offset:3072
    s_add_u32 s61, s61, 4096
    buffer_load_dwordx4 v[252:255], v2, s[32:35], s61 offen offset:0
    v_bfe_u32 v10, v1, 2, 2
    v_cmp_eq_u32 s[66:67], s45, v10
    v_mov_b32 v11, 0x3f803f80
    v_and_b32 v14, 15, v1
    v_lshrrev_b32 v13, 4, v1
    v_lshlrev_b32 v13, 3, v13
    v_mul_u32_u24 v12, 80, v14
    v_add_u32 v12, v12, v13
    v_and_b32 v10, 3, v1
    v_mul_u32_u24 v10, 80, v10
    v_add_u32 v10, v10, v13
    v_add_u32 v10, 1280, v10
    v_mov_b32 v15, 0x7ff00000
    v_cndmask_b32 v4, v15, v10, s[66:67]
    s_lshl_b32 s56, s45, 2
    s_add_u32 s56, s56, 4
    s_and_b32 s56, s56, 15
    v_add_u32 v10, 1600, v13
    v_cmp_eq_u32 vcc, s56, v14
    s_nop 1
    v_cndmask_b32 v4, v4, v10, vcc
    s_lshl_b32 s64, s47, 2
    s_add_u32 s64, s64, s45
    s_lshl_b32 s64, s64, 4
    s_add_u32 s64, s64, s46
    s_lshl_b32 s65, s64, 2
    s_add_u32 s65, s65, 0xd2d000
    s_lshl_b32 s64, s64, 11
    s_add_u32 s64, s64, 0xc24000
    s_add_u32 s56, s45, 0
    s_and_b32 s56, s56, 3
    s_lshl_b32 s56, s56, 10
    v_add_u32 v16, s56, v2
    s_add_u32 s56, s45, 1
    s_and_b32 s56, s56, 3
    s_lshl_b32 s56, s56, 10
    v_add_u32 v17, s56, v2
    s_add_u32 s56, s45, 2
    s_and_b32 s56, s56, 3
    s_lshl_b32 s56, s56, 10
    v_add_u32 v18, s56, v2
    s_add_u32 s56, s45, 3
    s_and_b32 s56, s56, 3
    s_lshl_b32 s56, s56, 10
    v_add_u32 v19, s56, v2
    v_mov_b32 v20, 0x26000
    s_mov_b32 s60, 160000
LW_1:
    ds_read_b32 v10, v5 offset:0
    s_waitcnt lgkmcnt(0)
    v_readfirstlane_b32 s58, v10
    s_nop 1
    s_cmp_ge_u32 s58, 8
    s_nop 0
    s_cbranch_scc1 LW_1_OK
    s_sub_u32 s60, s60, 1
    s_cmp_lg_u32 s60, 0
    s_cbranch_scc1 LW_1
LW_1_OK:
    ds_read_b128 v[56:59], v8 offset:0
    ds_read_b128 v[60:63], v9 offset:0
    ds_read_b64_tr_b16 v[64:65], v7 offset:0
    ds_read_b64_tr_b16 v[66:67], v7 offset:5632
    ds_read_b64_tr_b16 v[68:69], v7 offset:32
    ds_read_b64_tr_b16 v[70:71], v7 offset:5664
    ds_read_b64_tr_b16 v[72:73], v7 offset:64
    ds_read_b64_tr_b16 v[74:75], v7 offset:5696
    ds_read_b128 v[76:79], v8 offset:5120
    ds_read_b128 v[80:83], v9 offset:5120
    ds_read_b64_tr_b16 v[84:85], v7 offset:11264
    ds_read_b64_tr_b16 v[86:87], v7 offset:16896
    ds_read_b64_tr_b16 v[88:89], v7 offset:11296
    ds_read_b64_tr_b16 v[90:91], v7 offset:16928
    ds_read_b64_tr_b16 v[92:93], v7 offset:11328
    ds_read_b64_tr_b16 v[94:95], v7 offset:16960
    s_waitcnt lgkmcnt(8)
    ds_read_b128 v[96:99], v8 offset:10240
    ds_read_b128 v[100:103], v9 offset:10240
    ds_read_b64_tr_b16 v[104:105], v7 offset:22528
    ds_read_b64_tr_b16 v[106:107], v7 offset:28160
    ds_read_b64_tr_b16 v[108:109], v7 offset:22560
    ds_read_b64_tr_b16 v[110:111], v7 offset:28192
    ds_read_b64_tr_b16 v[112:113], v7 offset:22592
    ds_read_b64_tr_b16 v[114:115], v7 offset:28224
    v_cndmask_b32 v60, v11, v60, s[66:67]
    v_cndmask_b32 v61, v11, v61, s[66:67]
    v_cndmask_b32 v62, v11, v62, s[66:67]
    v_cndmask_b32 v63, v11, v63, s[66:67]
    v_mfma_f32_16x16x32_bf16 v[140:143], v[64:67], v[56:59], 0
    v_mfma_f32_16x16x32_bf16 v[144:147], v[68:71], v[56:59], 0
    v_mfma_f32_16x16x32_bf16 v[148:151], v[72:75], v[56:59], 0
    v_mfma_f32_16x16x32_bf16 v[152:155], v[64:67], v[60:63], 0
    v_mfma_f32_16x16x32_bf16 v[156:159], v[68:71], v[60:63], 0
    v_mfma_f32_16x16x32_bf16 v[160:163], v[72:75], v[60:63], 0
    s_waitcnt lgkmcnt(8)
    ds_read_b128 v[116:119], v8 offset:15360
    ds_read_b128 v[120:123], v9 offset:15360
    ds_read_b64_tr_b16 v[124:125], v7 offset:33792
    ds_read_b64_tr_b16 v[126:127], v7 offset:39424
    ds_read_b64_tr_b16 v[128:129], v7 offset:33824
    ds_read_b64_tr_b16 v[130:131], v7 offset:39456
    ds_read_b64_tr_b16 v[132:133], v7 offset:33856
    ds_read_b64_tr_b16 v[134:135], v7 offset:39488
    v_cndmask_b32 v80, v11, v80, s[66:67]
    v_cndmask_b32 v81, v11, v81, s[66:67]
    v_cndmask_b32 v82, v11, v82, s[66:67]
    v_cndmask_b32 v83, v11, v83, s[66:67]
    v_mfma_f32_16x16x32_bf16 v[140:143], v[84:87], v[76:79], v[140:143]
    v_mfma_f32_16x16x32_bf16 v[144:147], v[88:91], v[76:79], v[144:147]
    v_mfma_f32_16x16x32_bf16 v[148:151], v[92:95], v[76:79], v[148:151]
    v_mfma_f32_16x16x32_bf16 v[152:155], v[84:87], v[80:83], v[152:155]
    v_mfma_f32_16x16x32_bf16 v[156:159], v[88:91], v[80:83], v[156:159]
    v_mfma_f32_16x16x32_bf16 v[160:163], v[92:95], v[80:83], v[160:163]
    s_waitcnt lgkmcnt(8)
    v_cndmask_b32 v100, v11, v100, s[66:67]
    v_cndmask_b32 v101, v11, v101, s[66:67]
    v_cndmask_b32 v102, v11, v102, s[66:67]
    v_cndmask_b32 v103, v11, v103, s[66:67]
    v_mfma_f32_16x16x32_bf16 v[140:143], v[104:107], v[96:99], v[140:143]
    v_mfma_f32_16x16x32_bf16 v[144:147], v[108:111], v[96:99], v[144:147]
    v_mfma_f32_16x16x32_bf16 v[148:151], v[112:115], v[96:99], v[148:151]
    v_mfma_f32_16x16x32_bf16 v[152:155], v[104:107], v[100:103], v[152:155]
    v_mfma_f32_16x16x32_bf16 v[156:159], v[108:111], v[100:103], v[156:159]
    v_mfma_f32_16x16x32_bf16 v[160:163], v[112:115], v[100:103], v[160:163]
    s_waitcnt lgkmcnt(0)
    s_mov_b64 exec, 1
    ds_add_u32 v5, v6 offset:36
    s_mov_b64 exec, -1
    v_cndmask_b32 v120, v11, v120, s[66:67]
    v_cndmask_b32 v121, v11, v121, s[66:67]
    v_cndmask_b32 v122, v11, v122, s[66:67]
    v_cndmask_b32 v123, v11, v123, s[66:67]
    v_mfma_f32_16x16x32_bf16 v[140:143], v[124:127], v[116:119], v[140:143]
    v_mfma_f32_16x16x32_bf16 v[144:147], v[128:131], v[116:119], v[144:147]
    v_mfma_f32_16x16x32_bf16 v[148:151], v[132:135], v[116:119], v[148:151]
    v_mfma_f32_16x16x32_bf16 v[152:155], v[124:127], v[120:123], v[152:155]
    v_mfma_f32_16x16x32_bf16 v[156:159], v[128:131], v[120:123], v[156:159]
    v_mfma_f32_16x16x32_bf16 v[160:163], v[132:135], v[120:123], v[160:163]
    s_waitcnt vmcnt(20)
    s_nop 1
    v_cvt_pk_bf16_f32 v140, v140, v141
    v_cvt_pk_bf16_f32 v141, v142, v143
    buffer_store_dwordx2 v[140:141], v12, s[32:35], s64 offen offset:0 sc1
    v_cvt_pk_bf16_f32 v152, v152, v153
    v_cvt_pk_bf16_f32 v153, v154, v155
    buffer_store_dwordx2 v[152:153], v4, s[32:35], s64 offen offset:0 sc1
    v_cvt_pk_bf16_f32 v144, v144, v145
    v_cvt_pk_bf16_f32 v145, v146, v147
    buffer_store_dwordx2 v[144:145], v12, s[32:35], s64 offen offset:32 sc1
    v_cvt_pk_bf16_f32 v156, v156, v157
    v_cvt_pk_bf16_f32 v157, v158, v159
    buffer_store_dwordx2 v[156:157], v4, s[32:35], s64 offen offset:32 sc1
    v_cvt_pk_bf16_f32 v148, v148, v149
    v_cvt_pk_bf16_f32 v149, v150, v151
    s_mov_b32 exec_hi, 0
    buffer_store_dwordx2 v[148:149], v12, s[32:35], s64 offen offset:64 sc1
    s_mov_b32 exec_hi, -1
    v_cvt_pk_bf16_f32 v160, v160, v161
    v_cvt_pk_bf16_f32 v161, v162, v163
    s_mov_b32 exec_hi, 0
    buffer_store_dwordx2 v[160:161], v4, s[32:35], s64 offen offset:64 sc1
    s_mov_b32 exec_hi, -1
    v_mov_b32 v26, s50
    v_mov_b32 v27, 0
    s_mov_b64 exec, 1
    buffer_store_dword v26, v27, s[32:35], s65 offen sc1
    s_mov_b64 exec, -1
    s_buffer_load_dwordx16 s[4:19], s[32:35], s75 offset:0 glc
    v_and_b32 v26, 15, v1
    v_lshlrev_b32 v27, 2, v26
    s_lshl_b32 s66, s48, 8
    s_add_u32 s66, s66, 0xd26000
    v_lshrrev_b32 v8, 10, v16
    v_lshl_add_u32 v12, v8, 6, v27
    v_lshrrev_b32 v4, 1, v16
    v_lshrrev_b32 v8, 10, v17
    v_lshl_add_u32 v13, v8, 6, v27
    v_lshrrev_b32 v5, 1, v17
    v_lshrrev_b32 v8, 10, v18
    v_lshl_add_u32 v14, v8, 6, v27
    v_lshrrev_b32 v6, 1, v18
    v_lshrrev_b32 v8, 10, v19
    v_lshl_add_u32 v15, v8, 6, v27
    v_lshrrev_b32 v7, 1, v19
    v_add_u32 v8, s78, v2
    v_add_u32 v0, 0x10000, v8
    v_add_u32 v3, 0x20000, v8
    s_sub_u32 s56, s45, 1
    s_and_b32 s56, s56, 3
    s_mul_i32 s56, s56, 5120
    s_add_u32 s56, s56, 0x2000
    v_add_u32 v9, s56, v2
    s_sub_u32 s56, s45, 2
    s_and_b32 s56, s56, 3
    s_mul_i32 s56, s56, 5120
    s_add_u32 s56, s56, 0x7000
    v_add_u32 v10, s56, v2
    s_sub_u32 s56, s45, 3
    s_and_b32 s56, s56, 3
    s_mul_i32 s56, s56, 5120
    s_add_u32 s56, s56, 0xc000
    v_add_u32 v11, s56, v2
    s_mov_b32 s28, s20
    s_and_b32 s29, s21, 0xffff
    s_mov_b32 s30, 0x280000
    s_mov_b32 s31, 0x20000
    v_mul_u32_u24 v22, 1280, v26
    v_lshrrev_b32 v25, 4, v1
    v_lshl_add_u32 v22, v25, 3, v22
    s_lshl_b32 s67, s48, 2
    s_add_u32 s67, s67, s45
    s_mul_i32 s67, s67, 20480
    s_mul_i32 s57, s49, 160
    s_add_u32 s67, s67, s57
    s_mov_b32 s60, 20000
SP_2:
    s_waitcnt lgkmcnt(0)
    s_xor_b64 s[4:5], s[4:5], s[50:51]
    s_xor_b64 s[6:7], s[6:7], s[50:51]
    s_xor_b64 s[8:9], s[8:9], s[50:51]
    s_xor_b64 s[10:11], s[10:11], s[50:51]
    s_xor_b64 s[12:13], s[12:13], s[50:51]
    s_xor_b64 s[14:15], s[14:15], s[50:51]
    s_xor_b64 s[16:17], s[16:17], s[50:51]
    s_xor_b64 s[18:19], s[18:19], s[50:51]
    s_or_b64 s[4:5], s[4:5], s[6:7]
    s_or_b64 s[4:5], s[4:5], s[8:9]
    s_or_b64 s[4:5], s[4:5], s[10:11]
    s_or_b64 s[4:5], s[4:5], s[12:13]
    s_or_b64 s[4:5], s[4:5], s[14:15]
    s_or_b64 s[4:5], s[4:5], s[16:17]
    s_or_b64 s[4:5], s[4:5], s[18:19]
    s_cbranch_scc0 SP_2_OK
    s_sub_u32 s60, s60, 1
    s_cbranch_scc1 SP_2_OK
    s_buffer_load_dwordx16 s[4:19], s[32:35], s75 offset:0 glc
    s_branch SP_2
SP_2_OK:
    s_add_u32 s57, s79, 0
    s_and_b32 s57, s57, 3
    s_mul_i32 s57, s57, 16384
    s_add_u32 s57, s57, s74
    buffer_load_dwordx4 v[112:115], v16, s[32:35], s57 offen
    buffer_load_dwordx4 v[116:119], v17, s[32:35], s57 offen
    buffer_load_dwordx4 v[120:123], v18, s[32:35], s57 offen
    buffer_load_dwordx4 v[124:127], v19, s[32:35], s57 offen
    s_add_u32 s57, s79, 1
    s_and_b32 s57, s57, 3
    s_mul_i32 s57, s57, 16384
    s_add_u32 s57, s57, s74
    buffer_load_dwordx4 v[128:131], v16, s[32:35], s57 offen
    buffer_load_dwordx4 v[132:135], v17, s[32:35], s57 offen
    buffer_load_dwordx4 v[136:139], v18, s[32:35], s57 offen
    buffer_load_dwordx4 v[140:143], v19, s[32:35], s57 offen
    s_add_u32 s57, s79, 2
    s_and_b32 s57, s57, 3
    s_mul_i32 s57, s57, 16384
    s_add_u32 s57, s57, s74
    buffer_load_dwordx4 v[144:147], v16, s[32:35], s57 offen
    buffer_load_dwordx4 v[148:151], v17, s[32:35], s57 offen
    buffer_load_dwordx4 v[152:155], v18, s[32:35], s57 offen
    buffer_load_dwordx4 v[156:159], v19, s[32:35], s57 offen
    s_add_u32 s57, s79, 3
    s_and_b32 s57, s57, 3
    s_mul_i32 s57, s57, 16384
    s_add_u32 s57, s57, s74
    buffer_load_dwordx4 v[160:163], v16, s[32:35], s57 offen
    buffer_load_dwordx4 v[164:167], v17, s[32:35], s57 offen
    buffer_load_dwordx4 v[168:171], v18, s[32:35], s57 offen
    buffer_load_dwordx4 v[172:175], v19, s[32:35], s57 offen
    s_setprio 0
    s_cmp_eq_u32 s80, 1
    s_cbranch_scc1 FBS_3
    s_waitcnt vmcnt(0)
    s_mul_i32 s56, s49, 5
    s_add_u32 s57, s56, 4
    s_lshr_b32 s56, s56, 3
    s_lshr_b32 s57, s57, 3
    s_lshl_b32 s56, s56, 9
    s_lshl_b32 s57, s57, 9
    v_mov_b32 v176, s56
    v_mov_b32 v177, s57
    v_cmp_gt_u32 vcc, 32, v1
    s_nop 1
    v_cndmask_b32 v176, v177, v176, vcc
    v_and_b32 v177, 31, v1
    v_lshl_add_u32 v176, v177, 4, v176
    v_mov_b32 v178, 0x7ff00000
    v_cmp_gt_u32 vcc, 19, v177
    s_nop 1
    v_cndmask_b32 v180, v178, v176, vcc
    buffer_load_dwordx4 v[176:179], v180, s[32:35], s77 offen offset:0 sc1
    s_waitcnt vmcnt(0)
    s_mov_b32 s60, 20000
POLL_4:
    v_cmp_eq_u32 s[58:59], s50, v176
    v_cmp_eq_u32 vcc, s50, v177
    s_nop 1
    s_and_b64 s[58:59], s[58:59], vcc
    v_cmp_eq_u32 vcc, s50, v178
    s_nop 1
    s_and_b64 s[58:59], s[58:59], vcc
    v_cmp_eq_u32 vcc, s50, v179
    s_nop 1
    s_and_b64 s[58:59], s[58:59], vcc
    s_orn2_b32 s58, s58, 0x7ffff
    s_orn2_b32 s59, s59, 0x7ffff
    s_and_b32 s58, s58, s59
    s_cmp_eq_u32 s58, -1
    s_cbranch_scc1 POLL_4_OK
    s_sub_u32 s60, s60, 1
    s_cmp_eq_u32 s60, 0
    s_cbranch_scc1 POLL_4_OK
    buffer_load_dwordx4 v[176:179], v180, s[32:35], s77 offen offset:0 sc1
    s_waitcnt vmcnt(0)
    s_branch POLL_4
POLL_4_OK:
    s_add_u32 s61, s79, 0
    s_and_b32 s61, s61, 3
    s_mul_i32 s61, s61, 20480
    s_add_u32 s61, s61, s76
    buffer_load_dwordx4 v[176:179], v2, s[32:35], s61 offen offset:0
    buffer_load_dwordx4 v[180:183], v2, s[32:35], s61 offen offset:1024
    buffer_load_dwordx4 v[184:187], v2, s[32:35], s61 offen offset:2048
    buffer_load_dwordx4 v[188:191], v2, s[32:35], s61 offen offset:3072
    s_add_u32 s61, s61, 4096
    buffer_load_dwordx4 v[192:195], v2, s[32:35], s61 offen offset:0
    s_add_u32 s61, s79, 1
    s_and_b32 s61, s61, 3
    s_mul_i32 s61, s61, 20480
    s_add_u32 s61, s61, s76
    buffer_load_dwordx4 v[196:199], v2, s[32:35], s61 offen offset:0
    buffer_load_dwordx4 v[200:203], v2, s[32:35], s61 offen offset:1024
    buffer_load_dwordx4 v[204:207], v2, s[32:35], s61 offen offset:2048
    buffer_load_dwordx4 v[208:211], v2, s[32:35], s61 offen offset:3072
    s_add_u32 s61, s61, 4096
    buffer_load_dwordx4 v[212:215], v2, s[32:35], s61 offen offset:0
    s_add_u32 s61, s79, 2
    s_and_b32 s61, s61, 3
    s_mul_i32 s61, s61, 20480
    s_add_u32 s61, s61, s76
    buffer_load_dwordx4 v[216:219], v2, s[32:35], s61 offen offset:0
    buffer_load_dwordx4 v[220:223], v2, s[32:35], s61 offen offset:1024
    buffer_load_dwordx4 v[224:227], v2, s[32:35], s61 offen offset:2048
    buffer_load_dwordx4 v[228:231], v2, s[32:35], s61 offen offset:3072
    s_add_u32 s61, s61, 4096
    buffer_load_dwordx4 v[232:235], v2, s[32:35], s61 offen offset:0
    s_add_u32 s61, s79, 3
    s_and_b32 s61, s61, 3
    s_mul_i32 s61, s61, 20480
    s_add_u32 s61, s61, s76
    buffer_load_dwordx4 v[236:239], v2, s[32:35], s61 offen offset:0
    buffer_load_dwordx4 v[240:243], v2, s[32:35], s61 offen offset:1024
    buffer_load_dwordx4 v[244:247], v2, s[32:35], s61 offen offset:2048
    buffer_load_dwordx4 v[248:251], v2, s[32:35], s61 offen offset:3072
    s_add_u32 s61, s61, 4096
    buffer_load_dwordx4 v[252:255], v2, s[32:35], s61 offen offset:0
    s_waitcnt vmcnt(0)
FBS_3:
    s_mov_b32 s60, 160000
LW_5:
    ds_read_b32 v25, v20 offset:36
    s_waitcnt lgkmcnt(0)
    v_readfirstlane_b32 s58, v25
    s_nop 1
    s_cmp_ge_u32 s58, 4
    s_nop 0
    s_cbranch_scc1 LW_5_OK
    s_sub_u32 s60, s60, 1
    s_cmp_lg_u32 s60, 0
    s_cbranch_scc1 LW_5
LW_5_OK:
    s_add_u32 m0, s78, 0xc000
    s_add_u32 s61, s79, 0
    s_and_b32 s61, s61, 3
    s_mul_i32 s61, s61, 20480
    s_add_u32 s61, s61, s76
    s_add_u32 s61, s61, 0x14000
    buffer_load_dwordx4 v2, s[32:35], s61 offen lds
    s_add_u32 m0, s78, 0xc400
    s_add_u32 s61, s61, 1024
    buffer_load_dwordx4 v2, s[32:35], s61 offen lds
    s_add_u32 m0, s78, 0xc800
    s_add_u32 s61, s61, 1024
    buffer_load_dwordx4 v2, s[32:35], s61 offen lds
    s_add_u32 m0, s78, 0xcc00
    s_add_u32 s61, s61, 1024
    buffer_load_dwordx4 v2, s[32:35], s61 offen lds
    s_add_u32 m0, s78, 0xd000
    s_add_u32 s61, s61, 1024
    buffer_load_dwordx4 v2, s[32:35], s61 offen lds
    s_waitcnt lgkmcnt(0)
    s_buffer_load_dwordx16 s[4:19], s[32:35], s75 offset:64 glc
    s_waitcnt vmcnt(17)
    v_mfma_f32_16x16x32_bf16 v[32:35], v[176:179], v[112:115], 0
    s_add_u32 m0, s78, 0x2000
    s_add_u32 s61, s79, 1
    s_and_b32 s61, s61, 3
    v_mfma_f32_16x16x32_bf16 v[52:55], v[176:179], v[116:119], 0
    s_mul_i32 s61, s61, 20480
    s_add_u32 s61, s61, s76
    s_add_u32 s61, s61, 0x14000
    v_mfma_f32_16x16x32_bf16 v[72:75], v[176:179], v[120:123], 0
    buffer_load_dwordx4 v2, s[32:35], s61 offen lds
    s_add_u32 m0, s78, 0x2400
    v_mfma_f32_16x16x32_bf16 v[92:95], v[176:179], v[124:127], 0
    s_add_u32 s61, s61, 1024
    buffer_load_dwordx4 v2, s[32:35], s61 offen lds
    v_mfma_f32_16x16x32_bf16 v[36:39], v[180:183], v[112:115], 0
    s_add_u32 m0, s78, 0x2800
    s_add_u32 s61, s61, 1024
    v_mfma_f32_16x16x32_bf16 v[56:59], v[180:183], v[116:119], 0
    buffer_load_dwordx4 v2, s[32:35], s61 offen lds
    s_add_u32 m0, s78, 0x2c00
    v_mfma_f32_16x16x32_bf16 v[76:79], v[180:183], v[120:123], 0
    s_add_u32 s61, s61, 1024
    buffer_load_dwordx4 v2, s[32:35], s61 offen lds
    v_mfma_f32_16x16x32_bf16 v[96:99], v[180:183], v[124:127], 0
    s_add_u32 m0, s78, 0x3000
    s_add_u32 s61, s61, 1024
    v_mfma_f32_16x16x32_bf16 v[40:43], v[184:187], v[112:115], 0
    buffer_load_dwordx4 v2, s[32:35], s61 offen lds
    v_mfma_f32_16x16x32_bf16 v[60:63], v[184:187], v[116:119], 0
    v_mfma_f32_16x16x32_bf16 v[80:83], v[184:187], v[120:123], 0
    v_mfma_f32_16x16x32_bf16 v[100:103], v[184:187], v[124:127], 0
    v_mfma_f32_16x16x32_bf16 v[44:47], v[188:191], v[112:115], 0
    v_mfma_f32_16x16x32_bf16 v[64:67], v[188:191], v[116:119], 0
    v_mfma_f32_16x16x32_bf16 v[84:87], v[188:191], v[120:123], 0
    v_mfma_f32_16x16x32_bf16 v[104:107], v[188:191], v[124:127], 0
    v_mfma_f32_16x16x32_bf16 v[48:51], v[192:195], v[112:115], 0
    v_mfma_f32_16x16x32_bf16 v[68:71], v[192:195], v[116:119], 0
    v_mfma_f32_16x16x32_bf16 v[88:91], v[192:195], v[120:123], 0
    v_mfma_f32_16x16x32_bf16 v[108:111], v[192:195], v[124:127], 0
    s_mov_b32 s60, 20000
SP_6:
    s_waitcnt lgkmcnt(0)
    s_xor_b64 s[4:5], s[4:5], s[50:51]
    s_xor_b64 s[6:7], s[6:7], s[50:51]
    s_xor_b64 s[8:9], s[8:9], s[50:51]
    s_xor_b64 s[10:11], s[10:11], s[50:51]
    s_xor_b64 s[12:13], s[12:13], s[50:51]
    s_xor_b64 s[14:15], s[14:15], s[50:51]
    s_xor_b64 s[16:17], s[16:17], s[50:51]
    s_xor_b64 s[18:19], s[18:19], s[50:51]
    s_or_b64 s[4:5], s[4:5], s[6:7]
    s_or_b64 s[4:5], s[4:5], s[8:9]
    s_or_b64 s[4:5], s[4:5], s[10:11]
    s_or_b64 s[4:5], s[4:5], s[12:13]
    s_or_b64 s[4:5], s[4:5], s[14:15]
    s_or_b64 s[4:5], s[4:5], s[16:17]
    s_or_b64 s[4:5], s[4:5], s[18:19]
    s_cbranch_scc0 SP_6_OK
    s_sub_u32 s60, s60, 1
    s_cbranch_scc1 SP_6_OK
    s_buffer_load_dwordx16 s[4:19], s[32:35], s75 offset:64 glc
    s_branch SP_6
SP_6_OK:
    s_add_u32 s57, s79, 0
    s_and_b32 s57, s57, 3
    s_mul_i32 s57, s57, 16384
    s_add_u32 s57, s57, s74
    s_add_u32 s57, s57, 0x10000
    buffer_load_dwordx4 v[112:115], v16, s[32:35], s57 offen
    buffer_load_dwordx4 v[116:119], v17, s[32:35], s57 offen
    buffer_load_dwordx4 v[120:123], v18, s[32:35], s57 offen
    buffer_load_dwordx4 v[124:127], v19, s[32:35], s57 offen
    s_waitcnt lgkmcnt(0)
    s_mov_b32 s60, 160000
LW_7:
    ds_read_b32 v25, v20 offset:72
    s_waitcnt lgkmcnt(0)
    v_readfirstlane_b32 s58, v25
    s_nop 1
    s_cmp_ge_u32 s58, 4
    s_nop 0
    s_cbranch_scc1 LW_7_OK
    s_sub_u32 s60, s60, 1
    s_cmp_lg_u32 s60, 0
    s_cbranch_scc1 LW_7
LW_7_OK:
    s_waitcnt vmcnt(22)
    v_mfma_f32_16x16x32_bf16 v[32:35], v[196:199], v[128:131], v[32:35]
    s_add_u32 m0, s78, 0x17000
    s_add_u32 s61, s79, 2
    s_and_b32 s61, s61, 3
    v_mfma_f32_16x16x32_bf16 v[52:55], v[196:199], v[132:135], v[52:55]
    s_mul_i32 s61, s61, 20480
    s_add_u32 s61, s61, s76
    s_add_u32 s61, s61, 0x14000
    v_mfma_f32_16x16x32_bf16 v[72:75], v[196:199], v[136:139], v[72:75]
    buffer_load_dwordx4 v2, s[32:35], s61 offen lds
    s_add_u32 m0, s78, 0x17400
    v_mfma_f32_16x16x32_bf16 v[92:95], v[196:199], v[140:143], v[92:95]
    s_add_u32 s61, s61, 1024
    buffer_load_dwordx4 v2, s[32:35], s61 offen lds
    v_mfma_f32_16x16x32_bf16 v[36:39], v[200:203], v[128:131], v[36:39]
    s_add_u32 m0, s78, 0x17800
    s_add_u32 s61, s61, 1024
    v_mfma_f32_16x16x32_bf16 v[56:59], v[200:203], v[132:135], v[56:59]
    buffer_load_dwordx4 v2, s[32:35], s61 offen lds
    s_add_u32 m0, s78, 0x17c00
    v_mfma_f32_16x16x32_bf16 v[76:79], v[200:203], v[136:139], v[76:79]
    s_add_u32 s61, s61, 1024
    buffer_load_dwordx4 v2, s[32:35], s61 offen lds
    v_mfma_f32_16x16x32_bf16 v[96:99], v[200:203], v[140:143], v[96:99]
    s_add_u32 m0, s78, 0x18000
    s_add_u32 s61, s61, 1024
    v_mfma_f32_16x16x32_bf16 v[40:43], v[204:207], v[128:131], v[40:43]
    buffer_load_dwordx4 v2, s[32:35], s61 offen lds
    v_mfma_f32_16x16x32_bf16 v[60:63], v[204:207], v[132:135], v[60:63]
    v_mfma_f32_16x16x32_bf16 v[80:83], v[204:207], v[136:139], v[80:83]
    v_mfma_f32_16x16x32_bf16 v[100:103], v[204:207], v[140:143], v[100:103]
    v_mfma_f32_16x16x32_bf16 v[44:47], v[208:211], v[128:131], v[44:47]
    v_mfma_f32_16x16x32_bf16 v[64:67], v[208:211], v[132:135], v[64:67]
    v_mfma_f32_16x16x32_bf16 v[84:87], v[208:211], v[136:139], v[84:87]
    v_mfma_f32_16x16x32_bf16 v[104:107], v[208:211], v[140:143], v[104:107]
    v_mfma_f32_16x16x32_bf16 v[48:51], v[212:215], v[128:131], v[48:51]
    v_mfma_f32_16x16x32_bf16 v[68:71], v[212:215], v[132:135], v[68:71]
    v_mfma_f32_16x16x32_bf16 v[88:91], v[212:215], v[136:139], v[88:91]
    v_mfma_f32_16x16x32_bf16 v[108:111], v[212:215], v[140:143], v[108:111]
    s_add_u32 s57, s79, 1
    s_and_b32 s57, s57, 3
    s_mul_i32 s57, s57, 16384
    s_add_u32 s57, s57, s74
    s_add_u32 s57, s57, 0x10000
    buffer_load_dwordx4 v[128:131], v16, s[32:35], s57 offen
    buffer_load_dwordx4 v[132:135], v17, s[32:35], s57 offen
    buffer_load_dwordx4 v[136:139], v18, s[32:35], s57 offen
    buffer_load_dwordx4 v[140:143], v19, s[32:35], s57 offen
    s_waitcnt lgkmcnt(0)
    s_mov_b32 s60, 160000
LW_8:
    ds_read_b32 v25, v20 offset:76
    s_waitcnt lgkmcnt(0)
    v_readfirstlane_b32 s58, v25
    s_nop 1
    s_cmp_ge_u32 s58, 4
    s_nop 0
    s_cbranch_scc1 LW_8_OK
    s_sub_u32 s60, s60, 1
    s_cmp_lg_u32 s60, 0
    s_cbranch_scc1 LW_8
LW_8_OK:
    s_waitcnt vmcnt(27)
    v_mfma_f32_16x16x32_bf16 v[32:35], v[216:219], v[144:147], v[32:35]
    s_add_u32 m0, s78, 0x1c000
    s_add_u32 s61, s79, 3
    s_and_b32 s61, s61, 3
    v_mfma_f32_16x16x32_bf16 v[52:55], v[216:219], v[148:151], v[52:55]
    s_mul_i32 s61, s61, 20480
    s_add_u32 s61, s61, s76
    s_add_u32 s61, s61, 0x14000
    v_mfma_f32_16x16x32_bf16 v[72:75], v[216:219], v[152:155], v[72:75]
    buffer_load_dwordx4 v2, s[32:35], s61 offen lds
    s_add_u32 m0, s78, 0x1c400
    v_mfma_f32_16x16x32_bf16 v[92:95], v[216:219], v[156:159], v[92:95]
    s_add_u32 s61, s61, 1024
    buffer_load_dwordx4 v2, s[32:35], s61 offen lds
    v_mfma_f32_16x16x32_bf16 v[36:39], v[220:223], v[144:147], v[36:39]
    s_add_u32 m0, s78, 0x1c800
    s_add_u32 s61, s61, 1024
    v_mfma_f32_16x16x32_bf16 v[56:59], v[220:223], v[148:151], v[56:59]
    buffer_load_dwordx4 v2, s[32:35], s61 offen lds
    s_add_u32 m0, s78, 0x1cc00
    v_mfma_f32_16x16x32_bf16 v[76:79], v[220:223], v[152:155], v[76:79]
    s_add_u32 s61, s61, 1024
    buffer_load_dwordx4 v2, s[32:35], s61 offen lds
    v_mfma_f32_16x16x32_bf16 v[96:99], v[220:223], v[156:159], v[96:99]
    s_add_u32 m0, s78, 0x1d000
    s_add_u32 s61, s61, 1024
    v_mfma_f32_16x16x32_bf16 v[40:43], v[224:227], v[144:147], v[40:43]
    buffer_load_dwordx4 v2, s[32:35], s61 offen lds
    v_mfma_f32_16x16x32_bf16 v[60:63], v[224:227], v[148:151], v[60:63]
    v_mfma_f32_16x16x32_bf16 v[80:83], v[224:227], v[152:155], v[80:83]
    v_mfma_f32_16x16x32_bf16 v[100:103], v[224:227], v[156:159], v[100:103]
    v_mfma_f32_16x16x32_bf16 v[44:47], v[228:231], v[144:147], v[44:47]
    v_mfma_f32_16x16x32_bf16 v[64:67], v[228:231], v[148:151], v[64:67]
    v_mfma_f32_16x16x32_bf16 v[84:87], v[228:231], v[152:155], v[84:87]
    v_mfma_f32_16x16x32_bf16 v[104:107], v[228:231], v[156:159], v[104:107]
    v_mfma_f32_16x16x32_bf16 v[48:51], v[232:235], v[144:147], v[48:51]
    v_mfma_f32_16x16x32_bf16 v[68:71], v[232:235], v[148:151], v[68:71]
    v_mfma_f32_16x16x32_bf16 v[88:91], v[232:235], v[152:155], v[88:91]
    v_mfma_f32_16x16x32_bf16 v[108:111], v[232:235], v[156:159], v[108:111]
    s_add_u32 s57, s79, 2
    s_and_b32 s57, s57, 3
    s_mul_i32 s57, s57, 16384
    s_add_u32 s57, s57, s74
    s_add_u32 s57, s57, 0x10000
    buffer_load_dwordx4 v[144:147], v16, s[32:35], s57 offen
    buffer_load_dwordx4 v[148:151], v17, s[32:35], s57 offen
    buffer_load_dwordx4 v[152:155], v18, s[32:35], s57 offen
    buffer_load_dwordx4 v[156:159], v19, s[32:35], s57 offen
    s_waitcnt lgkmcnt(0)
    s_waitcnt vmcnt(27)
    v_mfma_f32_16x16x32_bf16 v[32:35], v[236:239], v[160:163], v[32:35]
    ds_read_b128 v[176:179], v8 offset:49152
    v_mfma_f32_16x16x32_bf16 v[52:55], v[236:239], v[164:167], v[52:55]
    ds_read_b128 v[180:183], v8 offset:50176
    v_mfma_f32_16x16x32_bf16 v[72:75], v[236:239], v[168:171], v[72:75]
    ds_read_b128 v[184:187], v8 offset:51200
    v_mfma_f32_16x16x32_bf16 v[92:95], v[236:239], v[172:175], v[92:95]
    ds_read_b128 v[188:191], v8 offset:52224
    v_mfma_f32_16x16x32_bf16 v[36:39], v[240:243], v[160:163], v[36:39]
    ds_read_b128 v[192:195], v8 offset:53248
    v_mfma_f32_16x16x32_bf16 v[56:59], v[240:243], v[164:167], v[56:59]
    v_mfma_f32_16x16x32_bf16 v[76:79], v[240:243], v[168:171], v[76:79]
    v_mfma_f32_16x16x32_bf16 v[96:99], v[240:243], v[172:175], v[96:99]
    v_mfma_f32_16x16x32_bf16 v[40:43], v[244:247], v[160:163], v[40:43]
    v_mfma_f32_16x16x32_bf16 v[60:63], v[244:247], v[164:167], v[60:63]
    v_mfma_f32_16x16x32_bf16 v[80:83], v[244:247], v[168:171], v[80:83]
    v_mfma_f32_16x16x32_bf16 v[100:103], v[244:247], v[172:175], v[100:103]
    v_mfma_f32_16x16x32_bf16 v[44:47], v[248:251], v[160:163], v[44:47]
    v_mfma_f32_16x16x32_bf16 v[64:67], v[248:251], v[164:167], v[64:67]
    v_mfma_f32_16x16x32_bf16 v[84:87], v[248:251], v[168:171], v[84:87]
    v_mfma_f32_16x16x32_bf16 v[104:107], v[248:251], v[172:175], v[104:107]
    v_mfma_f32_16x16x32_bf16 v[48:51], v[252:255], v[160:163], v[48:51]
    v_mfma_f32_16x16x32_bf16 v[68:71], v[252:255], v[164:167], v[68:71]
    v_mfma_f32_16x16x32_bf16 v[88:91], v[252:255], v[168:171], v[88:91]
    v_mfma_f32_16x16x32_bf16 v[108:111], v[252:255], v[172:175], v[108:111]
    s_add_u32 s57, s79, 3
    s_and_b32 s57, s57, 3
    s_mul_i32 s57, s57, 16384
    s_add_u32 s57, s57, s74
    s_add_u32 s57, s57, 0x10000
    buffer_load_dwordx4 v[160:163], v16, s[32:35], s57 offen
    buffer_load_dwordx4 v[164:167], v17, s[32:35], s57 offen
    buffer_load_dwordx4 v[168:171], v18, s[32:35], s57 offen
    buffer_load_dwordx4 v[172:175], v19, s[32:35], s57 offen
    s_waitcnt lgkmcnt(0)
    s_waitcnt vmcnt(22)
    v_mfma_f32_16x16x32_bf16 v[32:35], v[176:179], v[112:115], v[32:35]
    ds_read_b128 v[196:199], v8 offset:8192
    s_add_u32 m0, s78, 0xc000
    v_mfma_f32_16x16x32_bf16 v[52:55], v[176:179], v[116:119], v[52:55]
    ds_read_b128 v[200:203], v8 offset:9216
    s_add_u32 s61, s79, 0
    v_mfma_f32_16x16x32_bf16 v[72:75], v[176:179], v[120:123], v[72:75]
    ds_read_b128 v[204:207], v8 offset:10240
    s_and_b32 s61, s61, 3
    v_mfma_f32_16x16x32_bf16 v[92:95], v[176:179], v[124:127], v[92:95]
    ds_read_b128 v[208:211], v8 offset:11264
    s_mul_i32 s61, s61, 20480
    v_mfma_f32_16x16x32_bf16 v[36:39], v[180:183], v[112:115], v[36:39]
    ds_read_b128 v[212:215], v8 offset:12288
    s_add_u32 s61, s61, s76
    v_mfma_f32_16x16x32_bf16 v[56:59], v[180:183], v[116:119], v[56:59]
    s_add_u32 s61, s61, 0x28000
    buffer_load_dwordx4 v2, s[32:35], s61 offen lds
    v_mfma_f32_16x16x32_bf16 v[76:79], v[180:183], v[120:123], v[76:79]
    s_add_u32 m0, s78, 0xc400
    s_add_u32 s61, s61, 1024
    v_mfma_f32_16x16x32_bf16 v[96:99], v[180:183], v[124:127], v[96:99]
    buffer_load_dwordx4 v2, s[32:35], s61 offen lds
    s_add_u32 m0, s78, 0xc800
    v_mfma_f32_16x16x32_bf16 v[40:43], v[184:187], v[112:115], v[40:43]
    s_add_u32 s61, s61, 1024
    buffer_load_dwordx4 v2, s[32:35], s61 offen lds
    v_mfma_f32_16x16x32_bf16 v[60:63], v[184:187], v[116:119], v[60:63]
    s_add_u32 m0, s78, 0xcc00
    s_add_u32 s61, s61, 1024
    v_mfma_f32_16x16x32_bf16 v[80:83], v[184:187], v[120:123], v[80:83]
    buffer_load_dwordx4 v2, s[32:35], s61 offen lds
    s_add_u32 m0, s78, 0xd000
    v_mfma_f32_16x16x32_bf16 v[100:103], v[184:187], v[124:127], v[100:103]
    s_add_u32 s61, s61, 1024
    buffer_load_dwordx4 v2, s[32:35], s61 offen lds
    v_mfma_f32_16x16x32_bf16 v[44:47], v[188:191], v[112:115], v[44:47]
    v_mfma_f32_16x16x32_bf16 v[64:67], v[188:191], v[116:119], v[64:67]
    v_mfma_f32_16x16x32_bf16 v[84:87], v[188:191], v[120:123], v[84:87]
    v_mfma_f32_16x16x32_bf16 v[104:107], v[188:191], v[124:127], v[104:107]
    v_mfma_f32_16x16x32_bf16 v[48:51], v[192:195], v[112:115], v[48:51]
    v_mfma_f32_16x16x32_bf16 v[68:71], v[192:195], v[116:119], v[68:71]
    v_mfma_f32_16x16x32_bf16 v[88:91], v[192:195], v[120:123], v[88:91]
    v_mfma_f32_16x16x32_bf16 v[108:111], v[192:195], v[124:127], v[108:111]
    s_waitcnt lgkmcnt(0)
    s_mov_b32 s60, 160000
LW_9:
    ds_read_b32 v25, v20 offset:56
    s_waitcnt lgkmcnt(0)
    v_readfirstlane_b32 s58, v25
    s_nop 1
    s_cmp_ge_u32 s58, 4
    s_nop 0
    s_cbranch_scc1 LW_9_OK
    s_sub_u32 s60, s60, 1
    s_cmp_lg_u32 s60, 0
    s_cbranch_scc1 LW_9
LW_9_OK:
    s_waitcnt vmcnt(18)
    v_mfma_f32_16x16x32_bf16 v[32:35], v[196:199], v[128:131], v[32:35]
    ds_read_b128 v[176:179], v0 offset:28672
    s_add_u32 m0, s78, 0x2000
    v_mfma_f32_16x16x32_bf16 v[52:55], v[196:199], v[132:135], v[52:55]
    ds_read_b128 v[180:183], v0 offset:29696
    s_add_u32 s61, s79, 1
    v_mfma_f32_16x16x32_bf16 v[72:75], v[196:199], v[136:139], v[72:75]
    ds_read_b128 v[184:187], v0 offset:30720
    s_and_b32 s61, s61, 3
    v_mfma_f32_16x16x32_bf16 v[92:95], v[196:199], v[140:143], v[92:95]
    ds_read_b128 v[188:191], v0 offset:31744
    s_mul_i32 s61, s61, 20480
    v_mfma_f32_16x16x32_bf16 v[36:39], v[200:203], v[128:131], v[36:39]
    ds_read_b128 v[192:195], v0 offset:32768
    s_add_u32 s61, s61, s76
    v_mfma_f32_16x16x32_bf16 v[56:59], v[200:203], v[132:135], v[56:59]
    s_add_u32 s61, s61, 0x28000
    buffer_load_dwordx4 v2, s[32:35], s61 offen lds
    v_mfma_f32_16x16x32_bf16 v[76:79], v[200:203], v[136:139], v[76:79]
    s_add_u32 m0, s78, 0x2400
    s_add_u32 s61, s61, 1024
    v_mfma_f32_16x16x32_bf16 v[96:99], v[200:203], v[140:143], v[96:99]
    buffer_load_dwordx4 v2, s[32:35], s61 offen lds
    s_add_u32 m0, s78, 0x2800
    s_add_u32 s61, s61, 1024
    v_mfma_f32_16x16x32_bf16 v[40:43], v[204:207], v[128:131], v[40:43]
    buffer_load_dwordx4 v2, s[32:35], s61 offen lds
    s_add_u32 m0, s78, 0x2c00
    v_mfma_f32_16x16x32_bf16 v[60:63], v[204:207], v[132:135], v[60:63]
    s_add_u32 s61, s61, 1024
    v_mfma_f32_16x16x32_bf16 v[80:83], v[204:207], v[136:139], v[80:83]
    buffer_load_dwordx4 v2, s[32:35], s61 offen lds
    s_add_u32 m0, s78, 0x3000
    s_add_u32 s61, s61, 1024
    v_mfma_f32_16x16x32_bf16 v[100:103], v[204:207], v[140:143], v[100:103]
    buffer_load_dwordx4 v2, s[32:35], s61 offen lds
    s_add_u32 m0, s78, 0x12000
    v_mfma_f32_16x16x32_bf16 v[44:47], v[208:211], v[128:131], v[44:47]
    s_add_u32 s61, s79, 2
    s_and_b32 s61, s61, 3
    s_mul_i32 s61, s61, 20480
    v_mfma_f32_16x16x32_bf16 v[64:67], v[208:211], v[132:135], v[64:67]
    s_add_u32 s61, s61, s76
    s_add_u32 s61, s61, 0x28000
    v_mfma_f32_16x16x32_bf16 v[84:87], v[208:211], v[136:139], v[84:87]
    buffer_load_dwordx4 v2, s[32:35], s61 offen lds
    s_add_u32 m0, s78, 0x12400
    s_add_u32 s61, s61, 1024
    v_mfma_f32_16x16x32_bf16 v[104:107], v[208:211], v[140:143], v[104:107]
    buffer_load_dwordx4 v2, s[32:35], s61 offen lds
    s_add_u32 m0, s78, 0x12800
    v_mfma_f32_16x16x32_bf16 v[48:51], v[212:215], v[128:131], v[48:51]
    s_add_u32 s61, s61, 1024
    v_mfma_f32_16x16x32_bf16 v[68:71], v[212:215], v[132:135], v[68:71]
    buffer_load_dwordx4 v2, s[32:35], s61 offen lds
    s_add_u32 m0, s78, 0x12c00
    s_add_u32 s61, s61, 1024
    v_mfma_f32_16x16x32_bf16 v[88:91], v[212:215], v[136:139], v[88:91]
    buffer_load_dwordx4 v2, s[32:35], s61 offen lds
    s_add_u32 m0, s78, 0x13000
    v_mfma_f32_16x16x32_bf16 v[108:111], v[212:215], v[140:143], v[108:111]
    s_add_u32 s61, s61, 1024
    buffer_load_dwordx4 v2, s[32:35], s61 offen lds
    s_waitcnt lgkmcnt(0)
    s_waitcnt vmcnt(19)
    v_mfma_f32_16x16x32_bf16 v[32:35], v[176:179], v[144:147], v[32:35]
    ds_read_b128 v[196:199], v0 offset:49152
    s_add_u32 m0, s78, 0x7000
    v_mfma_f32_16x16x32_bf16 v[52:55], v[176:179], v[148:151], v[52:55]
    ds_read_b128 v[200:203], v0 offset:50176
    s_add_u32 s61, s79, 3
    v_mfma_f32_16x16x32_bf16 v[72:75], v[176:179], v[152:155], v[72:75]
    ds_read_b128 v[204:207], v0 offset:51200
    s_and_b32 s61, s61, 3
    v_mfma_f32_16x16x32_bf16 v[92:95], v[176:179], v[156:159], v[92:95]
    ds_read_b128 v[208:211], v0 offset:52224
    s_mul_i32 s61, s61, 20480
    v_mfma_f32_16x16x32_bf16 v[36:39], v[180:183], v[144:147], v[36:39]
    ds_read_b128 v[212:215], v0 offset:53248
    s_add_u32 s61, s61, s76
    v_mfma_f32_16x16x32_bf16 v[56:59], v[180:183], v[148:151], v[56:59]
    s_add_u32 s61, s61, 0x28000
    buffer_load_dwordx4 v2, s[32:35], s61 offen lds
    v_mfma_f32_16x16x32_bf16 v[76:79], v[180:183], v[152:155], v[76:79]
    s_add_u32 m0, s78, 0x7400
    s_add_u32 s61, s61, 1024
    v_mfma_f32_16x16x32_bf16 v[96:99], v[180:183], v[156:159], v[96:99]
    buffer_load_dwordx4 v2, s[32:35], s61 offen lds
    s_add_u32 m0, s78, 0x7800
    v_mfma_f32_16x16x32_bf16 v[40:43], v[184:187], v[144:147], v[40:43]
    s_add_u32 s61, s61, 1024
    buffer_load_dwordx4 v2, s[32:35], s61 offen lds
    v_mfma_f32_16x16x32_bf16 v[60:63], v[184:187], v[148:151], v[60:63]
    s_add_u32 m0, s78, 0x7c00
    s_add_u32 s61, s61, 1024
    v_mfma_f32_16x16x32_bf16 v[80:83], v[184:187], v[152:155], v[80:83]
    buffer_load_dwordx4 v2, s[32:35], s61 offen lds
    s_add_u32 m0, s78, 0x8000
    v_mfma_f32_16x16x32_bf16 v[100:103], v[184:187], v[156:159], v[100:103]
    s_add_u32 s61, s61, 1024
    buffer_load_dwordx4 v2, s[32:35], s61 offen lds
    v_mfma_f32_16x16x32_bf16 v[44:47], v[188:191], v[144:147], v[44:47]
    s_add_u32 m0, s78, 0x17000
    s_add_u32 s61, s76, 0x3c000
    v_mfma_f32_16x16x32_bf16 v[64:67], v[188:191], v[148:151], v[64:67]
    buffer_load_dwordx4 v2, s[32:35], s61 offen lds
    s_add_u32 m0, s78, 0x17400
    v_mfma_f32_16x16x32_bf16 v[84:87], v[188:191], v[152:155], v[84:87]
    s_add_u32 s61, s61, 1024
    buffer_load_dwordx4 v2, s[32:35], s61 offen lds
    v_mfma_f32_16x16x32_bf16 v[104:107], v[188:191], v[156:159], v[104:107]
    s_add_u32 m0, s78, 0x17800
    s_add_u32 s61, s61, 1024
    v_mfma_f32_16x16x32_bf16 v[48:51], v[192:195], v[144:147], v[48:51]
    buffer_load_dwordx4 v2, s[32:35], s61 offen lds
    s_add_u32 m0, s78, 0x17c00
    v_mfma_f32_16x16x32_bf16 v[68:71], v[192:195], v[148:151], v[68:71]
    s_add_u32 s61, s61, 1024
    buffer_load_dwordx4 v2, s[32:35], s61 offen lds
    v_mfma_f32_16x16x32_bf16 v[88:91], v[192:195], v[152:155], v[88:91]
    s_add_u32 m0, s78, 0x18000
    s_add_u32 s61, s61, 1024
    v_mfma_f32_16x16x32_bf16 v[108:111], v[192:195], v[156:159], v[108:111]
    buffer_load_dwordx4 v2, s[32:35], s61 offen lds
    s_waitcnt lgkmcnt(0)
    s_buffer_load_dwordx16 s[4:19], s[32:35], s75 offset:128 glc
    s_waitcnt vmcnt(20)
    v_mfma_f32_16x16x32_bf16 v[32:35], v[196:199], v[160:163], v[32:35]
    ds_read_b128 v[176:179], v8 offset:49152
    s_add_u32 m0, s78, 0x1c000
    v_mfma_f32_16x16x32_bf16 v[52:55], v[196:199], v[164:167], v[52:55]
    ds_read_b128 v[180:183], v8 offset:50176
    s_add_u32 s61, s76, 0x41000
    v_mfma_f32_16x16x32_bf16 v[72:75], v[196:199], v[168:171], v[72:75]
    ds_read_b128 v[184:187], v8 offset:51200
    s_cmp_lt_u32 s45, 2
    v_mfma_f32_16x16x32_bf16 v[92:95], v[196:199], v[172:175], v[92:95]
    ds_read_b128 v[188:191], v8 offset:52224
    s_cselect_b32 s61, s61, 0x7ff00000
    v_mfma_f32_16x16x32_bf16 v[36:39], v[200:203], v[160:163], v[36:39]
    ds_read_b128 v[192:195], v8 offset:53248
    v_mfma_f32_16x16x32_bf16 v[56:59], v[200:203], v[164:167], v[56:59]
    buffer_load_dwordx4 v2, s[32:35], s61 offen lds
    s_add_u32 m0, s78, 0x1c400
    v_mfma_f32_16x16x32_bf16 v[76:79], v[200:203], v[168:171], v[76:79]
    s_add_u32 s61, s61, 1024
    buffer_load_dwordx4 v2, s[32:35], s61 offen lds
    v_mfma_f32_16x16x32_bf16 v[96:99], v[200:203], v[172:175], v[96:99]
    s_add_u32 m0, s78, 0x1c800
    s_add_u32 s61, s61, 1024
    v_mfma_f32_16x16x32_bf16 v[40:43], v[204:207], v[160:163], v[40:43]
    buffer_load_dwordx4 v2, s[32:35], s61 offen lds
    s_add_u32 m0, s78, 0x1cc00
    v_mfma_f32_16x16x32_bf16 v[60:63], v[204:207], v[164:167], v[60:63]
    s_add_u32 s61, s61, 1024
    buffer_load_dwordx4 v2, s[32:35], s61 offen lds
    v_mfma_f32_16x16x32_bf16 v[80:83], v[204:207], v[168:171], v[80:83]
    s_add_u32 m0, s78, 0x1d000
    s_add_u32 s61, s61, 1024
    v_mfma_f32_16x16x32_bf16 v[100:103], v[204:207], v[172:175], v[100:103]
    buffer_load_dwordx4 v2, s[32:35], s61 offen lds
    v_mfma_f32_16x16x32_bf16 v[44:47], v[208:211], v[160:163], v[44:47]
    v_mfma_f32_16x16x32_bf16 v[64:67], v[208:211], v[164:167], v[64:67]
    v_mfma_f32_16x16x32_bf16 v[84:87], v[208:211], v[168:171], v[84:87]
    v_mfma_f32_16x16x32_bf16 v[104:107], v[208:211], v[172:175], v[104:107]
    v_mfma_f32_16x16x32_bf16 v[48:51], v[212:215], v[160:163], v[48:51]
    v_mfma_f32_16x16x32_bf16 v[68:71], v[212:215], v[164:167], v[68:71]
    v_mfma_f32_16x16x32_bf16 v[88:91], v[212:215], v[168:171], v[88:91]
    v_mfma_f32_16x16x32_bf16 v[108:111], v[212:215], v[172:175], v[108:111]
    s_mov_b32 s60, 20000
SP_10:
    s_waitcnt lgkmcnt(0)
    s_xor_b64 s[4:5], s[4:5], s[50:51]
    s_xor_b64 s[6:7], s[6:7], s[50:51]
    s_xor_b64 s[8:9], s[8:9], s[50:51]
    s_xor_b64 s[10:11], s[10:11], s[50:51]
    s_xor_b64 s[12:13], s[12:13], s[50:51]
    s_xor_b64 s[14:15], s[14:15], s[50:51]
    s_xor_b64 s[16:17], s[16:17], s[50:51]
    s_xor_b64 s[18:19], s[18:19], s[50:51]
    s_or_b64 s[4:5], s[4:5], s[6:7]
    s_or_b64 s[4:5], s[4:5], s[8:9]
    s_or_b64 s[4:5], s[4:5], s[10:11]
    s_or_b64 s[4:5], s[4:5], s[12:13]
    s_or_b64 s[4:5], s[4:5], s[14:15]
    s_or_b64 s[4:5], s[4:5], s[16:17]
    s_or_b64 s[4:5], s[4:5], s[18:19]
    s_cbranch_scc0 SP_10_OK
    s_sub_u32 s60, s60, 1
    s_cbranch_scc1 SP_10_OK
    s_buffer_load_dwordx16 s[4:19], s[32:35], s75 offset:128 glc
    s_branch SP_10
SP_10_OK:
    s_add_u32 s57, s79, 0
    s_and_b32 s57, s57, 3
    s_mul_i32 s57, s57, 16384
    s_add_u32 s57, s57, s74
    s_add_u32 s57, s57, 0x20000
    buffer_load_dwordx4 v[112:115], v16, s[32:35], s57 offen
    buffer_load_dwordx4 v[116:119], v17, s[32:35], s57 offen
    buffer_load_dwordx4 v[120:123], v18, s[32:35], s57 offen
    buffer_load_dwordx4 v[124:127], v19, s[32:35], s57 offen
    s_add_u32 s57, s79, 1
    s_and_b32 s57, s57, 3
    s_mul_i32 s57, s57, 16384
    s_add_u32 s57, s57, s74
    s_add_u32 s57, s57, 0x20000
    buffer_load_dwordx4 v[128:131], v16, s[32:35], s57 offen
    buffer_load_dwordx4 v[132:135], v17, s[32:35], s57 offen
    buffer_load_dwordx4 v[136:139], v18, s[32:35], s57 offen
    buffer_load_dwordx4 v[140:143], v19, s[32:35], s57 offen
    s_add_u32 s57, s79, 2
    s_and_b32 s57, s57, 3
    s_mul_i32 s57, s57, 16384
    s_add_u32 s57, s57, s74
    s_add_u32 s57, s57, 0x20000
    buffer_load_dwordx4 v[144:147], v16, s[32:35], s57 offen
    buffer_load_dwordx4 v[148:151], v17, s[32:35], s57 offen
    buffer_load_dwordx4 v[152:155], v18, s[32:35], s57 offen
    buffer_load_dwordx4 v[156:159], v19, s[32:35], s57 offen
    s_add_u32 s57, s79, 3
    s_and_b32 s57, s57, 3
    s_mul_i32 s57, s57, 16384
    s_add_u32 s57, s57, s74
    s_add_u32 s57, s57, 0x20000
    buffer_load_dwordx4 v[160:163], v16, s[32:35], s57 offen
    buffer_load_dwordx4 v[164:167], v17, s[32:35], s57 offen
    buffer_load_dwordx4 v[168:171], v18, s[32:35], s57 offen
    buffer_load_dwordx4 v[172:175], v19, s[32:35], s57 offen
    s_waitcnt lgkmcnt(0)
    s_waitcnt vmcnt(12)
    v_mfma_f32_16x16x32_bf16 v[32:35], v[176:179], v[112:115], v[32:35]
    ds_read_b128 v[196:199], v8 offset:8192
    s_add_u32 m0, s78, 0xc000
    v_mfma_f32_16x16x32_bf16 v[52:55], v[176:179], v[116:119], v[52:55]
    ds_read_b128 v[200:203], v8 offset:9216
    s_add_u32 s61, s79, 0
    v_mfma_f32_16x16x32_bf16 v[72:75], v[176:179], v[120:123], v[72:75]
    ds_read_b128 v[204:207], v8 offset:10240
    s_and_b32 s61, s61, 3
    v_mfma_f32_16x16x32_bf16 v[92:95], v[176:179], v[124:127], v[92:95]
    ds_read_b128 v[208:211], v8 offset:11264
    s_mul_i32 s61, s61, 20480
    v_mfma_f32_16x16x32_bf16 v[36:39], v[180:183], v[112:115], v[36:39]
    ds_read_b128 v[212:215], v8 offset:12288
    s_add_u32 s61, s61, s76
    v_mfma_f32_16x16x32_bf16 v[56:59], v[180:183], v[116:119], v[56:59]
    s_add_u32 s61, s61, 0x43800
    buffer_load_dwordx4 v2, s[32:35], s61 offen lds
    v_mfma_f32_16x16x32_bf16 v[76:79], v[180:183], v[120:123], v[76:79]
    s_add_u32 m0, s78, 0xc400
    s_add_u32 s61, s61, 1024
    v_mfma_f32_16x16x32_bf16 v[96:99], v[180:183], v[124:127], v[96:99]
    buffer_load_dwordx4 v2, s[32:35], s61 offen lds
    s_add_u32 m0, s78, 0xc800
    v_mfma_f32_16x16x32_bf16 v[40:43], v[184:187], v[112:115], v[40:43]
    s_add_u32 s61, s61, 1024
    buffer_load_dwordx4 v2, s[32:35], s61 offen lds
    v_mfma_f32_16x16x32_bf16 v[60:63], v[184:187], v[116:119], v[60:63]
    s_add_u32 m0, s78, 0xcc00
    s_add_u32 s61, s61, 1024
    v_mfma_f32_16x16x32_bf16 v[80:83], v[184:187], v[120:123], v[80:83]
    buffer_load_dwordx4 v2, s[32:35], s61 offen lds
    s_add_u32 m0, s78, 0xd000
    v_mfma_f32_16x16x32_bf16 v[100:103], v[184:187], v[124:127], v[100:103]
    s_add_u32 s61, s61, 1024
    buffer_load_dwordx4 v2, s[32:35], s61 offen lds
    v_mfma_f32_16x16x32_bf16 v[44:47], v[188:191], v[112:115], v[44:47]
    v_mfma_f32_16x16x32_bf16 v[64:67], v[188:191], v[116:119], v[64:67]
    v_mfma_f32_16x16x32_bf16 v[84:87], v[188:191], v[120:123], v[84:87]
    v_mfma_f32_16x16x32_bf16 v[104:107], v[188:191], v[124:127], v[104:107]
    v_mfma_f32_16x16x32_bf16 v[48:51], v[192:195], v[112:115], v[48:51]
    v_mfma_f32_16x16x32_bf16 v[68:71], v[192:195], v[116:119], v[68:71]
    v_mfma_f32_16x16x32_bf16 v[88:91], v[192:195], v[120:123], v[88:91]
    v_mfma_f32_16x16x32_bf16 v[108:111], v[192:195], v[124:127], v[108:111]
    s_waitcnt lgkmcnt(0)
    s_waitcnt vmcnt(13)
    v_mfma_f32_16x16x32_bf16 v[32:35], v[196:199], v[128:131], v[32:35]
    ds_read_b128 v[176:179], v0 offset:8192
    s_add_u32 m0, s78, 0x2000
    v_mfma_f32_16x16x32_bf16 v[52:55], v[196:199], v[132:135], v[52:55]
    ds_read_b128 v[180:183], v0 offset:9216
    s_add_u32 s61, s79, 1
    v_mfma_f32_16x16x32_bf16 v[72:75], v[196:199], v[136:139], v[72:75]
    ds_read_b128 v[184:187], v0 offset:10240
    s_and_b32 s61, s61, 3
    v_mfma_f32_16x16x32_bf16 v[92:95], v[196:199], v[140:143], v[92:95]
    ds_read_b128 v[188:191], v0 offset:11264
    s_mul_i32 s61, s61, 20480
    v_mfma_f32_16x16x32_bf16 v[36:39], v[200:203], v[128:131], v[36:39]
    ds_read_b128 v[192:195], v0 offset:12288
    s_add_u32 s61, s61, s76
    v_mfma_f32_16x16x32_bf16 v[56:59], v[200:203], v[132:135], v[56:59]
    s_add_u32 s61, s61, 0x43800
    buffer_load_dwordx4 v2, s[32:35], s61 offen lds
    v_mfma_f32_16x16x32_bf16 v[76:79], v[200:203], v[136:139], v[76:79]
    s_add_u32 m0, s78, 0x2400
    s_add_u32 s61, s61, 1024
    v_mfma_f32_16x16x32_bf16 v[96:99], v[200:203], v[140:143], v[96:99]
    buffer_load_dwordx4 v2, s[32:35], s61 offen lds
    s_add_u32 m0, s78, 0x2800
    v_mfma_f32_16x16x32_bf16 v[40:43], v[204:207], v[128:131], v[40:43]
    s_add_u32 s61, s61, 1024
    buffer_load_dwordx4 v2, s[32:35], s61 offen lds
    v_mfma_f32_16x16x32_bf16 v[60:63], v[204:207], v[132:135], v[60:63]
    s_add_u32 m0, s78, 0x2c00
    s_add_u32 s61, s61, 1024
    v_mfma_f32_16x16x32_bf16 v[80:83], v[204:207], v[136:139], v[80:83]
    buffer_load_dwordx4 v2, s[32:35], s61 offen lds
    s_add_u32 m0, s78, 0x3000
    v_mfma_f32_16x16x32_bf16 v[100:103], v[204:207], v[140:143], v[100:103]
    s_add_u32 s61, s61, 1024
    buffer_load_dwordx4 v2, s[32:35], s61 offen lds
    v_mfma_f32_16x16x32_bf16 v[44:47], v[208:211], v[128:131], v[44:47]
    v_mfma_f32_16x16x32_bf16 v[64:67], v[208:211], v[132:135], v[64:67]
    v_mfma_f32_16x16x32_bf16 v[84:87], v[208:211], v[136:139], v[84:87]
    v_mfma_f32_16x16x32_bf16 v[104:107], v[208:211], v[140:143], v[104:107]
    v_mfma_f32_16x16x32_bf16 v[48:51], v[212:215], v[128:131], v[48:51]
    v_mfma_f32_16x16x32_bf16 v[68:71], v[212:215], v[132:135], v[68:71]
    v_mfma_f32_16x16x32_bf16 v[88:91], v[212:215], v[136:139], v[88:91]
    v_mfma_f32_16x16x32_bf16 v[108:111], v[212:215], v[140:143], v[108:111]
    s_waitcnt lgkmcnt(0)
    s_buffer_load_dwordx16 s[4:19], s[32:35], s75 offset:192 glc
    s_waitcnt vmcnt(14)
    v_mfma_f32_16x16x32_bf16 v[32:35], v[176:179], v[144:147], v[32:35]
    ds_read_b128 v[196:199], v8 offset:28672
    s_add_u32 m0, s78, 0x12000
    v_mfma_f32_16x16x32_bf16 v[52:55], v[176:179], v[148:151], v[52:55]
    ds_read_b128 v[200:203], v8 offset:29696
    s_add_u32 s61, s79, 2
    v_mfma_f32_16x16x32_bf16 v[72:75], v[176:179], v[152:155], v[72:75]
    ds_read_b128 v[204:207], v8 offset:30720
    s_and_b32 s61, s61, 3
    v_mfma_f32_16x16x32_bf16 v[92:95], v[176:179], v[156:159], v[92:95]
    ds_read_b128 v[208:211], v8 offset:31744
    s_mul_i32 s61, s61, 20480
    v_mfma_f32_16x16x32_bf16 v[36:39], v[180:183], v[144:147], v[36:39]
    ds_read_b128 v[212:215], v8 offset:32768
    s_add_u32 s61, s61, s76
    v_mfma_f32_16x16x32_bf16 v[56:59], v[180:183], v[148:151], v[56:59]
    s_add_u32 s61, s61, 0x43800
    buffer_load_dwordx4 v2, s[32:35], s61 offen lds
    v_mfma_f32_16x16x32_bf16 v[76:79], v[180:183], v[152:155], v[76:79]
    s_add_u32 m0, s78, 0x12400
    s_add_u32 s61, s61, 1024
    v_mfma_f32_16x16x32_bf16 v[96:99], v[180:183], v[156:159], v[96:99]
    buffer_load_dwordx4 v2, s[32:35], s61 offen lds
    s_add_u32 m0, s78, 0x12800
    v_mfma_f32_16x16x32_bf16 v[40:43], v[184:187], v[144:147], v[40:43]
    s_add_u32 s61, s61, 1024
    buffer_load_dwordx4 v2, s[32:35], s61 offen lds
    v_mfma_f32_16x16x32_bf16 v[60:63], v[184:187], v[148:151], v[60:63]
    s_add_u32 m0, s78, 0x12c00
    s_add_u32 s61, s61, 1024
    v_mfma_f32_16x16x32_bf16 v[80:83], v[184:187], v[152:155], v[80:83]
    buffer_load_dwordx4 v2, s[32:35], s61 offen lds
    s_add_u32 m0, s78, 0x13000
    v_mfma_f32_16x16x32_bf16 v[100:103], v[184:187], v[156:159], v[100:103]
    s_add_u32 s61, s61, 1024
    buffer_load_dwordx4 v2, s[32:35], s61 offen lds
    v_mfma_f32_16x16x32_bf16 v[44:47], v[188:191], v[144:147], v[44:47]
    v_mfma_f32_16x16x32_bf16 v[64:67], v[188:191], v[148:151], v[64:67]
    v_mfma_f32_16x16x32_bf16 v[84:87], v[188:191], v[152:155], v[84:87]
    v_mfma_f32_16x16x32_bf16 v[104:107], v[188:191], v[156:159], v[104:107]
    v_mfma_f32_16x16x32_bf16 v[48:51], v[192:195], v[144:147], v[48:51]
    v_mfma_f32_16x16x32_bf16 v[68:71], v[192:195], v[148:151], v[68:71]
    v_mfma_f32_16x16x32_bf16 v[88:91], v[192:195], v[152:155], v[88:91]
    v_mfma_f32_16x16x32_bf16 v[108:111], v[192:195], v[156:159], v[108:111]
    s_mov_b32 s60, 20000
SP_11:
    s_waitcnt lgkmcnt(0)
    s_xor_b64 s[4:5], s[4:5], s[50:51]
    s_xor_b64 s[6:7], s[6:7], s[50:51]
    s_xor_b64 s[8:9], s[8:9], s[50:51]
    s_xor_b64 s[10:11], s[10:11], s[50:51]
    s_xor_b64 s[12:13], s[12:13], s[50:51]
    s_xor_b64 s[14:15], s[14:15], s[50:51]
    s_xor_b64 s[16:17], s[16:17], s[50:51]
    s_xor_b64 s[18:19], s[18:19], s[50:51]
    s_or_b64 s[4:5], s[4:5], s[6:7]
    s_or_b64 s[4:5], s[4:5], s[8:9]
    s_or_b64 s[4:5], s[4:5], s[10:11]
    s_or_b64 s[4:5], s[4:5], s[12:13]
    s_or_b64 s[4:5], s[4:5], s[14:15]
    s_or_b64 s[4:5], s[4:5], s[16:17]
    s_or_b64 s[4:5], s[4:5], s[18:19]
    s_cbranch_scc0 SP_11_OK
    s_sub_u32 s60, s60, 1
    s_cbranch_scc1 SP_11_OK
    s_buffer_load_dwordx16 s[4:19], s[32:35], s75 offset:192 glc
    s_branch SP_11
SP_11_OK:
    s_add_u32 s57, s74, 0x30000
    buffer_load_dwordx4 v[216:219], v16, s[32:35], s57 offen
    buffer_load_dwordx4 v[220:223], v17, s[32:35], s57 offen
    buffer_load_dwordx4 v[224:227], v18, s[32:35], s57 offen
    buffer_load_dwordx4 v[228:231], v19, s[32:35], s57 offen
    s_add_u32 s57, s74, 0x34000
    s_cmp_lt_u32 s45, 2
    s_cselect_b32 s57, s57, 0x7ff00000
    buffer_load_dwordx4 v[232:235], v16, s[32:35], s57 offen
    buffer_load_dwordx4 v[236:239], v17, s[32:35], s57 offen
    buffer_load_dwordx4 v[240:243], v18, s[32:35], s57 offen
    buffer_load_dwordx4 v[244:247], v19, s[32:35], s57 offen
    s_waitcnt lgkmcnt(0)
    s_buffer_load_dwordx16 s[4:19], s[32:35], s75 offset:320 glc
    s_waitcnt vmcnt(23)
    v_mfma_f32_16x16x32_bf16 v[32:35], v[196:199], v[160:163], v[32:35]
    ds_read_b128 v[176:179], v0 offset:28672
    s_add_u32 m0, s78, 0x7000
    v_mfma_f32_16x16x32_bf16 v[52:55], v[196:199], v[164:167], v[52:55]
    ds_read_b128 v[180:183], v0 offset:29696
    s_add_u32 s61, s79, 3
    v_mfma_f32_16x16x32_bf16 v[72:75], v[196:199], v[168:171], v[72:75]
    ds_read_b128 v[184:187], v0 offset:30720
    s_and_b32 s61, s61, 3
    v_mfma_f32_16x16x32_bf16 v[92:95], v[196:199], v[172:175], v[92:95]
    ds_read_b128 v[188:191], v0 offset:31744
    s_mul_i32 s61, s61, 20480
    v_mfma_f32_16x16x32_bf16 v[36:39], v[200:203], v[160:163], v[36:39]
    ds_read_b128 v[192:195], v0 offset:32768
    s_add_u32 s61, s61, s76
    v_mfma_f32_16x16x32_bf16 v[56:59], v[200:203], v[164:167], v[56:59]
    s_add_u32 s61, s61, 0x43800
    buffer_load_dwordx4 v2, s[32:35], s61 offen lds
    v_mfma_f32_16x16x32_bf16 v[76:79], v[200:203], v[168:171], v[76:79]
    s_add_u32 m0, s78, 0x7400
    s_add_u32 s61, s61, 1024
    v_mfma_f32_16x16x32_bf16 v[96:99], v[200:203], v[172:175], v[96:99]
    buffer_load_dwordx4 v2, s[32:35], s61 offen lds
    s_add_u32 m0, s78, 0x7800
    v_mfma_f32_16x16x32_bf16 v[40:43], v[204:207], v[160:163], v[40:43]
    s_add_u32 s61, s61, 1024
    buffer_load_dwordx4 v2, s[32:35], s61 offen lds
    v_mfma_f32_16x16x32_bf16 v[60:63], v[204:207], v[164:167], v[60:63]
    s_add_u32 m0, s78, 0x7c00
    s_add_u32 s61, s61, 1024
    v_mfma_f32_16x16x32_bf16 v[80:83], v[204:207], v[168:171], v[80:83]
    buffer_load_dwordx4 v2, s[32:35], s61 offen lds
    s_add_u32 m0, s78, 0x8000
    v_mfma_f32_16x16x32_bf16 v[100:103], v[204:207], v[172:175], v[100:103]
    s_add_u32 s61, s61, 1024
    buffer_load_dwordx4 v2, s[32:35], s61 offen lds
    v_mfma_f32_16x16x32_bf16 v[44:47], v[208:211], v[160:163], v[44:47]
    v_mfma_f32_16x16x32_bf16 v[64:67], v[208:211], v[164:167], v[64:67]
    v_mfma_f32_16x16x32_bf16 v[84:87], v[208:211], v[168:171], v[84:87]
    v_mfma_f32_16x16x32_bf16 v[104:107], v[208:211], v[172:175], v[104:107]
    v_mfma_f32_16x16x32_bf16 v[48:51], v[212:215], v[160:163], v[48:51]
    v_mfma_f32_16x16x32_bf16 v[68:71], v[212:215], v[164:167], v[68:71]
    v_mfma_f32_16x16x32_bf16 v[88:91], v[212:215], v[168:171], v[88:91]
    v_mfma_f32_16x16x32_bf16 v[108:111], v[212:215], v[172:175], v[108:111]
    s_mov_b32 s60, 20000
SP_12:
    s_waitcnt lgkmcnt(0)
    s_xor_b64 s[4:5], s[4:5], s[50:51]
    s_xor_b64 s[6:7], s[6:7], s[50:51]
    s_xor_b64 s[8:9], s[8:9], s[50:51]
    s_xor_b64 s[10:11], s[10:11], s[50:51]
    s_xor_b64 s[12:13], s[12:13], s[50:51]
    s_xor_b64 s[14:15], s[14:15], s[50:51]
    s_xor_b64 s[16:17], s[16:17], s[50:51]
    s_xor_b64 s[18:19], s[18:19], s[50:51]
    s_or_b64 s[4:5], s[4:5], s[6:7]
    s_or_b64 s[4:5], s[4:5], s[8:9]
    s_or_b64 s[4:5], s[4:5], s[10:11]
    s_or_b64 s[4:5], s[4:5], s[12:13]
    s_or_b64 s[4:5], s[4:5], s[14:15]
    s_or_b64 s[4:5], s[4:5], s[16:17]
    s_or_b64 s[4:5], s[4:5], s[18:19]
    s_cbranch_scc0 SP_12_OK
    s_sub_u32 s60, s60, 1
    s_cbranch_scc1 SP_12_OK
    s_buffer_load_dwordx16 s[4:19], s[32:35], s75 offset:320 glc
    s_branch SP_12
SP_12_OK:
    buffer_load_dword v28, v12, s[32:35], s66 offen sc1
    buffer_load_dword v29, v13, s[32:35], s66 offen sc1
    buffer_load_dword v30, v14, s[32:35], s66 offen sc1
    buffer_load_dword v31, v15, s[32:35], s66 offen sc1
    s_sub_u32 s57, s66, 8192
    buffer_load_dword v24, v12, s[32:35], s57 offen sc1
    s_waitcnt lgkmcnt(0)
    s_buffer_load_dwordx16 s[4:19], s[32:35], s75 offset:256 glc
    s_waitcnt vmcnt(14)
    v_mfma_f32_16x16x32_bf16 v[32:35], v[176:179], v[216:219], v[32:35]
    ds_read_b128 v[196:199], v0 offset:49152
    s_add_u32 m0, s78, 0x17000
    v_mfma_f32_16x16x32_bf16 v[52:55], v[176:179], v[220:223], v[52:55]
    ds_read_b128 v[200:203], v0 offset:50176
    s_add_u32 s61, s76, 0x57800
    v_mfma_f32_16x16x32_bf16 v[72:75], v[176:179], v[224:227], v[72:75]
    ds_read_b128 v[204:207], v0 offset:51200
    v_mfma_f32_16x16x32_bf16 v[92:95], v[176:179], v[228:231], v[92:95]
    ds_read_b128 v[208:211], v0 offset:52224
    v_mfma_f32_16x16x32_bf16 v[36:39], v[180:183], v[216:219], v[36:39]
    ds_read_b128 v[212:215], v0 offset:53248
    v_mfma_f32_16x16x32_bf16 v[56:59], v[180:183], v[220:223], v[56:59]
    buffer_load_dwordx4 v2, s[32:35], s61 offen lds
    s_add_u32 m0, s78, 0x17400
    v_mfma_f32_16x16x32_bf16 v[76:79], v[180:183], v[224:227], v[76:79]
    s_add_u32 s61, s61, 1024
    buffer_load_dwordx4 v2, s[32:35], s61 offen lds
    v_mfma_f32_16x16x32_bf16 v[96:99], v[180:183], v[228:231], v[96:99]
    s_add_u32 m0, s78, 0x17800
    s_add_u32 s61, s61, 1024
    v_mfma_f32_16x16x32_bf16 v[40:43], v[184:187], v[216:219], v[40:43]
    buffer_load_dwordx4 v2, s[32:35], s61 offen lds
    s_add_u32 m0, s78, 0x17c00
    v_mfma_f32_16x16x32_bf16 v[60:63], v[184:187], v[220:223], v[60:63]
    s_add_u32 s61, s61, 1024
    buffer_load_dwordx4 v2, s[32:35], s61 offen lds
    v_mfma_f32_16x16x32_bf16 v[80:83], v[184:187], v[224:227], v[80:83]
    s_add_u32 m0, s78, 0x18000
    s_add_u32 s61, s61, 1024
    v_mfma_f32_16x16x32_bf16 v[100:103], v[184:187], v[228:231], v[100:103]
    buffer_load_dwordx4 v2, s[32:35], s61 offen lds
    v_mfma_f32_16x16x32_bf16 v[44:47], v[188:191], v[216:219], v[44:47]
    v_mfma_f32_16x16x32_bf16 v[64:67], v[188:191], v[220:223], v[64:67]
    v_mfma_f32_16x16x32_bf16 v[84:87], v[188:191], v[224:227], v[84:87]
    v_mfma_f32_16x16x32_bf16 v[104:107], v[188:191], v[228:231], v[104:107]
    v_mfma_f32_16x16x32_bf16 v[48:51], v[192:195], v[216:219], v[48:51]
    v_mfma_f32_16x16x32_bf16 v[68:71], v[192:195], v[220:223], v[68:71]
    v_mfma_f32_16x16x32_bf16 v[88:91], v[192:195], v[224:227], v[88:91]
    v_mfma_f32_16x16x32_bf16 v[108:111], v[192:195], v[228:231], v[108:111]
    s_mov_b32 s60, 20000
SP_13:
    s_waitcnt lgkmcnt(0)
    s_xor_b64 s[4:5], s[4:5], s[50:51]
    s_xor_b64 s[6:7], s[6:7], s[50:51]
    s_xor_b64 s[8:9], s[8:9], s[50:51]
    s_xor_b64 s[10:11], s[10:11], s[50:51]
    s_xor_b64 s[12:13], s[12:13], s[50:51]
    s_xor_b64 s[14:15], s[14:15], s[50:51]
    s_xor_b64 s[16:17], s[16:17], s[50:51]
    s_xor_b64 s[18:19], s[18:19], s[50:51]
    s_or_b64 s[4:5], s[4:5], s[6:7]
    s_or_b64 s[4:5], s[4:5], s[8:9]
    s_or_b64 s[4:5], s[4:5], s[10:11]
    s_or_b64 s[4:5], s[4:5], s[12:13]
    s_or_b64 s[4:5], s[4:5], s[14:15]
    s_or_b64 s[4:5], s[4:5], s[16:17]
    s_or_b64 s[4:5], s[4:5], s[18:19]
    s_cbranch_scc0 SP_13_OK
    s_sub_u32 s60, s60, 1
    s_cbranch_scc1 SP_13_OK
    s_buffer_load_dwordx16 s[4:19], s[32:35], s75 offset:256 glc
    s_branch SP_13
SP_13_OK:
    s_add_u32 s57, s79, 0
    s_and_b32 s57, s57, 3
    s_mul_i32 s57, s57, 16384
    s_add_u32 s57, s57, s74
    s_add_u32 s57, s57, 0x36000
    buffer_load_dwordx4 v[112:115], v16, s[32:35], s57 offen
    buffer_load_dwordx4 v[116:119], v17, s[32:35], s57 offen
    buffer_load_dwordx4 v[120:123], v18, s[32:35], s57 offen
    buffer_load_dwordx4 v[124:127], v19, s[32:35], s57 offen
    s_add_u32 s57, s79, 1
    s_and_b32 s57, s57, 3
    s_mul_i32 s57, s57, 16384
    s_add_u32 s57, s57, s74
    s_add_u32 s57, s57, 0x36000
    buffer_load_dwordx4 v[128:131], v16, s[32:35], s57 offen
    buffer_load_dwordx4 v[132:135], v17, s[32:35], s57 offen
    buffer_load_dwordx4 v[136:139], v18, s[32:35], s57 offen
    buffer_load_dwordx4 v[140:143], v19, s[32:35], s57 offen
    s_add_u32 s57, s79, 2
    s_and_b32 s57, s57, 3
    s_mul_i32 s57, s57, 16384
    s_add_u32 s57, s57, s74
    s_add_u32 s57, s57, 0x36000
    buffer_load_dwordx4 v[144:147], v16, s[32:35], s57 offen
    buffer_load_dwordx4 v[148:151], v17, s[32:35], s57 offen
    buffer_load_dwordx4 v[152:155], v18, s[32:35], s57 offen
    buffer_load_dwordx4 v[156:159], v19, s[32:35], s57 offen
    s_add_u32 s57, s79, 3
    s_and_b32 s57, s57, 3
    s_mul_i32 s57, s57, 16384
    s_add_u32 s57, s57, s74
    s_add_u32 s57, s57, 0x36000
    buffer_load_dwordx4 v[160:163], v16, s[32:35], s57 offen
    buffer_load_dwordx4 v[164:167], v17, s[32:35], s57 offen
    buffer_load_dwordx4 v[168:171], v18, s[32:35], s57 offen
    buffer_load_dwordx4 v[172:175], v19, s[32:35], s57 offen
    s_add_u32 s57, s74, 0x46000
    buffer_load_dwordx2 v[216:217], v4, s[32:35], s57 offen offset:0
    buffer_load_dwordx2 v[218:219], v4, s[32:35], s57 offen offset:2048
    buffer_load_dwordx2 v[220:221], v5, s[32:35], s57 offen offset:0
    buffer_load_dwordx2 v[222:223], v5, s[32:35], s57 offen offset:2048
    buffer_load_dwordx2 v[224:225], v6, s[32:35], s57 offen offset:0
    buffer_load_dwordx2 v[226:227], v6, s[32:35], s57 offen offset:2048
    buffer_load_dwordx2 v[228:229], v7, s[32:35], s57 offen offset:0
    buffer_load_dwordx2 v[230:231], v7, s[32:35], s57 offen offset:2048
    s_waitcnt lgkmcnt(0)
    s_waitcnt vmcnt(39)
    v_mfma_f32_16x16x32_bf16 v[32:35], v[196:199], v[232:235], v[32:35]
    ds_read_b128 v[176:179], v8 offset:49152
    v_mfma_f32_16x16x32_bf16 v[52:55], v[196:199], v[236:239], v[52:55]
    ds_read_b128 v[180:183], v8 offset:50176
    v_mfma_f32_16x16x32_bf16 v[72:75], v[196:199], v[240:243], v[72:75]
    ds_read_b128 v[184:187], v8 offset:51200
    v_mfma_f32_16x16x32_bf16 v[92:95], v[196:199], v[244:247], v[92:95]
    ds_read_b128 v[188:191], v8 offset:52224
    v_mfma_f32_16x16x32_bf16 v[36:39], v[200:203], v[232:235], v[36:39]
    ds_read_b128 v[192:195], v8 offset:53248
    v_mfma_f32_16x16x32_bf16 v[56:59], v[200:203], v[236:239], v[56:59]
    v_mfma_f32_16x16x32_bf16 v[76:79], v[200:203], v[240:243], v[76:79]
    v_mfma_f32_16x16x32_bf16 v[96:99], v[200:203], v[244:247], v[96:99]
    v_mfma_f32_16x16x32_bf16 v[40:43], v[204:207], v[232:235], v[40:43]
    v_mfma_f32_16x16x32_bf16 v[60:63], v[204:207], v[236:239], v[60:63]
    v_mfma_f32_16x16x32_bf16 v[80:83], v[204:207], v[240:243], v[80:83]
    v_mfma_f32_16x16x32_bf16 v[100:103], v[204:207], v[244:247], v[100:103]
    v_mfma_f32_16x16x32_bf16 v[44:47], v[208:211], v[232:235], v[44:47]
    v_mfma_f32_16x16x32_bf16 v[64:67], v[208:211], v[236:239], v[64:67]
    v_mfma_f32_16x16x32_bf16 v[84:87], v[208:211], v[240:243], v[84:87]
    v_mfma_f32_16x16x32_bf16 v[104:107], v[208:211], v[244:247], v[104:107]
    v_mfma_f32_16x16x32_bf16 v[48:51], v[212:215], v[232:235], v[48:51]
    v_mfma_f32_16x16x32_bf16 v[68:71], v[212:215], v[236:239], v[68:71]
    v_mfma_f32_16x16x32_bf16 v[88:91], v[212:215], v[240:243], v[88:91]
    v_mfma_f32_16x16x32_bf16 v[108:111], v[212:215], v[244:247], v[108:111]
    s_waitcnt vmcnt(29)
    v_pk_mul_f32 v[32:33], v[32:33], v[28:29] op_sel:[0,0] op_sel_hi:[1,0]
    v_pk_mul_f32 v[34:35], v[34:35], v[28:29] op_sel:[0,0] op_sel_hi:[1,0]
    v_pk_mul_f32 v[36:37], v[36:37], v[28:29] op_sel:[0,0] op_sel_hi:[1,0]
    v_pk_mul_f32 v[38:39], v[38:39], v[28:29] op_sel:[0,0] op_sel_hi:[1,0]
    v_pk_mul_f32 v[40:41], v[40:41], v[28:29] op_sel:[0,0] op_sel_hi:[1,0]
    v_pk_mul_f32 v[42:43], v[42:43], v[28:29] op_sel:[0,0] op_sel_hi:[1,0]
    v_pk_mul_f32 v[44:45], v[44:45], v[28:29] op_sel:[0,0] op_sel_hi:[1,0]
    v_pk_mul_f32 v[46:47], v[46:47], v[28:29] op_sel:[0,0] op_sel_hi:[1,0]
    v_pk_mul_f32 v[48:49], v[48:49], v[28:29] op_sel:[0,0] op_sel_hi:[1,0]
    v_pk_mul_f32 v[50:51], v[50:51], v[28:29] op_sel:[0,0] op_sel_hi:[1,0]
    v_pk_mul_f32 v[52:53], v[52:53], v[28:29] op_sel:[0,1] op_sel_hi:[1,1]
    v_pk_mul_f32 v[54:55], v[54:55], v[28:29] op_sel:[0,1] op_sel_hi:[1,1]
    v_pk_mul_f32 v[56:57], v[56:57], v[28:29] op_sel:[0,1] op_sel_hi:[1,1]
    v_pk_mul_f32 v[58:59], v[58:59], v[28:29] op_sel:[0,1] op_sel_hi:[1,1]
    v_pk_mul_f32 v[60:61], v[60:61], v[28:29] op_sel:[0,1] op_sel_hi:[1,1]
    v_pk_mul_f32 v[62:63], v[62:63], v[28:29] op_sel:[0,1] op_sel_hi:[1,1]
    v_pk_mul_f32 v[64:65], v[64:65], v[28:29] op_sel:[0,1] op_sel_hi:[1,1]
    v_pk_mul_f32 v[66:67], v[66:67], v[28:29] op_sel:[0,1] op_sel_hi:[1,1]
    v_pk_mul_f32 v[68:69], v[68:69], v[28:29] op_sel:[0,1] op_sel_hi:[1,1]
    v_pk_mul_f32 v[70:71], v[70:71], v[28:29] op_sel:[0,1] op_sel_hi:[1,1]
    v_pk_mul_f32 v[72:73], v[72:73], v[30:31] op_sel:[0,0] op_sel_hi:[1,0]
    v_pk_mul_f32 v[74:75], v[74:75], v[30:31] op_sel:[0,0] op_sel_hi:[1,0]
    v_pk_mul_f32 v[76:77], v[76:77], v[30:31] op_sel:[0,0] op_sel_hi:[1,0]
    v_pk_mul_f32 v[78:79], v[78:79], v[30:31] op_sel:[0,0] op_sel_hi:[1,0]
    v_pk_mul_f32 v[80:81], v[80:81], v[30:31] op_sel:[0,0] op_sel_hi:[1,0]
    v_pk_mul_f32 v[82:83], v[82:83], v[30:31] op_sel:[0,0] op_sel_hi:[1,0]
    v_pk_mul_f32 v[84:85], v[84:85], v[30:31] op_sel:[0,0] op_sel_hi:[1,0]
    v_pk_mul_f32 v[86:87], v[86:87], v[30:31] op_sel:[0,0] op_sel_hi:[1,0]
    v_pk_mul_f32 v[88:89], v[88:89], v[30:31] op_sel:[0,0] op_sel_hi:[1,0]
    v_pk_mul_f32 v[90:91], v[90:91], v[30:31] op_sel:[0,0] op_sel_hi:[1,0]
    v_pk_mul_f32 v[92:93], v[92:93], v[30:31] op_sel:[0,1] op_sel_hi:[1,1]
    v_pk_mul_f32 v[94:95], v[94:95], v[30:31] op_sel:[0,1] op_sel_hi:[1,1]
    v_pk_mul_f32 v[96:97], v[96:97], v[30:31] op_sel:[0,1] op_sel_hi:[1,1]
    v_pk_mul_f32 v[98:99], v[98:99], v[30:31] op_sel:[0,1] op_sel_hi:[1,1]
    v_pk_mul_f32 v[100:101], v[100:101], v[30:31] op_sel:[0,1] op_sel_hi:[1,1]
    v_pk_mul_f32 v[102:103], v[102:103], v[30:31] op_sel:[0,1] op_sel_hi:[1,1]
    v_pk_mul_f32 v[104:105], v[104:105], v[30:31] op_sel:[0,1] op_sel_hi:[1,1]
    v_pk_mul_f32 v[106:107], v[106:107], v[30:31] op_sel:[0,1] op_sel_hi:[1,1]
    v_pk_mul_f32 v[108:109], v[108:109], v[30:31] op_sel:[0,1] op_sel_hi:[1,1]
    v_pk_mul_f32 v[110:111], v[110:111], v[30:31] op_sel:[0,1] op_sel_hi:[1,1]
    s_waitcnt lgkmcnt(0)
    s_waitcnt vmcnt(20)
    v_mfma_f32_16x16x32_bf16 v[32:35], v[176:179], v[112:115], v[32:35]
    ds_read_b128 v[196:199], v8 offset:8192
    v_mfma_f32_16x16x32_bf16 v[52:55], v[176:179], v[116:119], v[52:55]
    ds_read_b128 v[200:203], v8 offset:9216
    v_mfma_f32_16x16x32_bf16 v[72:75], v[176:179], v[120:123], v[72:75]
    ds_read_b128 v[204:207], v8 offset:10240
    v_mfma_f32_16x16x32_bf16 v[92:95], v[176:179], v[124:127], v[92:95]
    ds_read_b128 v[208:211], v8 offset:11264
    v_mfma_f32_16x16x32_bf16 v[36:39], v[180:183], v[112:115], v[36:39]
    ds_read_b128 v[212:215], v8 offset:12288
    v_mfma_f32_16x16x32_bf16 v[56:59], v[180:183], v[116:119], v[56:59]
    v_mfma_f32_16x16x32_bf16 v[76:79], v[180:183], v[120:123], v[76:79]
    v_mfma_f32_16x16x32_bf16 v[96:99], v[180:183], v[124:127], v[96:99]
    v_mfma_f32_16x16x32_bf16 v[40:43], v[184:187], v[112:115], v[40:43]
    v_mfma_f32_16x16x32_bf16 v[60:63], v[184:187], v[116:119], v[60:63]
    v_mfma_f32_16x16x32_bf16 v[80:83], v[184:187], v[120:123], v[80:83]
    v_mfma_f32_16x16x32_bf16 v[100:103], v[184:187], v[124:127], v[100:103]
    v_mfma_f32_16x16x32_bf16 v[44:47], v[188:191], v[112:115], v[44:47]
    v_mfma_f32_16x16x32_bf16 v[64:67], v[188:191], v[116:119], v[64:67]
    v_mfma_f32_16x16x32_bf16 v[84:87], v[188:191], v[120:123], v[84:87]
    v_mfma_f32_16x16x32_bf16 v[104:107], v[188:191], v[124:127], v[104:107]
    v_mfma_f32_16x16x32_bf16 v[48:51], v[192:195], v[112:115], v[48:51]
    v_mfma_f32_16x16x32_bf16 v[68:71], v[192:195], v[116:119], v[68:71]
    v_mfma_f32_16x16x32_bf16 v[88:91], v[192:195], v[120:123], v[88:91]
    v_mfma_f32_16x16x32_bf16 v[108:111], v[192:195], v[124:127], v[108:111]
    s_waitcnt lgkmcnt(0)
    s_waitcnt vmcnt(16)
    v_mfma_f32_16x16x32_bf16 v[32:35], v[196:199], v[128:131], v[32:35]
    ds_read_b128 v[176:179], v0 offset:8192
    v_mfma_f32_16x16x32_bf16 v[52:55], v[196:199], v[132:135], v[52:55]
    ds_read_b128 v[180:183], v0 offset:9216
    v_mfma_f32_16x16x32_bf16 v[72:75], v[196:199], v[136:139], v[72:75]
    ds_read_b128 v[184:187], v0 offset:10240
    v_mfma_f32_16x16x32_bf16 v[92:95], v[196:199], v[140:143], v[92:95]
    ds_read_b128 v[188:191], v0 offset:11264
    v_mfma_f32_16x16x32_bf16 v[36:39], v[200:203], v[128:131], v[36:39]
    ds_read_b128 v[192:195], v0 offset:12288
    v_mfma_f32_16x16x32_bf16 v[56:59], v[200:203], v[132:135], v[56:59]
    v_mfma_f32_16x16x32_bf16 v[76:79], v[200:203], v[136:139], v[76:79]
    v_mfma_f32_16x16x32_bf16 v[96:99], v[200:203], v[140:143], v[96:99]
    v_mfma_f32_16x16x32_bf16 v[40:43], v[204:207], v[128:131], v[40:43]
    v_mfma_f32_16x16x32_bf16 v[60:63], v[204:207], v[132:135], v[60:63]
    v_mfma_f32_16x16x32_bf16 v[80:83], v[204:207], v[136:139], v[80:83]
    v_mfma_f32_16x16x32_bf16 v[100:103], v[204:207], v[140:143], v[100:103]
    v_mfma_f32_16x16x32_bf16 v[44:47], v[208:211], v[128:131], v[44:47]
    v_mfma_f32_16x16x32_bf16 v[64:67], v[208:211], v[132:135], v[64:67]
    v_mfma_f32_16x16x32_bf16 v[84:87], v[208:211], v[136:139], v[84:87]
    v_mfma_f32_16x16x32_bf16 v[104:107], v[208:211], v[140:143], v[104:107]
    v_mfma_f32_16x16x32_bf16 v[48:51], v[212:215], v[128:131], v[48:51]
    v_mfma_f32_16x16x32_bf16 v[68:71], v[212:215], v[132:135], v[68:71]
    v_mfma_f32_16x16x32_bf16 v[88:91], v[212:215], v[136:139], v[88:91]
    v_mfma_f32_16x16x32_bf16 v[108:111], v[212:215], v[140:143], v[108:111]
    s_waitcnt lgkmcnt(0)
    s_waitcnt vmcnt(12)
    v_mfma_f32_16x16x32_bf16 v[32:35], v[176:179], v[144:147], v[32:35]
    ds_read_b128 v[196:199], v8 offset:28672
    v_mfma_f32_16x16x32_bf16 v[52:55], v[176:179], v[148:151], v[52:55]
    ds_read_b128 v[200:203], v8 offset:29696
    v_mfma_f32_16x16x32_bf16 v[72:75], v[176:179], v[152:155], v[72:75]
    ds_read_b128 v[204:207], v8 offset:30720
    v_mfma_f32_16x16x32_bf16 v[92:95], v[176:179], v[156:159], v[92:95]
    ds_read_b128 v[208:211], v8 offset:31744
    v_mfma_f32_16x16x32_bf16 v[36:39], v[180:183], v[144:147], v[36:39]
    ds_read_b128 v[212:215], v8 offset:32768
    v_mfma_f32_16x16x32_bf16 v[56:59], v[180:183], v[148:151], v[56:59]
    v_mfma_f32_16x16x32_bf16 v[76:79], v[180:183], v[152:155], v[76:79]
    v_mfma_f32_16x16x32_bf16 v[96:99], v[180:183], v[156:159], v[96:99]
    v_mfma_f32_16x16x32_bf16 v[40:43], v[184:187], v[144:147], v[40:43]
    v_mfma_f32_16x16x32_bf16 v[60:63], v[184:187], v[148:151], v[60:63]
    v_mfma_f32_16x16x32_bf16 v[80:83], v[184:187], v[152:155], v[80:83]
    v_mfma_f32_16x16x32_bf16 v[100:103], v[184:187], v[156:159], v[100:103]
    v_mfma_f32_16x16x32_bf16 v[44:47], v[188:191], v[144:147], v[44:47]
    v_mfma_f32_16x16x32_bf16 v[64:67], v[188:191], v[148:151], v[64:67]
    v_mfma_f32_16x16x32_bf16 v[84:87], v[188:191], v[152:155], v[84:87]
    v_mfma_f32_16x16x32_bf16 v[104:107], v[188:191], v[156:159], v[104:107]
    v_mfma_f32_16x16x32_bf16 v[48:51], v[192:195], v[144:147], v[48:51]
    v_mfma_f32_16x16x32_bf16 v[68:71], v[192:195], v[148:151], v[68:71]
    v_mfma_f32_16x16x32_bf16 v[88:91], v[192:195], v[152:155], v[88:91]
    v_mfma_f32_16x16x32_bf16 v[108:111], v[192:195], v[156:159], v[108:111]
    s_waitcnt lgkmcnt(0)
    s_waitcnt vmcnt(8)
    v_mfma_f32_16x16x32_bf16 v[32:35], v[196:199], v[160:163], v[32:35]
    ds_read_b128 v[176:179], v0 offset:28672
    v_mfma_f32_16x16x32_bf16 v[52:55], v[196:199], v[164:167], v[52:55]
    ds_read_b128 v[180:183], v0 offset:29696
    v_mfma_f32_16x16x32_bf16 v[72:75], v[196:199], v[168:171], v[72:75]
    ds_read_b128 v[184:187], v0 offset:30720
    v_mfma_f32_16x16x32_bf16 v[92:95], v[196:199], v[172:175], v[92:95]
    ds_read_b128 v[188:191], v0 offset:31744
    v_mfma_f32_16x16x32_bf16 v[36:39], v[200:203], v[160:163], v[36:39]
    ds_read_b128 v[192:195], v0 offset:32768
    v_mfma_f32_16x16x32_bf16 v[56:59], v[200:203], v[164:167], v[56:59]
    v_mfma_f32_16x16x32_bf16 v[76:79], v[200:203], v[168:171], v[76:79]
    v_mfma_f32_16x16x32_bf16 v[96:99], v[200:203], v[172:175], v[96:99]
    v_mfma_f32_16x16x32_bf16 v[40:43], v[204:207], v[160:163], v[40:43]
    v_mfma_f32_16x16x32_bf16 v[60:63], v[204:207], v[164:167], v[60:63]
    v_mfma_f32_16x16x32_bf16 v[80:83], v[204:207], v[168:171], v[80:83]
    v_mfma_f32_16x16x32_bf16 v[100:103], v[204:207], v[172:175], v[100:103]
    v_mfma_f32_16x16x32_bf16 v[44:47], v[208:211], v[160:163], v[44:47]
    v_mfma_f32_16x16x32_bf16 v[64:67], v[208:211], v[164:167], v[64:67]
    v_mfma_f32_16x16x32_bf16 v[84:87], v[208:211], v[168:171], v[84:87]
    v_mfma_f32_16x16x32_bf16 v[104:107], v[208:211], v[172:175], v[104:107]
    v_mfma_f32_16x16x32_bf16 v[48:51], v[212:215], v[160:163], v[48:51]
    v_mfma_f32_16x16x32_bf16 v[68:71], v[212:215], v[164:167], v[68:71]
    v_mfma_f32_16x16x32_bf16 v[88:91], v[212:215], v[168:171], v[88:91]
    v_mfma_f32_16x16x32_bf16 v[108:111], v[212:215], v[172:175], v[108:111]
    s_waitcnt lgkmcnt(0)
    s_waitcnt vmcnt(0)
    v_mfma_f32_16x16x32_bf16 v[32:35], v[176:179], v[216:219], v[32:35]
    v_mfma_f32_16x16x32_bf16 v[52:55], v[176:179], v[220:223], v[52:55]
    v_mfma_f32_16x16x32_bf16 v[72:75], v[176:179], v[224:227], v[72:75]
    v_mfma_f32_16x16x32_bf16 v[92:95], v[176:179], v[228:231], v[92:95]
    v_mfma_f32_16x16x32_bf16 v[36:39], v[180:183], v[216:219], v[36:39]
    v_mfma_f32_16x16x32_bf16 v[56:59], v[180:183], v[220:223], v[56:59]
    v_mfma_f32_16x16x32_bf16 v[76:79], v[180:183], v[224:227], v[76:79]
    v_mfma_f32_16x16x32_bf16 v[96:99], v[180:183], v[228:231], v[96:99]
    v_mfma_f32_16x16x32_bf16 v[40:43], v[184:187], v[216:219], v[40:43]
    v_mfma_f32_16x16x32_bf16 v[60:63], v[184:187], v[220:223], v[60:63]
    v_mfma_f32_16x16x32_bf16 v[80:83], v[184:187], v[224:227], v[80:83]
    v_mfma_f32_16x16x32_bf16 v[100:103], v[184:187], v[228:231], v[100:103]
    v_mfma_f32_16x16x32_bf16 v[44:47], v[188:191], v[216:219], v[44:47]
    v_mfma_f32_16x16x32_bf16 v[64:67], v[188:191], v[220:223], v[64:67]
    v_mfma_f32_16x16x32_bf16 v[84:87], v[188:191], v[224:227], v[84:87]
    v_mfma_f32_16x16x32_bf16 v[104:107], v[188:191], v[228:231], v[104:107]
    v_mfma_f32_16x16x32_bf16 v[48:51], v[192:195], v[216:219], v[48:51]
    v_mfma_f32_16x16x32_bf16 v[68:71], v[192:195], v[220:223], v[68:71]
    v_mfma_f32_16x16x32_bf16 v[88:91], v[192:195], v[224:227], v[88:91]
    v_mfma_f32_16x16x32_bf16 v[108:111], v[192:195], v[228:231], v[108:111]
    ds_write_b128 v8, v[52:55] offset:8192
    ds_write_b128 v8, v[56:59] offset:9216
    ds_write_b128 v8, v[60:63] offset:10240
    ds_write_b128 v8, v[64:67] offset:11264
    s_nop 1
    ds_write_b128 v8, v[68:71] offset:12288
    ds_write_b128 v8, v[72:75] offset:28672
    ds_write_b128 v8, v[76:79] offset:29696
    ds_write_b128 v8, v[80:83] offset:30720
    ds_write_b128 v8, v[84:87] offset:31744
    ds_write_b128 v8, v[88:91] offset:32768
    ds_write_b128 v8, v[92:95] offset:49152
    ds_write_b128 v8, v[96:99] offset:50176
    ds_write_b128 v8, v[100:103] offset:51200
    ds_write_b128 v8, v[104:107] offset:52224
    ds_write_b128 v8, v[108:111] offset:53248
    s_waitcnt lgkmcnt(0)
    s_barrier
    ds_read_b128 v[112:115], v9 offset:0
    ds_read_b128 v[116:119], v10 offset:0
    ds_read_b128 v[120:123], v11 offset:0
    ds_read_b128 v[124:127], v9 offset:1024
    ds_read_b128 v[128:131], v10 offset:1024
    ds_read_b128 v[132:135], v11 offset:1024
    ds_read_b128 v[136:139], v9 offset:2048
    ds_read_b128 v[140:143], v10 offset:2048
    ds_read_b128 v[144:147], v11 offset:2048
    ds_read_b128 v[148:151], v9 offset:3072
    ds_read_b128 v[152:155], v10 offset:3072
    ds_read_b128 v[156:159], v11 offset:3072
    ds_read_b128 v[160:163], v9 offset:4096
    ds_read_b128 v[164:167], v10 offset:4096
    ds_read_b128 v[168:171], v11 offset:4096
    s_waitcnt lgkmcnt(12)
    v_pk_add_f32 v[32:33], v[32:33], v[112:113]
    v_pk_add_f32 v[116:117], v[116:117], v[120:121]
    v_pk_add_f32 v[32:33], v[32:33], v[116:117]
    v_pk_mul_f32 v[32:33], v[32:33], v[24:25] op_sel_hi:[1,0]
    v_pk_add_f32 v[34:35], v[34:35], v[114:115]
    v_pk_add_f32 v[118:119], v[118:119], v[122:123]
    v_pk_add_f32 v[34:35], v[34:35], v[118:119]
    v_pk_mul_f32 v[34:35], v[34:35], v[24:25] op_sel_hi:[1,0]
    v_cvt_pk_bf16_f32 v32, v32, v33
    v_cvt_pk_bf16_f32 v33, v34, v35
    buffer_store_dwordx2 v[32:33], v22, s[28:31], s67 offen offset:0
    s_waitcnt lgkmcnt(9)
    v_pk_add_f32 v[36:37], v[36:37], v[124:125]
    v_pk_add_f32 v[128:129], v[128:129], v[132:133]
    v_pk_add_f32 v[36:37], v[36:37], v[128:129]
    v_pk_mul_f32 v[36:37], v[36:37], v[24:25] op_sel_hi:[1,0]
    v_pk_add_f32 v[38:39], v[38:39], v[126:127]
    v_pk_add_f32 v[130:131], v[130:131], v[134:135]
    v_pk_add_f32 v[38:39], v[38:39], v[130:131]
    v_pk_mul_f32 v[38:39], v[38:39], v[24:25] op_sel_hi:[1,0]
    v_cvt_pk_bf16_f32 v36, v36, v37
    v_cvt_pk_bf16_f32 v37, v38, v39
    buffer_store_dwordx2 v[36:37], v22, s[28:31], s67 offen offset:32
    s_waitcnt lgkmcnt(6)
    v_pk_add_f32 v[40:41], v[40:41], v[136:137]
    v_pk_add_f32 v[140:141], v[140:141], v[144:145]
    v_pk_add_f32 v[40:41], v[40:41], v[140:141]
    v_pk_mul_f32 v[40:41], v[40:41], v[24:25] op_sel_hi:[1,0]
    v_pk_add_f32 v[42:43], v[42:43], v[138:139]
    v_pk_add_f32 v[142:143], v[142:143], v[146:147]
    v_pk_add_f32 v[42:43], v[42:43], v[142:143]
    v_pk_mul_f32 v[42:43], v[42:43], v[24:25] op_sel_hi:[1,0]
    v_cvt_pk_bf16_f32 v40, v40, v41
    v_cvt_pk_bf16_f32 v41, v42, v43
    buffer_store_dwordx2 v[40:41], v22, s[28:31], s67 offen offset:64
    s_waitcnt lgkmcnt(3)
    v_pk_add_f32 v[44:45], v[44:45], v[148:149]
    v_pk_add_f32 v[152:153], v[152:153], v[156:157]
    v_pk_add_f32 v[44:45], v[44:45], v[152:153]
    v_pk_mul_f32 v[44:45], v[44:45], v[24:25] op_sel_hi:[1,0]
    v_pk_add_f32 v[46:47], v[46:47], v[150:151]
    v_pk_add_f32 v[154:155], v[154:155], v[158:159]
    v_pk_add_f32 v[46:47], v[46:47], v[154:155]
    v_pk_mul_f32 v[46:47], v[46:47], v[24:25] op_sel_hi:[1,0]
    v_cvt_pk_bf16_f32 v44, v44, v45
    v_cvt_pk_bf16_f32 v45, v46, v47
    buffer_store_dwordx2 v[44:45], v22, s[28:31], s67 offen offset:96
    s_waitcnt lgkmcnt(0)
    v_pk_add_f32 v[48:49], v[48:49], v[160:161]
    v_pk_add_f32 v[164:165], v[164:165], v[168:169]
    v_pk_add_f32 v[48:49], v[48:49], v[164:165]
    v_pk_mul_f32 v[48:49], v[48:49], v[24:25] op_sel_hi:[1,0]
    v_pk_add_f32 v[50:51], v[50:51], v[162:163]
    v_pk_add_f32 v[166:167], v[166:167], v[170:171]
    v_pk_add_f32 v[50:51], v[50:51], v[166:167]
    v_pk_mul_f32 v[50:51], v[50:51], v[24:25] op_sel_hi:[1,0]
    v_cvt_pk_bf16_f32 v48, v48, v49
    v_cvt_pk_bf16_f32 v49, v50, v51
    buffer_store_dwordx2 v[48:49], v22, s[28:31], s67 offen offset:128
    s_branch L_END
L_X1:
    s_mov_b32 s28, s6
    s_and_b32 s29, s7, 0xffff
    s_mov_b32 s30, 0x258000
    s_mov_b32 s31, 0x20000
    s_mul_i32 s53, s45, 61440
    s_mul_i32 s56, s47, 160
    s_add_u32 s53, s53, s56
    s_add_u32 s53, s53, 2560
    s_mul_i32 s56, s82, 245760
    s_add_u32 s53, s53, s56
    s_mul_i32 s55, s45, 2560
    v_add_u32 v13, 0, v1
    v_mul_u32_u24 v14, 6554, v13
    v_lshrrev_b32 v14, 16, v14
    v_mul_u32_u24 v15, 10, v14
    v_sub_u32 v13, v13, v15
    v_and_b32 v15, 0x13, v14
    v_and_b32 v4, 4, v14
    v_lshl_or_b32 v15, v4, 1, v15
    v_bfe_u32 v4, v14, 3, 1
    v_lshl_or_b32 v15, v4, 2, v15
    v_mul_u32_u24 v15, 3840, v15
    v_lshl_add_u32 v4, v13, 4, v15
    v_add_u32 v13, 64, v1
    v_mul_u32_u24 v14, 6554, v13
    v_lshrrev_b32 v14, 16, v14
    v_mul_u32_u24 v15, 10, v14
    v_sub_u32 v13, v13, v15
    v_and_b32 v15, 0x13, v14
    v_and_b32 v5, 4, v14
    v_lshl_or_b32 v15, v5, 1, v15
    v_bfe_u32 v5, v14, 3, 1
    v_lshl_or_b32 v15, v5, 2, v15
    v_mul_u32_u24 v15, 3840, v15
    v_lshl_add_u32 v5, v13, 4, v15
    v_add_u32 v13, 128, v1
    v_mul_u32_u24 v14, 6554, v13
    v_lshrrev_b32 v14, 16, v14
    v_mul_u32_u24 v15, 10, v14
    v_sub_u32 v13, v13, v15
    v_and_b32 v15, 0x13, v14
    v_and_b32 v6, 4, v14
    v_lshl_or_b32 v15, v6, 1, v15
    v_bfe_u32 v6, v14, 3, 1
    v_lshl_or_b32 v15, v6, 2, v15
    v_mul_u32_u24 v15, 3840, v15
    v_lshl_add_u32 v6, v13, 4, v15
    s_bitcmp1_b32 s20, 0
    s_cselect_b32 s21, 0x500, 0
    s_sub_u32 s21, s52, s21
    s_add_u32 m0, s54, 0x0
    s_add_u32 s56, s21, 0x0
    buffer_load_dwordx4 v3, s[24:27], s56 offen lds
    s_add_u32 m0, s54, 0x2000
    s_add_u32 s56, s21, 0x14000
    buffer_load_dwordx4 v3, s[24:27], s56 offen lds
    s_bitcmp1_b32 s20, 0
    s_cselect_b32 s12, 0x258000, 0
    s_sub_u32 s12, s53, s12
    s_add_u32 m0, s55, 0x6800
    s_add_u32 s56, s12, 0x0
    buffer_load_dwordx4 v4, s[28:31], s56 offen lds
    s_add_u32 m0, s55, 0x6c00
    s_add_u32 s56, s12, 0x0
    buffer_load_dwordx4 v5, s[28:31], s56 offen lds
    s_add_u32 m0, s55, 0x7000
    s_add_u32 s56, s12, 0x0
    s_mov_b32 exec_hi, 0
    buffer_load_dwordx4 v6, s[28:31], s56 offen lds
    s_mov_b32 exec_hi, -1
    s_barrier
    s_bitcmp1_b32 s20, 1
    s_cselect_b32 s21, 0x500, 0
    s_sub_u32 s21, s52, s21
    s_add_u32 m0, s54, 0x9000
    s_add_u32 s56, s21, 0x80
    buffer_load_dwordx4 v3, s[24:27], s56 offen lds
    s_add_u32 m0, s54, 0xb000
    s_add_u32 s56, s21, 0x14080
    buffer_load_dwordx4 v3, s[24:27], s56 offen lds
    s_bitcmp1_b32 s20, 1
    s_cselect_b32 s12, 0x258000, 0
    s_sub_u32 s12, s53, s12
    s_add_u32 m0, s55, 0xf800
    s_add_u32 s56, s12, 0x3c000
    buffer_load_dwordx4 v4, s[28:31], s56 offen lds
    s_add_u32 m0, s55, 0xfc00
    s_add_u32 s56, s12, 0x3c000
    buffer_load_dwordx4 v5, s[28:31], s56 offen lds
    s_add_u32 m0, s55, 0x10000
    s_add_u32 s56, s12, 0x3c000
    s_mov_b32 exec_hi, 0
    buffer_load_dwordx4 v6, s[28:31], s56 offen lds
    s_mov_b32 exec_hi, -1
    v_and_b32 v13, 15, v1
    v_bfe_u32 v14, v1, 1, 3
    v_lshrrev_b32 v15, 4, v1
    v_xor_b32 v14, v14, v15
    v_lshlrev_b32 v13, 7, v13
    v_lshl_add_u32 v7, v14, 4, v13
    s_lshl_b32 s56, s45, 12
    v_add_u32 v7, s56, v7
    v_xor_b32 v8, 64, v7
    s_lshl_b32 s56, s45, 10
    s_add_u32 s56, s56, 0x27400
    s_cmp_lt_u32 s45, 2
    s_cselect_b32 m0, s56, 0x26000
    s_mov_b32 s56, 0x7ff00000
    buffer_load_dwordx4 v2, s[24:27], s56 offen lds
    s_mov_b32 s36, s14
    s_and_b32 s37, s15, 0xffff
    s_mov_b32 s38, 0x21c000
    s_mov_b32 s39, 0x20000
    s_mul_i32 s64, s45, 55296
    s_mul_i32 s56, s47, 128
    s_add_u32 s64, s64, s56
    s_add_u32 s64, s64, 2048
    s_mul_i32 s56, s82, 221184
    s_add_u32 s64, s64, s56
    s_mul_i32 s65, s45, 2048
    v_lshrrev_b32 v13, 5, v1
    v_lshlrev_b32 v13, 3, v13
    v_bfe_u32 v14, v1, 3, 2
    v_add_u32 v13, v13, v14
    v_mul_u32_u24 v13, 3456, v13
    v_bfe_u32 v14, v1, 4, 2
    v_lshlrev_b32 v14, 1, v14
    v_and_b32 v11, 7, v1
    v_xor_b32 v11, v11, v14
    v_lshl_add_u32 v11, v11, 4, v13
    s_lshr_b32 s56, s45, 1
    s_lshl_b32 s57, s46, 1
    s_add_u32 s56, s56, s57
    s_lshl_b32 s67, s56, 9
    s_mul_i32 s56, s56, 74
    s_mul_i32 s57, s47, 2
    s_add_u32 s56, s56, s57
    s_add_u32 s56, s56, 32
    s_lshl_b32 s66, s56, 12
    s_and_b32 s56, s45, 1
    s_lshl_b32 s57, s56, 11
    s_add_u32 s66, s66, s57
    s_mul_i32 s57, s47, 2
    s_add_u32 s56, s56, s57
    s_lshl_b32 s56, s56, 2
    s_add_u32 s67, s67, s56
    s_add_u32 s67, s67, 0xd29080
    s_mul_i32 s71, s45, 55296
    s_mul_i32 s56, s47, 64
    s_add_u32 s71, s71, s56
    s_add_u32 s71, s71, 3072
    s_mul_i32 s56, s82, 221184
    s_add_u32 s71, s71, s56
    s_mul_i32 s72, s45, 1024
    s_cmp_lt_u32 s47, 6
    s_cselect_b32 s71, s71, 0x8011c000
    v_bfe_u32 v13, v1, 4, 1
    v_lshlrev_b32 v14, 1, v13
    v_and_b32 v0, 3, v1
    v_xor_b32 v0, v0, v14
    v_lshlrev_b32 v13, 3, v13
    v_lshrrev_b32 v14, 5, v1
    v_lshl_add_u32 v13, v14, 2, v13
    v_bfe_u32 v14, v1, 2, 2
    v_add_u32 v13, v13, v14
    v_mul_u32_u24 v13, 3456, v13
    v_lshl_add_u32 v0, v0, 4, v13
    s_lshr_b32 s56, s45, 1
    s_lshl_b32 s57, s46, 1
    s_add_u32 s56, s56, s57
    s_lshl_b32 s74, s56, 9
    s_mul_i32 s56, s56, 74
    s_mul_i32 s57, s47, 1
    s_add_u32 s56, s56, s57
    s_add_u32 s56, s56, 48
    s_lshl_b32 s73, s56, 12
    s_and_b32 s56, s45, 1
    s_lshl_b32 s57, s56, 11
    s_add_u32 s73, s73, s57
    s_mul_i32 s57, s47, 2
    s_add_u32 s56, s56, s57
    s_lshl_b32 s56, s56, 2
    s_add_u32 s74, s74, s56
    s_add_u32 s74, s74, 0xd290c0
    s_cmp_lt_u32 s47, 6
    s_cselect_b32 s73, s73, 0x7ff00000
    v_lshrrev_b32 v13, 5, v1
    v_lshlrev_b32 v13, 4, v13
    v_bfe_u32 v14, v1, 2, 3
    v_add_u32 v13, v13, v14
    v_mul_u32_u24 v13, 160, v13
    v_add_u32 v13, 0x6800, v13
    v_and_b32 v14, 3, v1
    v_lshl_add_u32 v9, v14, 3, v13
    v_mul_u32_u24 v14, 40, v14
    v_add3_u32 v10, v13, v14, 32
    s_waitcnt lgkmcnt(0)
    s_mul_i32 s50, s50, 0x9e3779b1
    s_add_u32 s50, s50, 0x7f4a7c15
    s_mov_b32 s51, s50
    s_waitcnt vmcnt(6)
    s_barrier
    ds_read_b128 v[96:99], v7 offset:0
    ds_read_b128 v[100:103], v7 offset:2048
    ds_read_b64_tr_b16 v[16:17], v9 offset:0
    ds_read_b64_tr_b16 v[18:19], v9 offset:1280
    ds_read_b64_tr_b16 v[20:21], v9 offset:40
    ds_read_b64_tr_b16 v[22:23], v9 offset:1320
    ds_read_b64_tr_b16 v[24:25], v9 offset:80
    ds_read_b64_tr_b16 v[26:27], v9 offset:1360
    ds_read_b64_tr_b16 v[28:29], v9 offset:120
    ds_read_b64_tr_b16 v[30:31], v9 offset:1400
    ds_read_b64_tr_b16 v[32:33], v10 offset:0
    ds_read_b64_tr_b16 v[34:35], v10 offset:1280
    s_waitcnt lgkmcnt(0)
    v_mfma_f32_16x16x32_bf16 v[56:59], v[96:99], v[16:19], 0
    ds_read_b128 v[104:107], v8 offset:0
    ds_read_b128 v[108:111], v8 offset:2048
    s_bitcmp1_b32 s20, 2
    s_cselect_b32 s21, 0x500, 0
    s_sub_u32 s21, s52, s21
    s_add_u32 m0, s54, 0x12000
    s_add_u32 s56, s21, 0x100
    buffer_load_dwordx4 v3, s[24:27], s56 offen lds
    v_mfma_f32_16x16x32_bf16 v[60:63], v[100:103], v[16:19], 0
    ds_read_b64_tr_b16 v[36:37], v9 offset:5120
    ds_read_b64_tr_b16 v[38:39], v9 offset:6400
    s_add_u32 m0, s54, 0x14000
    s_add_u32 s56, s21, 0x14100
    buffer_load_dwordx4 v3, s[24:27], s56 offen lds
    v_mfma_f32_16x16x32_bf16 v[64:67], v[96:99], v[20:23], 0
    ds_read_b64_tr_b16 v[40:41], v9 offset:5160
    ds_read_b64_tr_b16 v[42:43], v9 offset:6440
    s_bitcmp1_b32 s20, 2
    s_cselect_b32 s12, 0x258000, 0
    s_sub_u32 s12, s53, s12
    s_add_u32 m0, s55, 0x18800
    s_add_u32 s56, s12, 0x78000
    buffer_load_dwordx4 v4, s[28:31], s56 offen lds
    v_mfma_f32_16x16x32_bf16 v[68:71], v[100:103], v[20:23], 0
    ds_read_b64_tr_b16 v[44:45], v9 offset:5200
    ds_read_b64_tr_b16 v[46:47], v9 offset:6480
    s_add_u32 m0, s55, 0x18c00
    s_add_u32 s56, s12, 0x78000
    buffer_load_dwordx4 v5, s[28:31], s56 offen lds
    v_mfma_f32_16x16x32_bf16 v[72:75], v[96:99], v[24:27], 0
    ds_read_b64_tr_b16 v[48:49], v9 offset:5240
    ds_read_b64_tr_b16 v[50:51], v9 offset:6520
    s_add_u32 m0, s55, 0x19000
    s_add_u32 s56, s12, 0x78000
    s_mov_b32 exec_hi, 0
    buffer_load_dwordx4 v6, s[28:31], s56 offen lds
    s_mov_b32 exec_hi, -1
    v_mfma_f32_16x16x32_bf16 v[76:79], v[100:103], v[24:27], 0
    ds_read_b64_tr_b16 v[52:53], v10 offset:5120
    ds_read_b64_tr_b16 v[54:55], v10 offset:6400
    v_mfma_f32_16x16x32_bf16 v[80:83], v[96:99], v[28:31], 0
    v_mfma_f32_16x16x32_bf16 v[84:87], v[100:103], v[28:31], 0
    v_mfma_f32_16x16x32_bf16 v[88:91], v[96:99], v[32:35], 0
    v_mfma_f32_16x16x32_bf16 v[92:95], v[100:103], v[32:35], 0
    s_waitcnt lgkmcnt(0)
    s_waitcnt vmcnt(6)
    s_barrier
    v_mfma_f32_16x16x32_bf16 v[56:59], v[104:107], v[36:39], v[56:59]
    ds_read_b128 v[112:115], v7 offset:36864
    ds_read_b128 v[116:119], v7 offset:38912
    s_bitcmp1_b32 s20, 3
    s_cselect_b32 s21, 0x500, 0
    s_sub_u32 s21, s52, s21
    s_add_u32 m0, s54, 0x1b000
    s_add_u32 s56, s21, 0x180
    buffer_load_dwordx4 v3, s[24:27], s56 offen lds
    v_mfma_f32_16x16x32_bf16 v[60:63], v[108:111], v[36:39], v[60:63]
    ds_read_b64_tr_b16 v[16:17], v9 offset:36864
    ds_read_b64_tr_b16 v[18:19], v9 offset:38144
    s_add_u32 m0, s54, 0x1d000
    s_add_u32 s56, s21, 0x14180
    buffer_load_dwordx4 v3, s[24:27], s56 offen lds
    v_mfma_f32_16x16x32_bf16 v[64:67], v[104:107], v[40:43], v[64:67]
    ds_read_b64_tr_b16 v[20:21], v9 offset:36904
    ds_read_b64_tr_b16 v[22:23], v9 offset:38184
    v_mfma_f32_16x16x32_bf16 v[68:71], v[108:111], v[40:43], v[68:71]
    ds_read_b64_tr_b16 v[24:25], v9 offset:36944
    ds_read_b64_tr_b16 v[26:27], v9 offset:38224
    v_mfma_f32_16x16x32_bf16 v[72:75], v[104:107], v[44:47], v[72:75]
    ds_read_b64_tr_b16 v[28:29], v9 offset:36984
    ds_read_b64_tr_b16 v[30:31], v9 offset:38264
    v_mfma_f32_16x16x32_bf16 v[76:79], v[108:111], v[44:47], v[76:79]
    ds_read_b64_tr_b16 v[32:33], v10 offset:36864
    ds_read_b64_tr_b16 v[34:35], v10 offset:38144
    v_mfma_f32_16x16x32_bf16 v[80:83], v[104:107], v[48:51], v[80:83]
    v_mfma_f32_16x16x32_bf16 v[84:87], v[108:111], v[48:51], v[84:87]
    v_mfma_f32_16x16x32_bf16 v[88:91], v[104:107], v[52:55], v[88:91]
    v_mfma_f32_16x16x32_bf16 v[92:95], v[108:111], v[52:55], v[92:95]
    s_waitcnt lgkmcnt(0)
    v_mfma_f32_16x16x32_bf16 v[56:59], v[112:115], v[16:19], v[56:59]
    ds_read_b128 v[120:123], v8 offset:36864
    ds_read_b128 v[124:127], v8 offset:38912
    s_bitcmp1_b32 s20, 3
    s_cselect_b32 s12, 0x258000, 0
    s_sub_u32 s12, s53, s12
    s_add_u32 m0, s55, 0x21800
    s_add_u32 s56, s12, 0xb4000
    buffer_load_dwordx4 v4, s[28:31], s56 offen lds
    v_mfma_f32_16x16x32_bf16 v[60:63], v[116:119], v[16:19], v[60:63]
    ds_read_b64_tr_b16 v[36:37], v9 offset:41984
    ds_read_b64_tr_b16 v[38:39], v9 offset:43264
    s_add_u32 m0, s55, 0x21c00
    s_add_u32 s56, s12, 0xb4000
    buffer_load_dwordx4 v5, s[28:31], s56 offen lds
    v_mfma_f32_16x16x32_bf16 v[64:67], v[112:115], v[20:23], v[64:67]
    ds_read_b64_tr_b16 v[40:41], v9 offset:42024
    ds_read_b64_tr_b16 v[42:43], v9 offset:43304
    s_add_u32 m0, s55, 0x22000
    s_add_u32 s56, s12, 0xb4000
    s_mov_b32 exec_hi, 0
    buffer_load_dwordx4 v6, s[28:31], s56 offen lds
    s_mov_b32 exec_hi, -1
    v_mfma_f32_16x16x32_bf16 v[68:71], v[116:119], v[20:23], v[68:71]
    ds_read_b64_tr_b16 v[44:45], v9 offset:42064
    ds_read_b64_tr_b16 v[46:47], v9 offset:43344
    v_mfma_f32_16x16x32_bf16 v[72:75], v[112:115], v[24:27], v[72:75]
    ds_read_b64_tr_b16 v[48:49], v9 offset:42104
    ds_read_b64_tr_b16 v[50:51], v9 offset:43384
    v_mfma_f32_16x16x32_bf16 v[76:79], v[116:119], v[24:27], v[76:79]
    ds_read_b64_tr_b16 v[52:53], v10 offset:41984
    ds_read_b64_tr_b16 v[54:55], v10 offset:43264
    v_mfma_f32_16x16x32_bf16 v[80:83], v[112:115], v[28:31], v[80:83]
    v_mfma_f32_16x16x32_bf16 v[84:87], v[116:119], v[28:31], v[84:87]
    v_mfma_f32_16x16x32_bf16 v[88:91], v[112:115], v[32:35], v[88:91]
    v_mfma_f32_16x16x32_bf16 v[92:95], v[116:119], v[32:35], v[92:95]
    s_waitcnt lgkmcnt(0)
    s_waitcnt vmcnt(5)
    s_barrier
    v_mfma_f32_16x16x32_bf16 v[56:59], v[120:123], v[36:39], v[56:59]
    v_add_u32 v7, 0x12000, v7
    v_add_u32 v8, 0x12000, v8
    ds_read_b128 v[128:131], v7 offset:0
    ds_read_b128 v[132:135], v7 offset:2048
    s_bitcmp1_b32 s20, 4
    s_cselect_b32 s21, 0x500, 0
    s_sub_u32 s21, s52, s21
    s_add_u32 m0, s54, 0x0
    s_add_u32 s56, s21, 0x200
    buffer_load_dwordx4 v3, s[24:27], s56 offen lds
    v_mfma_f32_16x16x32_bf16 v[60:63], v[124:127], v[36:39], v[60:63]
    v_add_u32 v9, 0x12000, v9
    v_add_u32 v10, 0x12000, v10
    ds_read_b64_tr_b16 v[16:17], v9 offset:0
    ds_read_b64_tr_b16 v[18:19], v9 offset:1280
    s_add_u32 m0, s54, 0x2000
    s_add_u32 s56, s21, 0x14200
    buffer_load_dwordx4 v3, s[24:27], s56 offen lds
    v_mfma_f32_16x16x32_bf16 v[64:67], v[120:123], v[40:43], v[64:67]
    ds_read_b64_tr_b16 v[20:21], v9 offset:40
    ds_read_b64_tr_b16 v[22:23], v9 offset:1320
    v_mfma_f32_16x16x32_bf16 v[68:71], v[124:127], v[40:43], v[68:71]
    ds_read_b64_tr_b16 v[24:25], v9 offset:80
    ds_read_b64_tr_b16 v[26:27], v9 offset:1360
    v_mfma_f32_16x16x32_bf16 v[72:75], v[120:123], v[44:47], v[72:75]
    ds_read_b64_tr_b16 v[28:29], v9 offset:120
    ds_read_b64_tr_b16 v[30:31], v9 offset:1400
    v_mfma_f32_16x16x32_bf16 v[76:79], v[124:127], v[44:47], v[76:79]
    ds_read_b64_tr_b16 v[32:33], v10 offset:0
    ds_read_b64_tr_b16 v[34:35], v10 offset:1280
    v_mfma_f32_16x16x32_bf16 v[80:83], v[120:123], v[48:51], v[80:83]
    v_mfma_f32_16x16x32_bf16 v[84:87], v[124:127], v[48:51], v[84:87]
    v_mfma_f32_16x16x32_bf16 v[88:91], v[120:123], v[52:55], v[88:91]
    v_mfma_f32_16x16x32_bf16 v[92:95], v[124:127], v[52:55], v[92:95]
    s_waitcnt lgkmcnt(0)
    v_mfma_f32_16x16x32_bf16 v[56:59], v[128:131], v[16:19], v[56:59]
    ds_read_b128 v[136:139], v8 offset:0
    ds_read_b128 v[140:143], v8 offset:2048
    s_bitcmp1_b32 s20, 4
    s_cselect_b32 s12, 0x258000, 0
    s_sub_u32 s12, s53, s12
    s_add_u32 m0, s55, 0x6800
    s_add_u32 s56, s12, 0xf0000
    buffer_load_dwordx4 v4, s[28:31], s56 offen lds
    v_mfma_f32_16x16x32_bf16 v[60:63], v[132:135], v[16:19], v[60:63]
    ds_read_b64_tr_b16 v[36:37], v9 offset:5120
    ds_read_b64_tr_b16 v[38:39], v9 offset:6400
    s_add_u32 m0, s55, 0x6c00
    s_add_u32 s56, s12, 0xf0000
    buffer_load_dwordx4 v5, s[28:31], s56 offen lds
    v_mfma_f32_16x16x32_bf16 v[64:67], v[128:131], v[20:23], v[64:67]
    ds_read_b64_tr_b16 v[40:41], v9 offset:5160
    ds_read_b64_tr_b16 v[42:43], v9 offset:6440
    s_add_u32 m0, s55, 0x7000
    s_add_u32 s56, s12, 0xf0000
    s_mov_b32 exec_hi, 0
    buffer_load_dwordx4 v6, s[28:31], s56 offen lds
    s_mov_b32 exec_hi, -1
    v_mfma_f32_16x16x32_bf16 v[68:71], v[132:135], v[20:23], v[68:71]
    ds_read_b64_tr_b16 v[44:45], v9 offset:5200
    ds_read_b64_tr_b16 v[46:47], v9 offset:6480
    v_mfma_f32_16x16x32_bf16 v[72:75], v[128:131], v[24:27], v[72:75]
    ds_read_b64_tr_b16 v[48:49], v9 offset:5240
    ds_read_b64_tr_b16 v[50:51], v9 offset:6520
    v_mfma_f32_16x16x32_bf16 v[76:79], v[132:135], v[24:27], v[76:79]
    ds_read_b64_tr_b16 v[52:53], v10 offset:5120
    ds_read_b64_tr_b16 v[54:55], v10 offset:6400
    v_mfma_f32_16x16x32_bf16 v[80:83], v[128:131], v[28:31], v[80:83]
    v_mfma_f32_16x16x32_bf16 v[84:87], v[132:135], v[28:31], v[84:87]
    v_mfma_f32_16x16x32_bf16 v[88:91], v[128:131], v[32:35], v[88:91]
    v_mfma_f32_16x16x32_bf16 v[92:95], v[132:135], v[32:35], v[92:95]
    s_waitcnt lgkmcnt(0)
    s_waitcnt vmcnt(5)
    s_barrier
    v_mfma_f32_16x16x32_bf16 v[56:59], v[136:139], v[36:39], v[56:59]
    ds_read_b128 v[144:147], v7 offset:36864
    ds_read_b128 v[148:151], v7 offset:38912
    s_bitcmp1_b32 s20, 5
    s_cselect_b32 s21, 0x500, 0
    s_sub_u32 s21, s52, s21
    s_add_u32 m0, s54, 0x9000
    s_add_u32 s56, s21, 0x280
    buffer_load_dwordx4 v3, s[24:27], s56 offen lds
    v_mfma_f32_16x16x32_bf16 v[60:63], v[140:143], v[36:39], v[60:63]
    ds_read_b64_tr_b16 v[16:17], v9 offset:36864
    ds_read_b64_tr_b16 v[18:19], v9 offset:38144
    s_add_u32 m0, s54, 0xb000
    s_add_u32 s56, s21, 0x14280
    buffer_load_dwordx4 v3, s[24:27], s56 offen lds
    v_mfma_f32_16x16x32_bf16 v[64:67], v[136:139], v[40:43], v[64:67]
    ds_read_b64_tr_b16 v[20:21], v9 offset:36904
    ds_read_b64_tr_b16 v[22:23], v9 offset:38184
    v_mfma_f32_16x16x32_bf16 v[68:71], v[140:143], v[40:43], v[68:71]
    ds_read_b64_tr_b16 v[24:25], v9 offset:36944
    ds_read_b64_tr_b16 v[26:27], v9 offset:38224
    v_mfma_f32_16x16x32_bf16 v[72:75], v[136:139], v[44:47], v[72:75]
    ds_read_b64_tr_b16 v[28:29], v9 offset:36984
    ds_read_b64_tr_b16 v[30:31], v9 offset:38264
    v_mfma_f32_16x16x32_bf16 v[76:79], v[140:143], v[44:47], v[76:79]
    ds_read_b64_tr_b16 v[32:33], v10 offset:36864
    ds_read_b64_tr_b16 v[34:35], v10 offset:38144
    v_mfma_f32_16x16x32_bf16 v[80:83], v[136:139], v[48:51], v[80:83]
    v_mfma_f32_16x16x32_bf16 v[84:87], v[140:143], v[48:51], v[84:87]
    v_mfma_f32_16x16x32_bf16 v[88:91], v[136:139], v[52:55], v[88:91]
    v_mfma_f32_16x16x32_bf16 v[92:95], v[140:143], v[52:55], v[92:95]
    s_waitcnt lgkmcnt(0)
    v_mfma_f32_16x16x32_bf16 v[56:59], v[144:147], v[16:19], v[56:59]
    ds_read_b128 v[152:155], v8 offset:36864
    ds_read_b128 v[156:159], v8 offset:38912
    s_bitcmp1_b32 s20, 5
    s_cselect_b32 s12, 0x258000, 0
    s_sub_u32 s12, s53, s12
    s_add_u32 m0, s55, 0xf800
    s_add_u32 s56, s12, 0x12c000
    buffer_load_dwordx4 v4, s[28:31], s56 offen lds
    v_mfma_f32_16x16x32_bf16 v[60:63], v[148:151], v[16:19], v[60:63]
    ds_read_b64_tr_b16 v[36:37], v9 offset:41984
    ds_read_b64_tr_b16 v[38:39], v9 offset:43264
    s_add_u32 m0, s55, 0xfc00
    s_add_u32 s56, s12, 0x12c000
    buffer_load_dwordx4 v5, s[28:31], s56 offen lds
    v_mfma_f32_16x16x32_bf16 v[64:67], v[144:147], v[20:23], v[64:67]
    ds_read_b64_tr_b16 v[40:41], v9 offset:42024
    ds_read_b64_tr_b16 v[42:43], v9 offset:43304
    s_add_u32 m0, s55, 0x10000
    s_add_u32 s56, s12, 0x12c000
    s_mov_b32 exec_hi, 0
    buffer_load_dwordx4 v6, s[28:31], s56 offen lds
    s_mov_b32 exec_hi, -1
    v_mfma_f32_16x16x32_bf16 v[68:71], v[148:151], v[20:23], v[68:71]
    ds_read_b64_tr_b16 v[44:45], v9 offset:42064
    ds_read_b64_tr_b16 v[46:47], v9 offset:43344
    v_mfma_f32_16x16x32_bf16 v[72:75], v[144:147], v[24:27], v[72:75]
    ds_read_b64_tr_b16 v[48:49], v9 offset:42104
    ds_read_b64_tr_b16 v[50:51], v9 offset:43384
    v_mfma_f32_16x16x32_bf16 v[76:79], v[148:151], v[24:27], v[76:79]
    ds_read_b64_tr_b16 v[52:53], v10 offset:41984
    ds_read_b64_tr_b16 v[54:55], v10 offset:43264
    v_mfma_f32_16x16x32_bf16 v[80:83], v[144:147], v[28:31], v[80:83]
    v_mfma_f32_16x16x32_bf16 v[84:87], v[148:151], v[28:31], v[84:87]
    v_mfma_f32_16x16x32_bf16 v[88:91], v[144:147], v[32:35], v[88:91]
    v_mfma_f32_16x16x32_bf16 v[92:95], v[148:151], v[32:35], v[92:95]
    s_waitcnt lgkmcnt(0)
    s_waitcnt vmcnt(5)
    s_barrier
    v_mfma_f32_16x16x32_bf16 v[56:59], v[152:155], v[36:39], v[56:59]
    v_add_u32 v7, 0xfffee000, v7
    v_add_u32 v8, 0xfffee000, v8
    ds_read_b128 v[160:163], v7 offset:0
    ds_read_b128 v[164:167], v7 offset:2048
    s_bitcmp1_b32 s20, 6
    s_cselect_b32 s21, 0x500, 0
    s_sub_u32 s21, s52, s21
    s_add_u32 m0, s54, 0x12000
    s_add_u32 s56, s21, 0x300
    buffer_load_dwordx4 v3, s[24:27], s56 offen lds
    v_mfma_f32_16x16x32_bf16 v[60:63], v[156:159], v[36:39], v[60:63]
    v_add_u32 v9, 0xfffee000, v9
    v_add_u32 v10, 0xfffee000, v10
    ds_read_b64_tr_b16 v[16:17], v9 offset:0
    ds_read_b64_tr_b16 v[18:19], v9 offset:1280
    s_add_u32 m0, s54, 0x14000
    s_add_u32 s56, s21, 0x14300
    buffer_load_dwordx4 v3, s[24:27], s56 offen lds
    v_mfma_f32_16x16x32_bf16 v[64:67], v[152:155], v[40:43], v[64:67]
    ds_read_b64_tr_b16 v[20:21], v9 offset:40
    ds_read_b64_tr_b16 v[22:23], v9 offset:1320
    v_mfma_f32_16x16x32_bf16 v[68:71], v[156:159], v[40:43], v[68:71]
    ds_read_b64_tr_b16 v[24:25], v9 offset:80
    ds_read_b64_tr_b16 v[26:27], v9 offset:1360
    v_mfma_f32_16x16x32_bf16 v[72:75], v[152:155], v[44:47], v[72:75]
    ds_read_b64_tr_b16 v[28:29], v9 offset:120
    ds_read_b64_tr_b16 v[30:31], v9 offset:1400
    v_mfma_f32_16x16x32_bf16 v[76:79], v[156:159], v[44:47], v[76:79]
    ds_read_b64_tr_b16 v[32:33], v10 offset:0
    ds_read_b64_tr_b16 v[34:35], v10 offset:1280
    v_mfma_f32_16x16x32_bf16 v[80:83], v[152:155], v[48:51], v[80:83]
    v_mfma_f32_16x16x32_bf16 v[84:87], v[156:159], v[48:51], v[84:87]
    v_mfma_f32_16x16x32_bf16 v[88:91], v[152:155], v[52:55], v[88:91]
    v_mfma_f32_16x16x32_bf16 v[92:95], v[156:159], v[52:55], v[92:95]
    s_waitcnt lgkmcnt(0)
    v_mfma_f32_16x16x32_bf16 v[56:59], v[160:163], v[16:19], v[56:59]
    ds_read_b128 v[168:171], v8 offset:0
    ds_read_b128 v[172:175], v8 offset:2048
    s_bitcmp1_b32 s20, 6
    s_cselect_b32 s12, 0x258000, 0
    s_sub_u32 s12, s53, s12
    s_add_u32 m0, s55, 0x18800
    s_add_u32 s56, s12, 0x168000
    buffer_load_dwordx4 v4, s[28:31], s56 offen lds
    v_mfma_f32_16x16x32_bf16 v[60:63], v[164:167], v[16:19], v[60:63]
    ds_read_b64_tr_b16 v[36:37], v9 offset:5120
    ds_read_b64_tr_b16 v[38:39], v9 offset:6400
    s_add_u32 m0, s55, 0x18c00
    s_add_u32 s56, s12, 0x168000
    buffer_load_dwordx4 v5, s[28:31], s56 offen lds
    v_mfma_f32_16x16x32_bf16 v[64:67], v[160:163], v[20:23], v[64:67]
    ds_read_b64_tr_b16 v[40:41], v9 offset:5160
    ds_read_b64_tr_b16 v[42:43], v9 offset:6440
    s_add_u32 m0, s55, 0x19000
    s_add_u32 s56, s12, 0x168000
    s_mov_b32 exec_hi, 0
    buffer_load_dwordx4 v6, s[28:31], s56 offen lds
    s_mov_b32 exec_hi, -1
    v_mfma_f32_16x16x32_bf16 v[68:71], v[164:167], v[20:23], v[68:71]
    ds_read_b64_tr_b16 v[44:45], v9 offset:5200
    ds_read_b64_tr_b16 v[46:47], v9 offset:6480
    v_mfma_f32_16x16x32_bf16 v[72:75], v[160:163], v[24:27], v[72:75]
    ds_read_b64_tr_b16 v[48:49], v9 offset:5240
    ds_read_b64_tr_b16 v[50:51], v9 offset:6520
    v_mfma_f32_16x16x32_bf16 v[76:79], v[164:167], v[24:27], v[76:79]
    ds_read_b64_tr_b16 v[52:53], v10 offset:5120
    ds_read_b64_tr_b16 v[54:55], v10 offset:6400
    v_mfma_f32_16x16x32_bf16 v[80:83], v[160:163], v[28:31], v[80:83]
    v_mfma_f32_16x16x32_bf16 v[84:87], v[164:167], v[28:31], v[84:87]
    v_mfma_f32_16x16x32_bf16 v[88:91], v[160:163], v[32:35], v[88:91]
    v_mfma_f32_16x16x32_bf16 v[92:95], v[164:167], v[32:35], v[92:95]
    s_waitcnt lgkmcnt(0)
    s_waitcnt vmcnt(5)
    s_barrier
    v_mfma_f32_16x16x32_bf16 v[56:59], v[168:171], v[36:39], v[56:59]
    ds_read_b128 v[176:179], v7 offset:36864
    ds_read_b128 v[180:183], v7 offset:38912
    s_bitcmp1_b32 s20, 7
    s_cselect_b32 s21, 0x500, 0
    s_sub_u32 s21, s52, s21
    s_add_u32 m0, s54, 0x1b000
    s_add_u32 s56, s21, 0x380
    buffer_load_dwordx4 v3, s[24:27], s56 offen lds
    v_mfma_f32_16x16x32_bf16 v[60:63], v[172:175], v[36:39], v[60:63]
    ds_read_b64_tr_b16 v[16:17], v9 offset:36864
    ds_read_b64_tr_b16 v[18:19], v9 offset:38144
    s_add_u32 m0, s54, 0x1d000
    s_add_u32 s56, s21, 0x14380
    buffer_load_dwordx4 v3, s[24:27], s56 offen lds
    v_mfma_f32_16x16x32_bf16 v[64:67], v[168:171], v[40:43], v[64:67]
    ds_read_b64_tr_b16 v[20:21], v9 offset:36904
    ds_read_b64_tr_b16 v[22:23], v9 offset:38184
    v_mfma_f32_16x16x32_bf16 v[68:71], v[172:175], v[40:43], v[68:71]
    ds_read_b64_tr_b16 v[24:25], v9 offset:36944
    ds_read_b64_tr_b16 v[26:27], v9 offset:38224
    v_mfma_f32_16x16x32_bf16 v[72:75], v[168:171], v[44:47], v[72:75]
    ds_read_b64_tr_b16 v[28:29], v9 offset:36984
    ds_read_b64_tr_b16 v[30:31], v9 offset:38264
    v_mfma_f32_16x16x32_bf16 v[76:79], v[172:175], v[44:47], v[76:79]
    ds_read_b64_tr_b16 v[32:33], v10 offset:36864
    ds_read_b64_tr_b16 v[34:35], v10 offset:38144
    v_mfma_f32_16x16x32_bf16 v[80:83], v[168:171], v[48:51], v[80:83]
    v_mfma_f32_16x16x32_bf16 v[84:87], v[172:175], v[48:51], v[84:87]
    v_mfma_f32_16x16x32_bf16 v[88:91], v[168:171], v[52:55], v[88:91]
    v_mfma_f32_16x16x32_bf16 v[92:95], v[172:175], v[52:55], v[92:95]
    s_waitcnt lgkmcnt(0)
    v_mfma_f32_16x16x32_bf16 v[56:59], v[176:179], v[16:19], v[56:59]
    ds_read_b128 v[184:187], v8 offset:36864
    ds_read_b128 v[188:191], v8 offset:38912
    s_bitcmp1_b32 s20, 7
    s_cselect_b32 s12, 0x258000, 0
    s_sub_u32 s12, s53, s12
    s_add_u32 m0, s55, 0x21800
    s_add_u32 s56, s12, 0x1a4000
    buffer_load_dwordx4 v4, s[28:31], s56 offen lds
    v_mfma_f32_16x16x32_bf16 v[60:63], v[180:183], v[16:19], v[60:63]
    ds_read_b64_tr_b16 v[36:37], v9 offset:41984
    ds_read_b64_tr_b16 v[38:39], v9 offset:43264
    s_add_u32 m0, s55, 0x21c00
    s_add_u32 s56, s12, 0x1a4000
    buffer_load_dwordx4 v5, s[28:31], s56 offen lds
    v_mfma_f32_16x16x32_bf16 v[64:67], v[176:179], v[20:23], v[64:67]
    ds_read_b64_tr_b16 v[40:41], v9 offset:42024
    ds_read_b64_tr_b16 v[42:43], v9 offset:43304
    s_add_u32 m0, s55, 0x22000
    s_add_u32 s56, s12, 0x1a4000
    s_mov_b32 exec_hi, 0
    buffer_load_dwordx4 v6, s[28:31], s56 offen lds
    s_mov_b32 exec_hi, -1
    v_mfma_f32_16x16x32_bf16 v[68:71], v[180:183], v[20:23], v[68:71]
    ds_read_b64_tr_b16 v[44:45], v9 offset:42064
    ds_read_b64_tr_b16 v[46:47], v9 offset:43344
    v_mfma_f32_16x16x32_bf16 v[72:75], v[176:179], v[24:27], v[72:75]
    ds_read_b64_tr_b16 v[48:49], v9 offset:42104
    ds_read_b64_tr_b16 v[50:51], v9 offset:43384
    v_mfma_f32_16x16x32_bf16 v[76:79], v[180:183], v[24:27], v[76:79]
    ds_read_b64_tr_b16 v[52:53], v10 offset:41984
    ds_read_b64_tr_b16 v[54:55], v10 offset:43264
    v_mfma_f32_16x16x32_bf16 v[80:83], v[176:179], v[28:31], v[80:83]
    v_mfma_f32_16x16x32_bf16 v[84:87], v[180:183], v[28:31], v[84:87]
    v_mfma_f32_16x16x32_bf16 v[88:91], v[176:179], v[32:35], v[88:91]
    v_mfma_f32_16x16x32_bf16 v[92:95], v[180:183], v[32:35], v[92:95]
    s_waitcnt lgkmcnt(0)
    s_waitcnt vmcnt(5)
    s_barrier
    v_mfma_f32_16x16x32_bf16 v[56:59], v[184:187], v[36:39], v[56:59]
    v_add_u32 v7, 0x12000, v7
    v_add_u32 v8, 0x12000, v8
    ds_read_b128 v[192:195], v7 offset:0
    ds_read_b128 v[196:199], v7 offset:2048
    s_bitcmp1_b32 s20, 8
    s_cselect_b32 s21, 0x500, 0
    s_sub_u32 s21, s52, s21
    s_add_u32 m0, s54, 0x0
    s_add_u32 s56, s21, 0x400
    buffer_load_dwordx4 v3, s[24:27], s56 offen lds
    v_mfma_f32_16x16x32_bf16 v[60:63], v[188:191], v[36:39], v[60:63]
    v_add_u32 v9, 0x12000, v9
    v_add_u32 v10, 0x12000, v10
    ds_read_b64_tr_b16 v[16:17], v9 offset:0
    ds_read_b64_tr_b16 v[18:19], v9 offset:1280
    s_add_u32 m0, s54, 0x2000
    s_add_u32 s56, s21, 0x14400
    buffer_load_dwordx4 v3, s[24:27], s56 offen lds
    v_mfma_f32_16x16x32_bf16 v[64:67], v[184:187], v[40:43], v[64:67]
    ds_read_b64_tr_b16 v[20:21], v9 offset:40
    ds_read_b64_tr_b16 v[22:23], v9 offset:1320
    v_mfma_f32_16x16x32_bf16 v[68:71], v[188:191], v[40:43], v[68:71]
    ds_read_b64_tr_b16 v[24:25], v9 offset:80
    ds_read_b64_tr_b16 v[26:27], v9 offset:1360
    v_mfma_f32_16x16x32_bf16 v[72:75], v[184:187], v[44:47], v[72:75]
    ds_read_b64_tr_b16 v[28:29], v9 offset:120
    ds_read_b64_tr_b16 v[30:31], v9 offset:1400
    v_mfma_f32_16x16x32_bf16 v[76:79], v[188:191], v[44:47], v[76:79]
    ds_read_b64_tr_b16 v[32:33], v10 offset:0
    ds_read_b64_tr_b16 v[34:35], v10 offset:1280
    v_mfma_f32_16x16x32_bf16 v[80:83], v[184:187], v[48:51], v[80:83]
    v_mfma_f32_16x16x32_bf16 v[84:87], v[188:191], v[48:51], v[84:87]
    v_mfma_f32_16x16x32_bf16 v[88:91], v[184:187], v[52:55], v[88:91]
    v_mfma_f32_16x16x32_bf16 v[92:95], v[188:191], v[52:55], v[92:95]
    s_waitcnt lgkmcnt(0)
    v_mfma_f32_16x16x32_bf16 v[56:59], v[192:195], v[16:19], v[56:59]
    ds_read_b128 v[200:203], v8 offset:0
    ds_read_b128 v[204:207], v8 offset:2048
    s_bitcmp1_b32 s20, 8
    s_cselect_b32 s12, 0x258000, 0
    s_sub_u32 s12, s53, s12
    s_add_u32 m0, s55, 0x6800
    s_add_u32 s56, s12, 0x1e0000
    buffer_load_dwordx4 v4, s[28:31], s56 offen lds
    v_mfma_f32_16x16x32_bf16 v[60:63], v[196:199], v[16:19], v[60:63]
    ds_read_b64_tr_b16 v[36:37], v9 offset:5120
    ds_read_b64_tr_b16 v[38:39], v9 offset:6400
    s_add_u32 m0, s55, 0x6c00
    s_add_u32 s56, s12, 0x1e0000
    buffer_load_dwordx4 v5, s[28:31], s56 offen lds
    v_mfma_f32_16x16x32_bf16 v[64:67], v[192:195], v[20:23], v[64:67]
    ds_read_b64_tr_b16 v[40:41], v9 offset:5160
    ds_read_b64_tr_b16 v[42:43], v9 offset:6440
    s_add_u32 m0, s55, 0x7000
    s_add_u32 s56, s12, 0x1e0000
    s_mov_b32 exec_hi, 0
    buffer_load_dwordx4 v6, s[28:31], s56 offen lds
    s_mov_b32 exec_hi, -1
    v_mfma_f32_16x16x32_bf16 v[68:71], v[196:199], v[20:23], v[68:71]
    ds_read_b64_tr_b16 v[44:45], v9 offset:5200
    ds_read_b64_tr_b16 v[46:47], v9 offset:6480
    v_mfma_f32_16x16x32_bf16 v[72:75], v[192:195], v[24:27], v[72:75]
    ds_read_b64_tr_b16 v[48:49], v9 offset:5240
    ds_read_b64_tr_b16 v[50:51], v9 offset:6520
    v_mfma_f32_16x16x32_bf16 v[76:79], v[196:199], v[24:27], v[76:79]
    ds_read_b64_tr_b16 v[52:53], v10 offset:5120
    ds_read_b64_tr_b16 v[54:55], v10 offset:6400
    v_mfma_f32_16x16x32_bf16 v[80:83], v[192:195], v[28:31], v[80:83]
    v_mfma_f32_16x16x32_bf16 v[84:87], v[196:199], v[28:31], v[84:87]
    v_mfma_f32_16x16x32_bf16 v[88:91], v[192:195], v[32:35], v[88:91]
    v_mfma_f32_16x16x32_bf16 v[92:95], v[196:199], v[32:35], v[92:95]
    s_waitcnt lgkmcnt(0)
    s_waitcnt vmcnt(5)
    s_barrier
    v_mfma_f32_16x16x32_bf16 v[56:59], v[200:203], v[36:39], v[56:59]
    ds_read_b128 v[208:211], v7 offset:36864
    ds_read_b128 v[212:215], v7 offset:38912
    s_bitcmp1_b32 s20, 9
    s_cselect_b32 s21, 0x500, 0
    s_sub_u32 s21, s52, s21
    s_add_u32 m0, s54, 0x9000
    s_add_u32 s56, s21, 0x480
    buffer_load_dwordx4 v3, s[24:27], s56 offen lds
    v_mfma_f32_16x16x32_bf16 v[60:63], v[204:207], v[36:39], v[60:63]
    ds_read_b64_tr_b16 v[16:17], v9 offset:36864
    ds_read_b64_tr_b16 v[18:19], v9 offset:38144
    s_add_u32 m0, s54, 0xb000
    s_add_u32 s56, s21, 0x14480
    buffer_load_dwordx4 v3, s[24:27], s56 offen lds
    v_mfma_f32_16x16x32_bf16 v[64:67], v[200:203], v[40:43], v[64:67]
    ds_read_b64_tr_b16 v[20:21], v9 offset:36904
    ds_read_b64_tr_b16 v[22:23], v9 offset:38184
    v_mfma_f32_16x16x32_bf16 v[68:71], v[204:207], v[40:43], v[68:71]
    ds_read_b64_tr_b16 v[24:25], v9 offset:36944
    ds_read_b64_tr_b16 v[26:27], v9 offset:38224
    v_mfma_f32_16x16x32_bf16 v[72:75], v[200:203], v[44:47], v[72:75]
    ds_read_b64_tr_b16 v[28:29], v9 offset:36984
    ds_read_b64_tr_b16 v[30:31], v9 offset:38264
    v_mfma_f32_16x16x32_bf16 v[76:79], v[204:207], v[44:47], v[76:79]
    ds_read_b64_tr_b16 v[32:33], v10 offset:36864
    ds_read_b64_tr_b16 v[34:35], v10 offset:38144
    v_mfma_f32_16x16x32_bf16 v[80:83], v[200:203], v[48:51], v[80:83]
    v_mfma_f32_16x16x32_bf16 v[84:87], v[204:207], v[48:51], v[84:87]
    v_mfma_f32_16x16x32_bf16 v[88:91], v[200:203], v[52:55], v[88:91]
    v_mfma_f32_16x16x32_bf16 v[92:95], v[204:207], v[52:55], v[92:95]
    s_waitcnt lgkmcnt(0)
    v_mfma_f32_16x16x32_bf16 v[56:59], v[208:211], v[16:19], v[56:59]
    ds_read_b128 v[216:219], v8 offset:36864
    ds_read_b128 v[220:223], v8 offset:38912
    s_bitcmp1_b32 s20, 9
    s_cselect_b32 s12, 0x258000, 0
    s_sub_u32 s12, s53, s12
    s_add_u32 m0, s55, 0xf800
    s_add_u32 s56, s12, 0x21c000
    buffer_load_dwordx4 v4, s[28:31], s56 offen lds
    v_mfma_f32_16x16x32_bf16 v[60:63], v[212:215], v[16:19], v[60:63]
    ds_read_b64_tr_b16 v[36:37], v9 offset:41984
    ds_read_b64_tr_b16 v[38:39], v9 offset:43264
    s_add_u32 m0, s55, 0xfc00
    s_add_u32 s56, s12, 0x21c000
    buffer_load_dwordx4 v5, s[28:31], s56 offen lds
    v_mfma_f32_16x16x32_bf16 v[64:67], v[208:211], v[20:23], v[64:67]
    ds_read_b64_tr_b16 v[40:41], v9 offset:42024
    ds_read_b64_tr_b16 v[42:43], v9 offset:43304
    s_add_u32 m0, s55, 0x10000
    s_add_u32 s56, s12, 0x21c000
    s_mov_b32 exec_hi, 0
    buffer_load_dwordx4 v6, s[28:31], s56 offen lds
    s_mov_b32 exec_hi, -1
    v_mfma_f32_16x16x32_bf16 v[68:71], v[212:215], v[20:23], v[68:71]
    ds_read_b64_tr_b16 v[44:45], v9 offset:42064
    ds_read_b64_tr_b16 v[46:47], v9 offset:43344
    s_bitcmp1_b32 s20, 0
    s_cselect_b32 s12, 0x21c000, 0
    s_sub_u32 s12, s64, s12
    s_add_u32 m0, s65, 0x12000
    s_add_u32 s56, s12, 0x0
    buffer_load_dwordx4 v11, s[36:39], s56 offen lds
    v_mfma_f32_16x16x32_bf16 v[72:75], v[208:211], v[24:27], v[72:75]
    ds_read_b64_tr_b16 v[48:49], v9 offset:42104
    ds_read_b64_tr_b16 v[50:51], v9 offset:43384
    s_add_u32 m0, s65, 0x12400
    s_add_u32 s56, s12, 0x3600
    buffer_load_dwordx4 v11, s[36:39], s56 offen lds
    v_mfma_f32_16x16x32_bf16 v[76:79], v[212:215], v[24:27], v[76:79]
    ds_read_b64_tr_b16 v[52:53], v10 offset:41984
    ds_read_b64_tr_b16 v[54:55], v10 offset:43264
    v_mfma_f32_16x16x32_bf16 v[80:83], v[208:211], v[28:31], v[80:83]
    v_mfma_f32_16x16x32_bf16 v[84:87], v[212:215], v[28:31], v[84:87]
    v_mfma_f32_16x16x32_bf16 v[88:91], v[208:211], v[32:35], v[88:91]
    v_mfma_f32_16x16x32_bf16 v[92:95], v[212:215], v[32:35], v[92:95]
    s_waitcnt lgkmcnt(0)
    s_waitcnt vmcnt(7)
    s_barrier
    v_mfma_f32_16x16x32_bf16 v[56:59], v[216:219], v[36:39], v[56:59]
    v_add_u32 v7, 0xfffee000, v7
    v_add_u32 v8, 0xfffee000, v8
    ds_read_b128 v[224:227], v7 offset:0
    ds_read_b128 v[228:231], v7 offset:2048
    s_bitcmp1_b32 s20, 1
    s_cselect_b32 s12, 0x21c000, 0
    s_sub_u32 s12, s64, s12
    s_add_u32 m0, s65, 0x14000
    s_add_u32 s56, s12, 0x36000
    buffer_load_dwordx4 v11, s[36:39], s56 offen lds
    v_mfma_f32_16x16x32_bf16 v[60:63], v[220:223], v[36:39], v[60:63]
    v_add_u32 v9, 0xfffee000, v9
    v_add_u32 v10, 0xfffee000, v10
    ds_read_b64_tr_b16 v[16:17], v9 offset:0
    ds_read_b64_tr_b16 v[18:19], v9 offset:1280
    s_add_u32 m0, s65, 0x14400
    s_add_u32 s56, s12, 0x39600
    buffer_load_dwordx4 v11, s[36:39], s56 offen lds
    v_mfma_f32_16x16x32_bf16 v[64:67], v[216:219], v[40:43], v[64:67]
    ds_read_b64_tr_b16 v[20:21], v9 offset:40
    ds_read_b64_tr_b16 v[22:23], v9 offset:1320
    s_bitcmp1_b32 s20, 2
    s_cselect_b32 s12, 0x21c000, 0
    s_sub_u32 s12, s64, s12
    s_add_u32 m0, s65, 0x16000
    s_add_u32 s56, s12, 0x6c000
    buffer_load_dwordx4 v11, s[36:39], s56 offen lds
    v_mfma_f32_16x16x32_bf16 v[68:71], v[220:223], v[40:43], v[68:71]
    ds_read_b64_tr_b16 v[24:25], v9 offset:80
    ds_read_b64_tr_b16 v[26:27], v9 offset:1360
    s_add_u32 m0, s65, 0x16400
    s_add_u32 s56, s12, 0x6f600
    buffer_load_dwordx4 v11, s[36:39], s56 offen lds
    v_mfma_f32_16x16x32_bf16 v[72:75], v[216:219], v[44:47], v[72:75]
    ds_read_b64_tr_b16 v[28:29], v9 offset:120
    ds_read_b64_tr_b16 v[30:31], v9 offset:1400
    v_mfma_f32_16x16x32_bf16 v[76:79], v[220:223], v[44:47], v[76:79]
    ds_read_b64_tr_b16 v[32:33], v10 offset:0
    ds_read_b64_tr_b16 v[34:35], v10 offset:1280
    v_mfma_f32_16x16x32_bf16 v[80:83], v[216:219], v[48:51], v[80:83]
    v_mfma_f32_16x16x32_bf16 v[84:87], v[220:223], v[48:51], v[84:87]
    v_mfma_f32_16x16x32_bf16 v[88:91], v[216:219], v[52:55], v[88:91]
    v_mfma_f32_16x16x32_bf16 v[92:95], v[220:223], v[52:55], v[92:95]
    s_waitcnt lgkmcnt(0)
    v_mfma_f32_16x16x32_bf16 v[56:59], v[224:227], v[16:19], v[56:59]
    ds_read_b128 v[232:235], v8 offset:0
    ds_read_b128 v[236:239], v8 offset:2048
    s_bitcmp1_b32 s20, 3
    s_cselect_b32 s12, 0x21c000, 0
    s_sub_u32 s12, s64, s12
    s_add_u32 m0, s65, 0x18000
    s_add_u32 s56, s12, 0xa2000
    buffer_load_dwordx4 v11, s[36:39], s56 offen lds
    v_mfma_f32_16x16x32_bf16 v[60:63], v[228:231], v[16:19], v[60:63]
    ds_read_b64_tr_b16 v[36:37], v9 offset:5120
    ds_read_b64_tr_b16 v[38:39], v9 offset:6400
    s_add_u32 m0, s65, 0x18400
    s_add_u32 s56, s12, 0xa5600
    buffer_load_dwordx4 v11, s[36:39], s56 offen lds
    v_mfma_f32_16x16x32_bf16 v[64:67], v[224:227], v[20:23], v[64:67]
    ds_read_b64_tr_b16 v[40:41], v9 offset:5160
    ds_read_b64_tr_b16 v[42:43], v9 offset:6440
    s_bitcmp1_b32 s20, 4
    s_cselect_b32 s12, 0x21c000, 0
    s_sub_u32 s12, s64, s12
    s_add_u32 m0, s65, 0x1a000
    s_add_u32 s56, s12, 0xd8000
    buffer_load_dwordx4 v11, s[36:39], s56 offen lds
    v_mfma_f32_16x16x32_bf16 v[68:71], v[228:231], v[20:23], v[68:71]
    ds_read_b64_tr_b16 v[44:45], v9 offset:5200
    ds_read_b64_tr_b16 v[46:47], v9 offset:6480
    s_add_u32 m0, s65, 0x1a400
    s_add_u32 s56, s12, 0xdb600
    buffer_load_dwordx4 v11, s[36:39], s56 offen lds
    v_mfma_f32_16x16x32_bf16 v[72:75], v[224:227], v[24:27], v[72:75]
    ds_read_b64_tr_b16 v[48:49], v9 offset:5240
    ds_read_b64_tr_b16 v[50:51], v9 offset:6520
    v_mfma_f32_16x16x32_bf16 v[76:79], v[228:231], v[24:27], v[76:79]
    ds_read_b64_tr_b16 v[52:53], v10 offset:5120
    ds_read_b64_tr_b16 v[54:55], v10 offset:6400
    v_mfma_f32_16x16x32_bf16 v[80:83], v[224:227], v[28:31], v[80:83]
    v_mfma_f32_16x16x32_bf16 v[84:87], v[228:231], v[28:31], v[84:87]
    v_mfma_f32_16x16x32_bf16 v[88:91], v[224:227], v[32:35], v[88:91]
    v_mfma_f32_16x16x32_bf16 v[92:95], v[228:231], v[32:35], v[92:95]
    s_waitcnt lgkmcnt(0)
    s_waitcnt vmcnt(10)
    s_barrier
    v_mfma_f32_16x16x32_bf16 v[56:59], v[232:235], v[36:39], v[56:59]
    ds_read_b128 v[240:243], v7 offset:36864
    ds_read_b128 v[244:247], v7 offset:38912
    s_bitcmp1_b32 s20, 5
    s_cselect_b32 s12, 0x21c000, 0
    s_sub_u32 s12, s64, s12
    s_add_u32 m0, s65, 0x1c000
    s_add_u32 s56, s12, 0x10e000
    buffer_load_dwordx4 v11, s[36:39], s56 offen lds
    v_mfma_f32_16x16x32_bf16 v[60:63], v[236:239], v[36:39], v[60:63]
    ds_read_b64_tr_b16 v[16:17], v9 offset:36864
    ds_read_b64_tr_b16 v[18:19], v9 offset:38144
    s_add_u32 m0, s65, 0x1c400
    s_add_u32 s56, s12, 0x111600
    buffer_load_dwordx4 v11, s[36:39], s56 offen lds
    v_mfma_f32_16x16x32_bf16 v[64:67], v[232:235], v[40:43], v[64:67]
    ds_read_b64_tr_b16 v[20:21], v9 offset:36904
    ds_read_b64_tr_b16 v[22:23], v9 offset:38184
    s_bitcmp1_b32 s20, 6
    s_cselect_b32 s12, 0x21c000, 0
    s_sub_u32 s12, s64, s12
    s_add_u32 m0, s65, 0x1e000
    s_add_u32 s56, s12, 0x144000
    buffer_load_dwordx4 v11, s[36:39], s56 offen lds
    v_mfma_f32_16x16x32_bf16 v[68:71], v[236:239], v[40:43], v[68:71]
    ds_read_b64_tr_b16 v[24:25], v9 offset:36944
    ds_read_b64_tr_b16 v[26:27], v9 offset:38224
    s_add_u32 m0, s65, 0x1e400
    s_add_u32 s56, s12, 0x147600
    buffer_load_dwordx4 v11, s[36:39], s56 offen lds
    v_mfma_f32_16x16x32_bf16 v[72:75], v[232:235], v[44:47], v[72:75]
    ds_read_b64_tr_b16 v[28:29], v9 offset:36984
    ds_read_b64_tr_b16 v[30:31], v9 offset:38264
    v_mfma_f32_16x16x32_bf16 v[76:79], v[236:239], v[44:47], v[76:79]
    ds_read_b64_tr_b16 v[32:33], v10 offset:36864
    ds_read_b64_tr_b16 v[34:35], v10 offset:38144
    v_mfma_f32_16x16x32_bf16 v[80:83], v[232:235], v[48:51], v[80:83]
    v_mfma_f32_16x16x32_bf16 v[84:87], v[236:239], v[48:51], v[84:87]
    v_mfma_f32_16x16x32_bf16 v[88:91], v[232:235], v[52:55], v[88:91]
    v_mfma_f32_16x16x32_bf16 v[92:95], v[236:239], v[52:55], v[92:95]
    s_waitcnt lgkmcnt(0)
    v_mfma_f32_16x16x32_bf16 v[56:59], v[240:243], v[16:19], v[56:59]
    ds_read_b128 v[248:251], v8 offset:36864
    ds_read_b128 v[252:255], v8 offset:38912
    s_bitcmp1_b32 s20, 7
    s_cselect_b32 s12, 0x21c000, 0
    s_sub_u32 s12, s64, s12
    s_add_u32 m0, s65, 0x20000
    s_add_u32 s56, s12, 0x17a000
    buffer_load_dwordx4 v11, s[36:39], s56 offen lds
    v_mfma_f32_16x16x32_bf16 v[60:63], v[244:247], v[16:19], v[60:63]
    ds_read_b64_tr_b16 v[36:37], v9 offset:41984
    ds_read_b64_tr_b16 v[38:39], v9 offset:43264
    s_add_u32 m0, s65, 0x20400
    s_add_u32 s56, s12, 0x17d600
    buffer_load_dwordx4 v11, s[36:39], s56 offen lds
    v_mfma_f32_16x16x32_bf16 v[64:67], v[240:243], v[20:23], v[64:67]
    ds_read_b64_tr_b16 v[40:41], v9 offset:42024
    ds_read_b64_tr_b16 v[42:43], v9 offset:43304
    s_bitcmp1_b32 s20, 8
    s_cselect_b32 s12, 0x21c000, 0
    s_sub_u32 s12, s64, s12
    s_add_u32 m0, s65, 0x22000
    s_add_u32 s56, s12, 0x1b0000
    buffer_load_dwordx4 v11, s[36:39], s56 offen lds
    v_mfma_f32_16x16x32_bf16 v[68:71], v[244:247], v[20:23], v[68:71]
    ds_read_b64_tr_b16 v[44:45], v9 offset:42064
    ds_read_b64_tr_b16 v[46:47], v9 offset:43344
    s_add_u32 m0, s65, 0x22400
    s_add_u32 s56, s12, 0x1b3600
    buffer_load_dwordx4 v11, s[36:39], s56 offen lds
    v_mfma_f32_16x16x32_bf16 v[72:75], v[240:243], v[24:27], v[72:75]
    ds_read_b64_tr_b16 v[48:49], v9 offset:42104
    ds_read_b64_tr_b16 v[50:51], v9 offset:43384
    v_mfma_f32_16x16x32_bf16 v[76:79], v[244:247], v[24:27], v[76:79]
    ds_read_b64_tr_b16 v[52:53], v10 offset:41984
    ds_read_b64_tr_b16 v[54:55], v10 offset:43264
    v_mfma_f32_16x16x32_bf16 v[80:83], v[240:243], v[28:31], v[80:83]
    v_mfma_f32_16x16x32_bf16 v[84:87], v[244:247], v[28:31], v[84:87]
    v_mfma_f32_16x16x32_bf16 v[88:91], v[240:243], v[32:35], v[88:91]
    v_mfma_f32_16x16x32_bf16 v[92:95], v[244:247], v[32:35], v[92:95]
    s_waitcnt lgkmcnt(0)
    s_barrier
    v_mfma_f32_16x16x32_bf16 v[56:59], v[248:251], v[36:39], v[56:59]
    s_bitcmp1_b32 s20, 9
    s_cselect_b32 s12, 0x21c000, 0
    s_sub_u32 s12, s64, s12
    s_add_u32 m0, s65, 0x0
    s_add_u32 s56, s12, 0x1e6000
    buffer_load_dwordx4 v11, s[36:39], s56 offen lds
    v_mfma_f32_16x16x32_bf16 v[60:63], v[252:255], v[36:39], v[60:63]
    s_add_u32 m0, s65, 0x400
    s_add_u32 s56, s12, 0x1e9600
    buffer_load_dwordx4 v11, s[36:39], s56 offen lds
    v_mfma_f32_16x16x32_bf16 v[64:67], v[248:251], v[40:43], v[64:67]
    v_mfma_f32_16x16x32_bf16 v[68:71], v[252:255], v[40:43], v[68:71]
    v_mfma_f32_16x16x32_bf16 v[72:75], v[248:251], v[44:47], v[72:75]
    v_mfma_f32_16x16x32_bf16 v[76:79], v[252:255], v[44:47], v[76:79]
    v_mfma_f32_16x16x32_bf16 v[80:83], v[248:251], v[48:51], v[80:83]
    v_mfma_f32_16x16x32_bf16 v[84:87], v[252:255], v[48:51], v[84:87]
    v_mfma_f32_16x16x32_bf16 v[88:91], v[248:251], v[52:55], v[88:91]
    v_mfma_f32_16x16x32_bf16 v[92:95], v[252:255], v[52:55], v[92:95]
    v_mov_b32 v5, 0x26000
    v_mov_b32 v6, 1
    s_mul_i32 s56, s45, 5120
    s_add_u32 s56, s56, 0x2000
    v_add_u32 v12, s56, v2
    v_cvt_pk_bf16_f32 v36, v56, v57
    v_cvt_pk_bf16_f32 v37, v58, v59
    v_cvt_pk_bf16_f32 v38, v60, v61
    v_cvt_pk_bf16_f32 v39, v62, v63
    ds_write_b128 v12, v[36:39] offset:0
    v_cvt_pk_bf16_f32 v40, v64, v65
    v_cvt_pk_bf16_f32 v41, v66, v67
    v_cvt_pk_bf16_f32 v42, v68, v69
    v_cvt_pk_bf16_f32 v43, v70, v71
    ds_write_b128 v12, v[40:43] offset:1024
    v_cvt_pk_bf16_f32 v44, v72, v73
    v_cvt_pk_bf16_f32 v45, v74, v75
    v_cvt_pk_bf16_f32 v46, v76, v77
    v_cvt_pk_bf16_f32 v47, v78, v79
    ds_write_b128 v12, v[44:47] offset:2048
    v_cvt_pk_bf16_f32 v48, v80, v81
    v_cvt_pk_bf16_f32 v49, v82, v83
    v_cvt_pk_bf16_f32 v50, v84, v85
    v_cvt_pk_bf16_f32 v51, v86, v87
    ds_write_b128 v12, v[48:51] offset:3072
    v_cvt_pk_bf16_f32 v52, v88, v89
    v_cvt_pk_bf16_f32 v53, v90, v91
    v_cvt_pk_bf16_f32 v54, v92, v93
    v_cvt_pk_bf16_f32 v55, v94, v95
    ds_write_b128 v12, v[52:55] offset:4096
    s_mov_b64 exec, 1
    ds_add_u32 v5, v6 offset:0
    s_mov_b64 exec, -1
    v_lshrrev_b32 v13, 5, v1
    v_lshlrev_b32 v13, 4, v13
    v_bfe_u32 v14, v1, 2, 3
    v_add_u32 v13, v13, v14
    v_lshlrev_b32 v13, 7, v13
    v_and_b32 v14, 3, v1
    v_lshl_add_u32 v13, v14, 3, v13
    v_add_u32 v13, 0x0, v13
    v_bfe_u32 v14, v1, 3, 2
    v_xor_b32 v7, 0, v14
    v_lshl_add_u32 v7, v7, 5, v13
    v_xor_b32 v8, 1, v14
    v_lshl_add_u32 v8, v8, 5, v13
    v_xor_b32 v9, 2, v14
    v_lshl_add_u32 v9, v9, 5, v13
    v_xor_b32 v10, 3, v14
    v_lshl_add_u32 v10, v10, 5, v13
    v_lshrrev_b32 v13, 5, v1
    v_lshlrev_b32 v13, 4, v13
    v_bfe_u32 v14, v1, 2, 3
    v_add_u32 v13, v13, v14
    v_lshlrev_b32 v13, 6, v13
    v_and_b32 v14, 3, v1
    v_lshl_add_u32 v13, v14, 3, v13
    v_add_u32 v13, 0x0, v13
    v_bfe_u32 v14, v1, 4, 1
    v_xor_b32 v3, 0, v14
    v_lshl_add_u32 v3, v3, 5, v13
    v_xor_b32 v4, 1, v14
    v_lshl_add_u32 v4, v4, 5, v13
    s_waitcnt vmcnt(0)
    s_mov_b64 exec, 1
    ds_add_u32 v5, v6 offset:4
    s_mov_b64 exec, -1
    s_mov_b32 s60, 160000
LW_14:
    ds_read_b32 v13, v5 offset:4
    s_waitcnt lgkmcnt(0)
    v_readfirstlane_b32 s58, v13
    s_nop 1
    s_cmp_ge_u32 s58, 4
    s_nop 0
    s_cbranch_scc1 LW_14_OK
    s_sub_u32 s60, s60, 1
    s_cmp_lg_u32 s60, 0
    s_cbranch_scc1 LW_14
LW_14_OK:
    s_setprio 1
    v_add_u32 v7, 0x12000, v7
    v_add_u32 v8, 0x12000, v8
    v_add_u32 v9, 0x12000, v9
    v_add_u32 v10, 0x12000, v10
    ds_read_b64_tr_b16 v[16:17], v7 offset:0
    ds_read_b64_tr_b16 v[18:19], v7 offset:1024
    ds_read_b64_tr_b16 v[20:21], v8 offset:0
    ds_read_b64_tr_b16 v[22:23], v8 offset:1024
    ds_read_b64_tr_b16 v[24:25], v9 offset:0
    ds_read_b64_tr_b16 v[26:27], v9 offset:1024
    ds_read_b64_tr_b16 v[28:29], v10 offset:0
    ds_read_b64_tr_b16 v[30:31], v10 offset:1024
    s_waitcnt lgkmcnt(6)
    v_mfma_f32_16x16x32_bf16 v[56:59], v[16:19], v[96:99], 0
    ds_read_b64_tr_b16 v[36:37], v7 offset:4096
    v_mfma_f32_16x16x32_bf16 v[60:63], v[16:19], v[100:103], 0
    ds_read_b64_tr_b16 v[38:39], v7 offset:5120
    s_waitcnt lgkmcnt(6)
    v_mfma_f32_16x16x32_bf16 v[64:67], v[20:23], v[96:99], 0
    ds_read_b64_tr_b16 v[40:41], v8 offset:4096
    v_mfma_f32_16x16x32_bf16 v[68:71], v[20:23], v[100:103], 0
    ds_read_b64_tr_b16 v[42:43], v8 offset:5120
    s_waitcnt lgkmcnt(6)
    v_mfma_f32_16x16x32_bf16 v[72:75], v[24:27], v[96:99], 0
    ds_read_b64_tr_b16 v[44:45], v9 offset:4096
    v_mfma_f32_16x16x32_bf16 v[76:79], v[24:27], v[100:103], 0
    ds_read_b64_tr_b16 v[46:47], v9 offset:5120
    s_waitcnt lgkmcnt(6)
    v_mfma_f32_16x16x32_bf16 v[80:83], v[28:31], v[96:99], 0
    ds_read_b64_tr_b16 v[48:49], v10 offset:4096
    v_mfma_f32_16x16x32_bf16 v[84:87], v[28:31], v[100:103], 0
    ds_read_b64_tr_b16 v[50:51], v10 offset:5120
    s_waitcnt lgkmcnt(6)
    v_mfma_f32_16x16x32_bf16 v[56:59], v[36:39], v[104:107], v[56:59]
    ds_read_b64_tr_b16 v[16:17], v7 offset:8192
    v_mfma_f32_16x16x32_bf16 v[60:63], v[36:39], v[108:111], v[60:63]
    ds_read_b64_tr_b16 v[18:19], v7 offset:9216
    s_waitcnt lgkmcnt(6)
    v_mfma_f32_16x16x32_bf16 v[64:67], v[40:43], v[104:107], v[64:67]
    ds_read_b64_tr_b16 v[20:21], v8 offset:8192
    v_mfma_f32_16x16x32_bf16 v[68:71], v[40:43], v[108:111], v[68:71]
    ds_read_b64_tr_b16 v[22:23], v8 offset:9216
    s_waitcnt lgkmcnt(6)
    v_mfma_f32_16x16x32_bf16 v[72:75], v[44:47], v[104:107], v[72:75]
    ds_read_b64_tr_b16 v[24:25], v9 offset:8192
    v_mfma_f32_16x16x32_bf16 v[76:79], v[44:47], v[108:111], v[76:79]
    ds_read_b64_tr_b16 v[26:27], v9 offset:9216
    s_waitcnt lgkmcnt(6)
    v_mfma_f32_16x16x32_bf16 v[80:83], v[48:51], v[104:107], v[80:83]
    ds_read_b64_tr_b16 v[28:29], v10 offset:8192
    v_mfma_f32_16x16x32_bf16 v[84:87], v[48:51], v[108:111], v[84:87]
    ds_read_b64_tr_b16 v[30:31], v10 offset:9216
    s_waitcnt lgkmcnt(6)
    v_mfma_f32_16x16x32_bf16 v[56:59], v[16:19], v[112:115], v[56:59]
    ds_read_b64_tr_b16 v[36:37], v7 offset:12288
    v_mfma_f32_16x16x32_bf16 v[60:63], v[16:19], v[116:119], v[60:63]
    ds_read_b64_tr_b16 v[38:39], v7 offset:13312
    s_waitcnt lgkmcnt(6)
    v_mfma_f32_16x16x32_bf16 v[64:67], v[20:23], v[112:115], v[64:67]
    ds_read_b64_tr_b16 v[40:41], v8 offset:12288
    v_mfma_f32_16x16x32_bf16 v[68:71], v[20:23], v[116:119], v[68:71]
    ds_read_b64_tr_b16 v[42:43], v8 offset:13312
    s_waitcnt lgkmcnt(6)
    v_mfma_f32_16x16x32_bf16 v[72:75], v[24:27], v[112:115], v[72:75]
    ds_read_b64_tr_b16 v[44:45], v9 offset:12288
    v_mfma_f32_16x16x32_bf16 v[76:79], v[24:27], v[116:119], v[76:79]
    ds_read_b64_tr_b16 v[46:47], v9 offset:13312
    s_waitcnt lgkmcnt(6)
    v_mfma_f32_16x16x32_bf16 v[80:83], v[28:31], v[112:115], v[80:83]
    ds_read_b64_tr_b16 v[48:49], v10 offset:12288
    v_mfma_f32_16x16x32_bf16 v[84:87], v[28:31], v[116:119], v[84:87]
    ds_read_b64_tr_b16 v[50:51], v10 offset:13312
    s_waitcnt lgkmcnt(0)
    s_mov_b64 exec, 1
    ds_add_u32 v5, v6 offset:100
    s_mov_b64 exec, -1
    v_mfma_f32_16x16x32_bf16 v[56:59], v[36:39], v[120:123], v[56:59]
    ds_read_b64_tr_b16 v[16:17], v7 offset:16384
    v_mfma_f32_16x16x32_bf16 v[60:63], v[36:39], v[124:127], v[60:63]
    ds_read_b64_tr_b16 v[18:19], v7 offset:17408
    v_mfma_f32_16x16x32_bf16 v[64:67], v[40:43], v[120:123], v[64:67]
    ds_read_b64_tr_b16 v[20:21], v8 offset:16384
    v_mfma_f32_16x16x32_bf16 v[68:71], v[40:43], v[124:127], v[68:71]
    ds_read_b64_tr_b16 v[22:23], v8 offset:17408
    v_mfma_f32_16x16x32_bf16 v[72:75], v[44:47], v[120:123], v[72:75]
    ds_read_b64_tr_b16 v[24:25], v9 offset:16384
    v_mfma_f32_16x16x32_bf16 v[76:79], v[44:47], v[124:127], v[76:79]
    ds_read_b64_tr_b16 v[26:27], v9 offset:17408
    v_mfma_f32_16x16x32_bf16 v[80:83], v[48:51], v[120:123], v[80:83]
    ds_read_b64_tr_b16 v[28:29], v10 offset:16384
    v_mfma_f32_16x16x32_bf16 v[84:87], v[48:51], v[124:127], v[84:87]
    ds_read_b64_tr_b16 v[30:31], v10 offset:17408
    s_waitcnt lgkmcnt(0)
    s_mov_b32 s60, 160000
LW_15:
    ds_read_b32 v13, v5 offset:100
    s_waitcnt lgkmcnt(0)
    v_readfirstlane_b32 s58, v13
    s_nop 1
    s_cmp_ge_u32 s58, 4
    s_nop 0
    s_cbranch_scc1 LW_15_OK
    s_sub_u32 s60, s60, 1
    s_cmp_lg_u32 s60, 0
    s_cbranch_scc1 LW_15
LW_15_OK:
    s_bitcmp1_b32 s20, 0
    s_cselect_b32 s12, 0x21c000, 0
    s_sub_u32 s12, s71, s12
    s_add_u32 m0, s72, 0x12000
    s_add_u32 s56, s12, 0x0
    buffer_load_dwordx4 v0, s[36:39], s56 offen lds
    s_bitcmp1_b32 s20, 1
    s_cselect_b32 s12, 0x21c000, 0
    s_sub_u32 s12, s71, s12
    s_add_u32 m0, s72, 0x13000
    s_add_u32 s56, s12, 0x36000
    buffer_load_dwordx4 v0, s[36:39], s56 offen lds
    s_bitcmp1_b32 s20, 2
    s_cselect_b32 s12, 0x21c000, 0
    s_sub_u32 s12, s71, s12
    s_add_u32 m0, s72, 0x14000
    s_add_u32 s56, s12, 0x6c000
    buffer_load_dwordx4 v0, s[36:39], s56 offen lds
    s_bitcmp1_b32 s20, 3
    s_cselect_b32 s12, 0x21c000, 0
    s_sub_u32 s12, s71, s12
    s_add_u32 m0, s72, 0x15000
    s_add_u32 s56, s12, 0xa2000
    buffer_load_dwordx4 v0, s[36:39], s56 offen lds
    s_bitcmp1_b32 s20, 4
    s_cselect_b32 s12, 0x21c000, 0
    s_sub_u32 s12, s71, s12
    s_add_u32 m0, s72, 0x24000
    s_add_u32 s56, s12, 0xd8000
    buffer_load_dwordx4 v0, s[36:39], s56 offen lds
    s_bitcmp1_b32 s20, 5
    s_cselect_b32 s12, 0x21c000, 0
    s_sub_u32 s12, s71, s12
    s_add_u32 m0, s72, 0x25000
    s_add_u32 s56, s12, 0x10e000
    buffer_load_dwordx4 v0, s[36:39], s56 offen lds
    s_mov_b32 s60, 160000
LW_16:
    ds_read_b32 v13, v5 offset:0
    s_waitcnt lgkmcnt(0)
    v_readfirstlane_b32 s58, v13
    s_nop 1
    s_cmp_ge_u32 s58, 8
    s_nop 0
    s_cbranch_scc1 LW_16_OK
    s_sub_u32 s60, s60, 1
    s_cmp_lg_u32 s60, 0
    s_cbranch_scc1 LW_16
LW_16_OK:
    v_mfma_f32_16x16x32_bf16 v[56:59], v[16:19], v[128:131], v[56:59]
    ds_read_b64_tr_b16 v[36:37], v7 offset:20480
    v_mfma_f32_16x16x32_bf16 v[60:63], v[16:19], v[132:135], v[60:63]
    ds_read_b64_tr_b16 v[38:39], v7 offset:21504
    v_mfma_f32_16x16x32_bf16 v[64:67], v[20:23], v[128:131], v[64:67]
    ds_read_b64_tr_b16 v[40:41], v8 offset:20480
    v_mfma_f32_16x16x32_bf16 v[68:71], v[20:23], v[132:135], v[68:71]
    ds_read_b64_tr_b16 v[42:43], v8 offset:21504
    v_mfma_f32_16x16x32_bf16 v[72:75], v[24:27], v[128:131], v[72:75]
    ds_read_b64_tr_b16 v[44:45], v9 offset:20480
    v_mfma_f32_16x16x32_bf16 v[76:79], v[24:27], v[132:135], v[76:79]
    ds_read_b64_tr_b16 v[46:47], v9 offset:21504
    v_mfma_f32_16x16x32_bf16 v[80:83], v[28:31], v[128:131], v[80:83]
    ds_read_b64_tr_b16 v[48:49], v10 offset:20480
    v_mfma_f32_16x16x32_bf16 v[84:87], v[28:31], v[132:135], v[84:87]
    ds_read_b64_tr_b16 v[50:51], v10 offset:21504
    s_waitcnt lgkmcnt(0)
    s_mov_b64 exec, 1
    ds_add_u32 v5, v6 offset:40
    s_mov_b64 exec, -1
    v_mfma_f32_16x16x32_bf16 v[56:59], v[36:39], v[136:139], v[56:59]
    ds_read_b64_tr_b16 v[16:17], v7 offset:24576
    v_mfma_f32_16x16x32_bf16 v[60:63], v[36:39], v[140:143], v[60:63]
    ds_read_b64_tr_b16 v[18:19], v7 offset:25600
    v_mfma_f32_16x16x32_bf16 v[64:67], v[40:43], v[136:139], v[64:67]
    ds_read_b64_tr_b16 v[20:21], v8 offset:24576
    v_mfma_f32_16x16x32_bf16 v[68:71], v[40:43], v[140:143], v[68:71]
    ds_read_b64_tr_b16 v[22:23], v8 offset:25600
    v_mfma_f32_16x16x32_bf16 v[72:75], v[44:47], v[136:139], v[72:75]
    ds_read_b64_tr_b16 v[24:25], v9 offset:24576
    v_mfma_f32_16x16x32_bf16 v[76:79], v[44:47], v[140:143], v[76:79]
    ds_read_b64_tr_b16 v[26:27], v9 offset:25600
    v_mfma_f32_16x16x32_bf16 v[80:83], v[48:51], v[136:139], v[80:83]
    ds_read_b64_tr_b16 v[28:29], v10 offset:24576
    v_mfma_f32_16x16x32_bf16 v[84:87], v[48:51], v[140:143], v[84:87]
    ds_read_b64_tr_b16 v[30:31], v10 offset:25600
    s_waitcnt lgkmcnt(6)
    v_mfma_f32_16x16x32_bf16 v[56:59], v[16:19], v[144:147], v[56:59]
    ds_read_b64_tr_b16 v[36:37], v7 offset:28672
    v_mfma_f32_16x16x32_bf16 v[60:63], v[16:19], v[148:151], v[60:63]
    ds_read_b64_tr_b16 v[38:39], v7 offset:29696
    s_waitcnt lgkmcnt(6)
    v_mfma_f32_16x16x32_bf16 v[64:67], v[20:23], v[144:147], v[64:67]
    ds_read_b64_tr_b16 v[40:41], v8 offset:28672
    v_mfma_f32_16x16x32_bf16 v[68:71], v[20:23], v[148:151], v[68:71]
    ds_read_b64_tr_b16 v[42:43], v8 offset:29696
    s_waitcnt lgkmcnt(6)
    v_mfma_f32_16x16x32_bf16 v[72:75], v[24:27], v[144:147], v[72:75]
    ds_read_b64_tr_b16 v[44:45], v9 offset:28672
    v_mfma_f32_16x16x32_bf16 v[76:79], v[24:27], v[148:151], v[76:79]
    ds_read_b64_tr_b16 v[46:47], v9 offset:29696
    s_waitcnt lgkmcnt(6)
    v_mfma_f32_16x16x32_bf16 v[80:83], v[28:31], v[144:147], v[80:83]
    ds_read_b64_tr_b16 v[48:49], v10 offset:28672
    v_mfma_f32_16x16x32_bf16 v[84:87], v[28:31], v[148:151], v[84:87]
    ds_read_b64_tr_b16 v[50:51], v10 offset:29696
    s_waitcnt lgkmcnt(6)
    v_mfma_f32_16x16x32_bf16 v[56:59], v[36:39], v[152:155], v[56:59]
    ds_read_b64_tr_b16 v[16:17], v7 offset:32768
    v_mfma_f32_16x16x32_bf16 v[60:63], v[36:39], v[156:159], v[60:63]
    ds_read_b64_tr_b16 v[18:19], v7 offset:33792
    s_waitcnt lgkmcnt(6)
    v_mfma_f32_16x16x32_bf16 v[64:67], v[40:43], v[152:155], v[64:67]
    ds_read_b64_tr_b16 v[20:21], v8 offset:32768
    v_mfma_f32_16x16x32_bf16 v[68:71], v[40:43], v[156:159], v[68:71]
    ds_read_b64_tr_b16 v[22:23], v8 offset:33792
    s_waitcnt lgkmcnt(6)
    v_mfma_f32_16x16x32_bf16 v[72:75], v[44:47], v[152:155], v[72:75]
    ds_read_b64_tr_b16 v[24:25], v9 offset:32768
    v_mfma_f32_16x16x32_bf16 v[76:79], v[44:47], v[156:159], v[76:79]
    ds_read_b64_tr_b16 v[26:27], v9 offset:33792
    s_waitcnt lgkmcnt(6)
    v_mfma_f32_16x16x32_bf16 v[80:83], v[48:51], v[152:155], v[80:83]
    ds_read_b64_tr_b16 v[28:29], v10 offset:32768
    v_mfma_f32_16x16x32_bf16 v[84:87], v[48:51], v[156:159], v[84:87]
    ds_read_b64_tr_b16 v[30:31], v10 offset:33792
    s_waitcnt lgkmcnt(6)
    v_mfma_f32_16x16x32_bf16 v[56:59], v[16:19], v[160:163], v[56:59]
    ds_read_b64_tr_b16 v[36:37], v7 offset:36864
    v_mfma_f32_16x16x32_bf16 v[60:63], v[16:19], v[164:167], v[60:63]
    ds_read_b64_tr_b16 v[38:39], v7 offset:37888
    s_waitcnt lgkmcnt(6)
    v_mfma_f32_16x16x32_bf16 v[64:67], v[20:23], v[160:163], v[64:67]
    ds_read_b64_tr_b16 v[40:41], v8 offset:36864
    v_mfma_f32_16x16x32_bf16 v[68:71], v[20:23], v[164:167], v[68:71]
    ds_read_b64_tr_b16 v[42:43], v8 offset:37888
    s_waitcnt lgkmcnt(6)
    v_mfma_f32_16x16x32_bf16 v[72:75], v[24:27], v[160:163], v[72:75]
    ds_read_b64_tr_b16 v[44:45], v9 offset:36864
    v_mfma_f32_16x16x32_bf16 v[76:79], v[24:27], v[164:167], v[76:79]
    ds_read_b64_tr_b16 v[46:47], v9 offset:37888
    s_waitcnt lgkmcnt(6)
    v_mfma_f32_16x16x32_bf16 v[80:83], v[28:31], v[160:163], v[80:83]
    ds_read_b64_tr_b16 v[48:49], v10 offset:36864
    v_mfma_f32_16x16x32_bf16 v[84:87], v[28:31], v[164:167], v[84:87]
    ds_read_b64_tr_b16 v[50:51], v10 offset:37888
    s_waitcnt lgkmcnt(0)
    s_mov_b64 exec, 1
    ds_add_u32 v5, v6 offset:72
    s_mov_b64 exec, -1
    s_mov_b32 s60, 160000
LW_17:
    ds_read_b32 v13, v5 offset:36
    s_waitcnt lgkmcnt(0)
    v_readfirstlane_b32 s58, v13
    s_nop 1
    s_cmp_ge_u32 s58, 4
    s_nop 0
    s_cbranch_scc1 LW_17_OK
    s_sub_u32 s60, s60, 1
    s_cmp_lg_u32 s60, 0
    s_cbranch_scc1 LW_17
LW_17_OK:
    v_mfma_f32_16x16x32_bf16 v[56:59], v[36:39], v[168:171], v[56:59]
    ds_read_b64_tr_b16 v[16:17], v7 offset:40960
    v_mfma_f32_16x16x32_bf16 v[60:63], v[36:39], v[172:175], v[60:63]
    ds_read_b64_tr_b16 v[18:19], v7 offset:41984
    v_mfma_f32_16x16x32_bf16 v[64:67], v[40:43], v[168:171], v[64:67]
    ds_read_b64_tr_b16 v[20:21], v8 offset:40960
    v_mfma_f32_16x16x32_bf16 v[68:71], v[40:43], v[172:175], v[68:71]
    ds_read_b64_tr_b16 v[22:23], v8 offset:41984
    v_mfma_f32_16x16x32_bf16 v[72:75], v[44:47], v[168:171], v[72:75]
    ds_read_b64_tr_b16 v[24:25], v9 offset:40960
    v_mfma_f32_16x16x32_bf16 v[76:79], v[44:47], v[172:175], v[76:79]
    ds_read_b64_tr_b16 v[26:27], v9 offset:41984
    v_mfma_f32_16x16x32_bf16 v[80:83], v[48:51], v[168:171], v[80:83]
    ds_read_b64_tr_b16 v[28:29], v10 offset:40960
    v_mfma_f32_16x16x32_bf16 v[84:87], v[48:51], v[172:175], v[84:87]
    ds_read_b64_tr_b16 v[30:31], v10 offset:41984
    s_waitcnt lgkmcnt(6)
    v_mfma_f32_16x16x32_bf16 v[56:59], v[16:19], v[176:179], v[56:59]
    ds_read_b64_tr_b16 v[36:37], v7 offset:45056
    v_mfma_f32_16x16x32_bf16 v[60:63], v[16:19], v[180:183], v[60:63]
    ds_read_b64_tr_b16 v[38:39], v7 offset:46080
    s_waitcnt lgkmcnt(6)
    v_mfma_f32_16x16x32_bf16 v[64:67], v[20:23], v[176:179], v[64:67]
    ds_read_b64_tr_b16 v[40:41], v8 offset:45056
    v_mfma_f32_16x16x32_bf16 v[68:71], v[20:23], v[180:183], v[68:71]
    ds_read_b64_tr_b16 v[42:43], v8 offset:46080
    s_waitcnt lgkmcnt(6)
    v_mfma_f32_16x16x32_bf16 v[72:75], v[24:27], v[176:179], v[72:75]
    ds_read_b64_tr_b16 v[44:45], v9 offset:45056
    v_mfma_f32_16x16x32_bf16 v[76:79], v[24:27], v[180:183], v[76:79]
    ds_read_b64_tr_b16 v[46:47], v9 offset:46080
    s_waitcnt lgkmcnt(6)
    v_mfma_f32_16x16x32_bf16 v[80:83], v[28:31], v[176:179], v[80:83]
    ds_read_b64_tr_b16 v[48:49], v10 offset:45056
    v_mfma_f32_16x16x32_bf16 v[84:87], v[28:31], v[180:183], v[84:87]
    ds_read_b64_tr_b16 v[50:51], v10 offset:46080
    s_waitcnt lgkmcnt(6)
    v_mfma_f32_16x16x32_bf16 v[56:59], v[36:39], v[184:187], v[56:59]
    ds_read_b64_tr_b16 v[16:17], v7 offset:49152
    v_mfma_f32_16x16x32_bf16 v[60:63], v[36:39], v[188:191], v[60:63]
    ds_read_b64_tr_b16 v[18:19], v7 offset:50176
    s_waitcnt lgkmcnt(6)
    v_mfma_f32_16x16x32_bf16 v[64:67], v[40:43], v[184:187], v[64:67]
    ds_read_b64_tr_b16 v[20:21], v8 offset:49152
    v_mfma_f32_16x16x32_bf16 v[68:71], v[40:43], v[188:191], v[68:71]
    ds_read_b64_tr_b16 v[22:23], v8 offset:50176
    s_waitcnt lgkmcnt(6)
    v_mfma_f32_16x16x32_bf16 v[72:75], v[44:47], v[184:187], v[72:75]
    ds_read_b64_tr_b16 v[24:25], v9 offset:49152
    v_mfma_f32_16x16x32_bf16 v[76:79], v[44:47], v[188:191], v[76:79]
    ds_read_b64_tr_b16 v[26:27], v9 offset:50176
    s_waitcnt lgkmcnt(6)
    v_mfma_f32_16x16x32_bf16 v[80:83], v[48:51], v[184:187], v[80:83]
    ds_read_b64_tr_b16 v[28:29], v10 offset:49152
    v_mfma_f32_16x16x32_bf16 v[84:87], v[48:51], v[188:191], v[84:87]
    ds_read_b64_tr_b16 v[30:31], v10 offset:50176
    s_waitcnt lgkmcnt(6)
    v_mfma_f32_16x16x32_bf16 v[56:59], v[16:19], v[192:195], v[56:59]
    ds_read_b64_tr_b16 v[36:37], v7 offset:53248
    s_bitcmp1_b32 s20, 6
    v_mfma_f32_16x16x32_bf16 v[60:63], v[16:19], v[196:199], v[60:63]
    ds_read_b64_tr_b16 v[38:39], v7 offset:54272
    s_waitcnt lgkmcnt(6)
    v_mfma_f32_16x16x32_bf16 v[64:67], v[20:23], v[192:195], v[64:67]
    ds_read_b64_tr_b16 v[40:41], v8 offset:53248
    s_cselect_b32 s12, 0x21c000, 0
    v_mfma_f32_16x16x32_bf16 v[68:71], v[20:23], v[196:199], v[68:71]
    ds_read_b64_tr_b16 v[42:43], v8 offset:54272
    s_waitcnt lgkmcnt(6)
    v_mfma_f32_16x16x32_bf16 v[72:75], v[24:27], v[192:195], v[72:75]
    ds_read_b64_tr_b16 v[44:45], v9 offset:53248
    s_sub_u32 s12, s71, s12
    v_mfma_f32_16x16x32_bf16 v[76:79], v[24:27], v[196:199], v[76:79]
    ds_read_b64_tr_b16 v[46:47], v9 offset:54272
    s_waitcnt lgkmcnt(6)
    v_mfma_f32_16x16x32_bf16 v[80:83], v[28:31], v[192:195], v[80:83]
    ds_read_b64_tr_b16 v[48:49], v10 offset:53248
    s_add_u32 m0, s72, 0x8000
    v_mfma_f32_16x16x32_bf16 v[84:87], v[28:31], v[196:199], v[84:87]
    ds_read_b64_tr_b16 v[50:51], v10 offset:54272
    s_add_u32 s56, s12, 0x144000
    buffer_load_dwordx4 v0, s[36:39], s56 offen lds
    s_waitcnt lgkmcnt(6)
    v_mfma_f32_16x16x32_bf16 v[56:59], v[36:39], v[200:203], v[56:59]
    ds_read_b64_tr_b16 v[16:17], v7 offset:57344
    v_mfma_f32_16x16x32_bf16 v[60:63], v[36:39], v[204:207], v[60:63]
    ds_read_b64_tr_b16 v[18:19], v7 offset:58368
    s_waitcnt lgkmcnt(6)
    v_mfma_f32_16x16x32_bf16 v[64:67], v[40:43], v[200:203], v[64:67]
    ds_read_b64_tr_b16 v[20:21], v8 offset:57344
    v_mfma_f32_16x16x32_bf16 v[68:71], v[40:43], v[204:207], v[68:71]
    ds_read_b64_tr_b16 v[22:23], v8 offset:58368
    s_waitcnt lgkmcnt(6)
    v_mfma_f32_16x16x32_bf16 v[72:75], v[44:47], v[200:203], v[72:75]
    ds_read_b64_tr_b16 v[24:25], v9 offset:57344
    v_mfma_f32_16x16x32_bf16 v[76:79], v[44:47], v[204:207], v[76:79]
    ds_read_b64_tr_b16 v[26:27], v9 offset:58368
    s_waitcnt lgkmcnt(6)
    v_mfma_f32_16x16x32_bf16 v[80:83], v[48:51], v[200:203], v[80:83]
    ds_read_b64_tr_b16 v[28:29], v10 offset:57344
    v_mfma_f32_16x16x32_bf16 v[84:87], v[48:51], v[204:207], v[84:87]
    ds_read_b64_tr_b16 v[30:31], v10 offset:58368
    s_waitcnt lgkmcnt(6)
    v_mfma_f32_16x16x32_bf16 v[56:59], v[16:19], v[208:211], v[56:59]
    ds_read_b64_tr_b16 v[36:37], v7 offset:61440
    s_bitcmp1_b32 s20, 7
    v_mfma_f32_16x16x32_bf16 v[60:63], v[16:19], v[212:215], v[60:63]
    ds_read_b64_tr_b16 v[38:39], v7 offset:62464
    s_waitcnt lgkmcnt(6)
    v_mfma_f32_16x16x32_bf16 v[64:67], v[20:23], v[208:211], v[64:67]
    ds_read_b64_tr_b16 v[40:41], v8 offset:61440
    s_cselect_b32 s12, 0x21c000, 0
    v_mfma_f32_16x16x32_bf16 v[68:71], v[20:23], v[212:215], v[68:71]
    ds_read_b64_tr_b16 v[42:43], v8 offset:62464
    s_waitcnt lgkmcnt(6)
    v_mfma_f32_16x16x32_bf16 v[72:75], v[24:27], v[208:211], v[72:75]
    ds_read_b64_tr_b16 v[44:45], v9 offset:61440
    s_sub_u32 s12, s71, s12
    v_mfma_f32_16x16x32_bf16 v[76:79], v[24:27], v[212:215], v[76:79]
    ds_read_b64_tr_b16 v[46:47], v9 offset:62464
    s_waitcnt lgkmcnt(6)
    v_mfma_f32_16x16x32_bf16 v[80:83], v[28:31], v[208:211], v[80:83]
    ds_read_b64_tr_b16 v[48:49], v10 offset:61440
    s_add_u32 m0, s72, 0x9000
    v_mfma_f32_16x16x32_bf16 v[84:87], v[28:31], v[212:215], v[84:87]
    ds_read_b64_tr_b16 v[50:51], v10 offset:62464
    s_add_u32 s56, s12, 0x17a000
    buffer_load_dwordx4 v0, s[36:39], s56 offen lds
    s_waitcnt lgkmcnt(0)
    s_mov_b64 exec, 1
    ds_add_u32 v5, v6 offset:76
    s_mov_b64 exec, -1
    v_mfma_f32_16x16x32_bf16 v[56:59], v[36:39], v[216:219], v[56:59]
    v_add_u32 v7, 0x10000, v7
    v_add_u32 v8, 0x10000, v8
    v_add_u32 v9, 0x10000, v9
    v_add_u32 v10, 0x10000, v10
    ds_read_b64_tr_b16 v[16:17], v7 offset:0
    v_mfma_f32_16x16x32_bf16 v[60:63], v[36:39], v[220:223], v[60:63]
    ds_read_b64_tr_b16 v[18:19], v7 offset:1024
    v_mfma_f32_16x16x32_bf16 v[64:67], v[40:43], v[216:219], v[64:67]
    ds_read_b64_tr_b16 v[20:21], v8 offset:0
    v_mfma_f32_16x16x32_bf16 v[68:71], v[40:43], v[220:223], v[68:71]
    ds_read_b64_tr_b16 v[22:23], v8 offset:1024
    v_mfma_f32_16x16x32_bf16 v[72:75], v[44:47], v[216:219], v[72:75]
    ds_read_b64_tr_b16 v[24:25], v9 offset:0
    v_mfma_f32_16x16x32_bf16 v[76:79], v[44:47], v[220:223], v[76:79]
    ds_read_b64_tr_b16 v[26:27], v9 offset:1024
    v_mfma_f32_16x16x32_bf16 v[80:83], v[48:51], v[216:219], v[80:83]
    ds_read_b64_tr_b16 v[28:29], v10 offset:0
    v_mfma_f32_16x16x32_bf16 v[84:87], v[48:51], v[220:223], v[84:87]
    ds_read_b64_tr_b16 v[30:31], v10 offset:1024
    s_waitcnt lgkmcnt(6)
    v_mfma_f32_16x16x32_bf16 v[56:59], v[16:19], v[224:227], v[56:59]
    ds_read_b64_tr_b16 v[36:37], v7 offset:4096
    v_mfma_f32_16x16x32_bf16 v[60:63], v[16:19], v[228:231], v[60:63]
    ds_read_b64_tr_b16 v[38:39], v7 offset:5120
    s_waitcnt lgkmcnt(6)
    v_mfma_f32_16x16x32_bf16 v[64:67], v[20:23], v[224:227], v[64:67]
    ds_read_b64_tr_b16 v[40:41], v8 offset:4096
    v_mfma_f32_16x16x32_bf16 v[68:71], v[20:23], v[228:231], v[68:71]
    ds_read_b64_tr_b16 v[42:43], v8 offset:5120
    s_waitcnt lgkmcnt(6)
    v_mfma_f32_16x16x32_bf16 v[72:75], v[24:27], v[224:227], v[72:75]
    ds_read_b64_tr_b16 v[44:45], v9 offset:4096
    v_mfma_f32_16x16x32_bf16 v[76:79], v[24:27], v[228:231], v[76:79]
    ds_read_b64_tr_b16 v[46:47], v9 offset:5120
    s_waitcnt lgkmcnt(6)
    v_mfma_f32_16x16x32_bf16 v[80:83], v[28:31], v[224:227], v[80:83]
    ds_read_b64_tr_b16 v[48:49], v10 offset:4096
    v_mfma_f32_16x16x32_bf16 v[84:87], v[28:31], v[228:231], v[84:87]
    ds_read_b64_tr_b16 v[50:51], v10 offset:5120
    s_waitcnt lgkmcnt(6)
    v_mfma_f32_16x16x32_bf16 v[56:59], v[36:39], v[232:235], v[56:59]
    v_add_u32 v7, 0xfffde000, v7
    v_add_u32 v8, 0xfffde000, v8
    v_add_u32 v9, 0xfffde000, v9
    v_add_u32 v10, 0xfffde000, v10
    ds_read_b64_tr_b16 v[16:17], v7 offset:0
    v_mfma_f32_16x16x32_bf16 v[60:63], v[36:39], v[236:239], v[60:63]
    ds_read_b64_tr_b16 v[18:19], v7 offset:1024
    s_waitcnt lgkmcnt(6)
    v_mfma_f32_16x16x32_bf16 v[64:67], v[40:43], v[232:235], v[64:67]
    ds_read_b64_tr_b16 v[20:21], v8 offset:0
    v_mfma_f32_16x16x32_bf16 v[68:71], v[40:43], v[236:239], v[68:71]
    ds_read_b64_tr_b16 v[22:23], v8 offset:1024
    s_waitcnt lgkmcnt(6)
    v_mfma_f32_16x16x32_bf16 v[72:75], v[44:47], v[232:235], v[72:75]
    ds_read_b64_tr_b16 v[24:25], v9 offset:0
    v_mfma_f32_16x16x32_bf16 v[76:79], v[44:47], v[236:239], v[76:79]
    ds_read_b64_tr_b16 v[26:27], v9 offset:1024
    s_bitcmp1_b32 s20, 8
    s_waitcnt lgkmcnt(6)
    v_mfma_f32_16x16x32_bf16 v[80:83], v[48:51], v[232:235], v[80:83]
    ds_read_b64_tr_b16 v[28:29], v10 offset:0
    s_cselect_b32 s12, 0x21c000, 0
    s_sub_u32 s12, s71, s12
    v_mfma_f32_16x16x32_bf16 v[84:87], v[48:51], v[236:239], v[84:87]
    ds_read_b64_tr_b16 v[30:31], v10 offset:1024
    s_add_u32 m0, s72, 0xa000
    s_add_u32 s56, s12, 0x1b0000
    buffer_load_dwordx4 v0, s[36:39], s56 offen lds
    s_waitcnt lgkmcnt(6)
    v_mfma_f32_16x16x32_bf16 v[56:59], v[16:19], v[240:243], v[56:59]
    ds_read_b64_tr_b16 v[36:37], v7 offset:4096
    v_mfma_f32_16x16x32_bf16 v[60:63], v[16:19], v[244:247], v[60:63]
    ds_read_b64_tr_b16 v[38:39], v7 offset:5120
    s_waitcnt lgkmcnt(6)
    v_mfma_f32_16x16x32_bf16 v[64:67], v[20:23], v[240:243], v[64:67]
    ds_read_b64_tr_b16 v[40:41], v8 offset:4096
    v_mfma_f32_16x16x32_bf16 v[68:71], v[20:23], v[244:247], v[68:71]
    ds_read_b64_tr_b16 v[42:43], v8 offset:5120
    s_waitcnt lgkmcnt(6)
    v_mfma_f32_16x16x32_bf16 v[72:75], v[24:27], v[240:243], v[72:75]
    ds_read_b64_tr_b16 v[44:45], v9 offset:4096
    v_mfma_f32_16x16x32_bf16 v[76:79], v[24:27], v[244:247], v[76:79]
    ds_read_b64_tr_b16 v[46:47], v9 offset:5120
    s_waitcnt lgkmcnt(6)
    v_mfma_f32_16x16x32_bf16 v[80:83], v[28:31], v[240:243], v[80:83]
    ds_read_b64_tr_b16 v[48:49], v10 offset:4096
    v_mfma_f32_16x16x32_bf16 v[84:87], v[28:31], v[244:247], v[84:87]
    ds_read_b64_tr_b16 v[50:51], v10 offset:5120
    s_waitcnt lgkmcnt(0)
    s_mov_b64 exec, 1
    ds_add_u32 v5, v6 offset:80
    s_mov_b64 exec, -1
    v_mfma_f32_16x16x32_bf16 v[56:59], v[36:39], v[248:251], v[56:59]
    s_bitcmp1_b32 s20, 9
    s_cselect_b32 s12, 0x21c000, 0
    s_sub_u32 s12, s71, s12
    v_mfma_f32_16x16x32_bf16 v[60:63], v[36:39], v[252:255], v[60:63]
    s_add_u32 m0, s72, 0xb000
    s_add_u32 s56, s12, 0x1e6000
    v_mfma_f32_16x16x32_bf16 v[64:67], v[40:43], v[248:251], v[64:67]
    buffer_load_dwordx4 v0, s[36:39], s56 offen lds
    v_mfma_f32_16x16x32_bf16 v[68:71], v[40:43], v[252:255], v[68:71]
    v_mfma_f32_16x16x32_bf16 v[72:75], v[44:47], v[248:251], v[72:75]
    v_mfma_f32_16x16x32_bf16 v[76:79], v[44:47], v[252:255], v[76:79]
    v_mfma_f32_16x16x32_bf16 v[80:83], v[48:51], v[248:251], v[80:83]
    v_mfma_f32_16x16x32_bf16 v[84:87], v[48:51], v[252:255], v[84:87]
    s_setprio 2
    v_mov_b32 v48, 1.0
    v_mul_f32 v32, s63, v56
    v_mul_f32 v33, s63, v57
    v_mul_f32 v34, s63, v58
    v_mul_f32 v35, s63, v59
    v_mul_f32 v36, s63, v64
    v_mul_f32 v37, s63, v65
    v_mul_f32 v38, s63, v66
    v_mul_f32 v39, s63, v67
    v_exp_f32 v32, v32
    v_exp_f32 v33, v33
    v_exp_f32 v34, v34
    v_exp_f32 v35, v35
    v_exp_f32 v36, v36
    v_exp_f32 v37, v37
    v_exp_f32 v38, v38
    v_exp_f32 v39, v39
    v_add_f32 v32, 1.0, v32
    v_add_f32 v33, 1.0, v33
    v_add_f32 v34, 1.0, v34
    v_add_f32 v35, 1.0, v35
    v_add_f32 v36, 1.0, v36
    v_add_f32 v37, 1.0, v37
    v_add_f32 v38, 1.0, v38
    v_add_f32 v39, 1.0, v39
    v_rcp_f32 v32, v32
    v_rcp_f32 v33, v33
    v_rcp_f32 v34, v34
    v_rcp_f32 v35, v35
    v_rcp_f32 v36, v36
    v_rcp_f32 v37, v37
    v_rcp_f32 v38, v38
    v_rcp_f32 v39, v39
    v_mul_f32 v32, v32, v56
    v_mul_f32 v33, v33, v57
    v_mul_f32 v34, v34, v58
    v_mul_f32 v35, v35, v59
    v_mul_f32 v36, v36, v64
    v_mul_f32 v37, v37, v65
    v_mul_f32 v38, v38, v66
    v_mul_f32 v39, v39, v67
    v_cvt_pk_bf16_f32 v16, v32, v33
    v_cvt_pk_bf16_f32 v17, v34, v35
    v_cvt_pk_bf16_f32 v18, v36, v37
    v_cvt_pk_bf16_f32 v19, v38, v39
    v_mul_f32 v40, s63, v60
    v_mul_f32 v41, s63, v61
    v_mul_f32 v42, s63, v62
    v_mul_f32 v43, s63, v63
    v_mul_f32 v44, s63, v68
    v_mul_f32 v45, s63, v69
    v_mul_f32 v46, s63, v70
    v_mul_f32 v47, s63, v71
    v_exp_f32 v40, v40
    v_exp_f32 v41, v41
    v_exp_f32 v42, v42
    v_exp_f32 v43, v43
    v_exp_f32 v44, v44
    v_exp_f32 v45, v45
    v_exp_f32 v46, v46
    v_exp_f32 v47, v47
    v_add_f32 v40, 1.0, v40
    v_add_f32 v41, 1.0, v41
    v_add_f32 v42, 1.0, v42
    v_add_f32 v43, 1.0, v43
    v_add_f32 v44, 1.0, v44
    v_add_f32 v45, 1.0, v45
    v_add_f32 v46, 1.0, v46
    v_add_f32 v47, 1.0, v47
    v_rcp_f32 v40, v40
    v_rcp_f32 v41, v41
    v_rcp_f32 v42, v42
    v_rcp_f32 v43, v43
    v_rcp_f32 v44, v44
    v_rcp_f32 v45, v45
    v_rcp_f32 v46, v46
    v_rcp_f32 v47, v47
    v_mul_f32 v40, v40, v60
    v_mul_f32 v41, v41, v61
    v_mul_f32 v42, v42, v62
    v_mul_f32 v43, v43, v63
    v_mul_f32 v44, v44, v68
    v_mul_f32 v45, v45, v69
    v_mul_f32 v46, v46, v70
    v_mul_f32 v47, v47, v71
    v_cvt_pk_bf16_f32 v20, v40, v41
    v_cvt_pk_bf16_f32 v21, v42, v43
    v_cvt_pk_bf16_f32 v22, v44, v45
    v_cvt_pk_bf16_f32 v23, v46, v47
    v_mul_f32 v32, s63, v72
    v_mul_f32 v33, s63, v73
    v_mul_f32 v34, s63, v74
    v_mul_f32 v35, s63, v75
    v_mul_f32 v36, s63, v80
    v_mul_f32 v37, s63, v81
    v_mul_f32 v38, s63, v82
    v_mul_f32 v39, s63, v83
    v_exp_f32 v32, v32
    v_exp_f32 v33, v33
    v_exp_f32 v34, v34
    v_exp_f32 v35, v35
    v_exp_f32 v36, v36
    v_exp_f32 v37, v37
    v_exp_f32 v38, v38
    v_exp_f32 v39, v39
    v_add_f32 v32, 1.0, v32
    v_add_f32 v33, 1.0, v33
    v_add_f32 v34, 1.0, v34
    v_add_f32 v35, 1.0, v35
    v_add_f32 v36, 1.0, v36
    v_add_f32 v37, 1.0, v37
    v_add_f32 v38, 1.0, v38
    v_add_f32 v39, 1.0, v39
    v_rcp_f32 v32, v32
    v_rcp_f32 v33, v33
    v_rcp_f32 v34, v34
    v_rcp_f32 v35, v35
    v_rcp_f32 v36, v36
    v_rcp_f32 v37, v37
    v_rcp_f32 v38, v38
    v_rcp_f32 v39, v39
    v_mul_f32 v32, v32, v72
    v_mul_f32 v33, v33, v73
    v_mul_f32 v34, v34, v74
    v_mul_f32 v35, v35, v75
    v_mul_f32 v36, v36, v80
    v_mul_f32 v37, v37, v81
    v_mul_f32 v38, v38, v82
    v_mul_f32 v39, v39, v83
    v_cvt_pk_bf16_f32 v24, v32, v33
    v_cvt_pk_bf16_f32 v25, v34, v35
    v_cvt_pk_bf16_f32 v26, v36, v37
    v_cvt_pk_bf16_f32 v27, v38, v39
    v_mul_f32 v40, s63, v76
    v_mul_f32 v41, s63, v77
    v_mul_f32 v42, s63, v78
    v_mul_f32 v43, s63, v79
    v_mul_f32 v44, s63, v84
    v_mul_f32 v45, s63, v85
    v_mul_f32 v46, s63, v86
    v_mul_f32 v47, s63, v87
    v_exp_f32 v40, v40
    v_exp_f32 v41, v41
    v_exp_f32 v42, v42
    v_exp_f32 v43, v43
    v_exp_f32 v44, v44
    v_exp_f32 v45, v45
    v_exp_f32 v46, v46
    v_exp_f32 v47, v47
    v_add_f32 v40, 1.0, v40
    v_add_f32 v41, 1.0, v41
    v_add_f32 v42, 1.0, v42
    v_add_f32 v43, 1.0, v43
    v_add_f32 v44, 1.0, v44
    v_add_f32 v45, 1.0, v45
    v_add_f32 v46, 1.0, v46
    v_add_f32 v47, 1.0, v47
    v_rcp_f32 v40, v40
    v_rcp_f32 v41, v41
    v_rcp_f32 v42, v42
    v_rcp_f32 v43, v43
    v_rcp_f32 v44, v44
    v_rcp_f32 v45, v45
    v_rcp_f32 v46, v46
    v_rcp_f32 v47, v47
    v_mul_f32 v40, v40, v76
    v_mul_f32 v41, v41, v77
    v_mul_f32 v42, v42, v78
    v_mul_f32 v43, v43, v79
    v_mul_f32 v44, v44, v84
    v_mul_f32 v45, v45, v85
    v_mul_f32 v46, v46, v86
    v_mul_f32 v47, v47, v87
    v_cvt_pk_bf16_f32 v28, v40, v41
    v_cvt_pk_bf16_f32 v29, v42, v43
    v_cvt_pk_bf16_f32 v30, v44, v45
    v_cvt_pk_bf16_f32 v31, v46, v47
    s_add_u32 s57, s66, 4096
    buffer_store_dwordx4 v[16:19], v2, s[32:35], s66 offen offset:0 sc1
    buffer_store_dwordx4 v[20:23], v2, s[32:35], s66 offen offset:1024 sc1
    buffer_store_dwordx4 v[24:27], v2, s[32:35], s57 offen offset:0 sc1
    buffer_store_dwordx4 v[28:31], v2, s[32:35], s57 offen offset:1024 sc1
    s_waitcnt vmcnt(4)
    s_mov_b64 exec, 1
    ds_add_u32 v5, v6 offset:48
    s_mov_b64 exec, -1
    s_mov_b32 s60, 160000
LW_18:
    ds_read_b32 v13, v5 offset:48
    s_waitcnt lgkmcnt(0)
    v_readfirstlane_b32 s58, v13
    s_nop 1
    s_cmp_ge_u32 s58, 4
    s_nop 0
    s_cbranch_scc1 LW_18_OK
    s_sub_u32 s60, s60, 1
    s_cmp_lg_u32 s60, 0
    s_cbranch_scc1 LW_18
LW_18_OK:
    v_add_u32 v3, 0x12000, v3
    v_add_u32 v4, 0x12000, v4
    ds_read_b64_tr_b16 v[72:73], v3 offset:0
    ds_read_b64_tr_b16 v[74:75], v3 offset:512
    ds_read_b64_tr_b16 v[76:77], v4 offset:0
    ds_read_b64_tr_b16 v[78:79], v4 offset:512
    ds_read_b64_tr_b16 v[80:81], v3 offset:2048
    ds_read_b64_tr_b16 v[82:83], v3 offset:2560
    ds_read_b64_tr_b16 v[84:85], v4 offset:2048
    ds_read_b64_tr_b16 v[86:87], v4 offset:2560
    s_waitcnt lgkmcnt(6)
    v_mfma_f32_16x16x32_bf16 v[56:59], v[72:75], v[96:99], 0
    ds_read_b64_tr_b16 v[88:89], v3 offset:4096
    v_mfma_f32_16x16x32_bf16 v[60:63], v[72:75], v[100:103], 0
    ds_read_b64_tr_b16 v[90:91], v3 offset:4608
    s_waitcnt lgkmcnt(6)
    v_mfma_f32_16x16x32_bf16 v[64:67], v[76:79], v[96:99], 0
    ds_read_b64_tr_b16 v[92:93], v4 offset:4096
    v_mfma_f32_16x16x32_bf16 v[68:71], v[76:79], v[100:103], 0
    ds_read_b64_tr_b16 v[94:95], v4 offset:4608
    s_waitcnt lgkmcnt(6)
    v_mfma_f32_16x16x32_bf16 v[56:59], v[80:83], v[104:107], v[56:59]
    ds_read_b64_tr_b16 v[72:73], v3 offset:6144
    v_mfma_f32_16x16x32_bf16 v[60:63], v[80:83], v[108:111], v[60:63]
    ds_read_b64_tr_b16 v[74:75], v3 offset:6656
    s_waitcnt lgkmcnt(6)
    v_mfma_f32_16x16x32_bf16 v[64:67], v[84:87], v[104:107], v[64:67]
    ds_read_b64_tr_b16 v[76:77], v4 offset:6144
    v_mfma_f32_16x16x32_bf16 v[68:71], v[84:87], v[108:111], v[68:71]
    ds_read_b64_tr_b16 v[78:79], v4 offset:6656
    s_waitcnt lgkmcnt(6)
    v_mfma_f32_16x16x32_bf16 v[56:59], v[88:91], v[112:115], v[56:59]
    ds_read_b64_tr_b16 v[80:81], v3 offset:8192
    v_mfma_f32_16x16x32_bf16 v[60:63], v[88:91], v[116:119], v[60:63]
    ds_read_b64_tr_b16 v[82:83], v3 offset:8704
    s_waitcnt lgkmcnt(6)
    v_mfma_f32_16x16x32_bf16 v[64:67], v[92:95], v[112:115], v[64:67]
    ds_read_b64_tr_b16 v[84:85], v4 offset:8192
    v_mfma_f32_16x16x32_bf16 v[68:71], v[92:95], v[116:119], v[68:71]
    ds_read_b64_tr_b16 v[86:87], v4 offset:8704
    s_waitcnt lgkmcnt(6)
    v_mfma_f32_16x16x32_bf16 v[56:59], v[72:75], v[120:123], v[56:59]
    ds_read_b64_tr_b16 v[88:89], v3 offset:10240
    v_mfma_f32_16x16x32_bf16 v[60:63], v[72:75], v[124:127], v[60:63]
    ds_read_b64_tr_b16 v[90:91], v3 offset:10752
    s_waitcnt lgkmcnt(6)
    v_mfma_f32_16x16x32_bf16 v[64:67], v[76:79], v[120:123], v[64:67]
    ds_read_b64_tr_b16 v[92:93], v4 offset:10240
    v_mfma_f32_16x16x32_bf16 v[68:71], v[76:79], v[124:127], v[68:71]
    ds_read_b64_tr_b16 v[94:95], v4 offset:10752
    s_waitcnt lgkmcnt(6)
    v_mfma_f32_16x16x32_bf16 v[56:59], v[80:83], v[128:131], v[56:59]
    ds_read_b64_tr_b16 v[72:73], v3 offset:12288
    v_mfma_f32_16x16x32_bf16 v[60:63], v[80:83], v[132:135], v[60:63]
    ds_read_b64_tr_b16 v[74:75], v3 offset:12800
    s_waitcnt lgkmcnt(6)
    v_mfma_f32_16x16x32_bf16 v[64:67], v[84:87], v[128:131], v[64:67]
    ds_read_b64_tr_b16 v[76:77], v4 offset:12288
    v_mfma_f32_16x16x32_bf16 v[68:71], v[84:87], v[132:135], v[68:71]
    ds_read_b64_tr_b16 v[78:79], v4 offset:12800
    s_waitcnt lgkmcnt(6)
    v_mfma_f32_16x16x32_bf16 v[56:59], v[88:91], v[136:139], v[56:59]
    ds_read_b64_tr_b16 v[80:81], v3 offset:14336
    v_mfma_f32_16x16x32_bf16 v[60:63], v[88:91], v[140:143], v[60:63]
    ds_read_b64_tr_b16 v[82:83], v3 offset:14848
    s_waitcnt lgkmcnt(6)
    v_mfma_f32_16x16x32_bf16 v[64:67], v[92:95], v[136:139], v[64:67]
    ds_read_b64_tr_b16 v[84:85], v4 offset:14336
    v_mfma_f32_16x16x32_bf16 v[68:71], v[92:95], v[140:143], v[68:71]
    ds_read_b64_tr_b16 v[86:87], v4 offset:14848
    s_waitcnt lgkmcnt(0)
    v_mov_b32 v14, s50
    v_mov_b32 v15, 0
    s_waitcnt vmcnt(0)
    s_mov_b64 exec, 1
    buffer_store_dword v14, v15, s[32:35], s67 offen sc1
    s_mov_b64 exec, -1
    v_mfma_f32_16x16x32_bf16 v[56:59], v[72:75], v[144:147], v[56:59]
    v_add_u32 v3, 0x12000, v3
    v_add_u32 v4, 0x12000, v4
    ds_read_b64_tr_b16 v[88:89], v3 offset:0
    v_mfma_f32_16x16x32_bf16 v[60:63], v[72:75], v[148:151], v[60:63]
    ds_read_b64_tr_b16 v[90:91], v3 offset:512
    v_mfma_f32_16x16x32_bf16 v[64:67], v[76:79], v[144:147], v[64:67]
    ds_read_b64_tr_b16 v[92:93], v4 offset:0
    v_mfma_f32_16x16x32_bf16 v[68:71], v[76:79], v[148:151], v[68:71]
    ds_read_b64_tr_b16 v[94:95], v4 offset:512
    v_mfma_f32_16x16x32_bf16 v[56:59], v[80:83], v[152:155], v[56:59]
    ds_read_b64_tr_b16 v[72:73], v3 offset:2048
    v_mfma_f32_16x16x32_bf16 v[60:63], v[80:83], v[156:159], v[60:63]
    ds_read_b64_tr_b16 v[74:75], v3 offset:2560
    v_mfma_f32_16x16x32_bf16 v[64:67], v[84:87], v[152:155], v[64:67]
    ds_read_b64_tr_b16 v[76:77], v4 offset:2048
    v_mfma_f32_16x16x32_bf16 v[68:71], v[84:87], v[156:159], v[68:71]
    ds_read_b64_tr_b16 v[78:79], v4 offset:2560
    s_waitcnt lgkmcnt(6)
    v_mfma_f32_16x16x32_bf16 v[56:59], v[88:91], v[160:163], v[56:59]
    ds_read_b64_tr_b16 v[80:81], v3 offset:4096
    v_mfma_f32_16x16x32_bf16 v[60:63], v[88:91], v[164:167], v[60:63]
    ds_read_b64_tr_b16 v[82:83], v3 offset:4608
    s_waitcnt lgkmcnt(6)
    v_mfma_f32_16x16x32_bf16 v[64:67], v[92:95], v[160:163], v[64:67]
    ds_read_b64_tr_b16 v[84:85], v4 offset:4096
    v_mfma_f32_16x16x32_bf16 v[68:71], v[92:95], v[164:167], v[68:71]
    ds_read_b64_tr_b16 v[86:87], v4 offset:4608
    s_waitcnt lgkmcnt(6)
    v_mfma_f32_16x16x32_bf16 v[56:59], v[72:75], v[168:171], v[56:59]
    ds_read_b64_tr_b16 v[88:89], v3 offset:6144
    v_mfma_f32_16x16x32_bf16 v[60:63], v[72:75], v[172:175], v[60:63]
    ds_read_b64_tr_b16 v[90:91], v3 offset:6656
    s_waitcnt lgkmcnt(6)
    v_mfma_f32_16x16x32_bf16 v[64:67], v[76:79], v[168:171], v[64:67]
    ds_read_b64_tr_b16 v[92:93], v4 offset:6144
    v_mfma_f32_16x16x32_bf16 v[68:71], v[76:79], v[172:175], v[68:71]
    ds_read_b64_tr_b16 v[94:95], v4 offset:6656
    s_waitcnt lgkmcnt(6)
    v_mfma_f32_16x16x32_bf16 v[56:59], v[80:83], v[176:179], v[56:59]
    v_add_u32 v3, 0xfffe4000, v3
    v_add_u32 v4, 0xfffe4000, v4
    ds_read_b64_tr_b16 v[72:73], v3 offset:0
    v_mfma_f32_16x16x32_bf16 v[60:63], v[80:83], v[180:183], v[60:63]
    ds_read_b64_tr_b16 v[74:75], v3 offset:512
    s_waitcnt lgkmcnt(6)
    v_mfma_f32_16x16x32_bf16 v[64:67], v[84:87], v[176:179], v[64:67]
    ds_read_b64_tr_b16 v[76:77], v4 offset:0
    v_mfma_f32_16x16x32_bf16 v[68:71], v[84:87], v[180:183], v[68:71]
    ds_read_b64_tr_b16 v[78:79], v4 offset:512
    s_waitcnt lgkmcnt(6)
    v_mfma_f32_16x16x32_bf16 v[56:59], v[88:91], v[184:187], v[56:59]
    ds_read_b64_tr_b16 v[80:81], v3 offset:2048
    v_mfma_f32_16x16x32_bf16 v[60:63], v[88:91], v[188:191], v[60:63]
    ds_read_b64_tr_b16 v[82:83], v3 offset:2560
    s_waitcnt lgkmcnt(6)
    v_mfma_f32_16x16x32_bf16 v[64:67], v[92:95], v[184:187], v[64:67]
    ds_read_b64_tr_b16 v[84:85], v4 offset:2048
    v_mfma_f32_16x16x32_bf16 v[68:71], v[92:95], v[188:191], v[68:71]
    ds_read_b64_tr_b16 v[86:87], v4 offset:2560
    s_waitcnt lgkmcnt(6)
    v_mfma_f32_16x16x32_bf16 v[56:59], v[72:75], v[192:195], v[56:59]
    ds_read_b64_tr_b16 v[88:89], v3 offset:4096
    v_mfma_f32_16x16x32_bf16 v[60:63], v[72:75], v[196:199], v[60:63]
    ds_read_b64_tr_b16 v[90:91], v3 offset:4608
    s_waitcnt lgkmcnt(6)
    v_mfma_f32_16x16x32_bf16 v[64:67], v[76:79], v[192:195], v[64:67]
    ds_read_b64_tr_b16 v[92:93], v4 offset:4096
    v_mfma_f32_16x16x32_bf16 v[68:71], v[76:79], v[196:199], v[68:71]
    ds_read_b64_tr_b16 v[94:95], v4 offset:4608
    s_waitcnt lgkmcnt(6)
    v_mfma_f32_16x16x32_bf16 v[56:59], v[80:83], v[200:203], v[56:59]
    ds_read_b64_tr_b16 v[72:73], v3 offset:6144
    v_mfma_f32_16x16x32_bf16 v[60:63], v[80:83], v[204:207], v[60:63]
    ds_read_b64_tr_b16 v[74:75], v3 offset:6656
    s_waitcnt lgkmcnt(6)
    v_mfma_f32_16x16x32_bf16 v[64:67], v[84:87], v[200:203], v[64:67]
    ds_read_b64_tr_b16 v[76:77], v4 offset:6144
    v_mfma_f32_16x16x32_bf16 v[68:71], v[84:87], v[204:207], v[68:71]
    ds_read_b64_tr_b16 v[78:79], v4 offset:6656
    s_waitcnt lgkmcnt(6)
    v_mfma_f32_16x16x32_bf16 v[56:59], v[88:91], v[208:211], v[56:59]
    ds_read_b64_tr_b16 v[80:81], v3 offset:8192
    v_mfma_f32_16x16x32_bf16 v[60:63], v[88:91], v[212:215], v[60:63]
    ds_read_b64_tr_b16 v[82:83], v3 offset:8704
    s_waitcnt lgkmcnt(6)
    v_mfma_f32_16x16x32_bf16 v[64:67], v[92:95], v[208:211], v[64:67]
    ds_read_b64_tr_b16 v[84:85], v4 offset:8192
    v_mfma_f32_16x16x32_bf16 v[68:71], v[92:95], v[212:215], v[68:71]
    ds_read_b64_tr_b16 v[86:87], v4 offset:8704
    s_waitcnt lgkmcnt(6)
    v_mfma_f32_16x16x32_bf16 v[56:59], v[72:75], v[216:219], v[56:59]
    ds_read_b64_tr_b16 v[88:89], v3 offset:10240
    v_mfma_f32_16x16x32_bf16 v[60:63], v[72:75], v[220:223], v[60:63]
    ds_read_b64_tr_b16 v[90:91], v3 offset:10752
    s_waitcnt lgkmcnt(6)
    v_mfma_f32_16x16x32_bf16 v[64:67], v[76:79], v[216:219], v[64:67]
    ds_read_b64_tr_b16 v[92:93], v4 offset:10240
    v_mfma_f32_16x16x32_bf16 v[68:71], v[76:79], v[220:223], v[68:71]
    ds_read_b64_tr_b16 v[94:95], v4 offset:10752
    s_waitcnt lgkmcnt(6)
    v_mfma_f32_16x16x32_bf16 v[56:59], v[80:83], v[224:227], v[56:59]
    ds_read_b64_tr_b16 v[72:73], v3 offset:12288
    v_mfma_f32_16x16x32_bf16 v[60:63], v[80:83], v[228:231], v[60:63]
    ds_read_b64_tr_b16 v[74:75], v3 offset:12800
    s_waitcnt lgkmcnt(6)
    v_mfma_f32_16x16x32_bf16 v[64:67], v[84:87], v[224:227], v[64:67]
    ds_read_b64_tr_b16 v[76:77], v4 offset:12288
    v_mfma_f32_16x16x32_bf16 v[68:71], v[84:87], v[228:231], v[68:71]
    ds_read_b64_tr_b16 v[78:79], v4 offset:12800
    s_waitcnt lgkmcnt(6)
    v_mfma_f32_16x16x32_bf16 v[56:59], v[88:91], v[232:235], v[56:59]
    ds_read_b64_tr_b16 v[80:81], v3 offset:14336
    v_mfma_f32_16x16x32_bf16 v[60:63], v[88:91], v[236:239], v[60:63]
    ds_read_b64_tr_b16 v[82:83], v3 offset:14848
    s_waitcnt lgkmcnt(6)
    v_mfma_f32_16x16x32_bf16 v[64:67], v[92:95], v[232:235], v[64:67]
    ds_read_b64_tr_b16 v[84:85], v4 offset:14336
    v_mfma_f32_16x16x32_bf16 v[68:71], v[92:95], v[236:239], v[68:71]
    ds_read_b64_tr_b16 v[86:87], v4 offset:14848
    s_waitcnt lgkmcnt(6)
    v_mfma_f32_16x16x32_bf16 v[56:59], v[72:75], v[240:243], v[56:59]
    v_mfma_f32_16x16x32_bf16 v[60:63], v[72:75], v[244:247], v[60:63]
    s_waitcnt lgkmcnt(4)
    v_mfma_f32_16x16x32_bf16 v[64:67], v[76:79], v[240:243], v[64:67]
    v_mfma_f32_16x16x32_bf16 v[68:71], v[76:79], v[244:247], v[68:71]
    s_waitcnt lgkmcnt(0)
    s_mov_b64 exec, 1
    ds_add_u32 v5, v6 offset:56
    s_mov_b64 exec, -1
    v_mfma_f32_16x16x32_bf16 v[56:59], v[80:83], v[248:251], v[56:59]
    v_mfma_f32_16x16x32_bf16 v[60:63], v[80:83], v[252:255], v[60:63]
    v_mfma_f32_16x16x32_bf16 v[64:67], v[84:87], v[248:251], v[64:67]
    v_mfma_f32_16x16x32_bf16 v[68:71], v[84:87], v[252:255], v[68:71]
    v_mov_b32 v40, 1.0
    s_nop 3
    v_mul_f32 v24, s63, v56
    v_mul_f32 v25, s63, v57
    v_mul_f32 v26, s63, v58
    v_mul_f32 v27, s63, v59
    v_mul_f32 v28, s63, v64
    v_mul_f32 v29, s63, v65
    v_mul_f32 v30, s63, v66
    v_mul_f32 v31, s63, v67
    v_exp_f32 v24, v24
    v_exp_f32 v25, v25
    v_exp_f32 v26, v26
    v_exp_f32 v27, v27
    v_exp_f32 v28, v28
    v_exp_f32 v29, v29
    v_exp_f32 v30, v30
    v_exp_f32 v31, v31
    v_add_f32 v24, 1.0, v24
    v_add_f32 v25, 1.0, v25
    v_add_f32 v26, 1.0, v26
    v_add_f32 v27, 1.0, v27
    v_add_f32 v28, 1.0, v28
    v_add_f32 v29, 1.0, v29
    v_add_f32 v30, 1.0, v30
    v_add_f32 v31, 1.0, v31
    v_rcp_f32 v24, v24
    v_rcp_f32 v25, v25
    v_rcp_f32 v26, v26
    v_rcp_f32 v27, v27
    v_rcp_f32 v28, v28
    v_rcp_f32 v29, v29
    v_rcp_f32 v30, v30
    v_rcp_f32 v31, v31
    v_mul_f32 v24, v24, v56
    v_mul_f32 v25, v25, v57
    v_mul_f32 v26, v26, v58
    v_mul_f32 v27, v27, v59
    v_mul_f32 v28, v28, v64
    v_mul_f32 v29, v29, v65
    v_mul_f32 v30, v30, v66
    v_mul_f32 v31, v31, v67
    v_cvt_pk_bf16_f32 v16, v24, v25
    v_cvt_pk_bf16_f32 v17, v26, v27
    v_cvt_pk_bf16_f32 v18, v28, v29
    v_cvt_pk_bf16_f32 v19, v30, v31
    v_mul_f32 v32, s63, v60
    v_mul_f32 v33, s63, v61
    v_mul_f32 v34, s63, v62
    v_mul_f32 v35, s63, v63
    v_mul_f32 v36, s63, v68
    v_mul_f32 v37, s63, v69
    v_mul_f32 v38, s63, v70
    v_mul_f32 v39, s63, v71
    v_exp_f32 v32, v32
    v_exp_f32 v33, v33
    v_exp_f32 v34, v34
    v_exp_f32 v35, v35
    v_exp_f32 v36, v36
    v_exp_f32 v37, v37
    v_exp_f32 v38, v38
    v_exp_f32 v39, v39
    v_add_f32 v32, 1.0, v32
    v_add_f32 v33, 1.0, v33
    v_add_f32 v34, 1.0, v34
    v_add_f32 v35, 1.0, v35
    v_add_f32 v36, 1.0, v36
    v_add_f32 v37, 1.0, v37
    v_add_f32 v38, 1.0, v38
    v_add_f32 v39, 1.0, v39
    v_rcp_f32 v32, v32
    v_rcp_f32 v33, v33
    v_rcp_f32 v34, v34
    v_rcp_f32 v35, v35
    v_rcp_f32 v36, v36
    v_rcp_f32 v37, v37
    v_rcp_f32 v38, v38
    v_rcp_f32 v39, v39
    v_mul_f32 v32, v32, v60
    v_mul_f32 v33, v33, v61
    v_mul_f32 v34, v34, v62
    v_mul_f32 v35, v35, v63
    v_mul_f32 v36, v36, v68
    v_mul_f32 v37, v37, v69
    v_mul_f32 v38, v38, v70
    v_mul_f32 v39, v39, v71
    v_cvt_pk_bf16_f32 v20, v32, v33
    v_cvt_pk_bf16_f32 v21, v34, v35
    v_cvt_pk_bf16_f32 v22, v36, v37
    v_cvt_pk_bf16_f32 v23, v38, v39
    s_add_u32 s57, s73, 4096
    buffer_store_dwordx4 v[16:19], v2, s[32:35], s73 offen offset:0 sc1
    buffer_store_dwordx4 v[20:23], v2, s[32:35], s73 offen offset:1024 sc1
    v_mov_b32 v42, s50
    v_mov_b32 v43, 0
    s_waitcnt vmcnt(0)
    s_mov_b64 exec, 1
    buffer_store_dword v42, v43, s[32:35], s74 offen sc1
    s_mov_b64 exec, -1
    s_or_b32 s56, s2, s45
    s_cmp_lg_u32 s56, 0
    s_cbranch_scc1 L_END
    s_setprio 0
    v_lshrrev_b32 v3, 2, v1
    v_lshlrev_b32 v3, 10, v3
    v_and_b32 v4, 3, v1
    v_lshl_add_u32 v3, v4, 4, v3
    s_mov_b32 s64, 0xd29000
    buffer_load_dwordx4 v[16:19], v3, s[32:35], s64 offen offset:0 sc1
    s_waitcnt vmcnt(0)
    s_mov_b32 s60, 20000
POLL_19:
    v_cmp_eq_u32 s[58:59], s50, v16
    v_cmp_eq_u32 vcc, s50, v17
    s_nop 1
    s_and_b64 s[58:59], s[58:59], vcc
    v_cmp_eq_u32 vcc, s50, v18
    s_nop 1
    s_and_b64 s[58:59], s[58:59], vcc
    v_cmp_eq_u32 vcc, s50, v19
    s_nop 1
    s_and_b64 s[58:59], s[58:59], vcc
    s_orn2_b32 s58, s58, 0xffffffff
    s_orn2_b32 s59, s59, 0xffffffff
    s_and_b32 s58, s58, s59
    s_cmp_eq_u32 s58, -1
    s_cbranch_scc1 POLL_19_OK
    s_sub_u32 s60, s60, 1
    s_cmp_eq_u32 s60, 0
    s_cbranch_scc1 POLL_19_OK
    buffer_load_dwordx4 v[16:19], v3, s[32:35], s64 offen offset:0 sc1
    s_waitcnt vmcnt(0)
    s_branch POLL_19
POLL_19_OK:
    buffer_load_dwordx4 v[16:19], v3, s[32:35], s64 offen offset:128 sc1
    s_waitcnt vmcnt(0)
    s_mov_b32 s60, 20000
POLL_20:
    v_cmp_eq_u32 s[58:59], s50, v16
    v_cmp_eq_u32 vcc, s50, v17
    s_nop 1
    s_and_b64 s[58:59], s[58:59], vcc
    v_cmp_eq_u32 vcc, s50, v18
    s_nop 1
    s_and_b64 s[58:59], s[58:59], vcc
    v_cmp_eq_u32 vcc, s50, v19
    s_nop 1
    s_and_b64 s[58:59], s[58:59], vcc
    s_orn2_b32 s58, s58, 0xffffffff
    s_orn2_b32 s59, s59, 0xffffffff
    s_and_b32 s58, s58, s59
    s_cmp_eq_u32 s58, -1
    s_cbranch_scc1 POLL_20_OK
    s_sub_u32 s60, s60, 1
    s_cmp_eq_u32 s60, 0
    s_cbranch_scc1 POLL_20_OK
    buffer_load_dwordx4 v[16:19], v3, s[32:35], s64 offen offset:128 sc1
    s_waitcnt vmcnt(0)
    s_branch POLL_20
POLL_20_OK:
    s_mov_b32 s64, 0xd2d800
    v_mov_b32 v16, s50
    v_mov_b32 v17, 0
    s_waitcnt vmcnt(0)
    s_mov_b64 exec, 1
    buffer_store_dword v16, v17, s[32:35], s64 offen sc1
    s_mov_b64 exec, -1
    s_nop 0
    s_branch L_END
L_Y0:
    s_mov_b32 s28, s14
    s_and_b32 s29, s15, 0xffff
    s_mov_b32 s30, 0x21c000
    s_mov_b32 s31, 0x20000
    s_mul_i32 s53, s45, 55296
    s_mul_i32 s56, s47, 128
    s_add_u32 s53, s53, s56
    s_add_u32 s53, s53, 0
    s_mul_i32 s56, s82, 221184
    s_add_u32 s53, s53, s56
    s_mul_i32 s55, s45, 2048
    v_lshrrev_b32 v13, 5, v1
    v_lshlrev_b32 v13, 3, v13
    v_bfe_u32 v14, v1, 3, 2
    v_add_u32 v13, v13, v14
    v_mul_u32_u24 v13, 3456, v13
    v_bfe_u32 v14, v1, 4, 2
    v_lshlrev_b32 v14, 1, v14
    v_and_b32 v4, 7, v1
    v_xor_b32 v4, v4, v14
    v_lshl_add_u32 v4, v4, 4, v13
    s_bitcmp1_b32 s20, 0
    s_cselect_b32 s21, 0x500, 0
    s_sub_u32 s21, s52, s21
    s_add_u32 m0, s54, 0x0
    s_add_u32 s56, s21, 0x0
    buffer_load_dwordx4 v3, s[24:27], s56 offen lds
    s_add_u32 m0, s54, 0x2000
    s_add_u32 s56, s21, 0x14000
    buffer_load_dwordx4 v3, s[24:27], s56 offen lds
    s_bitcmp1_b32 s20, 0
    s_cselect_b32 s12, 0x21c000, 0
    s_sub_u32 s12, s53, s12
    s_add_u32 m0, s55, 0x4000
    s_add_u32 s56, s12, 0x0
    buffer_load_dwordx4 v4, s[28:31], s56 offen lds
    s_add_u32 m0, s55, 0x4400
    s_add_u32 s56, s12, 0x3600
    buffer_load_dwordx4 v4, s[28:31], s56 offen lds
    s_barrier
    s_bitcmp1_b32 s20, 1
    s_cselect_b32 s21, 0x500, 0
    s_sub_u32 s21, s52, s21
    s_add_u32 m0, s54, 0x8000
    s_add_u32 s56, s21, 0x80
    buffer_load_dwordx4 v3, s[24:27], s56 offen lds
    s_add_u32 m0, s54, 0xa000
    s_add_u32 s56, s21, 0x14080
    buffer_load_dwordx4 v3, s[24:27], s56 offen lds
    s_bitcmp1_b32 s20, 1
    s_cselect_b32 s12, 0x21c000, 0
    s_sub_u32 s12, s53, s12
    s_add_u32 m0, s55, 0xc000
    s_add_u32 s56, s12, 0x36000
    buffer_load_dwordx4 v4, s[28:31], s56 offen lds
    s_add_u32 m0, s55, 0xc400
    s_add_u32 s56, s12, 0x39600
    buffer_load_dwordx4 v4, s[28:31], s56 offen lds
    v_and_b32 v13, 15, v1
    v_bfe_u32 v14, v1, 1, 3
    v_lshrrev_b32 v15, 4, v1
    v_xor_b32 v14, v14, v15
    v_lshlrev_b32 v13, 7, v13
    v_lshl_add_u32 v7, v14, 4, v13
    s_lshr_b32 s56, s45, 1
    s_lshl_b32 s56, s56, 13
    v_add_u32 v7, s56, v7
    v_xor_b32 v8, 64, v7
    s_mov_b32 s40, s8
    s_and_b32 s41, s9, 0xffff
    s_mov_b32 s42, 0x6400
    s_mov_b32 s43, 0x20000
    s_mul_i32 s57, s47, 3200
    s_lshl_b32 s56, s45, 10
    s_add_u32 s57, s57, s56
    s_add_u32 m0, s56, 0x26400
    s_nop 0
    buffer_load_dwordx4 v2, s[40:43], s57 offen lds
    s_mul_i32 s76, s49, 74
    s_add_u32 s76, s76, s45
    s_mul_i32 s76, s76, 5120
    s_add_u32 s76, s76, 0x940000
    s_mov_b32 s77, 0xd28000
    s_mul_i32 s78, s45, 5120
    s_mul_i32 s74, s48, 74
    s_add_u32 s74, s74, s45
    s_lshl_b32 s74, s74, 12
    s_lshl_b32 s75, s48, 9
    s_add_u32 s75, s75, 0xd29000
    s_lshr_b32 s79, s2, 3
    s_lshr_b32 s56, s2, 6
    s_add_u32 s79, s79, s56
    s_mul_i32 s56, s49, 5
    s_add_u32 s57, s56, 4
    s_lshr_b32 s56, s56, 3
    s_lshr_b32 s57, s57, 3
    s_lshl_b32 s56, s56, 9
    s_lshl_b32 s57, s57, 9
    v_mov_b32 v176, s56
    v_mov_b32 v177, s57
    v_cmp_gt_u32 vcc, 32, v1
    s_nop 1
    v_cndmask_b32 v176, v177, v176, vcc
    v_and_b32 v177, 31, v1
    v_lshl_add_u32 v176, v177, 4, v176
    v_mov_b32 v178, 0x7ff00000
    v_cmp_gt_u32 vcc, 19, v177
    s_nop 1
    v_cndmask_b32 v175, v178, v176, vcc
    s_lshr_b32 s56, s45, 1
    s_lshl_b32 s57, s46, 1
    s_add_u32 s56, s56, s57
    s_lshl_b32 s65, s56, 9
    s_mul_i32 s56, s56, 74
    s_mul_i32 s57, s47, 2
    s_add_u32 s56, s56, s57
    s_add_u32 s56, s56, 0
    s_lshl_b32 s64, s56, 12
    s_and_b32 s56, s45, 1
    s_lshl_b32 s57, s56, 11
    s_add_u32 s64, s64, s57
    s_mul_i32 s57, s47, 2
    s_add_u32 s56, s56, s57
    s_lshl_b32 s56, s56, 2
    s_add_u32 s65, s65, s56
    s_add_u32 s65, s65, 0xd29000
    s_and_b32 s56, s45, 1
    s_lshl_b32 s56, s56, 11
    s_add_u32 s64, s64, s56
    s_and_b32 s56, s2, 127
    s_lshl_b32 s60, s45, 7
    s_add_u32 s60, s60, s56
    s_mul_i32 s59, s60, 205
    s_lshr_b32 s59, s59, 10
    s_mul_i32 s56, s59, 5
    s_sub_u32 s61, s60, s56
    s_lshl_b32 s66, s59, 5
    s_mov_b32 s70, 5120
    s_mov_b32 s71, 20480
    s_mov_b32 s36, s16
    s_and_b32 s37, s17, 0xffff
    s_mov_b32 s38, 0x21c000
    s_mov_b32 s39, 0x20000
    s_cmp_lt_u32 s59, 54
    s_cbranch_scc1 RPW2_21
    s_mov_b32 s36, s10
    s_and_b32 s37, s11, 0xffff
    s_mov_b32 s38, 0xc8000
    s_mov_b32 s39, 0x20000
    s_sub_u32 s56, s59, 54
    s_lshr_b32 s57, s56, 1
    s_mul_i32 s57, s57, 80
    s_and_b32 s58, s56, 1
    s_lshl_b32 s58, s58, 3
    s_add_u32 s57, s57, s58
    s_mul_i32 s58, s56, 160
    s_sub_u32 s58, s58, 2544
    s_cmp_lt_u32 s56, 16
    s_cselect_b32 s66, s57, s58
    s_mov_b32 s71, 5120
    s_cselect_b32 s71, s71, 102400
    s_mov_b32 s70, 25600
RPW2_21:
    s_mul_i32 s66, s66, 1280
    s_lshl_b32 s56, s61, 8
    s_add_u32 s66, s66, s56
    s_mul_i32 s67, s59, 5120
    s_add_u32 s67, s67, 0x940000
    s_lshl_b32 s73, s61, 3
    s_lshl_b32 s72, s61, 7
    s_add_u32 s72, s72, s59
    s_lshl_b32 s72, s72, 2
    s_add_u32 s72, s72, 0xd28000
    s_cmp_ge_u32 s59, 72
    s_cselect_b32 s56, 8, 0
    v_mul_u32_u24 v134, s56, v1
    s_cmp_lt_u32 s60, 370
    s_cselect_b32 s66, s66, 0x7ff00000
    s_cselect_b32 s67, s67, 0x7ff00000
    s_cselect_b32 s72, s72, 0x7ff00000
    v_lshrrev_b32 v96, 5, v1
    v_mul_u32_u24 v96, s70, v96
    v_bfe_u32 v97, v1, 3, 2
    v_mul_u32_u24 v97, 1280, v97
    v_add_u32 v96, v96, v97
    v_bfe_u32 v97, v1, 4, 2
    v_lshlrev_b32 v97, 1, v97
    v_and_b32 v128, 7, v1
    v_xor_b32 v128, v128, v97
    v_lshl_add_u32 v128, v128, 4, v96
    s_lshl_b32 s70, s70, 1
    v_lshrrev_b32 v96, 5, v1
    v_lshlrev_b32 v96, 4, v96
    v_bfe_u32 v97, v1, 2, 3
    v_add_u32 v96, v96, v97
    v_lshlrev_b32 v96, 7, v96
    v_and_b32 v97, 3, v1
    v_lshl_add_u32 v96, v97, 3, v96
    v_add_u32 v96, 0x20000, v96
    v_bfe_u32 v97, v1, 3, 2
    v_xor_b32 v129, 0, v97
    v_lshl_add_u32 v129, v129, 5, v96
    v_xor_b32 v130, 1, v97
    v_lshl_add_u32 v130, v130, 5, v96
    v_xor_b32 v131, 2, v97
    v_lshl_add_u32 v131, v131, 5, v96
    v_xor_b32 v132, 3, v97
    v_lshl_add_u32 v132, v132, 5, v96
    s_min_u32 s56, s45, 2
    s_lshl_b32 s56, s56, 13
    v_add_u32 v129, s56, v129
    v_add_u32 v130, s56, v130
    v_add_u32 v131, s56, v131
    v_add_u32 v132, s56, v132
    s_add_u32 s68, s56, 0x20000
    s_cmp_lt_u32 s45, 3
    s_cselect_b32 s68, s68, 0x27400
    s_cselect_b32 s69, 1024, 0
    v_lshrrev_b32 v13, 5, v1
    v_lshlrev_b32 v13, 4, v13
    v_bfe_u32 v14, v1, 2, 3
    v_add_u32 v13, v13, v14
    v_lshlrev_b32 v13, 7, v13
    v_and_b32 v14, 3, v1
    v_lshl_add_u32 v13, v14, 3, v13
    v_add_u32 v13, 0x4000, v13
    v_bfe_u32 v14, v1, 3, 2
    s_and_b32 s56, s45, 1
    s_lshl_b32 s56, s56, 1
    v_xor_b32 v14, s56, v14
    v_xor_b32 v9, 0, v14
    v_lshl_add_u32 v9, v9, 5, v13
    v_xor_b32 v10, 1, v14
    v_lshl_add_u32 v10, v10, 5, v13
    s_waitcnt lgkmcnt(0)
    s_mul_i32 s50, s50, 0x9e3779b1
    s_add_u32 s50, s50, 0x7f4a7c15
    s_mov_b32 s51, s50
    s_waitcnt vmcnt(5)
    s_barrier
    ds_read_b128 v[64:67], v7 offset:0
    ds_read_b128 v[68:71], v7 offset:2048
    ds_read_b128 v[72:75], v7 offset:4096
    ds_read_b128 v[76:79], v7 offset:6144
    ds_read_b64_tr_b16 v[48:49], v9 offset:0
    ds_read_b64_tr_b16 v[50:51], v9 offset:1024
    ds_read_b64_tr_b16 v[52:53], v10 offset:0
    ds_read_b64_tr_b16 v[54:55], v10 offset:1024
    s_waitcnt lgkmcnt(0)
    v_mfma_f32_16x16x32_bf16 v[16:19], v[48:51], v[64:67], 0
    ds_read_b128 v[80:83], v8 offset:0
    ds_read_b128 v[84:87], v8 offset:2048
    s_bitcmp1_b32 s20, 2
    s_cselect_b32 s21, 0x500, 0
    s_sub_u32 s21, s52, s21
    s_add_u32 m0, s54, 0x10000
    s_add_u32 s56, s21, 0x100
    buffer_load_dwordx4 v3, s[24:27], s56 offen lds
    v_mfma_f32_16x16x32_bf16 v[20:23], v[48:51], v[68:71], 0
    ds_read_b128 v[88:91], v8 offset:4096
    ds_read_b128 v[92:95], v8 offset:6144
    s_add_u32 m0, s54, 0x12000
    s_add_u32 s56, s21, 0x14100
    buffer_load_dwordx4 v3, s[24:27], s56 offen lds
    v_mfma_f32_16x16x32_bf16 v[24:27], v[48:51], v[72:75], 0
    ds_read_b64_tr_b16 v[56:57], v9 offset:4096
    ds_read_b64_tr_b16 v[58:59], v9 offset:5120
    s_bitcmp1_b32 s20, 2
    s_cselect_b32 s12, 0x21c000, 0
    s_sub_u32 s12, s53, s12
    s_add_u32 m0, s55, 0x14000
    s_add_u32 s56, s12, 0x6c000
    buffer_load_dwordx4 v4, s[28:31], s56 offen lds
    v_mfma_f32_16x16x32_bf16 v[28:31], v[48:51], v[76:79], 0
    ds_read_b64_tr_b16 v[60:61], v10 offset:4096
    ds_read_b64_tr_b16 v[62:63], v10 offset:5120
    s_add_u32 m0, s55, 0x14400
    s_add_u32 s56, s12, 0x6f600
    buffer_load_dwordx4 v4, s[28:31], s56 offen lds
    v_mfma_f32_16x16x32_bf16 v[32:35], v[52:55], v[64:67], 0
    v_mfma_f32_16x16x32_bf16 v[36:39], v[52:55], v[68:71], 0
    v_mfma_f32_16x16x32_bf16 v[40:43], v[52:55], v[72:75], 0
    v_mfma_f32_16x16x32_bf16 v[44:47], v[52:55], v[76:79], 0
    s_waitcnt lgkmcnt(0)
    s_waitcnt vmcnt(5)
    s_barrier
    v_mfma_f32_16x16x32_bf16 v[16:19], v[56:59], v[80:83], v[16:19]
    ds_read_b128 v[64:67], v7 offset:32768
    ds_read_b128 v[68:71], v7 offset:34816
    s_bitcmp1_b32 s20, 3
    s_cselect_b32 s21, 0x500, 0
    s_sub_u32 s21, s52, s21
    s_add_u32 m0, s54, 0x18000
    s_add_u32 s56, s21, 0x180
    buffer_load_dwordx4 v3, s[24:27], s56 offen lds
    v_mfma_f32_16x16x32_bf16 v[20:23], v[56:59], v[84:87], v[20:23]
    ds_read_b128 v[72:75], v7 offset:36864
    ds_read_b128 v[76:79], v7 offset:38912
    s_add_u32 m0, s54, 0x1a000
    s_add_u32 s56, s21, 0x14180
    buffer_load_dwordx4 v3, s[24:27], s56 offen lds
    v_mfma_f32_16x16x32_bf16 v[24:27], v[56:59], v[88:91], v[24:27]
    ds_read_b64_tr_b16 v[48:49], v9 offset:32768
    ds_read_b64_tr_b16 v[50:51], v9 offset:33792
    s_mov_b32 m0, s68
    s_add_u32 s68, s68, s69
    s_add_u32 s56, s66, 0
    buffer_load_dwordx4 v128, s[36:39], s56 offen lds
    v_mfma_f32_16x16x32_bf16 v[28:31], v[56:59], v[92:95], v[28:31]
    ds_read_b64_tr_b16 v[52:53], v10 offset:32768
    ds_read_b64_tr_b16 v[54:55], v10 offset:33792
    s_mov_b32 m0, s68
    s_add_u32 s68, s68, s69
    s_add_u32 s56, s66, 0
    s_add_u32 s56, s56, s71
    buffer_load_dwordx4 v128, s[36:39], s56 offen lds
    v_mfma_f32_16x16x32_bf16 v[32:35], v[60:63], v[80:83], v[32:35]
    s_mov_b32 m0, s68
    s_add_u32 s68, s68, s69
    s_add_u32 s56, s66, 0
    s_add_u32 s56, s56, s70
    buffer_load_dwordx4 v128, s[36:39], s56 offen lds
    v_mfma_f32_16x16x32_bf16 v[36:39], v[60:63], v[84:87], v[36:39]
    s_mov_b32 m0, s68
    s_add_u32 s68, s68, s69
    s_add_u32 s56, s66, 0
    s_add_u32 s56, s56, s70
    s_add_u32 s56, s56, s71
    buffer_load_dwordx4 v128, s[36:39], s56 offen lds
    v_mfma_f32_16x16x32_bf16 v[40:43], v[60:63], v[88:91], v[40:43]
    v_mfma_f32_16x16x32_bf16 v[44:47], v[60:63], v[92:95], v[44:47]
    s_waitcnt lgkmcnt(0)
    v_mfma_f32_16x16x32_bf16 v[16:19], v[48:51], v[64:67], v[16:19]
    ds_read_b128 v[80:83], v8 offset:32768
    ds_read_b128 v[84:87], v8 offset:34816
    s_bitcmp1_b32 s20, 3
    s_cselect_b32 s12, 0x21c000, 0
    s_sub_u32 s12, s53, s12
    s_add_u32 m0, s55, 0x1c000
    s_add_u32 s56, s12, 0xa2000
    buffer_load_dwordx4 v4, s[28:31], s56 offen lds
    v_mfma_f32_16x16x32_bf16 v[20:23], v[48:51], v[68:71], v[20:23]
    ds_read_b128 v[88:91], v8 offset:36864
    ds_read_b128 v[92:95], v8 offset:38912
    s_add_u32 m0, s55, 0x1c400
    s_add_u32 s56, s12, 0xa5600
    buffer_load_dwordx4 v4, s[28:31], s56 offen lds
    v_mfma_f32_16x16x32_bf16 v[24:27], v[48:51], v[72:75], v[24:27]
    ds_read_b64_tr_b16 v[56:57], v9 offset:36864
    ds_read_b64_tr_b16 v[58:59], v9 offset:37888
    s_mov_b32 m0, s68
    s_add_u32 s68, s68, s69
    s_add_u32 s56, s66, 128
    buffer_load_dwordx4 v128, s[36:39], s56 offen lds
    v_mfma_f32_16x16x32_bf16 v[28:31], v[48:51], v[76:79], v[28:31]
    ds_read_b64_tr_b16 v[60:61], v10 offset:36864
    ds_read_b64_tr_b16 v[62:63], v10 offset:37888
    s_mov_b32 m0, s68
    s_add_u32 s68, s68, s69
    s_add_u32 s56, s66, 128
    s_add_u32 s56, s56, s71
    buffer_load_dwordx4 v128, s[36:39], s56 offen lds
    v_mfma_f32_16x16x32_bf16 v[32:35], v[52:55], v[64:67], v[32:35]
    s_mov_b32 m0, s68
    s_add_u32 s68, s68, s69
    s_add_u32 s56, s66, 128
    s_add_u32 s56, s56, s70
    buffer_load_dwordx4 v128, s[36:39], s56 offen lds
    v_mfma_f32_16x16x32_bf16 v[36:39], v[52:55], v[68:71], v[36:39]
    s_mov_b32 m0, s68
    s_add_u32 s68, s68, s69
    s_add_u32 s56, s66, 128
    s_add_u32 s56, s56, s70
    s_add_u32 s56, s56, s71
    buffer_load_dwordx4 v128, s[36:39], s56 offen lds
    v_mfma_f32_16x16x32_bf16 v[40:43], v[52:55], v[72:75], v[40:43]
    v_mfma_f32_16x16x32_bf16 v[44:47], v[52:55], v[76:79], v[44:47]
    s_waitcnt lgkmcnt(0)
    s_waitcnt vmcnt(12)
    s_barrier
    v_mfma_f32_16x16x32_bf16 v[16:19], v[56:59], v[80:83], v[16:19]
    v_add_u32 v7, 0x10000, v7
    v_add_u32 v8, 0x10000, v8
    ds_read_b128 v[64:67], v7 offset:0
    ds_read_b128 v[68:71], v7 offset:2048
    s_bitcmp1_b32 s20, 4
    s_cselect_b32 s21, 0x500, 0
    s_sub_u32 s21, s52, s21
    s_add_u32 m0, s54, 0x0
    s_add_u32 s56, s21, 0x200
    buffer_load_dwordx4 v3, s[24:27], s56 offen lds
    v_mfma_f32_16x16x32_bf16 v[20:23], v[56:59], v[84:87], v[20:23]
    ds_read_b128 v[72:75], v7 offset:4096
    ds_read_b128 v[76:79], v7 offset:6144
    s_add_u32 m0, s54, 0x2000
    s_add_u32 s56, s21, 0x14200
    buffer_load_dwordx4 v3, s[24:27], s56 offen lds
    v_mfma_f32_16x16x32_bf16 v[24:27], v[56:59], v[88:91], v[24:27]
    v_add_u32 v9, 0x10000, v9
    v_add_u32 v10, 0x10000, v10
    ds_read_b64_tr_b16 v[48:49], v9 offset:0
    ds_read_b64_tr_b16 v[50:51], v9 offset:1024
    v_mfma_f32_16x16x32_bf16 v[28:31], v[56:59], v[92:95], v[28:31]
    ds_read_b64_tr_b16 v[52:53], v10 offset:0
    ds_read_b64_tr_b16 v[54:55], v10 offset:1024
    v_mfma_f32_16x16x32_bf16 v[32:35], v[60:63], v[80:83], v[32:35]
    v_mfma_f32_16x16x32_bf16 v[36:39], v[60:63], v[84:87], v[36:39]
    v_mfma_f32_16x16x32_bf16 v[40:43], v[60:63], v[88:91], v[40:43]
    v_mfma_f32_16x16x32_bf16 v[44:47], v[60:63], v[92:95], v[44:47]
    s_waitcnt lgkmcnt(0)
    v_mfma_f32_16x16x32_bf16 v[16:19], v[48:51], v[64:67], v[16:19]
    ds_read_b128 v[80:83], v8 offset:0
    ds_read_b128 v[84:87], v8 offset:2048
    s_bitcmp1_b32 s20, 4
    s_cselect_b32 s12, 0x21c000, 0
    s_sub_u32 s12, s53, s12
    s_add_u32 m0, s55, 0x4000
    s_add_u32 s56, s12, 0xd8000
    buffer_load_dwordx4 v4, s[28:31], s56 offen lds
    v_mfma_f32_16x16x32_bf16 v[20:23], v[48:51], v[68:71], v[20:23]
    ds_read_b128 v[88:91], v8 offset:4096
    ds_read_b128 v[92:95], v8 offset:6144
    s_add_u32 m0, s55, 0x4400
    s_add_u32 s56, s12, 0xdb600
    buffer_load_dwordx4 v4, s[28:31], s56 offen lds
    v_mfma_f32_16x16x32_bf16 v[24:27], v[48:51], v[72:75], v[24:27]
    ds_read_b64_tr_b16 v[56:57], v9 offset:4096
    ds_read_b64_tr_b16 v[58:59], v9 offset:5120
    v_mfma_f32_16x16x32_bf16 v[28:31], v[48:51], v[76:79], v[28:31]
    ds_read_b64_tr_b16 v[60:61], v10 offset:4096
    ds_read_b64_tr_b16 v[62:63], v10 offset:5120
    v_mfma_f32_16x16x32_bf16 v[32:35], v[52:55], v[64:67], v[32:35]
    v_mfma_f32_16x16x32_bf16 v[36:39], v[52:55], v[68:71], v[36:39]
    v_mfma_f32_16x16x32_bf16 v[40:43], v[52:55], v[72:75], v[40:43]
    v_mfma_f32_16x16x32_bf16 v[44:47], v[52:55], v[76:79], v[44:47]
    s_waitcnt lgkmcnt(0)
    s_waitcnt vmcnt(8)
    s_barrier
    v_mfma_f32_16x16x32_bf16 v[16:19], v[56:59], v[80:83], v[16:19]
    ds_read_b128 v[64:67], v7 offset:32768
    ds_read_b128 v[68:71], v7 offset:34816
    s_bitcmp1_b32 s20, 5
    s_cselect_b32 s21, 0x500, 0
    s_sub_u32 s21, s52, s21
    s_add_u32 m0, s54, 0x8000
    s_add_u32 s56, s21, 0x280
    buffer_load_dwordx4 v3, s[24:27], s56 offen lds
    s_add_u32 m0, s54, 0xa000
    s_add_u32 s56, s21, 0x14280
    buffer_load_dwordx4 v3, s[24:27], s56 offen lds
    v_mfma_f32_16x16x32_bf16 v[20:23], v[56:59], v[84:87], v[20:23]
    ds_read_b128 v[72:75], v7 offset:36864
    ds_read_b128 v[76:79], v7 offset:38912
    s_waitcnt vmcnt(6)
    ds_read_b64_tr_b16 v[96:97], v129 offset:0
    v_mfma_f32_16x16x32_bf16 v[24:27], v[56:59], v[88:91], v[24:27]
    ds_read_b64_tr_b16 v[48:49], v9 offset:32768
    ds_read_b64_tr_b16 v[50:51], v9 offset:33792
    ds_read_b64_tr_b16 v[98:99], v129 offset:1024
    ds_read_b64_tr_b16 v[100:101], v130 offset:0
    v_mfma_f32_16x16x32_bf16 v[28:31], v[56:59], v[92:95], v[28:31]
    ds_read_b64_tr_b16 v[52:53], v10 offset:32768
    ds_read_b64_tr_b16 v[54:55], v10 offset:33792
    ds_read_b64_tr_b16 v[102:103], v130 offset:1024
    v_mfma_f32_16x16x32_bf16 v[32:35], v[60:63], v[80:83], v[32:35]
    ds_read_b64_tr_b16 v[104:105], v131 offset:0
    v_mfma_f32_16x16x32_bf16 v[36:39], v[60:63], v[84:87], v[36:39]
    ds_read_b64_tr_b16 v[106:107], v131 offset:1024
    v_mfma_f32_16x16x32_bf16 v[40:43], v[60:63], v[88:91], v[40:43]
    ds_read_b64_tr_b16 v[108:109], v132 offset:0
    v_mfma_f32_16x16x32_bf16 v[44:47], v[60:63], v[92:95], v[44:47]
    ds_read_b64_tr_b16 v[110:111], v132 offset:1024
    s_waitcnt lgkmcnt(0)
    v_mfma_f32_16x16x32_bf16 v[16:19], v[48:51], v[64:67], v[16:19]
    ds_read_b128 v[80:83], v8 offset:32768
    ds_read_b128 v[84:87], v8 offset:34816
    s_bitcmp1_b32 s20, 5
    s_cselect_b32 s12, 0x21c000, 0
    s_sub_u32 s12, s53, s12
    s_add_u32 m0, s55, 0xc000
    s_add_u32 s56, s12, 0x10e000
    buffer_load_dwordx4 v4, s[28:31], s56 offen lds
    s_add_u32 m0, s55, 0xc400
    s_add_u32 s56, s12, 0x111600
    buffer_load_dwordx4 v4, s[28:31], s56 offen lds
    v_mfma_f32_16x16x32_bf16 v[20:23], v[48:51], v[68:71], v[20:23]
    ds_read_b128 v[88:91], v8 offset:36864
    ds_read_b128 v[92:95], v8 offset:38912
    ds_read_b64_tr_b16 v[112:113], v129 offset:4096
    ds_read_b64_tr_b16 v[114:115], v129 offset:5120
    v_mfma_f32_16x16x32_bf16 v[24:27], v[48:51], v[72:75], v[24:27]
    ds_read_b64_tr_b16 v[56:57], v9 offset:36864
    ds_read_b64_tr_b16 v[58:59], v9 offset:37888
    ds_read_b64_tr_b16 v[116:117], v130 offset:4096
    ds_read_b64_tr_b16 v[118:119], v130 offset:5120
    v_mfma_f32_16x16x32_bf16 v[28:31], v[48:51], v[76:79], v[28:31]
    ds_read_b64_tr_b16 v[60:61], v10 offset:36864
    ds_read_b64_tr_b16 v[62:63], v10 offset:37888
    ds_read_b64_tr_b16 v[120:121], v131 offset:4096
    ds_read_b64_tr_b16 v[122:123], v131 offset:5120
    v_mfma_f32_16x16x32_bf16 v[32:35], v[52:55], v[64:67], v[32:35]
    ds_read_b64_tr_b16 v[124:125], v132 offset:4096
    ds_read_b64_tr_b16 v[126:127], v132 offset:5120
    v_mfma_f32_16x16x32_bf16 v[36:39], v[52:55], v[68:71], v[36:39]
    s_add_u32 s56, s73, 0
    s_mul_i32 s57, s56, 205
    s_lshr_b32 s57, s57, 10
    s_mul_i32 s57, s57, 373760
    s_lshl_b32 s56, s56, 10
    s_add_u32 s56, s56, s57
    s_add_u32 s56, s56, s67
    buffer_store_dwordx4 v[96:99], v2, s[32:35], s56 offen sc1
    s_add_u32 s56, s73, 1
    s_mul_i32 s57, s56, 205
    s_lshr_b32 s57, s57, 10
    s_mul_i32 s57, s57, 373760
    s_lshl_b32 s56, s56, 10
    s_add_u32 s56, s56, s57
    s_add_u32 s56, s56, s67
    buffer_store_dwordx4 v[100:103], v2, s[32:35], s56 offen sc1
    v_mfma_f32_16x16x32_bf16 v[40:43], v[52:55], v[72:75], v[40:43]
    s_add_u32 s56, s73, 2
    s_mul_i32 s57, s56, 205
    s_lshr_b32 s57, s57, 10
    s_mul_i32 s57, s57, 373760
    s_lshl_b32 s56, s56, 10
    s_add_u32 s56, s56, s57
    s_add_u32 s56, s56, s67
    buffer_store_dwordx4 v[104:107], v2, s[32:35], s56 offen sc1
    v_mfma_f32_16x16x32_bf16 v[44:47], v[52:55], v[76:79], v[44:47]
    s_add_u32 s56, s73, 3
    s_mul_i32 s57, s56, 205
    s_lshr_b32 s57, s57, 10
    s_mul_i32 s57, s57, 373760
    s_lshl_b32 s56, s56, 10
    s_add_u32 s56, s56, s57
    s_add_u32 s56, s56, s67
    buffer_store_dwordx4 v[108:111], v2, s[32:35], s56 offen sc1
    s_waitcnt lgkmcnt(0)
    s_waitcnt vmcnt(8)
    s_barrier
    v_mfma_f32_16x16x32_bf16 v[16:19], v[56:59], v[80:83], v[16:19]
    v_add_u32 v7, 0xffff0000, v7
    v_add_u32 v8, 0xffff0000, v8
    ds_read_b128 v[64:67], v7 offset:0
    ds_read_b128 v[68:71], v7 offset:2048
    s_bitcmp1_b32 s20, 6
    s_cselect_b32 s21, 0x500, 0
    s_sub_u32 s21, s52, s21
    s_add_u32 m0, s54, 0x10000
    s_add_u32 s56, s21, 0x300
    buffer_load_dwordx4 v3, s[24:27], s56 offen lds
    v_mfma_f32_16x16x32_bf16 v[20:23], v[56:59], v[84:87], v[20:23]
    ds_read_b128 v[72:75], v7 offset:4096
    ds_read_b128 v[76:79], v7 offset:6144
    s_add_u32 m0, s54, 0x12000
    s_add_u32 s56, s21, 0x14300
    buffer_load_dwordx4 v3, s[24:27], s56 offen lds
    v_mfma_f32_16x16x32_bf16 v[24:27], v[56:59], v[88:91], v[24:27]
    v_add_u32 v9, 0xffff0000, v9
    v_add_u32 v10, 0xffff0000, v10
    ds_read_b64_tr_b16 v[48:49], v9 offset:0
    ds_read_b64_tr_b16 v[50:51], v9 offset:1024
    s_add_u32 s56, s73, 4
    s_mul_i32 s57, s56, 205
    s_lshr_b32 s57, s57, 10
    s_mul_i32 s57, s57, 373760
    s_lshl_b32 s56, s56, 10
    s_add_u32 s56, s56, s57
    s_add_u32 s56, s56, s67
    buffer_store_dwordx4 v[112:115], v2, s[32:35], s56 offen sc1
    v_mfma_f32_16x16x32_bf16 v[28:31], v[56:59], v[92:95], v[28:31]
    ds_read_b64_tr_b16 v[52:53], v10 offset:0
    ds_read_b64_tr_b16 v[54:55], v10 offset:1024
    s_add_u32 s56, s73, 5
    s_mul_i32 s57, s56, 205
    s_lshr_b32 s57, s57, 10
    s_mul_i32 s57, s57, 373760
    s_lshl_b32 s56, s56, 10
    s_add_u32 s56, s56, s57
    s_add_u32 s56, s56, s67
    buffer_store_dwordx4 v[116:119], v2, s[32:35], s56 offen sc1
    v_mfma_f32_16x16x32_bf16 v[32:35], v[60:63], v[80:83], v[32:35]
    s_add_u32 s56, s73, 6
    s_mul_i32 s57, s56, 205
    s_lshr_b32 s57, s57, 10
    s_mul_i32 s57, s57, 373760
    s_lshl_b32 s56, s56, 10
    s_add_u32 s56, s56, s57
    s_add_u32 s56, s56, s67
    buffer_store_dwordx4 v[120:123], v2, s[32:35], s56 offen sc1
    v_mfma_f32_16x16x32_bf16 v[36:39], v[60:63], v[84:87], v[36:39]
    s_add_u32 s56, s73, 7
    s_mul_i32 s57, s56, 205
    s_lshr_b32 s57, s57, 10
    s_mul_i32 s57, s57, 373760
    s_lshl_b32 s56, s56, 10
    s_add_u32 s56, s56, s57
    s_add_u32 s56, s56, s67
    buffer_store_dwordx4 v[124:127], v2, s[32:35], s56 offen sc1
    v_mfma_f32_16x16x32_bf16 v[40:43], v[60:63], v[88:91], v[40:43]
    v_mfma_f32_16x16x32_bf16 v[44:47], v[60:63], v[92:95], v[44:47]
    s_waitcnt lgkmcnt(0)
    v_mfma_f32_16x16x32_bf16 v[16:19], v[48:51], v[64:67], v[16:19]
    ds_read_b128 v[80:83], v8 offset:0
    ds_read_b128 v[84:87], v8 offset:2048
    s_bitcmp1_b32 s20, 6
    s_cselect_b32 s12, 0x21c000, 0
    s_sub_u32 s12, s53, s12
    s_add_u32 m0, s55, 0x14000
    s_add_u32 s56, s12, 0x144000
    buffer_load_dwordx4 v4, s[28:31], s56 offen lds
    v_mfma_f32_16x16x32_bf16 v[20:23], v[48:51], v[68:71], v[20:23]
    ds_read_b128 v[88:91], v8 offset:4096
    ds_read_b128 v[92:95], v8 offset:6144
    s_add_u32 m0, s55, 0x14400
    s_add_u32 s56, s12, 0x147600
    buffer_load_dwordx4 v4, s[28:31], s56 offen lds
    v_mfma_f32_16x16x32_bf16 v[24:27], v[48:51], v[72:75], v[24:27]
    ds_read_b64_tr_b16 v[56:57], v9 offset:4096
    ds_read_b64_tr_b16 v[58:59], v9 offset:5120
    v_mfma_f32_16x16x32_bf16 v[28:31], v[48:51], v[76:79], v[28:31]
    ds_read_b64_tr_b16 v[60:61], v10 offset:4096
    ds_read_b64_tr_b16 v[62:63], v10 offset:5120
    v_mfma_f32_16x16x32_bf16 v[32:35], v[52:55], v[64:67], v[32:35]
    v_mfma_f32_16x16x32_bf16 v[36:39], v[52:55], v[68:71], v[36:39]
    v_mfma_f32_16x16x32_bf16 v[40:43], v[52:55], v[72:75], v[40:43]
    v_mfma_f32_16x16x32_bf16 v[44:47], v[52:55], v[76:79], v[44:47]
    s_waitcnt lgkmcnt(0)
    s_waitcnt vmcnt(12)
    s_barrier
    v_mfma_f32_16x16x32_bf16 v[16:19], v[56:59], v[80:83], v[16:19]
    ds_read_b128 v[64:67], v7 offset:32768
    ds_read_b128 v[68:71], v7 offset:34816
    s_bitcmp1_b32 s20, 7
    s_cselect_b32 s21, 0x500, 0
    s_sub_u32 s21, s52, s21
    s_add_u32 m0, s54, 0x18000
    s_add_u32 s56, s21, 0x380
    buffer_load_dwordx4 v3, s[24:27], s56 offen lds
    v_mfma_f32_16x16x32_bf16 v[20:23], v[56:59], v[84:87], v[20:23]
    ds_read_b128 v[72:75], v7 offset:36864
    ds_read_b128 v[76:79], v7 offset:38912
    s_add_u32 m0, s54, 0x1a000
    s_add_u32 s56, s21, 0x14380
    buffer_load_dwordx4 v3, s[24:27], s56 offen lds
    v_mfma_f32_16x16x32_bf16 v[24:27], v[56:59], v[88:91], v[24:27]
    ds_read_b64_tr_b16 v[48:49], v9 offset:32768
    ds_read_b64_tr_b16 v[50:51], v9 offset:33792
    v_mfma_f32_16x16x32_bf16 v[28:31], v[56:59], v[92:95], v[28:31]
    ds_read_b64_tr_b16 v[52:53], v10 offset:32768
    ds_read_b64_tr_b16 v[54:55], v10 offset:33792
    v_mfma_f32_16x16x32_bf16 v[32:35], v[60:63], v[80:83], v[32:35]
    v_mfma_f32_16x16x32_bf16 v[36:39], v[60:63], v[84:87], v[36:39]
    v_mfma_f32_16x16x32_bf16 v[40:43], v[60:63], v[88:91], v[40:43]
    v_mfma_f32_16x16x32_bf16 v[44:47], v[60:63], v[92:95], v[44:47]
    s_waitcnt lgkmcnt(0)
    v_mfma_f32_16x16x32_bf16 v[16:19], v[48:51], v[64:67], v[16:19]
    ds_read_b128 v[80:83], v8 offset:32768
    ds_read_b128 v[84:87], v8 offset:34816
    s_bitcmp1_b32 s20, 7
    s_cselect_b32 s12, 0x21c000, 0
    s_sub_u32 s12, s53, s12
    s_add_u32 m0, s55, 0x1c000
    s_add_u32 s56, s12, 0x17a000
    buffer_load_dwordx4 v4, s[28:31], s56 offen lds
    v_mfma_f32_16x16x32_bf16 v[20:23], v[48:51], v[68:71], v[20:23]
    ds_read_b128 v[88:91], v8 offset:36864
    ds_read_b128 v[92:95], v8 offset:38912
    s_add_u32 m0, s55, 0x1c400
    s_add_u32 s56, s12, 0x17d600
    buffer_load_dwordx4 v4, s[28:31], s56 offen lds
    v_mfma_f32_16x16x32_bf16 v[24:27], v[48:51], v[72:75], v[24:27]
    ds_read_b64_tr_b16 v[56:57], v9 offset:36864
    ds_read_b64_tr_b16 v[58:59], v9 offset:37888
    v_mfma_f32_16x16x32_bf16 v[28:31], v[48:51], v[76:79], v[28:31]
    ds_read_b64_tr_b16 v[60:61], v10 offset:36864
    ds_read_b64_tr_b16 v[62:63], v10 offset:37888
    v_mfma_f32_16x16x32_bf16 v[32:35], v[52:55], v[64:67], v[32:35]
    v_mfma_f32_16x16x32_bf16 v[36:39], v[52:55], v[68:71], v[36:39]
    v_mfma_f32_16x16x32_bf16 v[40:43], v[52:55], v[72:75], v[40:43]
    v_mfma_f32_16x16x32_bf16 v[44:47], v[52:55], v[76:79], v[44:47]
    s_waitcnt lgkmcnt(0)
    s_waitcnt vmcnt(4)
    s_barrier
    v_mfma_f32_16x16x32_bf16 v[16:19], v[56:59], v[80:83], v[16:19]
    v_add_u32 v7, 0x10000, v7
    v_add_u32 v8, 0x10000, v8
    ds_read_b128 v[64:67], v7 offset:0
    ds_read_b128 v[68:71], v7 offset:2048
    s_bitcmp1_b32 s20, 8
    s_cselect_b32 s21, 0x500, 0
    s_sub_u32 s21, s52, s21
    s_add_u32 m0, s54, 0x0
    s_add_u32 s56, s21, 0x400
    buffer_load_dwordx4 v3, s[24:27], s56 offen lds
    v_mfma_f32_16x16x32_bf16 v[20:23], v[56:59], v[84:87], v[20:23]
    ds_read_b128 v[72:75], v7 offset:4096
    ds_read_b128 v[76:79], v7 offset:6144
    s_add_u32 m0, s54, 0x2000
    s_add_u32 s56, s21, 0x14400
    buffer_load_dwordx4 v3, s[24:27], s56 offen lds
    v_mfma_f32_16x16x32_bf16 v[24:27], v[56:59], v[88:91], v[24:27]
    v_add_u32 v9, 0x10000, v9
    v_add_u32 v10, 0x10000, v10
    ds_read_b64_tr_b16 v[48:49], v9 offset:0
    ds_read_b64_tr_b16 v[50:51], v9 offset:1024
    v_mov_b32 v133, s50
    s_waitcnt vmcnt(8)
    s_mov_b64 exec, 3
    buffer_store_dword v133, v134, s[32:35], s72 offen sc1
    s_mov_b64 exec, -1
    v_mfma_f32_16x16x32_bf16 v[28:31], v[56:59], v[92:95], v[28:31]
    ds_read_b64_tr_b16 v[52:53], v10 offset:0
    ds_read_b64_tr_b16 v[54:55], v10 offset:1024
    v_mfma_f32_16x16x32_bf16 v[32:35], v[60:63], v[80:83], v[32:35]
    v_mfma_f32_16x16x32_bf16 v[36:39], v[60:63], v[84:87], v[36:39]
    v_mfma_f32_16x16x32_bf16 v[40:43], v[60:63], v[88:91], v[40:43]
    v_mfma_f32_16x16x32_bf16 v[44:47], v[60:63], v[92:95], v[44:47]
    s_waitcnt lgkmcnt(0)
    v_mfma_f32_16x16x32_bf16 v[16:19], v[48:51], v[64:67], v[16:19]
    ds_read_b128 v[80:83], v8 offset:0
    ds_read_b128 v[84:87], v8 offset:2048
    s_bitcmp1_b32 s20, 8
    s_cselect_b32 s12, 0x21c000, 0
    s_sub_u32 s12, s53, s12
    s_add_u32 m0, s55, 0x4000
    s_add_u32 s56, s12, 0x1b0000
    buffer_load_dwordx4 v4, s[28:31], s56 offen lds
    v_mfma_f32_16x16x32_bf16 v[20:23], v[48:51], v[68:71], v[20:23]
    ds_read_b128 v[88:91], v8 offset:4096
    ds_read_b128 v[92:95], v8 offset:6144
    s_add_u32 m0, s55, 0x4400
    s_add_u32 s56, s12, 0x1b3600
    buffer_load_dwordx4 v4, s[28:31], s56 offen lds
    v_mfma_f32_16x16x32_bf16 v[24:27], v[48:51], v[72:75], v[24:27]
    ds_read_b64_tr_b16 v[56:57], v9 offset:4096
    ds_read_b64_tr_b16 v[58:59], v9 offset:5120
    v_mfma_f32_16x16x32_bf16 v[28:31], v[48:51], v[76:79], v[28:31]
    ds_read_b64_tr_b16 v[60:61], v10 offset:4096
    ds_read_b64_tr_b16 v[62:63], v10 offset:5120
    v_mfma_f32_16x16x32_bf16 v[32:35], v[52:55], v[64:67], v[32:35]
    v_mfma_f32_16x16x32_bf16 v[36:39], v[52:55], v[68:71], v[36:39]
    v_mfma_f32_16x16x32_bf16 v[40:43], v[52:55], v[72:75], v[40:43]
    v_mfma_f32_16x16x32_bf16 v[44:47], v[52:55], v[76:79], v[44:47]
    s_waitcnt lgkmcnt(0)
    s_waitcnt vmcnt(5)
    s_barrier
    v_mfma_f32_16x16x32_bf16 v[16:19], v[56:59], v[80:83], v[16:19]
    ds_read_b128 v[64:67], v7 offset:32768
    ds_read_b128 v[68:71], v7 offset:34816
    s_bitcmp1_b32 s20, 9
    s_cselect_b32 s21, 0x500, 0
    s_sub_u32 s21, s52, s21
    s_add_u32 m0, s54, 0x8000
    s_add_u32 s56, s21, 0x480
    buffer_load_dwordx4 v3, s[24:27], s56 offen lds
    v_mfma_f32_16x16x32_bf16 v[20:23], v[56:59], v[84:87], v[20:23]
    ds_read_b128 v[72:75], v7 offset:36864
    ds_read_b128 v[76:79], v7 offset:38912
    s_add_u32 m0, s54, 0xa000
    s_add_u32 s56, s21, 0x14480
    buffer_load_dwordx4 v3, s[24:27], s56 offen lds
    v_mfma_f32_16x16x32_bf16 v[24:27], v[56:59], v[88:91], v[24:27]
    ds_read_b64_tr_b16 v[48:49], v9 offset:32768
    ds_read_b64_tr_b16 v[50:51], v9 offset:33792
    v_mfma_f32_16x16x32_bf16 v[28:31], v[56:59], v[92:95], v[28:31]
    ds_read_b64_tr_b16 v[52:53], v10 offset:32768
    ds_read_b64_tr_b16 v[54:55], v10 offset:33792
    v_mfma_f32_16x16x32_bf16 v[32:35], v[60:63], v[80:83], v[32:35]
    v_mfma_f32_16x16x32_bf16 v[36:39], v[60:63], v[84:87], v[36:39]
    v_mfma_f32_16x16x32_bf16 v[40:43], v[60:63], v[88:91], v[40:43]
    v_mfma_f32_16x16x32_bf16 v[44:47], v[60:63], v[92:95], v[44:47]
    s_waitcnt lgkmcnt(0)
    v_mfma_f32_16x16x32_bf16 v[16:19], v[48:51], v[64:67], v[16:19]
    ds_read_b128 v[80:83], v8 offset:32768
    ds_read_b128 v[84:87], v8 offset:34816
    s_bitcmp1_b32 s20, 9
    s_cselect_b32 s12, 0x21c000, 0
    s_sub_u32 s12, s53, s12
    s_add_u32 m0, s55, 0xc000
    s_add_u32 s56, s12, 0x1e6000
    buffer_load_dwordx4 v4, s[28:31], s56 offen lds
    v_mfma_f32_16x16x32_bf16 v[20:23], v[48:51], v[68:71], v[20:23]
    ds_read_b128 v[88:91], v8 offset:36864
    ds_read_b128 v[92:95], v8 offset:38912
    s_add_u32 m0, s55, 0xc400
    s_add_u32 s56, s12, 0x1e9600
    buffer_load_dwordx4 v4, s[28:31], s56 offen lds
    v_mfma_f32_16x16x32_bf16 v[24:27], v[48:51], v[72:75], v[24:27]
    ds_read_b64_tr_b16 v[56:57], v9 offset:36864
    ds_read_b64_tr_b16 v[58:59], v9 offset:37888
    v_mfma_f32_16x16x32_bf16 v[28:31], v[48:51], v[76:79], v[28:31]
    ds_read_b64_tr_b16 v[60:61], v10 offset:36864
    ds_read_b64_tr_b16 v[62:63], v10 offset:37888
    v_mfma_f32_16x16x32_bf16 v[32:35], v[52:55], v[64:67], v[32:35]
    v_mfma_f32_16x16x32_bf16 v[36:39], v[52:55], v[68:71], v[36:39]
    v_mfma_f32_16x16x32_bf16 v[40:43], v[52:55], v[72:75], v[40:43]
    v_mfma_f32_16x16x32_bf16 v[44:47], v[52:55], v[76:79], v[44:47]
    s_waitcnt lgkmcnt(0)
    s_waitcnt vmcnt(4)
    s_barrier
    v_mfma_f32_16x16x32_bf16 v[16:19], v[56:59], v[80:83], v[16:19]
    v_add_u32 v7, 0xffff0000, v7
    v_add_u32 v8, 0xffff0000, v8
    ds_read_b128 v[64:67], v7 offset:0
    ds_read_b128 v[68:71], v7 offset:2048
    s_lshr_b32 s82, s45, 1
    s_lshl1_add_u32 s82, s46, s82
    s_lshl3_add_u32 s82, s82, s47
    s_and_b32 s83, s45, 1
    s_lshl1_add_u32 s82, s82, s83
    s_mul_i32 s83, s82, 5120
    s_lshl_b32 s82, s82, 4
    s_add_u32 s82, s82, 0xd24000
    v_mfma_f32_16x16x32_bf16 v[20:23], v[56:59], v[84:87], v[20:23]
    ds_read_b128 v[72:75], v7 offset:4096
    ds_read_b128 v[76:79], v7 offset:6144
    s_mov_b32 s40, s18
    s_and_b32 s41, s19, 0xffff
    s_mov_b32 s42, 0x500
    s_mov_b32 s43, 0x20000
    v_mfma_f32_16x16x32_bf16 v[24:27], v[56:59], v[88:91], v[24:27]
    v_add_u32 v9, 0xffff0000, v9
    v_add_u32 v10, 0xffff0000, v10
    ds_read_b64_tr_b16 v[48:49], v9 offset:0
    ds_read_b64_tr_b16 v[50:51], v9 offset:1024
    v_mfma_f32_16x16x32_bf16 v[28:31], v[56:59], v[92:95], v[28:31]
    ds_read_b64_tr_b16 v[52:53], v10 offset:0
    ds_read_b64_tr_b16 v[54:55], v10 offset:1024
    v_mfma_f32_16x16x32_bf16 v[32:35], v[60:63], v[80:83], v[32:35]
    v_mfma_f32_16x16x32_bf16 v[36:39], v[60:63], v[84:87], v[36:39]
    v_mfma_f32_16x16x32_bf16 v[40:43], v[60:63], v[88:91], v[40:43]
    v_mfma_f32_16x16x32_bf16 v[44:47], v[60:63], v[92:95], v[44:47]
    s_waitcnt lgkmcnt(0)
    v_mfma_f32_16x16x32_bf16 v[16:19], v[48:51], v[64:67], v[16:19]
    ds_read_b128 v[80:83], v8 offset:0
    ds_read_b128 v[84:87], v8 offset:2048
    s_lshr_b32 s56, s45, 1
    s_lshl_b32 s57, s46, 1
    s_add_u32 s56, s56, s57
    s_lshl_b32 s69, s56, 9
    s_mul_i32 s56, s56, 74
    s_mul_i32 s57, s47, 2
    s_add_u32 s56, s56, s57
    s_add_u32 s56, s56, 16
    s_lshl_b32 s68, s56, 12
    s_and_b32 s56, s45, 1
    s_lshl_b32 s57, s56, 11
    s_add_u32 s68, s68, s57
    s_mul_i32 s57, s47, 2
    s_add_u32 s56, s56, s57
    s_lshl_b32 s56, s56, 2
    s_add_u32 s69, s69, s56
    s_add_u32 s69, s69, 0xd29040
    v_mfma_f32_16x16x32_bf16 v[20:23], v[48:51], v[68:71], v[20:23]
    ds_read_b128 v[88:91], v8 offset:4096
    ds_read_b128 v[92:95], v8 offset:6144
    v_mfma_f32_16x16x32_bf16 v[24:27], v[48:51], v[72:75], v[24:27]
    ds_read_b64_tr_b16 v[56:57], v9 offset:4096
    ds_read_b64_tr_b16 v[58:59], v9 offset:5120
    v_mfma_f32_16x16x32_bf16 v[28:31], v[48:51], v[76:79], v[28:31]
    ds_read_b64_tr_b16 v[60:61], v10 offset:4096
    ds_read_b64_tr_b16 v[62:63], v10 offset:5120
    v_mfma_f32_16x16x32_bf16 v[32:35], v[52:55], v[64:67], v[32:35]
    v_mfma_f32_16x16x32_bf16 v[36:39], v[52:55], v[68:71], v[36:39]
    v_mfma_f32_16x16x32_bf16 v[40:43], v[52:55], v[72:75], v[40:43]
    v_mfma_f32_16x16x32_bf16 v[44:47], v[52:55], v[76:79], v[44:47]
    s_waitcnt lgkmcnt(0)
    s_waitcnt vmcnt(0)
    s_barrier
    v_mfma_f32_16x16x32_bf16 v[16:19], v[56:59], v[80:83], v[16:19]
    ds_read_b128 v[64:67], v7 offset:32768
    ds_read_b128 v[68:71], v7 offset:34816
    s_load_dwordx2 s[20:21], s[0:1], 64
    v_mfma_f32_16x16x32_bf16 v[20:23], v[56:59], v[84:87], v[20:23]
    ds_read_b128 v[72:75], v7 offset:36864
    ds_read_b128 v[76:79], v7 offset:38912
    v_mfma_f32_16x16x32_bf16 v[24:27], v[56:59], v[88:91], v[24:27]
    ds_read_b64_tr_b16 v[48:49], v9 offset:32768
    ds_read_b64_tr_b16 v[50:51], v9 offset:33792
    v_mfma_f32_16x16x32_bf16 v[28:31], v[56:59], v[92:95], v[28:31]
    ds_read_b64_tr_b16 v[52:53], v10 offset:32768
    ds_read_b64_tr_b16 v[54:55], v10 offset:33792
    v_mfma_f32_16x16x32_bf16 v[32:35], v[60:63], v[80:83], v[32:35]
    v_mfma_f32_16x16x32_bf16 v[36:39], v[60:63], v[84:87], v[36:39]
    v_mfma_f32_16x16x32_bf16 v[40:43], v[60:63], v[88:91], v[40:43]
    v_mfma_f32_16x16x32_bf16 v[44:47], v[60:63], v[92:95], v[44:47]
    s_waitcnt lgkmcnt(0)
    v_mfma_f32_16x16x32_bf16 v[16:19], v[48:51], v[64:67], v[16:19]
    ds_read_b128 v[80:83], v8 offset:32768
    ds_read_b128 v[84:87], v8 offset:34816
    buffer_load_dwordx4 v[176:179], v175, s[32:35], s77 offen offset:0 sc1
    v_mfma_f32_16x16x32_bf16 v[20:23], v[48:51], v[68:71], v[20:23]
    ds_read_b128 v[88:91], v8 offset:36864
    ds_read_b128 v[92:95], v8 offset:38912
    v_mfma_f32_16x16x32_bf16 v[24:27], v[48:51], v[72:75], v[24:27]
    ds_read_b64_tr_b16 v[56:57], v9 offset:36864
    ds_read_b64_tr_b16 v[58:59], v9 offset:37888
    v_mfma_f32_16x16x32_bf16 v[28:31], v[48:51], v[76:79], v[28:31]
    ds_read_b64_tr_b16 v[60:61], v10 offset:36864
    ds_read_b64_tr_b16 v[62:63], v10 offset:37888
    v_mfma_f32_16x16x32_bf16 v[32:35], v[52:55], v[64:67], v[32:35]
    v_mfma_f32_16x16x32_bf16 v[36:39], v[52:55], v[68:71], v[36:39]
    v_mfma_f32_16x16x32_bf16 v[40:43], v[52:55], v[72:75], v[40:43]
    v_mfma_f32_16x16x32_bf16 v[44:47], v[52:55], v[76:79], v[44:47]
    s_waitcnt lgkmcnt(0)
    s_barrier
    v_mfma_f32_16x16x32_bf16 v[16:19], v[56:59], v[80:83], v[16:19]
    v_mfma_f32_16x16x32_bf16 v[20:23], v[56:59], v[84:87], v[20:23]
    v_mfma_f32_16x16x32_bf16 v[24:27], v[56:59], v[88:91], v[24:27]
    v_mfma_f32_16x16x32_bf16 v[28:31], v[56:59], v[92:95], v[28:31]
    v_mfma_f32_16x16x32_bf16 v[32:35], v[60:63], v[80:83], v[32:35]
    v_mfma_f32_16x16x32_bf16 v[36:39], v[60:63], v[84:87], v[36:39]
    v_mfma_f32_16x16x32_bf16 v[40:43], v[60:63], v[88:91], v[40:43]
    v_mfma_f32_16x16x32_bf16 v[44:47], v[60:63], v[92:95], v[44:47]
    s_setprio 3
    v_mov_b32 v80, 1.0
    s_waitcnt vmcnt(0)
    v_cmp_eq_u32 s[58:59], s50, v176
    v_cmp_eq_u32 vcc, s50, v177
    s_nop 1
    s_and_b64 s[58:59], s[58:59], vcc
    v_cmp_eq_u32 vcc, s50, v178
    s_nop 1
    s_and_b64 s[58:59], s[58:59], vcc
    v_cmp_eq_u32 vcc, s50, v179
    s_nop 1
    s_and_b64 s[58:59], s[58:59], vcc
    s_orn2_b32 s58, s58, 0x7ffff
    s_orn2_b32 s59, s59, 0x7ffff
    s_and_b32 s58, s58, s59
    s_cmp_eq_u32 s58, -1
    s_cselect_b32 s80, 1, 0
    s_cselect_b32 s81, s76, 0x7ff00000
    v_pk_mul_f32 v[64:65], v[16:17], s[62:63] op_sel:[0,1] op_sel_hi:[1,1]
    v_pk_mul_f32 v[66:67], v[18:19], s[62:63] op_sel:[0,1] op_sel_hi:[1,1]
    v_pk_mul_f32 v[68:69], v[32:33], s[62:63] op_sel:[0,1] op_sel_hi:[1,1]
    v_pk_mul_f32 v[70:71], v[34:35], s[62:63] op_sel:[0,1] op_sel_hi:[1,1]
    v_exp_f32 v64, v64
    v_exp_f32 v65, v65
    v_exp_f32 v66, v66
    v_exp_f32 v67, v67
    v_exp_f32 v68, v68
    v_exp_f32 v69, v69
    v_exp_f32 v70, v70
    v_exp_f32 v71, v71
    v_pk_add_f32 v[64:65], v[64:65], v[80:81] op_sel_hi:[1,0]
    v_pk_add_f32 v[66:67], v[66:67], v[80:81] op_sel_hi:[1,0]
    v_pk_add_f32 v[68:69], v[68:69], v[80:81] op_sel_hi:[1,0]
    v_pk_add_f32 v[70:71], v[70:71], v[80:81] op_sel_hi:[1,0]
    v_rcp_f32 v64, v64
    v_rcp_f32 v65, v65
    v_rcp_f32 v66, v66
    v_rcp_f32 v67, v67
    v_rcp_f32 v68, v68
    v_rcp_f32 v69, v69
    v_rcp_f32 v70, v70
    v_rcp_f32 v71, v71
    v_pk_mul_f32 v[64:65], v[64:65], v[16:17]
    v_pk_mul_f32 v[66:67], v[66:67], v[18:19]
    v_pk_mul_f32 v[68:69], v[68:69], v[32:33]
    v_pk_mul_f32 v[70:71], v[70:71], v[34:35]
    v_cvt_pk_bf16_f32 v48, v64, v65
    v_cvt_pk_bf16_f32 v49, v66, v67
    v_cvt_pk_bf16_f32 v50, v68, v69
    v_cvt_pk_bf16_f32 v51, v70, v71
    buffer_store_dwordx4 v[48:51], v2, s[32:35], s64 offen offset:0 sc1
    v_pk_mul_f32 v[72:73], v[20:21], s[62:63] op_sel:[0,1] op_sel_hi:[1,1]
    s_add_u32 s61, s79, 0
    s_and_b32 s61, s61, 3
    s_mul_i32 s61, s61, 20480
    s_add_u32 s61, s61, s81
    buffer_load_dwordx4 v[176:179], v2, s[32:35], s61 offen offset:0
    v_pk_mul_f32 v[74:75], v[22:23], s[62:63] op_sel:[0,1] op_sel_hi:[1,1]
    v_pk_mul_f32 v[76:77], v[36:37], s[62:63] op_sel:[0,1] op_sel_hi:[1,1]
    v_pk_mul_f32 v[78:79], v[38:39], s[62:63] op_sel:[0,1] op_sel_hi:[1,1]
    v_exp_f32 v72, v72
    v_exp_f32 v73, v73
    v_exp_f32 v74, v74
    v_exp_f32 v75, v75
    v_exp_f32 v76, v76
    v_exp_f32 v77, v77
    v_exp_f32 v78, v78
    v_exp_f32 v79, v79
    v_pk_add_f32 v[72:73], v[72:73], v[80:81] op_sel_hi:[1,0]
    v_pk_add_f32 v[74:75], v[74:75], v[80:81] op_sel_hi:[1,0]
    v_pk_add_f32 v[76:77], v[76:77], v[80:81] op_sel_hi:[1,0]
    buffer_load_dwordx4 v[180:183], v2, s[32:35], s61 offen offset:1024
    v_pk_add_f32 v[78:79], v[78:79], v[80:81] op_sel_hi:[1,0]
    v_rcp_f32 v72, v72
    v_rcp_f32 v73, v73
    v_rcp_f32 v74, v74
    v_rcp_f32 v75, v75
    v_rcp_f32 v76, v76
    v_rcp_f32 v77, v77
    v_rcp_f32 v78, v78
    v_rcp_f32 v79, v79
    v_pk_mul_f32 v[72:73], v[72:73], v[20:21]
    v_pk_mul_f32 v[74:75], v[74:75], v[22:23]
    v_pk_mul_f32 v[76:77], v[76:77], v[36:37]
    v_pk_mul_f32 v[78:79], v[78:79], v[38:39]
    v_cvt_pk_bf16_f32 v52, v72, v73
    buffer_load_dwordx4 v[184:187], v2, s[32:35], s61 offen offset:2048
    v_cvt_pk_bf16_f32 v53, v74, v75
    v_cvt_pk_bf16_f32 v54, v76, v77
    v_cvt_pk_bf16_f32 v55, v78, v79
    buffer_store_dwordx4 v[52:55], v2, s[32:35], s64 offen offset:1024 sc1
    v_pk_mul_f32 v[64:65], v[24:25], s[62:63] op_sel:[0,1] op_sel_hi:[1,1]
    v_pk_mul_f32 v[66:67], v[26:27], s[62:63] op_sel:[0,1] op_sel_hi:[1,1]
    v_pk_mul_f32 v[68:69], v[40:41], s[62:63] op_sel:[0,1] op_sel_hi:[1,1]
    v_pk_mul_f32 v[70:71], v[42:43], s[62:63] op_sel:[0,1] op_sel_hi:[1,1]
    v_exp_f32 v64, v64
    v_exp_f32 v65, v65
    v_exp_f32 v66, v66
    v_exp_f32 v67, v67
    v_exp_f32 v68, v68
    v_exp_f32 v69, v69
    v_exp_f32 v70, v70
    buffer_load_dwordx4 v[188:191], v2, s[32:35], s61 offen offset:3072
    v_exp_f32 v71, v71
    v_pk_add_f32 v[64:65], v[64:65], v[80:81] op_sel_hi:[1,0]
    v_pk_add_f32 v[66:67], v[66:67], v[80:81] op_sel_hi:[1,0]
    v_pk_add_f32 v[68:69], v[68:69], v[80:81] op_sel_hi:[1,0]
    v_pk_add_f32 v[70:71], v[70:71], v[80:81] op_sel_hi:[1,0]
    v_rcp_f32 v64, v64
    v_rcp_f32 v65, v65
    v_rcp_f32 v66, v66
    v_rcp_f32 v67, v67
    v_rcp_f32 v68, v68
    v_rcp_f32 v69, v69
    v_rcp_f32 v70, v70
    v_rcp_f32 v71, v71
    v_pk_mul_f32 v[64:65], v[64:65], v[24:25]
    s_add_u32 s61, s61, 4096
    buffer_load_dwordx4 v[192:195], v2, s[32:35], s61 offen offset:0
    v_pk_mul_f32 v[66:67], v[66:67], v[26:27]
    v_pk_mul_f32 v[68:69], v[68:69], v[40:41]
    v_pk_mul_f32 v[70:71], v[70:71], v[42:43]
    v_cvt_pk_bf16_f32 v56, v64, v65
    v_cvt_pk_bf16_f32 v57, v66, v67
    v_cvt_pk_bf16_f32 v58, v68, v69
    v_cvt_pk_bf16_f32 v59, v70, v71
    buffer_store_dwordx4 v[56:59], v2, s[32:35], s64 offen offset:2048 sc1
    v_pk_mul_f32 v[72:73], v[28:29], s[62:63] op_sel:[0,1] op_sel_hi:[1,1]
    v_pk_mul_f32 v[74:75], v[30:31], s[62:63] op_sel:[0,1] op_sel_hi:[1,1]
    v_pk_mul_f32 v[76:77], v[44:45], s[62:63] op_sel:[0,1] op_sel_hi:[1,1]
    v_pk_mul_f32 v[78:79], v[46:47], s[62:63] op_sel:[0,1] op_sel_hi:[1,1]
    v_exp_f32 v72, v72
    v_exp_f32 v73, v73
    v_exp_f32 v74, v74
    s_add_u32 s61, s79, 1
    s_and_b32 s61, s61, 3
    s_mul_i32 s61, s61, 20480
    s_add_u32 s61, s61, s81
    buffer_load_dwordx4 v[196:199], v2, s[32:35], s61 offen offset:0
    v_exp_f32 v75, v75
    v_exp_f32 v76, v76
    v_exp_f32 v77, v77
    v_exp_f32 v78, v78
    v_exp_f32 v79, v79
    v_pk_add_f32 v[72:73], v[72:73], v[80:81] op_sel_hi:[1,0]
    v_pk_add_f32 v[74:75], v[74:75], v[80:81] op_sel_hi:[1,0]
    v_pk_add_f32 v[76:77], v[76:77], v[80:81] op_sel_hi:[1,0]
    v_pk_add_f32 v[78:79], v[78:79], v[80:81] op_sel_hi:[1,0]
    v_rcp_f32 v72, v72
    v_rcp_f32 v73, v73
    v_rcp_f32 v74, v74
    v_rcp_f32 v75, v75
    v_rcp_f32 v76, v76
    buffer_load_dwordx4 v[200:203], v2, s[32:35], s61 offen offset:1024
    v_rcp_f32 v77, v77
    v_rcp_f32 v78, v78
    v_rcp_f32 v79, v79
    v_pk_mul_f32 v[72:73], v[72:73], v[28:29]
    v_pk_mul_f32 v[74:75], v[74:75], v[30:31]
    v_pk_mul_f32 v[76:77], v[76:77], v[44:45]
    v_pk_mul_f32 v[78:79], v[78:79], v[46:47]
    v_cvt_pk_bf16_f32 v60, v72, v73
    v_cvt_pk_bf16_f32 v61, v74, v75
    v_cvt_pk_bf16_f32 v62, v76, v77
    v_cvt_pk_bf16_f32 v63, v78, v79
    buffer_store_dwordx4 v[60:63], v2, s[32:35], s64 offen offset:3072 sc1
    s_add_u32 s56, s45, 0
    s_and_b32 s56, s56, 3
    s_lshl_b32 s56, s56, 10
    v_add_u32 v16, s56, v2
    s_add_u32 s56, s45, 1
    s_and_b32 s56, s56, 3
    s_lshl_b32 s56, s56, 10
    v_add_u32 v17, s56, v2
    s_add_u32 s56, s45, 2
    s_and_b32 s56, s56, 3
    s_lshl_b32 s56, s56, 10
    v_add_u32 v18, s56, v2
    s_add_u32 s56, s45, 3
    s_and_b32 s56, s56, 3
    s_lshl_b32 s56, s56, 10
    v_add_u32 v19, s56, v2
    v_mov_b32 v20, 0x26000
    v_and_b32 v26, 15, v1
    v_lshlrev_b32 v27, 2, v26
    s_lshl_b32 s66, s48, 8
    s_add_u32 s66, s66, 0xd26000
    v_lshrrev_b32 v8, 10, v16
    v_lshl_add_u32 v12, v8, 6, v27
    v_lshrrev_b32 v4, 1, v16
    v_lshrrev_b32 v8, 10, v17
    v_lshl_add_u32 v13, v8, 6, v27
    v_lshrrev_b32 v5, 1, v17
    v_lshrrev_b32 v8, 10, v18
    v_lshl_add_u32 v14, v8, 6, v27
    v_lshrrev_b32 v6, 1, v18
    v_lshrrev_b32 v8, 10, v19
    v_lshl_add_u32 v15, v8, 6, v27
    v_lshrrev_b32 v7, 1, v19
    v_add_u32 v8, s78, v2
    v_add_u32 v0, 0x10000, v8
    v_add_u32 v3, 0x20000, v8
    s_sub_u32 s56, s45, 1
    s_and_b32 s56, s56, 3
    s_mul_i32 s56, s56, 5120
    s_add_u32 s56, s56, 0x10000
    v_add_u32 v9, s56, v2
    s_sub_u32 s56, s45, 2
    s_and_b32 s56, s56, 3
    s_mul_i32 s56, s56, 5120
    s_add_u32 s56, s56, 0x15000
    v_add_u32 v10, s56, v2
    s_sub_u32 s56, s45, 3
    s_and_b32 s56, s56, 3
    s_mul_i32 s56, s56, 5120
    s_add_u32 s56, s56, 0x1a000
    v_add_u32 v11, s56, v2
    s_mov_b32 s28, s20
    s_and_b32 s29, s21, 0xffff
    s_mov_b32 s30, 0x280000
    s_mov_b32 s31, 0x20000
    v_mul_u32_u24 v22, 1280, v26
    v_lshrrev_b32 v25, 4, v1
    v_lshl_add_u32 v22, v25, 3, v22
    s_lshl_b32 s67, s48, 2
    s_add_u32 s67, s67, s45
    s_mul_i32 s67, s67, 20480
    s_mul_i32 s57, s49, 160
    s_add_u32 s67, s67, s57
    s_mov_b32 s60, 160000
LW_22:
    ds_read_b32 v25, v20 offset:56
    s_waitcnt lgkmcnt(0)
    v_readfirstlane_b32 s58, v25
    s_nop 1
    s_cmp_ge_u32 s58, 4
    s_nop 0
    s_cbranch_scc1 LW_22_OK
    s_sub_u32 s60, s60, 1
    s_cmp_lg_u32 s60, 0
    s_cbranch_scc1 LW_22
LW_22_OK:
    ds_read_b128 v[84:87], v8 offset:43008
    ds_read_b128 v[88:91], v8 offset:44032
    ds_read_b128 v[92:95], v8 offset:45056
    ds_read_b128 v[96:99], v8 offset:46080
    s_add_u32 s70, s68, 4096
    s_waitcnt lgkmcnt(3)
    v_lshlrev_b32 v100, 16, v84
    v_and_b32 v101, 0xffff0000, v84
    v_lshlrev_b32 v102, 16, v85
    buffer_load_dwordx4 v[204:207], v2, s[32:35], s61 offen offset:2048
    v_and_b32 v103, 0xffff0000, v85
    v_lshlrev_b32 v104, 16, v86
    v_and_b32 v105, 0xffff0000, v86
    v_lshlrev_b32 v106, 16, v87
    v_and_b32 v107, 0xffff0000, v87
    v_mul_f32 v64, s63, v100
    v_mul_f32 v65, s63, v101
    v_mul_f32 v66, s63, v102
    v_mul_f32 v67, s63, v103
    v_mul_f32 v68, s63, v104
    v_mul_f32 v69, s63, v105
    v_mul_f32 v70, s63, v106
    v_mul_f32 v71, s63, v107
    v_exp_f32 v64, v64
    buffer_load_dwordx4 v[208:211], v2, s[32:35], s61 offen offset:3072
    v_exp_f32 v65, v65
    v_exp_f32 v66, v66
    v_exp_f32 v67, v67
    v_exp_f32 v68, v68
    v_exp_f32 v69, v69
    v_exp_f32 v70, v70
    v_exp_f32 v71, v71
    v_add_f32 v64, 1.0, v64
    v_add_f32 v65, 1.0, v65
    v_add_f32 v66, 1.0, v66
    v_add_f32 v67, 1.0, v67
    v_add_f32 v68, 1.0, v68
    v_add_f32 v69, 1.0, v69
    v_add_f32 v70, 1.0, v70
    s_add_u32 s61, s61, 4096
    buffer_load_dwordx4 v[212:215], v2, s[32:35], s61 offen offset:0
    v_add_f32 v71, 1.0, v71
    v_rcp_f32 v64, v64
    v_rcp_f32 v65, v65
    v_rcp_f32 v66, v66
    v_rcp_f32 v67, v67
    v_rcp_f32 v68, v68
    v_rcp_f32 v69, v69
    v_rcp_f32 v70, v70
    v_rcp_f32 v71, v71
    v_mul_f32 v64, v64, v100
    v_mul_f32 v65, v65, v101
    v_mul_f32 v66, v66, v102
    v_mul_f32 v67, v67, v103
    v_mul_f32 v68, v68, v104
    s_add_u32 s61, s79, 2
    s_and_b32 s61, s61, 3
    s_mul_i32 s61, s61, 20480
    s_add_u32 s61, s61, s81
    buffer_load_dwordx4 v[216:219], v2, s[32:35], s61 offen offset:0
    v_mul_f32 v69, v69, v105
    v_mul_f32 v70, v70, v106
    v_mul_f32 v71, v71, v107
    v_cvt_pk_bf16_f32 v84, v64, v65
    v_cvt_pk_bf16_f32 v85, v66, v67
    v_cvt_pk_bf16_f32 v86, v68, v69
    v_cvt_pk_bf16_f32 v87, v70, v71
    buffer_store_dwordx4 v[84:87], v2, s[32:35], s68 offen offset:0 sc1
    s_waitcnt lgkmcnt(2)
    v_lshlrev_b32 v100, 16, v88
    v_and_b32 v101, 0xffff0000, v88
    v_lshlrev_b32 v102, 16, v89
    v_and_b32 v103, 0xffff0000, v89
    v_lshlrev_b32 v104, 16, v90
    v_and_b32 v105, 0xffff0000, v90
    v_lshlrev_b32 v106, 16, v91
    buffer_load_dwordx4 v[220:223], v2, s[32:35], s61 offen offset:1024
    v_and_b32 v107, 0xffff0000, v91
    v_mul_f32 v72, s63, v100
    v_mul_f32 v73, s63, v101
    v_mul_f32 v74, s63, v102
    v_mul_f32 v75, s63, v103
    v_mul_f32 v76, s63, v104
    v_mul_f32 v77, s63, v105
    v_mul_f32 v78, s63, v106
    v_mul_f32 v79, s63, v107
    v_exp_f32 v72, v72
    v_exp_f32 v73, v73
    v_exp_f32 v74, v74
    v_exp_f32 v75, v75
    v_exp_f32 v76, v76
    buffer_load_dwordx4 v[224:227], v2, s[32:35], s61 offen offset:2048
    v_exp_f32 v77, v77
    v_exp_f32 v78, v78
    v_exp_f32 v79, v79
    v_add_f32 v72, 1.0, v72
    v_add_f32 v73, 1.0, v73
    v_add_f32 v74, 1.0, v74
    v_add_f32 v75, 1.0, v75
    v_add_f32 v76, 1.0, v76
    v_add_f32 v77, 1.0, v77
    v_add_f32 v78, 1.0, v78
    v_add_f32 v79, 1.0, v79
    v_rcp_f32 v72, v72
    v_rcp_f32 v73, v73
    v_rcp_f32 v74, v74
    buffer_load_dwordx4 v[228:231], v2, s[32:35], s61 offen offset:3072
    v_rcp_f32 v75, v75
    v_rcp_f32 v76, v76
    v_rcp_f32 v77, v77
    v_rcp_f32 v78, v78
    v_rcp_f32 v79, v79
    v_mul_f32 v72, v72, v100
    v_mul_f32 v73, v73, v101
    v_mul_f32 v74, v74, v102
    v_mul_f32 v75, v75, v103
    v_mul_f32 v76, v76, v104
    v_mul_f32 v77, v77, v105
    v_mul_f32 v78, v78, v106
    v_mul_f32 v79, v79, v107
    v_cvt_pk_bf16_f32 v88, v72, v73
    s_add_u32 s61, s61, 4096
    buffer_load_dwordx4 v[232:235], v2, s[32:35], s61 offen offset:0
    v_cvt_pk_bf16_f32 v89, v74, v75
    v_cvt_pk_bf16_f32 v90, v76, v77
    v_cvt_pk_bf16_f32 v91, v78, v79
    buffer_store_dwordx4 v[88:91], v2, s[32:35], s68 offen offset:1024 sc1
    v_mov_b32 v26, s50
    v_mov_b32 v27, 0
    s_waitcnt vmcnt(10)
    s_mov_b64 exec, 1
    buffer_store_dword v26, v27, s[32:35], s65 offen sc1
    s_mov_b64 exec, -1
    s_waitcnt lgkmcnt(1)
    v_lshlrev_b32 v100, 16, v92
    v_and_b32 v101, 0xffff0000, v92
    v_lshlrev_b32 v102, 16, v93
    v_and_b32 v103, 0xffff0000, v93
    v_lshlrev_b32 v104, 16, v94
    v_and_b32 v105, 0xffff0000, v94
    v_lshlrev_b32 v106, 16, v95
    v_and_b32 v107, 0xffff0000, v95
    v_mul_f32 v64, s63, v100
    v_mul_f32 v65, s63, v101
    v_mul_f32 v66, s63, v102
    s_add_u32 s61, s79, 3
    s_and_b32 s61, s61, 3
    s_mul_i32 s61, s61, 20480
    s_add_u32 s61, s61, s81
    buffer_load_dwordx4 v[236:239], v2, s[32:35], s61 offen offset:0
    v_mul_f32 v67, s63, v103
    v_mul_f32 v68, s63, v104
    v_mul_f32 v69, s63, v105
    v_mul_f32 v70, s63, v106
    v_mul_f32 v71, s63, v107
    v_exp_f32 v64, v64
    v_exp_f32 v65, v65
    v_exp_f32 v66, v66
    v_exp_f32 v67, v67
    v_exp_f32 v68, v68
    v_exp_f32 v69, v69
    v_exp_f32 v70, v70
    v_exp_f32 v71, v71
    v_add_f32 v64, 1.0, v64
    buffer_load_dwordx4 v[240:243], v2, s[32:35], s61 offen offset:1024
    v_add_f32 v65, 1.0, v65
    v_add_f32 v66, 1.0, v66
    v_add_f32 v67, 1.0, v67
    v_add_f32 v68, 1.0, v68
    v_add_f32 v69, 1.0, v69
    v_add_f32 v70, 1.0, v70
    v_add_f32 v71, 1.0, v71
    v_rcp_f32 v64, v64
    v_rcp_f32 v65, v65
    v_rcp_f32 v66, v66
    v_rcp_f32 v67, v67
    v_rcp_f32 v68, v68
    v_rcp_f32 v69, v69
    v_rcp_f32 v70, v70
    buffer_load_dwordx4 v[244:247], v2, s[32:35], s61 offen offset:2048
    v_rcp_f32 v71, v71
    v_mul_f32 v64, v64, v100
    v_mul_f32 v65, v65, v101
    v_mul_f32 v66, v66, v102
    v_mul_f32 v67, v67, v103
    v_mul_f32 v68, v68, v104
    v_mul_f32 v69, v69, v105
    v_mul_f32 v70, v70, v106
    v_mul_f32 v71, v71, v107
    v_cvt_pk_bf16_f32 v92, v64, v65
    v_cvt_pk_bf16_f32 v93, v66, v67
    v_cvt_pk_bf16_f32 v94, v68, v69
    v_cvt_pk_bf16_f32 v95, v70, v71
    buffer_store_dwordx4 v[92:95], v2, s[32:35], s70 offen offset:0 sc1
    s_waitcnt lgkmcnt(0)
    v_lshlrev_b32 v100, 16, v96
    buffer_load_dwordx4 v[248:251], v2, s[32:35], s61 offen offset:3072
    v_and_b32 v101, 0xffff0000, v96
    v_lshlrev_b32 v102, 16, v97
    v_and_b32 v103, 0xffff0000, v97
    v_lshlrev_b32 v104, 16, v98
    v_and_b32 v105, 0xffff0000, v98
    v_lshlrev_b32 v106, 16, v99
    v_and_b32 v107, 0xffff0000, v99
    v_mul_f32 v72, s63, v100
    v_mul_f32 v73, s63, v101
    v_mul_f32 v74, s63, v102
    v_mul_f32 v75, s63, v103
    v_mul_f32 v76, s63, v104
    v_mul_f32 v77, s63, v105
    v_mul_f32 v78, s63, v106
    s_add_u32 s61, s61, 4096
    buffer_load_dwordx4 v[252:255], v2, s[32:35], s61 offen offset:0
    v_mul_f32 v79, s63, v107
    v_exp_f32 v72, v72
    v_exp_f32 v73, v73
    v_exp_f32 v74, v74
    v_exp_f32 v75, v75
    v_exp_f32 v76, v76
    v_exp_f32 v77, v77
    v_exp_f32 v78, v78
    v_exp_f32 v79, v79
    v_add_f32 v72, 1.0, v72
    v_add_f32 v73, 1.0, v73
    v_add_f32 v74, 1.0, v74
    v_add_f32 v75, 1.0, v75
    v_add_f32 v76, 1.0, v76
    v_add_f32 v77, 1.0, v77
    v_add_f32 v78, 1.0, v78
    v_add_f32 v79, 1.0, v79
    v_rcp_f32 v72, v72
    v_rcp_f32 v73, v73
    v_rcp_f32 v74, v74
    v_rcp_f32 v75, v75
    v_rcp_f32 v76, v76
    v_rcp_f32 v77, v77
    v_rcp_f32 v78, v78
    v_rcp_f32 v79, v79
    v_mul_f32 v72, v72, v100
    v_mul_f32 v73, v73, v101
    v_mul_f32 v74, v74, v102
    v_mul_f32 v75, v75, v103
    v_mul_f32 v76, v76, v104
    v_mul_f32 v77, v77, v105
    v_mul_f32 v78, v78, v106
    v_mul_f32 v79, v79, v107
    v_cvt_pk_bf16_f32 v96, v72, v73
    v_cvt_pk_bf16_f32 v97, v74, v75
    v_cvt_pk_bf16_f32 v98, v76, v77
    v_cvt_pk_bf16_f32 v99, v78, v79
    buffer_store_dwordx4 v[96:99], v2, s[32:35], s70 offen offset:1024 sc1
    s_setprio 0
    s_buffer_load_dwordx16 s[4:19], s[32:35], s75 offset:0 glc
    v_and_b32 v72, 3, v1
    v_lshlrev_b32 v72, 6, v72
    v_lshrrev_b32 v73, 4, v1
    v_lshl_add_u32 v72, v73, 4, v72
    v_bfe_u32 v73, v1, 2, 2
    v_mul_u32_u24 v73, 1280, v73
    v_add_u32 v73, v73, v72
    buffer_load_dwordx4 v[52:55], v72, s[40:43], 0 offen offset:0
    buffer_load_dwordx4 v[32:35], v73, s[24:27], s83 offen offset:0
    buffer_load_dwordx4 v[56:59], v72, s[40:43], 0 offen offset:256
    buffer_load_dwordx4 v[36:39], v73, s[24:27], s83 offen offset:256
    buffer_load_dwordx4 v[60:63], v72, s[40:43], 0 offen offset:512
    buffer_load_dwordx4 v[40:43], v73, s[24:27], s83 offen offset:512
    buffer_load_dwordx4 v[64:67], v72, s[40:43], 0 offen offset:768
    buffer_load_dwordx4 v[44:47], v73, s[24:27], s83 offen offset:768
    buffer_load_dwordx4 v[68:71], v72, s[40:43], 0 offen offset:1024
    buffer_load_dwordx4 v[48:51], v73, s[24:27], s83 offen offset:1024
    v_mov_b32 v26, s50
    v_mov_b32 v27, 0
    s_waitcnt vmcnt(10)
    s_mov_b64 exec, 1
    buffer_store_dword v26, v27, s[32:35], s69 offen sc1
    s_mov_b64 exec, -1
    s_cmp_eq_u32 s80, 1
    s_cbranch_scc1 FBS_23
    s_waitcnt vmcnt(0)
    s_mul_i32 s56, s49, 5
    s_add_u32 s57, s56, 4
    s_lshr_b32 s56, s56, 3
    s_lshr_b32 s57, s57, 3
    s_lshl_b32 s56, s56, 9
    s_lshl_b32 s57, s57, 9
    v_mov_b32 v176, s56
    v_mov_b32 v177, s57
    v_cmp_gt_u32 vcc, 32, v1
    s_nop 1
    v_cndmask_b32 v176, v177, v176, vcc
    v_and_b32 v177, 31, v1
    v_lshl_add_u32 v176, v177, 4, v176
    v_mov_b32 v178, 0x7ff00000
    v_cmp_gt_u32 vcc, 19, v177
    s_nop 1
    v_cndmask_b32 v180, v178, v176, vcc
    buffer_load_dwordx4 v[176:179], v180, s[32:35], s77 offen offset:0 sc1
    s_waitcnt vmcnt(0)
    s_mov_b32 s60, 20000
POLL_24:
    v_cmp_eq_u32 s[58:59], s50, v176
    v_cmp_eq_u32 vcc, s50, v177
    s_nop 1
    s_and_b64 s[58:59], s[58:59], vcc
    v_cmp_eq_u32 vcc, s50, v178
    s_nop 1
    s_and_b64 s[58:59], s[58:59], vcc
    v_cmp_eq_u32 vcc, s50, v179
    s_nop 1
    s_and_b64 s[58:59], s[58:59], vcc
    s_orn2_b32 s58, s58, 0x7ffff
    s_orn2_b32 s59, s59, 0x7ffff
    s_and_b32 s58, s58, s59
    s_cmp_eq_u32 s58, -1
    s_cbranch_scc1 POLL_24_OK
    s_sub_u32 s60, s60, 1
    s_cmp_eq_u32 s60, 0
    s_cbranch_scc1 POLL_24_OK
    buffer_load_dwordx4 v[176:179], v180, s[32:35], s77 offen offset:0 sc1
    s_waitcnt vmcnt(0)
    s_branch POLL_24
POLL_24_OK:
    s_add_u32 s61, s79, 0
    s_and_b32 s61, s61, 3
    s_mul_i32 s61, s61, 20480
    s_add_u32 s61, s61, s76
    buffer_load_dwordx4 v[176:179], v2, s[32:35], s61 offen offset:0
    buffer_load_dwordx4 v[180:183], v2, s[32:35], s61 offen offset:1024
    buffer_load_dwordx4 v[184:187], v2, s[32:35], s61 offen offset:2048
    buffer_load_dwordx4 v[188:191], v2, s[32:35], s61 offen offset:3072
    s_add_u32 s61, s61, 4096
    buffer_load_dwordx4 v[192:195], v2, s[32:35], s61 offen offset:0
    s_add_u32 s61, s79, 1
    s_and_b32 s61, s61, 3
    s_mul_i32 s61, s61, 20480
    s_add_u32 s61, s61, s76
    buffer_load_dwordx4 v[196:199], v2, s[32:35], s61 offen offset:0
    buffer_load_dwordx4 v[200:203], v2, s[32:35], s61 offen offset:1024
    buffer_load_dwordx4 v[204:207], v2, s[32:35], s61 offen offset:2048
    buffer_load_dwordx4 v[208:211], v2, s[32:35], s61 offen offset:3072
    s_add_u32 s61, s61, 4096
    buffer_load_dwordx4 v[212:215], v2, s[32:35], s61 offen offset:0
    s_add_u32 s61, s79, 2
    s_and_b32 s61, s61, 3
    s_mul_i32 s61, s61, 20480
    s_add_u32 s61, s61, s76
    buffer_load_dwordx4 v[216:219], v2, s[32:35], s61 offen offset:0
    buffer_load_dwordx4 v[220:223], v2, s[32:35], s61 offen offset:1024
    buffer_load_dwordx4 v[224:227], v2, s[32:35], s61 offen offset:2048
    buffer_load_dwordx4 v[228:231], v2, s[32:35], s61 offen offset:3072
    s_add_u32 s61, s61, 4096
    buffer_load_dwordx4 v[232:235], v2, s[32:35], s61 offen offset:0
    s_add_u32 s61, s79, 3
    s_and_b32 s61, s61, 3
    s_mul_i32 s61, s61, 20480
    s_add_u32 s61, s61, s76
    buffer_load_dwordx4 v[236:239], v2, s[32:35], s61 offen offset:0
    buffer_load_dwordx4 v[240:243], v2, s[32:35], s61 offen offset:1024
    buffer_load_dwordx4 v[244:247], v2, s[32:35], s61 offen offset:2048
    buffer_load_dwordx4 v[248:251], v2, s[32:35], s61 offen offset:3072
    s_add_u32 s61, s61, 4096
    buffer_load_dwordx4 v[252:255], v2, s[32:35], s61 offen offset:0
    s_waitcnt vmcnt(0)
FBS_23:
    v_mov_b32 v80, 0x3f803f80
    v_mov_b32 v81, 0x3f803f80
    v_mov_b32 v82, 0x3f803f80
    v_mov_b32 v83, 0x3f803f80
    s_waitcnt vmcnt(9)
    s_add_u32 m0, s78, 0x20000
    s_add_u32 s61, s79, 0
    s_and_b32 s61, s61, 3
    s_mul_i32 s61, s61, 20480
    s_add_u32 s61, s61, s76
    s_add_u32 s61, s61, 0x14000
    buffer_load_dwordx4 v2, s[32:35], s61 offen lds
    v_lshlrev_b32 v72, 16, v32
    v_and_b32 v73, 0xffff0000, v32
    v_lshlrev_b32 v74, 16, v52
    v_and_b32 v75, 0xffff0000, v52
    v_mul_f32 v72, v72, v74
    s_add_u32 m0, s78, 0x20400
    s_add_u32 s61, s61, 1024
    buffer_load_dwordx4 v2, s[32:35], s61 offen lds
    v_mul_f32 v73, v73, v75
    v_cvt_pk_bf16_f32 v32, v72, v73
    v_lshlrev_b32 v76, 16, v33
    v_and_b32 v77, 0xffff0000, v33
    v_lshlrev_b32 v78, 16, v53
    s_add_u32 m0, s78, 0x20800
    s_add_u32 s61, s61, 1024
    buffer_load_dwordx4 v2, s[32:35], s61 offen lds
    v_and_b32 v79, 0xffff0000, v53
    v_mul_f32 v76, v76, v78
    v_mul_f32 v77, v77, v79
    v_cvt_pk_bf16_f32 v33, v76, v77
    v_lshlrev_b32 v72, 16, v34
    s_add_u32 m0, s78, 0x20c00
    s_add_u32 s61, s61, 1024
    buffer_load_dwordx4 v2, s[32:35], s61 offen lds
    v_and_b32 v73, 0xffff0000, v34
    v_lshlrev_b32 v74, 16, v54
    v_and_b32 v75, 0xffff0000, v54
    v_mul_f32 v72, v72, v74
    v_mul_f32 v73, v73, v75
    s_add_u32 m0, s78, 0x21000
    s_add_u32 s61, s61, 1024
    buffer_load_dwordx4 v2, s[32:35], s61 offen lds
    v_cvt_pk_bf16_f32 v34, v72, v73
    v_lshlrev_b32 v76, 16, v35
    v_and_b32 v77, 0xffff0000, v35
    v_lshlrev_b32 v78, 16, v55
    v_and_b32 v79, 0xffff0000, v55
    s_mov_b32 s60, 20000
SP_25:
    s_waitcnt lgkmcnt(0)
    s_xor_b64 s[4:5], s[4:5], s[50:51]
    s_xor_b64 s[6:7], s[6:7], s[50:51]
    s_xor_b64 s[8:9], s[8:9], s[50:51]
    s_xor_b64 s[10:11], s[10:11], s[50:51]
    s_xor_b64 s[12:13], s[12:13], s[50:51]
    s_xor_b64 s[14:15], s[14:15], s[50:51]
    s_xor_b64 s[16:17], s[16:17], s[50:51]
    s_xor_b64 s[18:19], s[18:19], s[50:51]
    s_or_b64 s[4:5], s[4:5], s[6:7]
    s_or_b64 s[4:5], s[4:5], s[8:9]
    s_or_b64 s[4:5], s[4:5], s[10:11]
    s_or_b64 s[4:5], s[4:5], s[12:13]
    s_or_b64 s[4:5], s[4:5], s[14:15]
    s_or_b64 s[4:5], s[4:5], s[16:17]
    s_or_b64 s[4:5], s[4:5], s[18:19]
    s_cbranch_scc0 SP_25_OK
    s_sub_u32 s60, s60, 1
    s_cbranch_scc1 SP_25_OK
    s_buffer_load_dwordx16 s[4:19], s[32:35], s75 offset:0 glc
    s_branch SP_25
SP_25_OK:
    v_mul_f32 v76, v76, v78
    v_mul_f32 v77, v77, v79
    v_cvt_pk_bf16_f32 v35, v76, v77
    s_waitcnt vmcnt(12)
    v_lshlrev_b32 v72, 16, v36
    s_add_u32 s57, s79, 0
    s_and_b32 s57, s57, 3
    s_mul_i32 s57, s57, 16384
    s_add_u32 s57, s57, s74
    buffer_load_dwordx4 v[112:115], v16, s[32:35], s57 offen
    v_and_b32 v73, 0xffff0000, v36
    v_lshlrev_b32 v74, 16, v56
    v_and_b32 v75, 0xffff0000, v56
    v_mul_f32 v72, v72, v74
    v_mul_f32 v73, v73, v75
    buffer_load_dwordx4 v[116:119], v17, s[32:35], s57 offen
    v_cvt_pk_bf16_f32 v36, v72, v73
    v_lshlrev_b32 v76, 16, v37
    v_and_b32 v77, 0xffff0000, v37
    v_lshlrev_b32 v78, 16, v57
    v_and_b32 v79, 0xffff0000, v57
    buffer_load_dwordx4 v[120:123], v18, s[32:35], s57 offen
    v_mul_f32 v76, v76, v78
    v_mul_f32 v77, v77, v79
    v_cvt_pk_bf16_f32 v37, v76, v77
    v_mfma_f32_16x16x32_bf16 v[84:87], v[32:35], v[80:83], 0
    v_lshlrev_b32 v72, 16, v38
    buffer_load_dwordx4 v[124:127], v19, s[32:35], s57 offen
    v_and_b32 v73, 0xffff0000, v38
    v_lshlrev_b32 v74, 16, v58
    v_and_b32 v75, 0xffff0000, v58
    v_mul_f32 v72, v72, v74
    v_mul_f32 v73, v73, v75
    s_add_u32 s57, s79, 1
    s_and_b32 s57, s57, 3
    s_mul_i32 s57, s57, 16384
    s_add_u32 s57, s57, s74
    buffer_load_dwordx4 v[128:131], v16, s[32:35], s57 offen
    v_cvt_pk_bf16_f32 v38, v72, v73
    v_lshlrev_b32 v76, 16, v39
    v_and_b32 v77, 0xffff0000, v39
    v_lshlrev_b32 v78, 16, v59
    v_and_b32 v79, 0xffff0000, v59
    buffer_load_dwordx4 v[132:135], v17, s[32:35], s57 offen
    v_mul_f32 v76, v76, v78
    v_mul_f32 v77, v77, v79
    v_cvt_pk_bf16_f32 v39, v76, v77
    s_waitcnt vmcnt(16)
    v_lshlrev_b32 v72, 16, v40
    buffer_load_dwordx4 v[136:139], v18, s[32:35], s57 offen
    v_and_b32 v73, 0xffff0000, v40
    v_lshlrev_b32 v74, 16, v60
    v_and_b32 v75, 0xffff0000, v60
    v_mul_f32 v72, v72, v74
    v_mul_f32 v73, v73, v75
    buffer_load_dwordx4 v[140:143], v19, s[32:35], s57 offen
    v_cvt_pk_bf16_f32 v40, v72, v73
    v_lshlrev_b32 v76, 16, v41
    v_and_b32 v77, 0xffff0000, v41
    v_lshlrev_b32 v78, 16, v61
    v_and_b32 v79, 0xffff0000, v61
    s_add_u32 s57, s79, 2
    s_and_b32 s57, s57, 3
    s_mul_i32 s57, s57, 16384
    s_add_u32 s57, s57, s74
    buffer_load_dwordx4 v[144:147], v16, s[32:35], s57 offen
    v_mul_f32 v76, v76, v78
    v_mul_f32 v77, v77, v79
    v_cvt_pk_bf16_f32 v41, v76, v77
    v_mfma_f32_16x16x32_bf16 v[84:87], v[36:39], v[80:83], v[84:87]
    v_lshlrev_b32 v72, 16, v42
    buffer_load_dwordx4 v[148:151], v17, s[32:35], s57 offen
    v_and_b32 v73, 0xffff0000, v42
    v_lshlrev_b32 v74, 16, v62
    v_and_b32 v75, 0xffff0000, v62
    v_mul_f32 v72, v72, v74
    v_mul_f32 v73, v73, v75
    buffer_load_dwordx4 v[152:155], v18, s[32:35], s57 offen
    v_cvt_pk_bf16_f32 v42, v72, v73
    v_lshlrev_b32 v76, 16, v43
    v_and_b32 v77, 0xffff0000, v43
    v_lshlrev_b32 v78, 16, v63
    v_and_b32 v79, 0xffff0000, v63
    buffer_load_dwordx4 v[156:159], v19, s[32:35], s57 offen
    v_mul_f32 v76, v76, v78
    v_mul_f32 v77, v77, v79
    v_cvt_pk_bf16_f32 v43, v76, v77
    s_waitcnt vmcnt(20)
    v_lshlrev_b32 v72, 16, v44
    s_add_u32 s57, s79, 3
    s_and_b32 s57, s57, 3
    s_mul_i32 s57, s57, 16384
    s_add_u32 s57, s57, s74
    buffer_load_dwordx4 v[160:163], v16, s[32:35], s57 offen
    v_and_b32 v73, 0xffff0000, v44
    v_lshlrev_b32 v74, 16, v64
    v_and_b32 v75, 0xffff0000, v64
    v_mul_f32 v72, v72, v74
    v_mul_f32 v73, v73, v75
    buffer_load_dwordx4 v[164:167], v17, s[32:35], s57 offen
    v_cvt_pk_bf16_f32 v44, v72, v73
    v_lshlrev_b32 v76, 16, v45
    v_and_b32 v77, 0xffff0000, v45
    v_lshlrev_b32 v78, 16, v65
    v_and_b32 v79, 0xffff0000, v65
    buffer_load_dwordx4 v[168:171], v18, s[32:35], s57 offen
    v_mul_f32 v76, v76, v78
    v_mul_f32 v77, v77, v79
    v_cvt_pk_bf16_f32 v45, v76, v77
    v_mfma_f32_16x16x32_bf16 v[84:87], v[40:43], v[80:83], v[84:87]
    v_lshlrev_b32 v72, 16, v46
    buffer_load_dwordx4 v[172:175], v19, s[32:35], s57 offen
    v_and_b32 v73, 0xffff0000, v46
    v_lshlrev_b32 v74, 16, v66
    v_and_b32 v75, 0xffff0000, v66
    v_mul_f32 v72, v72, v74
    v_mul_f32 v73, v73, v75
    s_add_u32 m0, s78, 0xa800
    s_add_u32 s61, s79, 1
    s_and_b32 s61, s61, 3
    s_mul_i32 s61, s61, 20480
    s_add_u32 s61, s61, s76
    s_add_u32 s61, s61, 0x14000
    buffer_load_dwordx4 v2, s[32:35], s61 offen lds
    v_cvt_pk_bf16_f32 v46, v72, v73
    v_lshlrev_b32 v76, 16, v47
    v_and_b32 v77, 0xffff0000, v47
    v_lshlrev_b32 v78, 16, v67
    v_and_b32 v79, 0xffff0000, v67
    s_add_u32 m0, s78, 0xac00
    s_add_u32 s61, s61, 1024
    buffer_load_dwordx4 v2, s[32:35], s61 offen lds
    v_mul_f32 v76, v76, v78
    v_mul_f32 v77, v77, v79
    v_cvt_pk_bf16_f32 v47, v76, v77
    s_waitcnt vmcnt(24)
    v_lshlrev_b32 v72, 16, v48
    s_add_u32 m0, s78, 0xb000
    s_add_u32 s61, s61, 1024
    buffer_load_dwordx4 v2, s[32:35], s61 offen lds
    v_and_b32 v73, 0xffff0000, v48
    v_lshlrev_b32 v74, 16, v68
    v_and_b32 v75, 0xffff0000, v68
    v_mul_f32 v72, v72, v74
    v_mul_f32 v73, v73, v75
    s_add_u32 m0, s78, 0xb400
    s_add_u32 s61, s61, 1024
    buffer_load_dwordx4 v2, s[32:35], s61 offen lds
    v_cvt_pk_bf16_f32 v48, v72, v73
    v_lshlrev_b32 v76, 16, v49
    v_and_b32 v77, 0xffff0000, v49
    v_lshlrev_b32 v78, 16, v69
    v_and_b32 v79, 0xffff0000, v69
    s_add_u32 m0, s78, 0xb800
    s_add_u32 s61, s61, 1024
    buffer_load_dwordx4 v2, s[32:35], s61 offen lds
    v_mul_f32 v76, v76, v78
    v_mul_f32 v77, v77, v79
    v_cvt_pk_bf16_f32 v49, v76, v77
    v_mfma_f32_16x16x32_bf16 v[84:87], v[44:47], v[80:83], v[84:87]
    v_lshlrev_b32 v72, 16, v50
    s_mov_b32 s60, 160000
LW_26:
    ds_read_b32 v23, v20 offset:52
    s_waitcnt lgkmcnt(0)
    v_readfirstlane_b32 s58, v23
    s_nop 1
    s_cmp_ge_u32 s58, 4
    s_nop 0
    s_cbranch_scc1 LW_26_OK
    s_sub_u32 s60, s60, 1
    s_cmp_lg_u32 s60, 0
    s_cbranch_scc1 LW_26
LW_26_OK:
    v_and_b32 v73, 0xffff0000, v50
    v_lshlrev_b32 v74, 16, v70
    v_and_b32 v75, 0xffff0000, v70
    v_mul_f32 v72, v72, v74
    v_mul_f32 v73, v73, v75
    s_add_u32 m0, s78, 0x10000
    s_add_u32 s61, s79, 2
    s_and_b32 s61, s61, 3
    s_mul_i32 s61, s61, 20480
    s_add_u32 s61, s61, s76
    s_add_u32 s61, s61, 0x14000
    buffer_load_dwordx4 v2, s[32:35], s61 offen lds
    v_cvt_pk_bf16_f32 v50, v72, v73
    v_lshlrev_b32 v76, 16, v51
    v_and_b32 v77, 0xffff0000, v51
    v_lshlrev_b32 v78, 16, v71
    v_and_b32 v79, 0xffff0000, v71
    s_add_u32 m0, s78, 0x10400
    s_add_u32 s61, s61, 1024
    buffer_load_dwordx4 v2, s[32:35], s61 offen lds
    v_mul_f32 v76, v76, v78
    v_mul_f32 v77, v77, v79
    v_cvt_pk_bf16_f32 v51, v76, v77
    s_nop 1
    v_mfma_f32_16x16x32_bf16 v[84:87], v[48:51], v[80:83], v[84:87]
    v_and_b32 v72, 15, v1
    s_add_u32 m0, s78, 0x10800
    s_add_u32 s61, s61, 1024
    buffer_load_dwordx4 v2, s[32:35], s61 offen lds
    v_mov_b32 v73, 0x7ff00000
    v_cmp_eq_u32 vcc, 0, v72
    v_lshrrev_b32 v72, 2, v1
    s_nop 0
    v_cndmask_b32 v72, v73, v72, vcc
    v_add_f32 v84, v84, v85
    v_add_f32 v86, v86, v87
    v_add_f32 v80, v84, v86
    s_add_u32 m0, s78, 0x10c00
    s_add_u32 s61, s61, 1024
    buffer_load_dwordx4 v2, s[32:35], s61 offen lds
    v_cvt_pk_bf16_f32 v80, v80, v80
    v_lshlrev_b32 v80, 16, v80
    v_mul_f32 v80, s63, v80
    v_exp_f32 v80, v80
    s_nop 0
    v_add_f32 v80, 1.0, v80
    s_add_u32 m0, s78, 0x11000
    s_add_u32 s61, s61, 1024
    buffer_load_dwordx4 v2, s[32:35], s61 offen lds
    v_rcp_f32 v80, v80
    s_nop 0
    v_cvt_pk_bf16_f32 v80, v80, v80
    v_lshlrev_b32 v80, 16, v80
    v_sub_f32 v81, 1.0, v80
    v_cvt_pk_bf16_f32 v81, v81, v81
    s_add_u32 m0, s78, 0x15000
    s_add_u32 s61, s79, 3
    s_and_b32 s61, s61, 3
    s_mul_i32 s61, s61, 20480
    s_add_u32 s61, s61, s76
    s_add_u32 s61, s61, 0x14000
    buffer_load_dwordx4 v2, s[32:35], s61 offen lds
    v_lshlrev_b32 v81, 16, v81
    v_max_f32 v80, 0x21800000, v80
    v_rcp_f32 v82, v80
    s_nop 0
    v_mul_f32 v81, v81, v82
    s_add_u32 s83, s82, 8192
    buffer_store_dword v80, v72, s[32:35], s82 offen sc1
    buffer_store_dword v81, v72, s[32:35], s83 offen sc1
    s_add_u32 m0, s78, 0x15400
    s_add_u32 s61, s61, 1024
    buffer_load_dwordx4 v2, s[32:35], s61 offen lds
    s_add_u32 m0, s78, 0x15800
    s_add_u32 s61, s61, 1024
    buffer_load_dwordx4 v2, s[32:35], s61 offen lds
    s_add_u32 m0, s78, 0x15c00
    s_add_u32 s61, s61, 1024
    buffer_load_dwordx4 v2, s[32:35], s61 offen lds
    s_add_u32 m0, s78, 0x16000
    s_add_u32 s61, s61, 1024
    buffer_load_dwordx4 v2, s[32:35], s61 offen lds
    s_add_u32 m0, s78, 0x1a000
    s_add_u32 s61, s79, 0
    s_and_b32 s61, s61, 3
    s_mul_i32 s61, s61, 20480
    s_add_u32 s61, s61, s76
    s_add_u32 s61, s61, 0x28000
    buffer_load_dwordx4 v2, s[32:35], s61 offen lds
    s_add_u32 m0, s78, 0x1a400
    s_add_u32 s61, s61, 1024
    buffer_load_dwordx4 v2, s[32:35], s61 offen lds
    s_add_u32 m0, s78, 0x1a800
    s_add_u32 s61, s61, 1024
    buffer_load_dwordx4 v2, s[32:35], s61 offen lds
    s_add_u32 m0, s78, 0x1ac00
    s_add_u32 s61, s61, 1024
    buffer_load_dwordx4 v2, s[32:35], s61 offen lds
    s_add_u32 m0, s78, 0x1b000
    s_add_u32 s61, s61, 1024
    buffer_load_dwordx4 v2, s[32:35], s61 offen lds
    s_add_u32 m0, s78, 0x0
    s_add_u32 s61, s79, 1
    s_and_b32 s61, s61, 3
    s_mul_i32 s61, s61, 20480
    s_add_u32 s61, s61, s76
    s_add_u32 s61, s61, 0x28000
    buffer_load_dwordx4 v2, s[32:35], s61 offen lds
    s_add_u32 m0, s78, 0x400
    s_add_u32 s61, s61, 1024
    buffer_load_dwordx4 v2, s[32:35], s61 offen lds
    s_add_u32 m0, s78, 0x800
    s_add_u32 s61, s61, 1024
    buffer_load_dwordx4 v2, s[32:35], s61 offen lds
    s_add_u32 m0, s78, 0xc00
    s_add_u32 s61, s61, 1024
    buffer_load_dwordx4 v2, s[32:35], s61 offen lds
    s_add_u32 m0, s78, 0x1000
    s_add_u32 s61, s61, 1024
    buffer_load_dwordx4 v2, s[32:35], s61 offen lds
    s_add_u32 s82, s65, 320
    s_waitcnt lgkmcnt(0)
    s_mov_b32 s60, 160000
LW_27:
    ds_read_b32 v25, v20 offset:68
    s_waitcnt lgkmcnt(0)
    v_readfirstlane_b32 s58, v25
    s_nop 1
    s_cmp_ge_u32 s58, 4
    s_nop 0
    s_cbranch_scc1 LW_27_OK
    s_sub_u32 s60, s60, 1
    s_cmp_lg_u32 s60, 0
    s_cbranch_scc1 LW_27
LW_27_OK:
    s_buffer_load_dwordx16 s[4:19], s[32:35], s75 offset:64 glc
    s_waitcnt vmcnt(39)
    v_mfma_f32_16x16x32_bf16 v[32:35], v[176:179], v[112:115], 0
    v_mfma_f32_16x16x32_bf16 v[52:55], v[176:179], v[116:119], 0
    v_mfma_f32_16x16x32_bf16 v[72:75], v[176:179], v[120:123], 0
    v_mfma_f32_16x16x32_bf16 v[92:95], v[176:179], v[124:127], 0
    v_mfma_f32_16x16x32_bf16 v[36:39], v[180:183], v[112:115], 0
    v_mfma_f32_16x16x32_bf16 v[56:59], v[180:183], v[116:119], 0
    v_mfma_f32_16x16x32_bf16 v[76:79], v[180:183], v[120:123], 0
    v_mfma_f32_16x16x32_bf16 v[96:99], v[180:183], v[124:127], 0
    v_mfma_f32_16x16x32_bf16 v[40:43], v[184:187], v[112:115], 0
    v_mfma_f32_16x16x32_bf16 v[60:63], v[184:187], v[116:119], 0
    v_mfma_f32_16x16x32_bf16 v[80:83], v[184:187], v[120:123], 0
    v_mfma_f32_16x16x32_bf16 v[100:103], v[184:187], v[124:127], 0
    v_mfma_f32_16x16x32_bf16 v[44:47], v[188:191], v[112:115], 0
    v_mfma_f32_16x16x32_bf16 v[64:67], v[188:191], v[116:119], 0
    v_mfma_f32_16x16x32_bf16 v[84:87], v[188:191], v[120:123], 0
    v_mfma_f32_16x16x32_bf16 v[104:107], v[188:191], v[124:127], 0
    v_mfma_f32_16x16x32_bf16 v[48:51], v[192:195], v[112:115], 0
    v_mfma_f32_16x16x32_bf16 v[68:71], v[192:195], v[116:119], 0
    v_mfma_f32_16x16x32_bf16 v[88:91], v[192:195], v[120:123], 0
    v_mfma_f32_16x16x32_bf16 v[108:111], v[192:195], v[124:127], 0
    s_mov_b32 s60, 20000
SP_28:
    s_waitcnt lgkmcnt(0)
    s_xor_b64 s[4:5], s[4:5], s[50:51]
    s_xor_b64 s[6:7], s[6:7], s[50:51]
    s_xor_b64 s[8:9], s[8:9], s[50:51]
    s_xor_b64 s[10:11], s[10:11], s[50:51]
    s_xor_b64 s[12:13], s[12:13], s[50:51]
    s_xor_b64 s[14:15], s[14:15], s[50:51]
    s_xor_b64 s[16:17], s[16:17], s[50:51]
    s_xor_b64 s[18:19], s[18:19], s[50:51]
    s_or_b64 s[4:5], s[4:5], s[6:7]
    s_or_b64 s[4:5], s[4:5], s[8:9]
    s_or_b64 s[4:5], s[4:5], s[10:11]
    s_or_b64 s[4:5], s[4:5], s[12:13]
    s_or_b64 s[4:5], s[4:5], s[14:15]
    s_or_b64 s[4:5], s[4:5], s[16:17]
    s_or_b64 s[4:5], s[4:5], s[18:19]
    s_cbranch_scc0 SP_28_OK
    s_sub_u32 s60, s60, 1
    s_cbranch_scc1 SP_28_OK
    s_buffer_load_dwordx16 s[4:19], s[32:35], s75 offset:64 glc
    s_branch SP_28
SP_28_OK:
    s_add_u32 s57, s79, 0
    s_and_b32 s57, s57, 3
    s_mul_i32 s57, s57, 16384
    s_add_u32 s57, s57, s74
    s_add_u32 s57, s57, 0x10000
    buffer_load_dwordx4 v[112:115], v16, s[32:35], s57 offen
    buffer_load_dwordx4 v[116:119], v17, s[32:35], s57 offen
    buffer_load_dwordx4 v[120:123], v18, s[32:35], s57 offen
    buffer_load_dwordx4 v[124:127], v19, s[32:35], s57 offen
    s_waitcnt lgkmcnt(0)
    s_waitcnt vmcnt(39)
    v_mfma_f32_16x16x32_bf16 v[32:35], v[196:199], v[128:131], v[32:35]
    v_mfma_f32_16x16x32_bf16 v[52:55], v[196:199], v[132:135], v[52:55]
    v_mfma_f32_16x16x32_bf16 v[72:75], v[196:199], v[136:139], v[72:75]
    v_mfma_f32_16x16x32_bf16 v[92:95], v[196:199], v[140:143], v[92:95]
    v_mfma_f32_16x16x32_bf16 v[36:39], v[200:203], v[128:131], v[36:39]
    v_mfma_f32_16x16x32_bf16 v[56:59], v[200:203], v[132:135], v[56:59]
    v_mfma_f32_16x16x32_bf16 v[76:79], v[200:203], v[136:139], v[76:79]
    v_mfma_f32_16x16x32_bf16 v[96:99], v[200:203], v[140:143], v[96:99]
    v_mfma_f32_16x16x32_bf16 v[40:43], v[204:207], v[128:131], v[40:43]
    v_mfma_f32_16x16x32_bf16 v[60:63], v[204:207], v[132:135], v[60:63]
    v_mfma_f32_16x16x32_bf16 v[80:83], v[204:207], v[136:139], v[80:83]
    v_mfma_f32_16x16x32_bf16 v[100:103], v[204:207], v[140:143], v[100:103]
    v_mfma_f32_16x16x32_bf16 v[44:47], v[208:211], v[128:131], v[44:47]
    v_mfma_f32_16x16x32_bf16 v[64:67], v[208:211], v[132:135], v[64:67]
    v_mfma_f32_16x16x32_bf16 v[84:87], v[208:211], v[136:139], v[84:87]
    v_mfma_f32_16x16x32_bf16 v[104:107], v[208:211], v[140:143], v[104:107]
    v_mfma_f32_16x16x32_bf16 v[48:51], v[212:215], v[128:131], v[48:51]
    v_mfma_f32_16x16x32_bf16 v[68:71], v[212:215], v[132:135], v[68:71]
    v_mfma_f32_16x16x32_bf16 v[88:91], v[212:215], v[136:139], v[88:91]
    v_mfma_f32_16x16x32_bf16 v[108:111], v[212:215], v[140:143], v[108:111]
    s_add_u32 s57, s79, 1
    s_and_b32 s57, s57, 3
    s_mul_i32 s57, s57, 16384
    s_add_u32 s57, s57, s74
    s_add_u32 s57, s57, 0x10000
    buffer_load_dwordx4 v[128:131], v16, s[32:35], s57 offen
    buffer_load_dwordx4 v[132:135], v17, s[32:35], s57 offen
    buffer_load_dwordx4 v[136:139], v18, s[32:35], s57 offen
    buffer_load_dwordx4 v[140:143], v19, s[32:35], s57 offen
    s_waitcnt lgkmcnt(0)
    v_mov_b32 v26, s50
    v_mov_b32 v27, 0
    s_waitcnt vmcnt(22)
    s_mov_b64 exec, 1
    buffer_store_dword v26, v27, s[32:35], s82 offen sc1
    s_mov_b64 exec, -1
    s_waitcnt vmcnt(40)
    v_mfma_f32_16x16x32_bf16 v[32:35], v[216:219], v[144:147], v[32:35]
    v_mfma_f32_16x16x32_bf16 v[52:55], v[216:219], v[148:151], v[52:55]
    v_mfma_f32_16x16x32_bf16 v[72:75], v[216:219], v[152:155], v[72:75]
    v_mfma_f32_16x16x32_bf16 v[92:95], v[216:219], v[156:159], v[92:95]
    v_mfma_f32_16x16x32_bf16 v[36:39], v[220:223], v[144:147], v[36:39]
    v_mfma_f32_16x16x32_bf16 v[56:59], v[220:223], v[148:151], v[56:59]
    v_mfma_f32_16x16x32_bf16 v[76:79], v[220:223], v[152:155], v[76:79]
    v_mfma_f32_16x16x32_bf16 v[96:99], v[220:223], v[156:159], v[96:99]
    v_mfma_f32_16x16x32_bf16 v[40:43], v[224:227], v[144:147], v[40:43]
    v_mfma_f32_16x16x32_bf16 v[60:63], v[224:227], v[148:151], v[60:63]
    v_mfma_f32_16x16x32_bf16 v[80:83], v[224:227], v[152:155], v[80:83]
    v_mfma_f32_16x16x32_bf16 v[100:103], v[224:227], v[156:159], v[100:103]
    v_mfma_f32_16x16x32_bf16 v[44:47], v[228:231], v[144:147], v[44:47]
    v_mfma_f32_16x16x32_bf16 v[64:67], v[228:231], v[148:151], v[64:67]
    v_mfma_f32_16x16x32_bf16 v[84:87], v[228:231], v[152:155], v[84:87]
    v_mfma_f32_16x16x32_bf16 v[104:107], v[228:231], v[156:159], v[104:107]
    v_mfma_f32_16x16x32_bf16 v[48:51], v[232:235], v[144:147], v[48:51]
    v_mfma_f32_16x16x32_bf16 v[68:71], v[232:235], v[148:151], v[68:71]
    v_mfma_f32_16x16x32_bf16 v[88:91], v[232:235], v[152:155], v[88:91]
    v_mfma_f32_16x16x32_bf16 v[108:111], v[232:235], v[156:159], v[108:111]
    s_add_u32 s57, s79, 2
    s_and_b32 s57, s57, 3
    s_mul_i32 s57, s57, 16384
    s_add_u32 s57, s57, s74
    s_add_u32 s57, s57, 0x10000
    buffer_load_dwordx4 v[144:147], v16, s[32:35], s57 offen
    buffer_load_dwordx4 v[148:151], v17, s[32:35], s57 offen
    buffer_load_dwordx4 v[152:155], v18, s[32:35], s57 offen
    buffer_load_dwordx4 v[156:159], v19, s[32:35], s57 offen
    s_waitcnt lgkmcnt(0)
    s_waitcnt vmcnt(40)
    v_mfma_f32_16x16x32_bf16 v[32:35], v[236:239], v[160:163], v[32:35]
    ds_read_b128 v[176:179], v3 offset:0
    v_mfma_f32_16x16x32_bf16 v[52:55], v[236:239], v[164:167], v[52:55]
    ds_read_b128 v[180:183], v3 offset:1024
    v_mfma_f32_16x16x32_bf16 v[72:75], v[236:239], v[168:171], v[72:75]
    ds_read_b128 v[184:187], v3 offset:2048
    v_mfma_f32_16x16x32_bf16 v[92:95], v[236:239], v[172:175], v[92:95]
    ds_read_b128 v[188:191], v3 offset:3072
    v_mfma_f32_16x16x32_bf16 v[36:39], v[240:243], v[160:163], v[36:39]
    ds_read_b128 v[192:195], v3 offset:4096
    v_mfma_f32_16x16x32_bf16 v[56:59], v[240:243], v[164:167], v[56:59]
    v_mfma_f32_16x16x32_bf16 v[76:79], v[240:243], v[168:171], v[76:79]
    v_mfma_f32_16x16x32_bf16 v[96:99], v[240:243], v[172:175], v[96:99]
    v_mfma_f32_16x16x32_bf16 v[40:43], v[244:247], v[160:163], v[40:43]
    v_mfma_f32_16x16x32_bf16 v[60:63], v[244:247], v[164:167], v[60:63]
    v_mfma_f32_16x16x32_bf16 v[80:83], v[244:247], v[168:171], v[80:83]
    v_mfma_f32_16x16x32_bf16 v[100:103], v[244:247], v[172:175], v[100:103]
    v_mfma_f32_16x16x32_bf16 v[44:47], v[248:251], v[160:163], v[44:47]
    v_mfma_f32_16x16x32_bf16 v[64:67], v[248:251], v[164:167], v[64:67]
    v_mfma_f32_16x16x32_bf16 v[84:87], v[248:251], v[168:171], v[84:87]
    v_mfma_f32_16x16x32_bf16 v[104:107], v[248:251], v[172:175], v[104:107]
    v_mfma_f32_16x16x32_bf16 v[48:51], v[252:255], v[160:163], v[48:51]
    v_mfma_f32_16x16x32_bf16 v[68:71], v[252:255], v[164:167], v[68:71]
    v_mfma_f32_16x16x32_bf16 v[88:91], v[252:255], v[168:171], v[88:91]
    v_mfma_f32_16x16x32_bf16 v[108:111], v[252:255], v[172:175], v[108:111]
    s_add_u32 s57, s79, 3
    s_and_b32 s57, s57, 3
    s_mul_i32 s57, s57, 16384
    s_add_u32 s57, s57, s74
    s_add_u32 s57, s57, 0x10000
    buffer_load_dwordx4 v[160:163], v16, s[32:35], s57 offen
    buffer_load_dwordx4 v[164:167], v17, s[32:35], s57 offen
    buffer_load_dwordx4 v[168:171], v18, s[32:35], s57 offen
    buffer_load_dwordx4 v[172:175], v19, s[32:35], s57 offen
    s_waitcnt lgkmcnt(0)
    s_waitcnt vmcnt(13)
    v_mfma_f32_16x16x32_bf16 v[32:35], v[176:179], v[112:115], v[32:35]
    ds_read_b128 v[196:199], v8 offset:43008
    s_add_u32 m0, s78, 0x20000
    v_mfma_f32_16x16x32_bf16 v[52:55], v[176:179], v[116:119], v[52:55]
    ds_read_b128 v[200:203], v8 offset:44032
    s_add_u32 s61, s79, 2
    v_mfma_f32_16x16x32_bf16 v[72:75], v[176:179], v[120:123], v[72:75]
    ds_read_b128 v[204:207], v8 offset:45056
    s_and_b32 s61, s61, 3
    v_mfma_f32_16x16x32_bf16 v[92:95], v[176:179], v[124:127], v[92:95]
    ds_read_b128 v[208:211], v8 offset:46080
    s_mul_i32 s61, s61, 20480
    v_mfma_f32_16x16x32_bf16 v[36:39], v[180:183], v[112:115], v[36:39]
    ds_read_b128 v[212:215], v8 offset:47104
    s_add_u32 s61, s61, s76
    v_mfma_f32_16x16x32_bf16 v[56:59], v[180:183], v[116:119], v[56:59]
    s_add_u32 s61, s61, 0x28000
    buffer_load_dwordx4 v2, s[32:35], s61 offen lds
    v_mfma_f32_16x16x32_bf16 v[76:79], v[180:183], v[120:123], v[76:79]
    s_add_u32 m0, s78, 0x20400
    s_add_u32 s61, s61, 1024
    v_mfma_f32_16x16x32_bf16 v[96:99], v[180:183], v[124:127], v[96:99]
    buffer_load_dwordx4 v2, s[32:35], s61 offen lds
    s_add_u32 m0, s78, 0x20800
    v_mfma_f32_16x16x32_bf16 v[40:43], v[184:187], v[112:115], v[40:43]
    s_add_u32 s61, s61, 1024
    buffer_load_dwordx4 v2, s[32:35], s61 offen lds
    v_mfma_f32_16x16x32_bf16 v[60:63], v[184:187], v[116:119], v[60:63]
    s_add_u32 m0, s78, 0x20c00
    s_add_u32 s61, s61, 1024
    v_mfma_f32_16x16x32_bf16 v[80:83], v[184:187], v[120:123], v[80:83]
    buffer_load_dwordx4 v2, s[32:35], s61 offen lds
    s_add_u32 m0, s78, 0x21000
    v_mfma_f32_16x16x32_bf16 v[100:103], v[184:187], v[124:127], v[100:103]
    s_add_u32 s61, s61, 1024
    buffer_load_dwordx4 v2, s[32:35], s61 offen lds
    v_mfma_f32_16x16x32_bf16 v[44:47], v[188:191], v[112:115], v[44:47]
    v_mfma_f32_16x16x32_bf16 v[64:67], v[188:191], v[116:119], v[64:67]
    v_mfma_f32_16x16x32_bf16 v[84:87], v[188:191], v[120:123], v[84:87]
    v_mfma_f32_16x16x32_bf16 v[104:107], v[188:191], v[124:127], v[104:107]
    v_mfma_f32_16x16x32_bf16 v[48:51], v[192:195], v[112:115], v[48:51]
    v_mfma_f32_16x16x32_bf16 v[68:71], v[192:195], v[116:119], v[68:71]
    v_mfma_f32_16x16x32_bf16 v[88:91], v[192:195], v[120:123], v[88:91]
    v_mfma_f32_16x16x32_bf16 v[108:111], v[192:195], v[124:127], v[108:111]
    s_waitcnt lgkmcnt(0)
    s_waitcnt vmcnt(14)
    v_mfma_f32_16x16x32_bf16 v[32:35], v[196:199], v[128:131], v[32:35]
    ds_read_b128 v[176:179], v0 offset:0
    s_add_u32 m0, s78, 0xa800
    v_mfma_f32_16x16x32_bf16 v[52:55], v[196:199], v[132:135], v[52:55]
    ds_read_b128 v[180:183], v0 offset:1024
    s_add_u32 s61, s79, 3
    v_mfma_f32_16x16x32_bf16 v[72:75], v[196:199], v[136:139], v[72:75]
    ds_read_b128 v[184:187], v0 offset:2048
    s_and_b32 s61, s61, 3
    v_mfma_f32_16x16x32_bf16 v[92:95], v[196:199], v[140:143], v[92:95]
    ds_read_b128 v[188:191], v0 offset:3072
    s_mul_i32 s61, s61, 20480
    v_mfma_f32_16x16x32_bf16 v[36:39], v[200:203], v[128:131], v[36:39]
    ds_read_b128 v[192:195], v0 offset:4096
    s_add_u32 s61, s61, s76
    v_mfma_f32_16x16x32_bf16 v[56:59], v[200:203], v[132:135], v[56:59]
    s_add_u32 s61, s61, 0x28000
    buffer_load_dwordx4 v2, s[32:35], s61 offen lds
    v_mfma_f32_16x16x32_bf16 v[76:79], v[200:203], v[136:139], v[76:79]
    s_add_u32 m0, s78, 0xac00
    s_add_u32 s61, s61, 1024
    v_mfma_f32_16x16x32_bf16 v[96:99], v[200:203], v[140:143], v[96:99]
    buffer_load_dwordx4 v2, s[32:35], s61 offen lds
    s_add_u32 m0, s78, 0xb000
    v_mfma_f32_16x16x32_bf16 v[40:43], v[204:207], v[128:131], v[40:43]
    s_add_u32 s61, s61, 1024
    buffer_load_dwordx4 v2, s[32:35], s61 offen lds
    v_mfma_f32_16x16x32_bf16 v[60:63], v[204:207], v[132:135], v[60:63]
    s_add_u32 m0, s78, 0xb400
    s_add_u32 s61, s61, 1024
    v_mfma_f32_16x16x32_bf16 v[80:83], v[204:207], v[136:139], v[80:83]
    buffer_load_dwordx4 v2, s[32:35], s61 offen lds
    s_add_u32 m0, s78, 0xb800
    v_mfma_f32_16x16x32_bf16 v[100:103], v[204:207], v[140:143], v[100:103]
    s_add_u32 s61, s61, 1024
    buffer_load_dwordx4 v2, s[32:35], s61 offen lds
    v_mfma_f32_16x16x32_bf16 v[44:47], v[208:211], v[128:131], v[44:47]
    v_mfma_f32_16x16x32_bf16 v[64:67], v[208:211], v[132:135], v[64:67]
    v_mfma_f32_16x16x32_bf16 v[84:87], v[208:211], v[136:139], v[84:87]
    v_mfma_f32_16x16x32_bf16 v[104:107], v[208:211], v[140:143], v[104:107]
    v_mfma_f32_16x16x32_bf16 v[48:51], v[212:215], v[128:131], v[48:51]
    v_mfma_f32_16x16x32_bf16 v[68:71], v[212:215], v[132:135], v[68:71]
    v_mfma_f32_16x16x32_bf16 v[88:91], v[212:215], v[136:139], v[88:91]
    v_mfma_f32_16x16x32_bf16 v[108:111], v[212:215], v[140:143], v[108:111]
    s_waitcnt lgkmcnt(0)
    s_buffer_load_dwordx16 s[4:19], s[32:35], s75 offset:128 glc
    s_waitcnt vmcnt(14)
    v_mfma_f32_16x16x32_bf16 v[32:35], v[176:179], v[144:147], v[32:35]
    ds_read_b128 v[196:199], v0 offset:20480
    s_add_u32 m0, s78, 0x10000
    v_mfma_f32_16x16x32_bf16 v[52:55], v[176:179], v[148:151], v[52:55]
    ds_read_b128 v[200:203], v0 offset:21504
    s_add_u32 s61, s76, 0x3c000
    v_mfma_f32_16x16x32_bf16 v[72:75], v[176:179], v[152:155], v[72:75]
    ds_read_b128 v[204:207], v0 offset:22528
    v_mfma_f32_16x16x32_bf16 v[92:95], v[176:179], v[156:159], v[92:95]
    ds_read_b128 v[208:211], v0 offset:23552
    v_mfma_f32_16x16x32_bf16 v[36:39], v[180:183], v[144:147], v[36:39]
    ds_read_b128 v[212:215], v0 offset:24576
    v_mfma_f32_16x16x32_bf16 v[56:59], v[180:183], v[148:151], v[56:59]
    buffer_load_dwordx4 v2, s[32:35], s61 offen lds
    s_add_u32 m0, s78, 0x10400
    v_mfma_f32_16x16x32_bf16 v[76:79], v[180:183], v[152:155], v[76:79]
    s_add_u32 s61, s61, 1024
    buffer_load_dwordx4 v2, s[32:35], s61 offen lds
    v_mfma_f32_16x16x32_bf16 v[96:99], v[180:183], v[156:159], v[96:99]
    s_add_u32 m0, s78, 0x10800
    s_add_u32 s61, s61, 1024
    v_mfma_f32_16x16x32_bf16 v[40:43], v[184:187], v[144:147], v[40:43]
    buffer_load_dwordx4 v2, s[32:35], s61 offen lds
    s_add_u32 m0, s78, 0x10c00
    v_mfma_f32_16x16x32_bf16 v[60:63], v[184:187], v[148:151], v[60:63]
    s_add_u32 s61, s61, 1024
    buffer_load_dwordx4 v2, s[32:35], s61 offen lds
    v_mfma_f32_16x16x32_bf16 v[80:83], v[184:187], v[152:155], v[80:83]
    s_add_u32 m0, s78, 0x11000
    s_add_u32 s61, s61, 1024
    v_mfma_f32_16x16x32_bf16 v[100:103], v[184:187], v[156:159], v[100:103]
    buffer_load_dwordx4 v2, s[32:35], s61 offen lds
    v_mfma_f32_16x16x32_bf16 v[44:47], v[188:191], v[144:147], v[44:47]
    v_mfma_f32_16x16x32_bf16 v[64:67], v[188:191], v[148:151], v[64:67]
    v_mfma_f32_16x16x32_bf16 v[84:87], v[188:191], v[152:155], v[84:87]
    v_mfma_f32_16x16x32_bf16 v[104:107], v[188:191], v[156:159], v[104:107]
    v_mfma_f32_16x16x32_bf16 v[48:51], v[192:195], v[144:147], v[48:51]
    v_mfma_f32_16x16x32_bf16 v[68:71], v[192:195], v[148:151], v[68:71]
    v_mfma_f32_16x16x32_bf16 v[88:91], v[192:195], v[152:155], v[88:91]
    v_mfma_f32_16x16x32_bf16 v[108:111], v[192:195], v[156:159], v[108:111]
    s_mov_b32 s60, 20000
SP_29:
    s_waitcnt lgkmcnt(0)
    s_xor_b64 s[4:5], s[4:5], s[50:51]
    s_xor_b64 s[6:7], s[6:7], s[50:51]
    s_xor_b64 s[8:9], s[8:9], s[50:51]
    s_xor_b64 s[10:11], s[10:11], s[50:51]
    s_xor_b64 s[12:13], s[12:13], s[50:51]
    s_xor_b64 s[14:15], s[14:15], s[50:51]
    s_xor_b64 s[16:17], s[16:17], s[50:51]
    s_xor_b64 s[18:19], s[18:19], s[50:51]
    s_or_b64 s[4:5], s[4:5], s[6:7]
    s_or_b64 s[4:5], s[4:5], s[8:9]
    s_or_b64 s[4:5], s[4:5], s[10:11]
    s_or_b64 s[4:5], s[4:5], s[12:13]
    s_or_b64 s[4:5], s[4:5], s[14:15]
    s_or_b64 s[4:5], s[4:5], s[16:17]
    s_or_b64 s[4:5], s[4:5], s[18:19]
    s_cbranch_scc0 SP_29_OK
    s_sub_u32 s60, s60, 1
    s_cbranch_scc1 SP_29_OK
    s_buffer_load_dwordx16 s[4:19], s[32:35], s75 offset:128 glc
    s_branch SP_29
SP_29_OK:
    s_add_u32 s57, s79, 0
    s_and_b32 s57, s57, 3
    s_mul_i32 s57, s57, 16384
    s_add_u32 s57, s57, s74
    s_add_u32 s57, s57, 0x20000
    buffer_load_dwordx4 v[112:115], v16, s[32:35], s57 offen
    buffer_load_dwordx4 v[116:119], v17, s[32:35], s57 offen
    buffer_load_dwordx4 v[120:123], v18, s[32:35], s57 offen
    buffer_load_dwordx4 v[124:127], v19, s[32:35], s57 offen
    s_add_u32 s57, s79, 1
    s_and_b32 s57, s57, 3
    s_mul_i32 s57, s57, 16384
    s_add_u32 s57, s57, s74
    s_add_u32 s57, s57, 0x20000
    buffer_load_dwordx4 v[128:131], v16, s[32:35], s57 offen
    buffer_load_dwordx4 v[132:135], v17, s[32:35], s57 offen
    buffer_load_dwordx4 v[136:139], v18, s[32:35], s57 offen
    buffer_load_dwordx4 v[140:143], v19, s[32:35], s57 offen
    s_add_u32 s57, s79, 2
    s_and_b32 s57, s57, 3
    s_mul_i32 s57, s57, 16384
    s_add_u32 s57, s57, s74
    s_add_u32 s57, s57, 0x20000
    buffer_load_dwordx4 v[144:147], v16, s[32:35], s57 offen
    buffer_load_dwordx4 v[148:151], v17, s[32:35], s57 offen
    buffer_load_dwordx4 v[152:155], v18, s[32:35], s57 offen
    buffer_load_dwordx4 v[156:159], v19, s[32:35], s57 offen
    s_waitcnt lgkmcnt(0)
    s_waitcnt vmcnt(27)
    v_mfma_f32_16x16x32_bf16 v[32:35], v[196:199], v[160:163], v[32:35]
    ds_read_b128 v[176:179], v0 offset:40960
    s_add_u32 m0, s78, 0x15000
    v_mfma_f32_16x16x32_bf16 v[52:55], v[196:199], v[164:167], v[52:55]
    ds_read_b128 v[180:183], v0 offset:41984
    s_add_u32 s61, s76, 0x41000
    v_mfma_f32_16x16x32_bf16 v[72:75], v[196:199], v[168:171], v[72:75]
    ds_read_b128 v[184:187], v0 offset:43008
    s_cmp_lt_u32 s45, 2
    v_mfma_f32_16x16x32_bf16 v[92:95], v[196:199], v[172:175], v[92:95]
    ds_read_b128 v[188:191], v0 offset:44032
    s_cselect_b32 s61, s61, 0x7ff00000
    v_mfma_f32_16x16x32_bf16 v[36:39], v[200:203], v[160:163], v[36:39]
    ds_read_b128 v[192:195], v0 offset:45056
    v_mfma_f32_16x16x32_bf16 v[56:59], v[200:203], v[164:167], v[56:59]
    buffer_load_dwordx4 v2, s[32:35], s61 offen lds
    s_add_u32 m0, s78, 0x15400
    v_mfma_f32_16x16x32_bf16 v[76:79], v[200:203], v[168:171], v[76:79]
    s_add_u32 s61, s61, 1024
    buffer_load_dwordx4 v2, s[32:35], s61 offen lds
    v_mfma_f32_16x16x32_bf16 v[96:99], v[200:203], v[172:175], v[96:99]
    s_add_u32 m0, s78, 0x15800
    s_add_u32 s61, s61, 1024
    v_mfma_f32_16x16x32_bf16 v[40:43], v[204:207], v[160:163], v[40:43]
    buffer_load_dwordx4 v2, s[32:35], s61 offen lds
    s_add_u32 m0, s78, 0x15c00
    v_mfma_f32_16x16x32_bf16 v[60:63], v[204:207], v[164:167], v[60:63]
    s_add_u32 s61, s61, 1024
    buffer_load_dwordx4 v2, s[32:35], s61 offen lds
    v_mfma_f32_16x16x32_bf16 v[80:83], v[204:207], v[168:171], v[80:83]
    s_add_u32 m0, s78, 0x16000
    s_add_u32 s61, s61, 1024
    v_mfma_f32_16x16x32_bf16 v[100:103], v[204:207], v[172:175], v[100:103]
    buffer_load_dwordx4 v2, s[32:35], s61 offen lds
    v_mfma_f32_16x16x32_bf16 v[44:47], v[208:211], v[160:163], v[44:47]
    v_mfma_f32_16x16x32_bf16 v[64:67], v[208:211], v[164:167], v[64:67]
    v_mfma_f32_16x16x32_bf16 v[84:87], v[208:211], v[168:171], v[84:87]
    v_mfma_f32_16x16x32_bf16 v[104:107], v[208:211], v[172:175], v[104:107]
    v_mfma_f32_16x16x32_bf16 v[48:51], v[212:215], v[160:163], v[48:51]
    v_mfma_f32_16x16x32_bf16 v[68:71], v[212:215], v[164:167], v[68:71]
    v_mfma_f32_16x16x32_bf16 v[88:91], v[212:215], v[168:171], v[88:91]
    v_mfma_f32_16x16x32_bf16 v[108:111], v[212:215], v[172:175], v[108:111]
    s_add_u32 s57, s79, 3
    s_and_b32 s57, s57, 3
    s_mul_i32 s57, s57, 16384
    s_add_u32 s57, s57, s74
    s_add_u32 s57, s57, 0x20000
    buffer_load_dwordx4 v[160:163], v16, s[32:35], s57 offen
    buffer_load_dwordx4 v[164:167], v17, s[32:35], s57 offen
    buffer_load_dwordx4 v[168:171], v18, s[32:35], s57 offen
    buffer_load_dwordx4 v[172:175], v19, s[32:35], s57 offen
    s_waitcnt lgkmcnt(0)
    s_waitcnt vmcnt(17)
    v_mfma_f32_16x16x32_bf16 v[32:35], v[176:179], v[112:115], v[32:35]
    ds_read_b128 v[196:199], v8 offset:0
    s_add_u32 m0, s78, 0x1a000
    v_mfma_f32_16x16x32_bf16 v[52:55], v[176:179], v[116:119], v[52:55]
    ds_read_b128 v[200:203], v8 offset:1024
    s_add_u32 s61, s79, 0
    v_mfma_f32_16x16x32_bf16 v[72:75], v[176:179], v[120:123], v[72:75]
    ds_read_b128 v[204:207], v8 offset:2048
    s_and_b32 s61, s61, 3
    v_mfma_f32_16x16x32_bf16 v[92:95], v[176:179], v[124:127], v[92:95]
    ds_read_b128 v[208:211], v8 offset:3072
    s_mul_i32 s61, s61, 20480
    v_mfma_f32_16x16x32_bf16 v[36:39], v[180:183], v[112:115], v[36:39]
    ds_read_b128 v[212:215], v8 offset:4096
    s_add_u32 s61, s61, s76
    v_mfma_f32_16x16x32_bf16 v[56:59], v[180:183], v[116:119], v[56:59]
    s_add_u32 s61, s61, 0x43800
    buffer_load_dwordx4 v2, s[32:35], s61 offen lds
    v_mfma_f32_16x16x32_bf16 v[76:79], v[180:183], v[120:123], v[76:79]
    s_add_u32 m0, s78, 0x1a400
    s_add_u32 s61, s61, 1024
    v_mfma_f32_16x16x32_bf16 v[96:99], v[180:183], v[124:127], v[96:99]
    buffer_load_dwordx4 v2, s[32:35], s61 offen lds
    s_add_u32 m0, s78, 0x1a800
    v_mfma_f32_16x16x32_bf16 v[40:43], v[184:187], v[112:115], v[40:43]
    s_add_u32 s61, s61, 1024
    buffer_load_dwordx4 v2, s[32:35], s61 offen lds
    v_mfma_f32_16x16x32_bf16 v[60:63], v[184:187], v[116:119], v[60:63]
    s_add_u32 m0, s78, 0x1ac00
    s_add_u32 s61, s61, 1024
    v_mfma_f32_16x16x32_bf16 v[80:83], v[184:187], v[120:123], v[80:83]
    buffer_load_dwordx4 v2, s[32:35], s61 offen lds
    s_add_u32 m0, s78, 0x1b000
    v_mfma_f32_16x16x32_bf16 v[100:103], v[184:187], v[124:127], v[100:103]
    s_add_u32 s61, s61, 1024
    buffer_load_dwordx4 v2, s[32:35], s61 offen lds
    v_mfma_f32_16x16x32_bf16 v[44:47], v[188:191], v[112:115], v[44:47]
    v_mfma_f32_16x16x32_bf16 v[64:67], v[188:191], v[116:119], v[64:67]
    v_mfma_f32_16x16x32_bf16 v[84:87], v[188:191], v[120:123], v[84:87]
    v_mfma_f32_16x16x32_bf16 v[104:107], v[188:191], v[124:127], v[104:107]
    v_mfma_f32_16x16x32_bf16 v[48:51], v[192:195], v[112:115], v[48:51]
    v_mfma_f32_16x16x32_bf16 v[68:71], v[192:195], v[116:119], v[68:71]
    v_mfma_f32_16x16x32_bf16 v[88:91], v[192:195], v[120:123], v[88:91]
    v_mfma_f32_16x16x32_bf16 v[108:111], v[192:195], v[124:127], v[108:111]
    s_waitcnt lgkmcnt(0)
    s_buffer_load_dwordx16 s[4:19], s[32:35], s75 offset:192 glc
    s_waitcnt vmcnt(18)
    v_mfma_f32_16x16x32_bf16 v[32:35], v[196:199], v[128:131], v[32:35]
    ds_read_b128 v[176:179], v3 offset:0
    s_add_u32 m0, s78, 0x0
    v_mfma_f32_16x16x32_bf16 v[52:55], v[196:199], v[132:135], v[52:55]
    ds_read_b128 v[180:183], v3 offset:1024
    s_add_u32 s61, s79, 1
    v_mfma_f32_16x16x32_bf16 v[72:75], v[196:199], v[136:139], v[72:75]
    ds_read_b128 v[184:187], v3 offset:2048
    s_and_b32 s61, s61, 3
    v_mfma_f32_16x16x32_bf16 v[92:95], v[196:199], v[140:143], v[92:95]
    ds_read_b128 v[188:191], v3 offset:3072
    s_mul_i32 s61, s61, 20480
    v_mfma_f32_16x16x32_bf16 v[36:39], v[200:203], v[128:131], v[36:39]
    ds_read_b128 v[192:195], v3 offset:4096
    s_add_u32 s61, s61, s76
    v_mfma_f32_16x16x32_bf16 v[56:59], v[200:203], v[132:135], v[56:59]
    s_add_u32 s61, s61, 0x43800
    buffer_load_dwordx4 v2, s[32:35], s61 offen lds
    v_mfma_f32_16x16x32_bf16 v[76:79], v[200:203], v[136:139], v[76:79]
    s_add_u32 m0, s78, 0x400
    s_add_u32 s61, s61, 1024
    v_mfma_f32_16x16x32_bf16 v[96:99], v[200:203], v[140:143], v[96:99]
    buffer_load_dwordx4 v2, s[32:35], s61 offen lds
    s_add_u32 m0, s78, 0x800
    v_mfma_f32_16x16x32_bf16 v[40:43], v[204:207], v[128:131], v[40:43]
    s_add_u32 s61, s61, 1024
    buffer_load_dwordx4 v2, s[32:35], s61 offen lds
    v_mfma_f32_16x16x32_bf16 v[60:63], v[204:207], v[132:135], v[60:63]
    s_add_u32 m0, s78, 0xc00
    s_add_u32 s61, s61, 1024
    v_mfma_f32_16x16x32_bf16 v[80:83], v[204:207], v[136:139], v[80:83]
    buffer_load_dwordx4 v2, s[32:35], s61 offen lds
    s_add_u32 m0, s78, 0x1000
    v_mfma_f32_16x16x32_bf16 v[100:103], v[204:207], v[140:143], v[100:103]
    s_add_u32 s61, s61, 1024
    buffer_load_dwordx4 v2, s[32:35], s61 offen lds
    v_mfma_f32_16x16x32_bf16 v[44:47], v[208:211], v[128:131], v[44:47]
    v_mfma_f32_16x16x32_bf16 v[64:67], v[208:211], v[132:135], v[64:67]
    v_mfma_f32_16x16x32_bf16 v[84:87], v[208:211], v[136:139], v[84:87]
    v_mfma_f32_16x16x32_bf16 v[104:107], v[208:211], v[140:143], v[104:107]
    v_mfma_f32_16x16x32_bf16 v[48:51], v[212:215], v[128:131], v[48:51]
    v_mfma_f32_16x16x32_bf16 v[68:71], v[212:215], v[132:135], v[68:71]
    v_mfma_f32_16x16x32_bf16 v[88:91], v[212:215], v[136:139], v[88:91]
    v_mfma_f32_16x16x32_bf16 v[108:111], v[212:215], v[140:143], v[108:111]
    s_mov_b32 s60, 20000
SP_30:
    s_waitcnt lgkmcnt(0)
    s_xor_b64 s[4:5], s[4:5], s[50:51]
    s_xor_b64 s[6:7], s[6:7], s[50:51]
    s_xor_b64 s[8:9], s[8:9], s[50:51]
    s_xor_b64 s[10:11], s[10:11], s[50:51]
    s_xor_b64 s[12:13], s[12:13], s[50:51]
    s_xor_b64 s[14:15], s[14:15], s[50:51]
    s_xor_b64 s[16:17], s[16:17], s[50:51]
    s_xor_b64 s[18:19], s[18:19], s[50:51]
    s_or_b64 s[4:5], s[4:5], s[6:7]
    s_or_b64 s[4:5], s[4:5], s[8:9]
    s_or_b64 s[4:5], s[4:5], s[10:11]
    s_or_b64 s[4:5], s[4:5], s[12:13]
    s_or_b64 s[4:5], s[4:5], s[14:15]
    s_or_b64 s[4:5], s[4:5], s[16:17]
    s_or_b64 s[4:5], s[4:5], s[18:19]
    s_cbranch_scc0 SP_30_OK
    s_sub_u32 s60, s60, 1
    s_cbranch_scc1 SP_30_OK
    s_buffer_load_dwordx16 s[4:19], s[32:35], s75 offset:192 glc
    s_branch SP_30
SP_30_OK:
    s_add_u32 s57, s74, 0x30000
    buffer_load_dwordx4 v[216:219], v16, s[32:35], s57 offen
    buffer_load_dwordx4 v[220:223], v17, s[32:35], s57 offen
    buffer_load_dwordx4 v[224:227], v18, s[32:35], s57 offen
    buffer_load_dwordx4 v[228:231], v19, s[32:35], s57 offen
    s_add_u32 s57, s74, 0x34000
    s_cmp_lt_u32 s45, 2
    s_cselect_b32 s57, s57, 0x7ff00000
    buffer_load_dwordx4 v[232:235], v16, s[32:35], s57 offen
    buffer_load_dwordx4 v[236:239], v17, s[32:35], s57 offen
    buffer_load_dwordx4 v[240:243], v18, s[32:35], s57 offen
    buffer_load_dwordx4 v[244:247], v19, s[32:35], s57 offen
    s_waitcnt lgkmcnt(0)
    s_buffer_load_dwordx16 s[4:19], s[32:35], s75 offset:320 glc
    s_waitcnt vmcnt(27)
    v_mfma_f32_16x16x32_bf16 v[32:35], v[176:179], v[144:147], v[32:35]
    ds_read_b128 v[196:199], v8 offset:43008
    s_add_u32 m0, s78, 0x20000
    v_mfma_f32_16x16x32_bf16 v[52:55], v[176:179], v[148:151], v[52:55]
    ds_read_b128 v[200:203], v8 offset:44032
    s_add_u32 s61, s79, 2
    v_mfma_f32_16x16x32_bf16 v[72:75], v[176:179], v[152:155], v[72:75]
    ds_read_b128 v[204:207], v8 offset:45056
    s_and_b32 s61, s61, 3
    v_mfma_f32_16x16x32_bf16 v[92:95], v[176:179], v[156:159], v[92:95]
    ds_read_b128 v[208:211], v8 offset:46080
    s_mul_i32 s61, s61, 20480
    v_mfma_f32_16x16x32_bf16 v[36:39], v[180:183], v[144:147], v[36:39]
    ds_read_b128 v[212:215], v8 offset:47104
    s_add_u32 s61, s61, s76
    v_mfma_f32_16x16x32_bf16 v[56:59], v[180:183], v[148:151], v[56:59]
    s_add_u32 s61, s61, 0x43800
    buffer_load_dwordx4 v2, s[32:35], s61 offen lds
    v_mfma_f32_16x16x32_bf16 v[76:79], v[180:183], v[152:155], v[76:79]
    s_add_u32 m0, s78, 0x20400
    s_add_u32 s61, s61, 1024
    v_mfma_f32_16x16x32_bf16 v[96:99], v[180:183], v[156:159], v[96:99]
    buffer_load_dwordx4 v2, s[32:35], s61 offen lds
    s_add_u32 m0, s78, 0x20800
    v_mfma_f32_16x16x32_bf16 v[40:43], v[184:187], v[144:147], v[40:43]
    s_add_u32 s61, s61, 1024
    buffer_load_dwordx4 v2, s[32:35], s61 offen lds
    v_mfma_f32_16x16x32_bf16 v[60:63], v[184:187], v[148:151], v[60:63]
    s_add_u32 m0, s78, 0x20c00
    s_add_u32 s61, s61, 1024
    v_mfma_f32_16x16x32_bf16 v[80:83], v[184:187], v[152:155], v[80:83]
    buffer_load_dwordx4 v2, s[32:35], s61 offen lds
    s_add_u32 m0, s78, 0x21000
    v_mfma_f32_16x16x32_bf16 v[100:103], v[184:187], v[156:159], v[100:103]
    s_add_u32 s61, s61, 1024
    buffer_load_dwordx4 v2, s[32:35], s61 offen lds
    v_mfma_f32_16x16x32_bf16 v[44:47], v[188:191], v[144:147], v[44:47]
    v_mfma_f32_16x16x32_bf16 v[64:67], v[188:191], v[148:151], v[64:67]
    v_mfma_f32_16x16x32_bf16 v[84:87], v[188:191], v[152:155], v[84:87]
    v_mfma_f32_16x16x32_bf16 v[104:107], v[188:191], v[156:159], v[104:107]
    v_mfma_f32_16x16x32_bf16 v[48:51], v[192:195], v[144:147], v[48:51]
    v_mfma_f32_16x16x32_bf16 v[68:71], v[192:195], v[148:151], v[68:71]
    v_mfma_f32_16x16x32_bf16 v[88:91], v[192:195], v[152:155], v[88:91]
    v_mfma_f32_16x16x32_bf16 v[108:111], v[192:195], v[156:159], v[108:111]
    s_mov_b32 s60, 20000
SP_31:
    s_waitcnt lgkmcnt(0)
    s_xor_b64 s[4:5], s[4:5], s[50:51]
    s_xor_b64 s[6:7], s[6:7], s[50:51]
    s_xor_b64 s[8:9], s[8:9], s[50:51]
    s_xor_b64 s[10:11], s[10:11], s[50:51]
    s_xor_b64 s[12:13], s[12:13], s[50:51]
    s_xor_b64 s[14:15], s[14:15], s[50:51]
    s_xor_b64 s[16:17], s[16:17], s[50:51]
    s_xor_b64 s[18:19], s[18:19], s[50:51]
    s_or_b64 s[4:5], s[4:5], s[6:7]
    s_or_b64 s[4:5], s[4:5], s[8:9]
    s_or_b64 s[4:5], s[4:5], s[10:11]
    s_or_b64 s[4:5], s[4:5], s[12:13]
    s_or_b64 s[4:5], s[4:5], s[14:15]
    s_or_b64 s[4:5], s[4:5], s[16:17]
    s_or_b64 s[4:5], s[4:5], s[18:19]
    s_cbranch_scc0 SP_31_OK
    s_sub_u32 s60, s60, 1
    s_cbranch_scc1 SP_31_OK
    s_buffer_load_dwordx16 s[4:19], s[32:35], s75 offset:320 glc
    s_branch SP_31
SP_31_OK:
    buffer_load_dword v28, v12, s[32:35], s66 offen sc1
    buffer_load_dword v29, v13, s[32:35], s66 offen sc1
    buffer_load_dword v30, v14, s[32:35], s66 offen sc1
    buffer_load_dword v31, v15, s[32:35], s66 offen sc1
    s_sub_u32 s57, s66, 8192
    buffer_load_dword v24, v12, s[32:35], s57 offen sc1
    s_waitcnt lgkmcnt(0)
    s_waitcnt vmcnt(28)
    v_mfma_f32_16x16x32_bf16 v[32:35], v[196:199], v[160:163], v[32:35]
    ds_read_b128 v[176:179], v0 offset:0
    s_add_u32 m0, s78, 0xa800
    v_mfma_f32_16x16x32_bf16 v[52:55], v[196:199], v[164:167], v[52:55]
    ds_read_b128 v[180:183], v0 offset:1024
    s_add_u32 s61, s79, 3
    v_mfma_f32_16x16x32_bf16 v[72:75], v[196:199], v[168:171], v[72:75]
    ds_read_b128 v[184:187], v0 offset:2048
    s_and_b32 s61, s61, 3
    v_mfma_f32_16x16x32_bf16 v[92:95], v[196:199], v[172:175], v[92:95]
    ds_read_b128 v[188:191], v0 offset:3072
    s_mul_i32 s61, s61, 20480
    v_mfma_f32_16x16x32_bf16 v[36:39], v[200:203], v[160:163], v[36:39]
    ds_read_b128 v[192:195], v0 offset:4096
    s_add_u32 s61, s61, s76
    v_mfma_f32_16x16x32_bf16 v[56:59], v[200:203], v[164:167], v[56:59]
    s_add_u32 s61, s61, 0x43800
    buffer_load_dwordx4 v2, s[32:35], s61 offen lds
    v_mfma_f32_16x16x32_bf16 v[76:79], v[200:203], v[168:171], v[76:79]
    s_add_u32 m0, s78, 0xac00
    s_add_u32 s61, s61, 1024
    v_mfma_f32_16x16x32_bf16 v[96:99], v[200:203], v[172:175], v[96:99]
    buffer_load_dwordx4 v2, s[32:35], s61 offen lds
    s_add_u32 m0, s78, 0xb000
    v_mfma_f32_16x16x32_bf16 v[40:43], v[204:207], v[160:163], v[40:43]
    s_add_u32 s61, s61, 1024
    buffer_load_dwordx4 v2, s[32:35], s61 offen lds
    v_mfma_f32_16x16x32_bf16 v[60:63], v[204:207], v[164:167], v[60:63]
    s_add_u32 m0, s78, 0xb400
    s_add_u32 s61, s61, 1024
    v_mfma_f32_16x16x32_bf16 v[80:83], v[204:207], v[168:171], v[80:83]
    buffer_load_dwordx4 v2, s[32:35], s61 offen lds
    s_add_u32 m0, s78, 0xb800
    v_mfma_f32_16x16x32_bf16 v[100:103], v[204:207], v[172:175], v[100:103]
    s_add_u32 s61, s61, 1024
    buffer_load_dwordx4 v2, s[32:35], s61 offen lds
    v_mfma_f32_16x16x32_bf16 v[44:47], v[208:211], v[160:163], v[44:47]
    v_mfma_f32_16x16x32_bf16 v[64:67], v[208:211], v[164:167], v[64:67]
    v_mfma_f32_16x16x32_bf16 v[84:87], v[208:211], v[168:171], v[84:87]
    v_mfma_f32_16x16x32_bf16 v[104:107], v[208:211], v[172:175], v[104:107]
    v_mfma_f32_16x16x32_bf16 v[48:51], v[212:215], v[160:163], v[48:51]
    v_mfma_f32_16x16x32_bf16 v[68:71], v[212:215], v[164:167], v[68:71]
    v_mfma_f32_16x16x32_bf16 v[88:91], v[212:215], v[168:171], v[88:91]
    v_mfma_f32_16x16x32_bf16 v[108:111], v[212:215], v[172:175], v[108:111]
    s_waitcnt lgkmcnt(0)
    s_waitcnt vmcnt(19)
    v_mfma_f32_16x16x32_bf16 v[32:35], v[176:179], v[216:219], v[32:35]
    ds_read_b128 v[196:199], v0 offset:20480
    s_add_u32 m0, s78, 0x10000
    v_mfma_f32_16x16x32_bf16 v[52:55], v[176:179], v[220:223], v[52:55]
    ds_read_b128 v[200:203], v0 offset:21504
    s_add_u32 s61, s76, 0x57800
    v_mfma_f32_16x16x32_bf16 v[72:75], v[176:179], v[224:227], v[72:75]
    ds_read_b128 v[204:207], v0 offset:22528
    v_mfma_f32_16x16x32_bf16 v[92:95], v[176:179], v[228:231], v[92:95]
    ds_read_b128 v[208:211], v0 offset:23552
    v_mfma_f32_16x16x32_bf16 v[36:39], v[180:183], v[216:219], v[36:39]
    ds_read_b128 v[212:215], v0 offset:24576
    v_mfma_f32_16x16x32_bf16 v[56:59], v[180:183], v[220:223], v[56:59]
    buffer_load_dwordx4 v2, s[32:35], s61 offen lds
    s_add_u32 m0, s78, 0x10400
    v_mfma_f32_16x16x32_bf16 v[76:79], v[180:183], v[224:227], v[76:79]
    s_add_u32 s61, s61, 1024
    buffer_load_dwordx4 v2, s[32:35], s61 offen lds
    v_mfma_f32_16x16x32_bf16 v[96:99], v[180:183], v[228:231], v[96:99]
    s_add_u32 m0, s78, 0x10800
    s_add_u32 s61, s61, 1024
    v_mfma_f32_16x16x32_bf16 v[40:43], v[184:187], v[216:219], v[40:43]
    buffer_load_dwordx4 v2, s[32:35], s61 offen lds
    s_add_u32 m0, s78, 0x10c00
    v_mfma_f32_16x16x32_bf16 v[60:63], v[184:187], v[220:223], v[60:63]
    s_add_u32 s61, s61, 1024
    buffer_load_dwordx4 v2, s[32:35], s61 offen lds
    v_mfma_f32_16x16x32_bf16 v[80:83], v[184:187], v[224:227], v[80:83]
    s_add_u32 m0, s78, 0x11000
    s_add_u32 s61, s61, 1024
    v_mfma_f32_16x16x32_bf16 v[100:103], v[184:187], v[228:231], v[100:103]
    buffer_load_dwordx4 v2, s[32:35], s61 offen lds
    v_mfma_f32_16x16x32_bf16 v[44:47], v[188:191], v[216:219], v[44:47]
    v_mfma_f32_16x16x32_bf16 v[64:67], v[188:191], v[220:223], v[64:67]
    v_mfma_f32_16x16x32_bf16 v[84:87], v[188:191], v[224:227], v[84:87]
    v_mfma_f32_16x16x32_bf16 v[104:107], v[188:191], v[228:231], v[104:107]
    v_mfma_f32_16x16x32_bf16 v[48:51], v[192:195], v[216:219], v[48:51]
    v_mfma_f32_16x16x32_bf16 v[68:71], v[192:195], v[220:223], v[68:71]
    v_mfma_f32_16x16x32_bf16 v[88:91], v[192:195], v[224:227], v[88:91]
    v_mfma_f32_16x16x32_bf16 v[108:111], v[192:195], v[228:231], v[108:111]
    s_waitcnt lgkmcnt(0)
    s_buffer_load_dwordx16 s[4:19], s[32:35], s75 offset:256 glc
    s_waitcnt vmcnt(20)
    v_mfma_f32_16x16x32_bf16 v[32:35], v[196:199], v[232:235], v[32:35]
    ds_read_b128 v[176:179], v0 offset:40960
    v_mfma_f32_16x16x32_bf16 v[52:55], v[196:199], v[236:239], v[52:55]
    ds_read_b128 v[180:183], v0 offset:41984
    v_mfma_f32_16x16x32_bf16 v[72:75], v[196:199], v[240:243], v[72:75]
    ds_read_b128 v[184:187], v0 offset:43008
    v_mfma_f32_16x16x32_bf16 v[92:95], v[196:199], v[244:247], v[92:95]
    ds_read_b128 v[188:191], v0 offset:44032
    v_mfma_f32_16x16x32_bf16 v[36:39], v[200:203], v[232:235], v[36:39]
    ds_read_b128 v[192:195], v0 offset:45056
    v_mfma_f32_16x16x32_bf16 v[56:59], v[200:203], v[236:239], v[56:59]
    v_mfma_f32_16x16x32_bf16 v[76:79], v[200:203], v[240:243], v[76:79]
    v_mfma_f32_16x16x32_bf16 v[96:99], v[200:203], v[244:247], v[96:99]
    v_mfma_f32_16x16x32_bf16 v[40:43], v[204:207], v[232:235], v[40:43]
    v_mfma_f32_16x16x32_bf16 v[60:63], v[204:207], v[236:239], v[60:63]
    v_mfma_f32_16x16x32_bf16 v[80:83], v[204:207], v[240:243], v[80:83]
    v_mfma_f32_16x16x32_bf16 v[100:103], v[204:207], v[244:247], v[100:103]
    v_mfma_f32_16x16x32_bf16 v[44:47], v[208:211], v[232:235], v[44:47]
    v_mfma_f32_16x16x32_bf16 v[64:67], v[208:211], v[236:239], v[64:67]
    v_mfma_f32_16x16x32_bf16 v[84:87], v[208:211], v[240:243], v[84:87]
    v_mfma_f32_16x16x32_bf16 v[104:107], v[208:211], v[244:247], v[104:107]
    v_mfma_f32_16x16x32_bf16 v[48:51], v[212:215], v[232:235], v[48:51]
    v_mfma_f32_16x16x32_bf16 v[68:71], v[212:215], v[236:239], v[68:71]
    v_mfma_f32_16x16x32_bf16 v[88:91], v[212:215], v[240:243], v[88:91]
    v_mfma_f32_16x16x32_bf16 v[108:111], v[212:215], v[244:247], v[108:111]
    s_mov_b32 s60, 20000
SP_32:
    s_waitcnt lgkmcnt(0)
    s_xor_b64 s[4:5], s[4:5], s[50:51]
    s_xor_b64 s[6:7], s[6:7], s[50:51]
    s_xor_b64 s[8:9], s[8:9], s[50:51]
    s_xor_b64 s[10:11], s[10:11], s[50:51]
    s_xor_b64 s[12:13], s[12:13], s[50:51]
    s_xor_b64 s[14:15], s[14:15], s[50:51]
    s_xor_b64 s[16:17], s[16:17], s[50:51]
    s_xor_b64 s[18:19], s[18:19], s[50:51]
    s_or_b64 s[4:5], s[4:5], s[6:7]
    s_or_b64 s[4:5], s[4:5], s[8:9]
    s_or_b64 s[4:5], s[4:5], s[10:11]
    s_or_b64 s[4:5], s[4:5], s[12:13]
    s_or_b64 s[4:5], s[4:5], s[14:15]
    s_or_b64 s[4:5], s[4:5], s[16:17]
    s_or_b64 s[4:5], s[4:5], s[18:19]
    s_cbranch_scc0 SP_32_OK
    s_sub_u32 s60, s60, 1
    s_cbranch_scc1 SP_32_OK
    s_buffer_load_dwordx16 s[4:19], s[32:35], s75 offset:256 glc
    s_branch SP_32
SP_32_OK:
    s_waitcnt vmcnt(10)
    v_pk_mul_f32 v[32:33], v[32:33], v[28:29] op_sel:[0,0] op_sel_hi:[1,0]
    v_pk_mul_f32 v[34:35], v[34:35], v[28:29] op_sel:[0,0] op_sel_hi:[1,0]
    v_pk_mul_f32 v[36:37], v[36:37], v[28:29] op_sel:[0,0] op_sel_hi:[1,0]
    v_pk_mul_f32 v[38:39], v[38:39], v[28:29] op_sel:[0,0] op_sel_hi:[1,0]
    v_pk_mul_f32 v[40:41], v[40:41], v[28:29] op_sel:[0,0] op_sel_hi:[1,0]
    v_pk_mul_f32 v[42:43], v[42:43], v[28:29] op_sel:[0,0] op_sel_hi:[1,0]
    v_pk_mul_f32 v[44:45], v[44:45], v[28:29] op_sel:[0,0] op_sel_hi:[1,0]
    v_pk_mul_f32 v[46:47], v[46:47], v[28:29] op_sel:[0,0] op_sel_hi:[1,0]
    v_pk_mul_f32 v[48:49], v[48:49], v[28:29] op_sel:[0,0] op_sel_hi:[1,0]
    v_pk_mul_f32 v[50:51], v[50:51], v[28:29] op_sel:[0,0] op_sel_hi:[1,0]
    v_pk_mul_f32 v[52:53], v[52:53], v[28:29] op_sel:[0,1] op_sel_hi:[1,1]
    v_pk_mul_f32 v[54:55], v[54:55], v[28:29] op_sel:[0,1] op_sel_hi:[1,1]
    v_pk_mul_f32 v[56:57], v[56:57], v[28:29] op_sel:[0,1] op_sel_hi:[1,1]
    v_pk_mul_f32 v[58:59], v[58:59], v[28:29] op_sel:[0,1] op_sel_hi:[1,1]
    v_pk_mul_f32 v[60:61], v[60:61], v[28:29] op_sel:[0,1] op_sel_hi:[1,1]
    v_pk_mul_f32 v[62:63], v[62:63], v[28:29] op_sel:[0,1] op_sel_hi:[1,1]
    v_pk_mul_f32 v[64:65], v[64:65], v[28:29] op_sel:[0,1] op_sel_hi:[1,1]
    v_pk_mul_f32 v[66:67], v[66:67], v[28:29] op_sel:[0,1] op_sel_hi:[1,1]
    v_pk_mul_f32 v[68:69], v[68:69], v[28:29] op_sel:[0,1] op_sel_hi:[1,1]
    v_pk_mul_f32 v[70:71], v[70:71], v[28:29] op_sel:[0,1] op_sel_hi:[1,1]
    v_pk_mul_f32 v[72:73], v[72:73], v[30:31] op_sel:[0,0] op_sel_hi:[1,0]
    v_pk_mul_f32 v[74:75], v[74:75], v[30:31] op_sel:[0,0] op_sel_hi:[1,0]
    v_pk_mul_f32 v[76:77], v[76:77], v[30:31] op_sel:[0,0] op_sel_hi:[1,0]
    v_pk_mul_f32 v[78:79], v[78:79], v[30:31] op_sel:[0,0] op_sel_hi:[1,0]
    v_pk_mul_f32 v[80:81], v[80:81], v[30:31] op_sel:[0,0] op_sel_hi:[1,0]
    v_pk_mul_f32 v[82:83], v[82:83], v[30:31] op_sel:[0,0] op_sel_hi:[1,0]
    v_pk_mul_f32 v[84:85], v[84:85], v[30:31] op_sel:[0,0] op_sel_hi:[1,0]
    v_pk_mul_f32 v[86:87], v[86:87], v[30:31] op_sel:[0,0] op_sel_hi:[1,0]
    v_pk_mul_f32 v[88:89], v[88:89], v[30:31] op_sel:[0,0] op_sel_hi:[1,0]
    v_pk_mul_f32 v[90:91], v[90:91], v[30:31] op_sel:[0,0] op_sel_hi:[1,0]
    v_pk_mul_f32 v[92:93], v[92:93], v[30:31] op_sel:[0,1] op_sel_hi:[1,1]
    v_pk_mul_f32 v[94:95], v[94:95], v[30:31] op_sel:[0,1] op_sel_hi:[1,1]
    v_pk_mul_f32 v[96:97], v[96:97], v[30:31] op_sel:[0,1] op_sel_hi:[1,1]
    v_pk_mul_f32 v[98:99], v[98:99], v[30:31] op_sel:[0,1] op_sel_hi:[1,1]
    v_pk_mul_f32 v[100:101], v[100:101], v[30:31] op_sel:[0,1] op_sel_hi:[1,1]
    v_pk_mul_f32 v[102:103], v[102:103], v[30:31] op_sel:[0,1] op_sel_hi:[1,1]
    v_pk_mul_f32 v[104:105], v[104:105], v[30:31] op_sel:[0,1] op_sel_hi:[1,1]
    v_pk_mul_f32 v[106:107], v[106:107], v[30:31] op_sel:[0,1] op_sel_hi:[1,1]
    v_pk_mul_f32 v[108:109], v[108:109], v[30:31] op_sel:[0,1] op_sel_hi:[1,1]
    v_pk_mul_f32 v[110:111], v[110:111], v[30:31] op_sel:[0,1] op_sel_hi:[1,1]
    s_add_u32 s57, s79, 0
    s_and_b32 s57, s57, 3
    s_mul_i32 s57, s57, 16384
    s_add_u32 s57, s57, s74
    s_add_u32 s57, s57, 0x36000
    buffer_load_dwordx4 v[112:115], v16, s[32:35], s57 offen
    buffer_load_dwordx4 v[116:119], v17, s[32:35], s57 offen
    buffer_load_dwordx4 v[120:123], v18, s[32:35], s57 offen
    buffer_load_dwordx4 v[124:127], v19, s[32:35], s57 offen
    s_add_u32 s57, s79, 1
    s_and_b32 s57, s57, 3
    s_mul_i32 s57, s57, 16384
    s_add_u32 s57, s57, s74
    s_add_u32 s57, s57, 0x36000
    buffer_load_dwordx4 v[128:131], v16, s[32:35], s57 offen
    buffer_load_dwordx4 v[132:135], v17, s[32:35], s57 offen
    buffer_load_dwordx4 v[136:139], v18, s[32:35], s57 offen
    buffer_load_dwordx4 v[140:143], v19, s[32:35], s57 offen
    s_add_u32 s57, s79, 2
    s_and_b32 s57, s57, 3
    s_mul_i32 s57, s57, 16384
    s_add_u32 s57, s57, s74
    s_add_u32 s57, s57, 0x36000
    buffer_load_dwordx4 v[144:147], v16, s[32:35], s57 offen
    buffer_load_dwordx4 v[148:151], v17, s[32:35], s57 offen
    buffer_load_dwordx4 v[152:155], v18, s[32:35], s57 offen
    buffer_load_dwordx4 v[156:159], v19, s[32:35], s57 offen
    s_add_u32 s57, s79, 3
    s_and_b32 s57, s57, 3
    s_mul_i32 s57, s57, 16384
    s_add_u32 s57, s57, s74
    s_add_u32 s57, s57, 0x36000
    buffer_load_dwordx4 v[160:163], v16, s[32:35], s57 offen
    buffer_load_dwordx4 v[164:167], v17, s[32:35], s57 offen
    buffer_load_dwordx4 v[168:171], v18, s[32:35], s57 offen
    buffer_load_dwordx4 v[172:175], v19, s[32:35], s57 offen
    s_add_u32 s57, s74, 0x46000
    buffer_load_dwordx2 v[216:217], v4, s[32:35], s57 offen offset:0
    buffer_load_dwordx2 v[218:219], v4, s[32:35], s57 offen offset:2048
    buffer_load_dwordx2 v[220:221], v5, s[32:35], s57 offen offset:0
    buffer_load_dwordx2 v[222:223], v5, s[32:35], s57 offen offset:2048
    buffer_load_dwordx2 v[224:225], v6, s[32:35], s57 offen offset:0
    buffer_load_dwordx2 v[226:227], v6, s[32:35], s57 offen offset:2048
    buffer_load_dwordx2 v[228:229], v7, s[32:35], s57 offen offset:0
    buffer_load_dwordx2 v[230:231], v7, s[32:35], s57 offen offset:2048
    s_waitcnt lgkmcnt(0)
    s_waitcnt vmcnt(20)
    v_mfma_f32_16x16x32_bf16 v[32:35], v[176:179], v[112:115], v[32:35]
    ds_read_b128 v[196:199], v8 offset:0
    v_mfma_f32_16x16x32_bf16 v[52:55], v[176:179], v[116:119], v[52:55]
    ds_read_b128 v[200:203], v8 offset:1024
    v_mfma_f32_16x16x32_bf16 v[72:75], v[176:179], v[120:123], v[72:75]
    ds_read_b128 v[204:207], v8 offset:2048
    v_mfma_f32_16x16x32_bf16 v[92:95], v[176:179], v[124:127], v[92:95]
    ds_read_b128 v[208:211], v8 offset:3072
    v_mfma_f32_16x16x32_bf16 v[36:39], v[180:183], v[112:115], v[36:39]
    ds_read_b128 v[212:215], v8 offset:4096
    v_mfma_f32_16x16x32_bf16 v[56:59], v[180:183], v[116:119], v[56:59]
    v_mfma_f32_16x16x32_bf16 v[76:79], v[180:183], v[120:123], v[76:79]
    v_mfma_f32_16x16x32_bf16 v[96:99], v[180:183], v[124:127], v[96:99]
    v_mfma_f32_16x16x32_bf16 v[40:43], v[184:187], v[112:115], v[40:43]
    v_mfma_f32_16x16x32_bf16 v[60:63], v[184:187], v[116:119], v[60:63]
    v_mfma_f32_16x16x32_bf16 v[80:83], v[184:187], v[120:123], v[80:83]
    v_mfma_f32_16x16x32_bf16 v[100:103], v[184:187], v[124:127], v[100:103]
    v_mfma_f32_16x16x32_bf16 v[44:47], v[188:191], v[112:115], v[44:47]
    v_mfma_f32_16x16x32_bf16 v[64:67], v[188:191], v[116:119], v[64:67]
    v_mfma_f32_16x16x32_bf16 v[84:87], v[188:191], v[120:123], v[84:87]
    v_mfma_f32_16x16x32_bf16 v[104:107], v[188:191], v[124:127], v[104:107]
    v_mfma_f32_16x16x32_bf16 v[48:51], v[192:195], v[112:115], v[48:51]
    v_mfma_f32_16x16x32_bf16 v[68:71], v[192:195], v[116:119], v[68:71]
    v_mfma_f32_16x16x32_bf16 v[88:91], v[192:195], v[120:123], v[88:91]
    v_mfma_f32_16x16x32_bf16 v[108:111], v[192:195], v[124:127], v[108:111]
    s_waitcnt lgkmcnt(0)
    s_waitcnt vmcnt(16)
    v_mfma_f32_16x16x32_bf16 v[32:35], v[196:199], v[128:131], v[32:35]
    ds_read_b128 v[176:179], v3 offset:0
    v_mfma_f32_16x16x32_bf16 v[52:55], v[196:199], v[132:135], v[52:55]
    ds_read_b128 v[180:183], v3 offset:1024
    v_mfma_f32_16x16x32_bf16 v[72:75], v[196:199], v[136:139], v[72:75]
    ds_read_b128 v[184:187], v3 offset:2048
    v_mfma_f32_16x16x32_bf16 v[92:95], v[196:199], v[140:143], v[92:95]
    ds_read_b128 v[188:191], v3 offset:3072
    v_mfma_f32_16x16x32_bf16 v[36:39], v[200:203], v[128:131], v[36:39]
    ds_read_b128 v[192:195], v3 offset:4096
    v_mfma_f32_16x16x32_bf16 v[56:59], v[200:203], v[132:135], v[56:59]
    v_mfma_f32_16x16x32_bf16 v[76:79], v[200:203], v[136:139], v[76:79]
    v_mfma_f32_16x16x32_bf16 v[96:99], v[200:203], v[140:143], v[96:99]
    v_mfma_f32_16x16x32_bf16 v[40:43], v[204:207], v[128:131], v[40:43]
    v_mfma_f32_16x16x32_bf16 v[60:63], v[204:207], v[132:135], v[60:63]
    v_mfma_f32_16x16x32_bf16 v[80:83], v[204:207], v[136:139], v[80:83]
    v_mfma_f32_16x16x32_bf16 v[100:103], v[204:207], v[140:143], v[100:103]
    v_mfma_f32_16x16x32_bf16 v[44:47], v[208:211], v[128:131], v[44:47]
    v_mfma_f32_16x16x32_bf16 v[64:67], v[208:211], v[132:135], v[64:67]
    v_mfma_f32_16x16x32_bf16 v[84:87], v[208:211], v[136:139], v[84:87]
    v_mfma_f32_16x16x32_bf16 v[104:107], v[208:211], v[140:143], v[104:107]
    v_mfma_f32_16x16x32_bf16 v[48:51], v[212:215], v[128:131], v[48:51]
    v_mfma_f32_16x16x32_bf16 v[68:71], v[212:215], v[132:135], v[68:71]
    v_mfma_f32_16x16x32_bf16 v[88:91], v[212:215], v[136:139], v[88:91]
    v_mfma_f32_16x16x32_bf16 v[108:111], v[212:215], v[140:143], v[108:111]
    s_waitcnt lgkmcnt(0)
    s_waitcnt vmcnt(12)
    v_mfma_f32_16x16x32_bf16 v[32:35], v[176:179], v[144:147], v[32:35]
    ds_read_b128 v[196:199], v8 offset:43008
    v_mfma_f32_16x16x32_bf16 v[52:55], v[176:179], v[148:151], v[52:55]
    ds_read_b128 v[200:203], v8 offset:44032
    v_mfma_f32_16x16x32_bf16 v[72:75], v[176:179], v[152:155], v[72:75]
    ds_read_b128 v[204:207], v8 offset:45056
    v_mfma_f32_16x16x32_bf16 v[92:95], v[176:179], v[156:159], v[92:95]
    ds_read_b128 v[208:211], v8 offset:46080
    v_mfma_f32_16x16x32_bf16 v[36:39], v[180:183], v[144:147], v[36:39]
    ds_read_b128 v[212:215], v8 offset:47104
    v_mfma_f32_16x16x32_bf16 v[56:59], v[180:183], v[148:151], v[56:59]
    v_mfma_f32_16x16x32_bf16 v[76:79], v[180:183], v[152:155], v[76:79]
    v_mfma_f32_16x16x32_bf16 v[96:99], v[180:183], v[156:159], v[96:99]
    v_mfma_f32_16x16x32_bf16 v[40:43], v[184:187], v[144:147], v[40:43]
    v_mfma_f32_16x16x32_bf16 v[60:63], v[184:187], v[148:151], v[60:63]
    v_mfma_f32_16x16x32_bf16 v[80:83], v[184:187], v[152:155], v[80:83]
    v_mfma_f32_16x16x32_bf16 v[100:103], v[184:187], v[156:159], v[100:103]
    v_mfma_f32_16x16x32_bf16 v[44:47], v[188:191], v[144:147], v[44:47]
    v_mfma_f32_16x16x32_bf16 v[64:67], v[188:191], v[148:151], v[64:67]
    v_mfma_f32_16x16x32_bf16 v[84:87], v[188:191], v[152:155], v[84:87]
    v_mfma_f32_16x16x32_bf16 v[104:107], v[188:191], v[156:159], v[104:107]
    v_mfma_f32_16x16x32_bf16 v[48:51], v[192:195], v[144:147], v[48:51]
    v_mfma_f32_16x16x32_bf16 v[68:71], v[192:195], v[148:151], v[68:71]
    v_mfma_f32_16x16x32_bf16 v[88:91], v[192:195], v[152:155], v[88:91]
    v_mfma_f32_16x16x32_bf16 v[108:111], v[192:195], v[156:159], v[108:111]
    s_waitcnt lgkmcnt(0)
    s_waitcnt vmcnt(8)
    v_mfma_f32_16x16x32_bf16 v[32:35], v[196:199], v[160:163], v[32:35]
    ds_read_b128 v[176:179], v0 offset:0
    v_mfma_f32_16x16x32_bf16 v[52:55], v[196:199], v[164:167], v[52:55]
    ds_read_b128 v[180:183], v0 offset:1024
    v_mfma_f32_16x16x32_bf16 v[72:75], v[196:199], v[168:171], v[72:75]
    ds_read_b128 v[184:187], v0 offset:2048
    v_mfma_f32_16x16x32_bf16 v[92:95], v[196:199], v[172:175], v[92:95]
    ds_read_b128 v[188:191], v0 offset:3072
    v_mfma_f32_16x16x32_bf16 v[36:39], v[200:203], v[160:163], v[36:39]
    ds_read_b128 v[192:195], v0 offset:4096
    v_mfma_f32_16x16x32_bf16 v[56:59], v[200:203], v[164:167], v[56:59]
    v_mfma_f32_16x16x32_bf16 v[76:79], v[200:203], v[168:171], v[76:79]
    v_mfma_f32_16x16x32_bf16 v[96:99], v[200:203], v[172:175], v[96:99]
    v_mfma_f32_16x16x32_bf16 v[40:43], v[204:207], v[160:163], v[40:43]
    v_mfma_f32_16x16x32_bf16 v[60:63], v[204:207], v[164:167], v[60:63]
    v_mfma_f32_16x16x32_bf16 v[80:83], v[204:207], v[168:171], v[80:83]
    v_mfma_f32_16x16x32_bf16 v[100:103], v[204:207], v[172:175], v[100:103]
    v_mfma_f32_16x16x32_bf16 v[44:47], v[208:211], v[160:163], v[44:47]
    v_mfma_f32_16x16x32_bf16 v[64:67], v[208:211], v[164:167], v[64:67]
    v_mfma_f32_16x16x32_bf16 v[84:87], v[208:211], v[168:171], v[84:87]
    v_mfma_f32_16x16x32_bf16 v[104:107], v[208:211], v[172:175], v[104:107]
    v_mfma_f32_16x16x32_bf16 v[48:51], v[212:215], v[160:163], v[48:51]
    v_mfma_f32_16x16x32_bf16 v[68:71], v[212:215], v[164:167], v[68:71]
    v_mfma_f32_16x16x32_bf16 v[88:91], v[212:215], v[168:171], v[88:91]
    v_mfma_f32_16x16x32_bf16 v[108:111], v[212:215], v[172:175], v[108:111]
    s_waitcnt lgkmcnt(0)
    s_waitcnt vmcnt(0)
    v_mfma_f32_16x16x32_bf16 v[32:35], v[176:179], v[216:219], v[32:35]
    v_mfma_f32_16x16x32_bf16 v[52:55], v[176:179], v[220:223], v[52:55]
    v_mfma_f32_16x16x32_bf16 v[72:75], v[176:179], v[224:227], v[72:75]
    v_mfma_f32_16x16x32_bf16 v[92:95], v[176:179], v[228:231], v[92:95]
    v_mfma_f32_16x16x32_bf16 v[36:39], v[180:183], v[216:219], v[36:39]
    v_mfma_f32_16x16x32_bf16 v[56:59], v[180:183], v[220:223], v[56:59]
    v_mfma_f32_16x16x32_bf16 v[76:79], v[180:183], v[224:227], v[76:79]
    v_mfma_f32_16x16x32_bf16 v[96:99], v[180:183], v[228:231], v[96:99]
    v_mfma_f32_16x16x32_bf16 v[40:43], v[184:187], v[216:219], v[40:43]
    v_mfma_f32_16x16x32_bf16 v[60:63], v[184:187], v[220:223], v[60:63]
    v_mfma_f32_16x16x32_bf16 v[80:83], v[184:187], v[224:227], v[80:83]
    v_mfma_f32_16x16x32_bf16 v[100:103], v[184:187], v[228:231], v[100:103]
    v_mfma_f32_16x16x32_bf16 v[44:47], v[188:191], v[216:219], v[44:47]
    v_mfma_f32_16x16x32_bf16 v[64:67], v[188:191], v[220:223], v[64:67]
    v_mfma_f32_16x16x32_bf16 v[84:87], v[188:191], v[224:227], v[84:87]
    v_mfma_f32_16x16x32_bf16 v[104:107], v[188:191], v[228:231], v[104:107]
    v_mfma_f32_16x16x32_bf16 v[48:51], v[192:195], v[216:219], v[48:51]
    v_mfma_f32_16x16x32_bf16 v[68:71], v[192:195], v[220:223], v[68:71]
    v_mfma_f32_16x16x32_bf16 v[88:91], v[192:195], v[224:227], v[88:91]
    v_mfma_f32_16x16x32_bf16 v[108:111], v[192:195], v[228:231], v[108:111]
    ds_write_b128 v0, v[52:55] offset:0
    ds_write_b128 v0, v[56:59] offset:1024
    ds_write_b128 v0, v[60:63] offset:2048
    ds_write_b128 v0, v[64:67] offset:3072
    s_nop 1
    ds_write_b128 v0, v[68:71] offset:4096
    ds_write_b128 v0, v[72:75] offset:20480
    ds_write_b128 v0, v[76:79] offset:21504
    ds_write_b128 v0, v[80:83] offset:22528
    ds_write_b128 v0, v[84:87] offset:23552
    ds_write_b128 v0, v[88:91] offset:24576
    ds_write_b128 v0, v[92:95] offset:40960
    ds_write_b128 v0, v[96:99] offset:41984
    ds_write_b128 v0, v[100:103] offset:43008
    ds_write_b128 v0, v[104:107] offset:44032
    ds_write_b128 v0, v[108:111] offset:45056
    s_waitcnt lgkmcnt(0)
    s_barrier
    ds_read_b128 v[112:115], v9 offset:0
    ds_read_b128 v[116:119], v10 offset:0
    ds_read_b128 v[120:123], v11 offset:0
    ds_read_b128 v[124:127], v9 offset:1024
    ds_read_b128 v[128:131], v10 offset:1024
    ds_read_b128 v[132:135], v11 offset:1024
    ds_read_b128 v[136:139], v9 offset:2048
    ds_read_b128 v[140:143], v10 offset:2048
    ds_read_b128 v[144:147], v11 offset:2048
    ds_read_b128 v[148:151], v9 offset:3072
    ds_read_b128 v[152:155], v10 offset:3072
    ds_read_b128 v[156:159], v11 offset:3072
    ds_read_b128 v[160:163], v9 offset:4096
    ds_read_b128 v[164:167], v10 offset:4096
    ds_read_b128 v[168:171], v11 offset:4096
    s_waitcnt lgkmcnt(12)
    v_pk_add_f32 v[32:33], v[32:33], v[112:113]
    v_pk_add_f32 v[116:117], v[116:117], v[120:121]
    v_pk_add_f32 v[32:33], v[32:33], v[116:117]
    v_pk_mul_f32 v[32:33], v[32:33], v[24:25] op_sel_hi:[1,0]
    v_pk_add_f32 v[34:35], v[34:35], v[114:115]
    v_pk_add_f32 v[118:119], v[118:119], v[122:123]
    v_pk_add_f32 v[34:35], v[34:35], v[118:119]
    v_pk_mul_f32 v[34:35], v[34:35], v[24:25] op_sel_hi:[1,0]
    v_cvt_pk_bf16_f32 v32, v32, v33
    v_cvt_pk_bf16_f32 v33, v34, v35
    buffer_store_dwordx2 v[32:33], v22, s[28:31], s67 offen offset:0
    s_waitcnt lgkmcnt(9)
    v_pk_add_f32 v[36:37], v[36:37], v[124:125]
    v_pk_add_f32 v[128:129], v[128:129], v[132:133]
    v_pk_add_f32 v[36:37], v[36:37], v[128:129]
    v_pk_mul_f32 v[36:37], v[36:37], v[24:25] op_sel_hi:[1,0]
    v_pk_add_f32 v[38:39], v[38:39], v[126:127]
    v_pk_add_f32 v[130:131], v[130:131], v[134:135]
    v_pk_add_f32 v[38:39], v[38:39], v[130:131]
    v_pk_mul_f32 v[38:39], v[38:39], v[24:25] op_sel_hi:[1,0]
    v_cvt_pk_bf16_f32 v36, v36, v37
    v_cvt_pk_bf16_f32 v37, v38, v39
    buffer_store_dwordx2 v[36:37], v22, s[28:31], s67 offen offset:32
    s_waitcnt lgkmcnt(6)
    v_pk_add_f32 v[40:41], v[40:41], v[136:137]
    v_pk_add_f32 v[140:141], v[140:141], v[144:145]
    v_pk_add_f32 v[40:41], v[40:41], v[140:141]
    v_pk_mul_f32 v[40:41], v[40:41], v[24:25] op_sel_hi:[1,0]
    v_pk_add_f32 v[42:43], v[42:43], v[138:139]
    v_pk_add_f32 v[142:143], v[142:143], v[146:147]
    v_pk_add_f32 v[42:43], v[42:43], v[142:143]
    v_pk_mul_f32 v[42:43], v[42:43], v[24:25] op_sel_hi:[1,0]
    v_cvt_pk_bf16_f32 v40, v40, v41
    v_cvt_pk_bf16_f32 v41, v42, v43
    buffer_store_dwordx2 v[40:41], v22, s[28:31], s67 offen offset:64
    s_waitcnt lgkmcnt(3)
    v_pk_add_f32 v[44:45], v[44:45], v[148:149]
    v_pk_add_f32 v[152:153], v[152:153], v[156:157]
    v_pk_add_f32 v[44:45], v[44:45], v[152:153]
    v_pk_mul_f32 v[44:45], v[44:45], v[24:25] op_sel_hi:[1,0]
    v_pk_add_f32 v[46:47], v[46:47], v[150:151]
    v_pk_add_f32 v[154:155], v[154:155], v[158:159]
    v_pk_add_f32 v[46:47], v[46:47], v[154:155]
    v_pk_mul_f32 v[46:47], v[46:47], v[24:25] op_sel_hi:[1,0]
    v_cvt_pk_bf16_f32 v44, v44, v45
    v_cvt_pk_bf16_f32 v45, v46, v47
    buffer_store_dwordx2 v[44:45], v22, s[28:31], s67 offen offset:96
    s_waitcnt lgkmcnt(0)
    v_pk_add_f32 v[48:49], v[48:49], v[160:161]
    v_pk_add_f32 v[164:165], v[164:165], v[168:169]
    v_pk_add_f32 v[48:49], v[48:49], v[164:165]
    v_pk_mul_f32 v[48:49], v[48:49], v[24:25] op_sel_hi:[1,0]
    v_pk_add_f32 v[50:51], v[50:51], v[162:163]
    v_pk_add_f32 v[166:167], v[166:167], v[170:171]
    v_pk_add_f32 v[50:51], v[50:51], v[166:167]
    v_pk_mul_f32 v[50:51], v[50:51], v[24:25] op_sel_hi:[1,0]
    v_cvt_pk_bf16_f32 v48, v48, v49
    v_cvt_pk_bf16_f32 v49, v50, v51
    buffer_store_dwordx2 v[48:49], v22, s[28:31], s67 offen offset:128
    s_branch L_END
L_Y1:
    s_mov_b32 s28, s14
    s_and_b32 s29, s15, 0xffff
    s_mov_b32 s30, 0x21c000
    s_mov_b32 s31, 0x20000
    s_mul_i32 s53, s45, 55296
    s_mul_i32 s56, s47, 128
    s_add_u32 s53, s53, s56
    s_add_u32 s53, s53, 1024
    s_mul_i32 s56, s82, 221184
    s_add_u32 s53, s53, s56
    s_mul_i32 s55, s45, 2048
    v_lshrrev_b32 v13, 5, v1
    v_lshlrev_b32 v13, 3, v13
    v_bfe_u32 v14, v1, 3, 2
    v_add_u32 v13, v13, v14
    v_mul_u32_u24 v13, 3456, v13
    v_bfe_u32 v14, v1, 4, 2
    v_lshlrev_b32 v14, 1, v14
    v_and_b32 v4, 7, v1
    v_xor_b32 v4, v4, v14
    v_lshl_add_u32 v4, v4, 4, v13
    s_bitcmp1_b32 s20, 0
    s_cselect_b32 s21, 0x500, 0
    s_sub_u32 s21, s52, s21
    s_add_u32 m0, s54, 0x0
    s_add_u32 s56, s21, 0x0
    buffer_load_dwordx4 v3, s[24:27], s56 offen lds
    s_add_u32 m0, s54, 0x2000
    s_add_u32 s56, s21, 0x14000
    buffer_load_dwordx4 v3, s[24:27], s56 offen lds
    s_bitcmp1_b32 s20, 0
    s_cselect_b32 s12, 0x21c000, 0
    s_sub_u32 s12, s53, s12
    s_add_u32 m0, s55, 0x6000
    s_add_u32 s56, s12, 0x0
    buffer_load_dwordx4 v4, s[28:31], s56 offen lds
    s_add_u32 m0, s55, 0x6400
    s_add_u32 s56, s12, 0x3600
    buffer_load_dwordx4 v4, s[28:31], s56 offen lds
    s_barrier
    s_bitcmp1_b32 s20, 1
    s_cselect_b32 s21, 0x500, 0
    s_sub_u32 s21, s52, s21
    s_add_u32 m0, s54, 0x8000
    s_add_u32 s56, s21, 0x80
    buffer_load_dwordx4 v3, s[24:27], s56 offen lds
    s_add_u32 m0, s54, 0xa000
    s_add_u32 s56, s21, 0x14080
    buffer_load_dwordx4 v3, s[24:27], s56 offen lds
    s_bitcmp1_b32 s20, 1
    s_cselect_b32 s12, 0x21c000, 0
    s_sub_u32 s12, s53, s12
    s_add_u32 m0, s55, 0xe000
    s_add_u32 s56, s12, 0x36000
    buffer_load_dwordx4 v4, s[28:31], s56 offen lds
    s_add_u32 m0, s55, 0xe400
    s_add_u32 s56, s12, 0x39600
    buffer_load_dwordx4 v4, s[28:31], s56 offen lds
    v_and_b32 v13, 15, v1
    v_bfe_u32 v14, v1, 1, 3
    v_lshrrev_b32 v15, 4, v1
    v_xor_b32 v14, v14, v15
    v_lshlrev_b32 v13, 7, v13
    v_lshl_add_u32 v7, v14, 4, v13
    s_lshl_b32 s56, s45, 12
    v_add_u32 v7, s56, v7
    v_xor_b32 v8, 64, v7
    s_lshl_b32 s56, s45, 10
    s_add_u32 s56, s56, 0x27400
    s_cmp_lt_u32 s45, 2
    s_cselect_b32 m0, s56, 0x26000
    s_mov_b32 s56, 0x7ff00000
    buffer_load_dwordx4 v2, s[24:27], s56 offen lds
    s_mov_b32 s36, s6
    s_and_b32 s37, s7, 0xffff
    s_mov_b32 s38, 0x258000
    s_mov_b32 s39, 0x20000
    s_mul_i32 s64, s45, 61440
    s_mul_i32 s56, s47, 160
    s_add_u32 s64, s64, s56
    s_add_u32 s64, s64, 0
    s_mul_i32 s56, s82, 245760
    s_add_u32 s64, s64, s56
    s_mul_i32 s65, s45, 2560
    v_add_u32 v91, 0, v1
    v_mul_u32_u24 v92, 6554, v91
    v_lshrrev_b32 v92, 16, v92
    v_mul_u32_u24 v93, 10, v92
    v_sub_u32 v91, v91, v93
    v_and_b32 v93, 0x13, v92
    v_and_b32 v88, 4, v92
    v_lshl_or_b32 v93, v88, 1, v93
    v_bfe_u32 v88, v92, 3, 1
    v_lshl_or_b32 v93, v88, 2, v93
    v_mul_u32_u24 v93, 3840, v93
    v_lshl_add_u32 v88, v91, 4, v93
    v_add_u32 v91, 64, v1
    v_mul_u32_u24 v92, 6554, v91
    v_lshrrev_b32 v92, 16, v92
    v_mul_u32_u24 v93, 10, v92
    v_sub_u32 v91, v91, v93
    v_and_b32 v93, 0x13, v92
    v_and_b32 v89, 4, v92
    v_lshl_or_b32 v93, v89, 1, v93
    v_bfe_u32 v89, v92, 3, 1
    v_lshl_or_b32 v93, v89, 2, v93
    v_mul_u32_u24 v93, 3840, v93
    v_lshl_add_u32 v89, v91, 4, v93
    v_add_u32 v91, 128, v1
    v_mul_u32_u24 v92, 6554, v91
    v_lshrrev_b32 v92, 16, v92
    v_mul_u32_u24 v93, 10, v92
    v_sub_u32 v91, v91, v93
    v_and_b32 v93, 0x13, v92
    v_and_b32 v90, 4, v92
    v_lshl_or_b32 v93, v90, 1, v93
    v_bfe_u32 v90, v92, 3, 1
    v_lshl_or_b32 v93, v90, 2, v93
    v_mul_u32_u24 v93, 3840, v93
    v_lshl_add_u32 v90, v91, 4, v93
    s_lshr_b32 s56, s45, 1
    s_lshl_b32 s57, s46, 1
    s_add_u32 s56, s56, s57
    s_lshl_b32 s73, s56, 9
    s_mul_i32 s56, s56, 74
    s_mul_i32 s57, s47, 2
    s_add_u32 s56, s56, s57
    s_add_u32 s56, s56, 54
    s_lshl_b32 s72, s56, 12
    s_and_b32 s56, s45, 1
    s_lshl_b32 s57, s56, 11
    s_add_u32 s72, s72, s57
    s_mul_i32 s57, s47, 2
    s_add_u32 s56, s56, s57
    s_lshl_b32 s56, s56, 2
    s_add_u32 s73, s73, s56
    s_add_u32 s73, s73, 0xd29100
    v_lshrrev_b32 v13, 5, v1
    v_lshlrev_b32 v13, 4, v13
    v_bfe_u32 v14, v1, 2, 3
    v_add_u32 v13, v13, v14
    v_lshlrev_b32 v13, 7, v13
    v_and_b32 v14, 3, v1
    v_lshl_add_u32 v13, v14, 3, v13
    v_add_u32 v13, 0x6000, v13
    v_bfe_u32 v14, v1, 3, 2
    v_xor_b32 v9, 0, v14
    v_lshl_add_u32 v9, v9, 5, v13
    v_xor_b32 v10, 1, v14
    v_lshl_add_u32 v10, v10, 5, v13
    v_xor_b32 v11, 2, v14
    v_lshl_add_u32 v11, v11, 5, v13
    v_xor_b32 v12, 3, v14
    v_lshl_add_u32 v12, v12, 5, v13
    s_waitcnt lgkmcnt(0)
    s_mul_i32 s50, s50, 0x9e3779b1
    s_add_u32 s50, s50, 0x7f4a7c15
    s_mov_b32 s51, s50
    s_waitcnt vmcnt(5)
    s_barrier
    ds_read_b128 v[96:99], v7 offset:0
    ds_read_b128 v[100:103], v7 offset:2048
    ds_read_b64_tr_b16 v[16:17], v9 offset:0
    ds_read_b64_tr_b16 v[18:19], v9 offset:1024
    ds_read_b64_tr_b16 v[20:21], v10 offset:0
    ds_read_b64_tr_b16 v[22:23], v10 offset:1024
    ds_read_b64_tr_b16 v[24:25], v11 offset:0
    ds_read_b64_tr_b16 v[26:27], v11 offset:1024
    ds_read_b64_tr_b16 v[28:29], v12 offset:0
    ds_read_b64_tr_b16 v[30:31], v12 offset:1024
    s_waitcnt lgkmcnt(0)
    v_mfma_f32_16x16x32_bf16 v[56:59], v[16:19], v[96:99], 0
    ds_read_b128 v[104:107], v8 offset:0
    ds_read_b128 v[108:111], v8 offset:2048
    s_bitcmp1_b32 s20, 2
    s_cselect_b32 s21, 0x500, 0
    s_sub_u32 s21, s52, s21
    s_add_u32 m0, s54, 0x10000
    s_add_u32 s56, s21, 0x100
    buffer_load_dwordx4 v3, s[24:27], s56 offen lds
    v_mfma_f32_16x16x32_bf16 v[60:63], v[16:19], v[100:103], 0
    ds_read_b64_tr_b16 v[36:37], v9 offset:4096
    ds_read_b64_tr_b16 v[38:39], v9 offset:5120
    s_add_u32 m0, s54, 0x12000
    s_add_u32 s56, s21, 0x14100
    buffer_load_dwordx4 v3, s[24:27], s56 offen lds
    v_mfma_f32_16x16x32_bf16 v[64:67], v[20:23], v[96:99], 0
    ds_read_b64_tr_b16 v[40:41], v10 offset:4096
    ds_read_b64_tr_b16 v[42:43], v10 offset:5120
    s_bitcmp1_b32 s20, 2
    s_cselect_b32 s12, 0x21c000, 0
    s_sub_u32 s12, s53, s12
    s_add_u32 m0, s55, 0x16000
    s_add_u32 s56, s12, 0x6c000
    buffer_load_dwordx4 v4, s[28:31], s56 offen lds
    v_mfma_f32_16x16x32_bf16 v[68:71], v[20:23], v[100:103], 0
    ds_read_b64_tr_b16 v[44:45], v11 offset:4096
    ds_read_b64_tr_b16 v[46:47], v11 offset:5120
    s_add_u32 m0, s55, 0x16400
    s_add_u32 s56, s12, 0x6f600
    buffer_load_dwordx4 v4, s[28:31], s56 offen lds
    v_mfma_f32_16x16x32_bf16 v[72:75], v[24:27], v[96:99], 0
    ds_read_b64_tr_b16 v[48:49], v12 offset:4096
    ds_read_b64_tr_b16 v[50:51], v12 offset:5120
    v_mfma_f32_16x16x32_bf16 v[76:79], v[24:27], v[100:103], 0
    v_mfma_f32_16x16x32_bf16 v[80:83], v[28:31], v[96:99], 0
    v_mfma_f32_16x16x32_bf16 v[84:87], v[28:31], v[100:103], 0
    s_waitcnt lgkmcnt(0)
    s_waitcnt vmcnt(5)
    s_barrier
    v_mfma_f32_16x16x32_bf16 v[56:59], v[36:39], v[104:107], v[56:59]
    ds_read_b128 v[112:115], v7 offset:32768
    ds_read_b128 v[116:119], v7 offset:34816
    s_bitcmp1_b32 s20, 3
    s_cselect_b32 s21, 0x500, 0
    s_sub_u32 s21, s52, s21
    s_add_u32 m0, s54, 0x18000
    s_add_u32 s56, s21, 0x180
    buffer_load_dwordx4 v3, s[24:27], s56 offen lds
    v_mfma_f32_16x16x32_bf16 v[60:63], v[36:39], v[108:111], v[60:63]
    ds_read_b64_tr_b16 v[16:17], v9 offset:32768
    ds_read_b64_tr_b16 v[18:19], v9 offset:33792
    s_add_u32 m0, s54, 0x1a000
    s_add_u32 s56, s21, 0x14180
    buffer_load_dwordx4 v3, s[24:27], s56 offen lds
    v_mfma_f32_16x16x32_bf16 v[64:67], v[40:43], v[104:107], v[64:67]
    ds_read_b64_tr_b16 v[20:21], v10 offset:32768
    ds_read_b64_tr_b16 v[22:23], v10 offset:33792
    v_mfma_f32_16x16x32_bf16 v[68:71], v[40:43], v[108:111], v[68:71]
    ds_read_b64_tr_b16 v[24:25], v11 offset:32768
    ds_read_b64_tr_b16 v[26:27], v11 offset:33792
    v_mfma_f32_16x16x32_bf16 v[72:75], v[44:47], v[104:107], v[72:75]
    ds_read_b64_tr_b16 v[28:29], v12 offset:32768
    ds_read_b64_tr_b16 v[30:31], v12 offset:33792
    v_mfma_f32_16x16x32_bf16 v[76:79], v[44:47], v[108:111], v[76:79]
    v_mfma_f32_16x16x32_bf16 v[80:83], v[48:51], v[104:107], v[80:83]
    v_mfma_f32_16x16x32_bf16 v[84:87], v[48:51], v[108:111], v[84:87]
    s_waitcnt lgkmcnt(0)
    v_mfma_f32_16x16x32_bf16 v[56:59], v[16:19], v[112:115], v[56:59]
    ds_read_b128 v[120:123], v8 offset:32768
    ds_read_b128 v[124:127], v8 offset:34816
    s_bitcmp1_b32 s20, 3
    s_cselect_b32 s12, 0x21c000, 0
    s_sub_u32 s12, s53, s12
    s_add_u32 m0, s55, 0x1e000
    s_add_u32 s56, s12, 0xa2000
    buffer_load_dwordx4 v4, s[28:31], s56 offen lds
    v_mfma_f32_16x16x32_bf16 v[60:63], v[16:19], v[116:119], v[60:63]
    ds_read_b64_tr_b16 v[36:37], v9 offset:36864
    ds_read_b64_tr_b16 v[38:39], v9 offset:37888
    s_add_u32 m0, s55, 0x1e400
    s_add_u32 s56, s12, 0xa5600
    buffer_load_dwordx4 v4, s[28:31], s56 offen lds
    v_mfma_f32_16x16x32_bf16 v[64:67], v[20:23], v[112:115], v[64:67]
    ds_read_b64_tr_b16 v[40:41], v10 offset:36864
    ds_read_b64_tr_b16 v[42:43], v10 offset:37888
    v_mfma_f32_16x16x32_bf16 v[68:71], v[20:23], v[116:119], v[68:71]
    ds_read_b64_tr_b16 v[44:45], v11 offset:36864
    ds_read_b64_tr_b16 v[46:47], v11 offset:37888
    v_mfma_f32_16x16x32_bf16 v[72:75], v[24:27], v[112:115], v[72:75]
    ds_read_b64_tr_b16 v[48:49], v12 offset:36864
    ds_read_b64_tr_b16 v[50:51], v12 offset:37888
    v_mfma_f32_16x16x32_bf16 v[76:79], v[24:27], v[116:119], v[76:79]
    v_mfma_f32_16x16x32_bf16 v[80:83], v[28:31], v[112:115], v[80:83]
    v_mfma_f32_16x16x32_bf16 v[84:87], v[28:31], v[116:119], v[84:87]
    s_waitcnt lgkmcnt(0)
    s_waitcnt vmcnt(4)
    s_barrier
    v_mfma_f32_16x16x32_bf16 v[56:59], v[36:39], v[120:123], v[56:59]
    v_add_u32 v7, 0x10000, v7
    v_add_u32 v8, 0x10000, v8
    ds_read_b128 v[128:131], v7 offset:0
    ds_read_b128 v[132:135], v7 offset:2048
    s_bitcmp1_b32 s20, 4
    s_cselect_b32 s21, 0x500, 0
    s_sub_u32 s21, s52, s21
    s_add_u32 m0, s54, 0x0
    s_add_u32 s56, s21, 0x200
    buffer_load_dwordx4 v3, s[24:27], s56 offen lds
    v_mfma_f32_16x16x32_bf16 v[60:63], v[36:39], v[124:127], v[60:63]
    v_add_u32 v9, 0x10000, v9
    v_add_u32 v10, 0x10000, v10
    v_add_u32 v11, 0x10000, v11
    v_add_u32 v12, 0x10000, v12
    ds_read_b64_tr_b16 v[16:17], v9 offset:0
    ds_read_b64_tr_b16 v[18:19], v9 offset:1024
    s_add_u32 m0, s54, 0x2000
    s_add_u32 s56, s21, 0x14200
    buffer_load_dwordx4 v3, s[24:27], s56 offen lds
    v_mfma_f32_16x16x32_bf16 v[64:67], v[40:43], v[120:123], v[64:67]
    ds_read_b64_tr_b16 v[20:21], v10 offset:0
    ds_read_b64_tr_b16 v[22:23], v10 offset:1024
    v_mfma_f32_16x16x32_bf16 v[68:71], v[40:43], v[124:127], v[68:71]
    ds_read_b64_tr_b16 v[24:25], v11 offset:0
    ds_read_b64_tr_b16 v[26:27], v11 offset:1024
    v_mfma_f32_16x16x32_bf16 v[72:75], v[44:47], v[120:123], v[72:75]
    ds_read_b64_tr_b16 v[28:29], v12 offset:0
    ds_read_b64_tr_b16 v[30:31], v12 offset:1024
    v_mfma_f32_16x16x32_bf16 v[76:79], v[44:47], v[124:127], v[76:79]
    v_mfma_f32_16x16x32_bf16 v[80:83], v[48:51], v[120:123], v[80:83]
    v_mfma_f32_16x16x32_bf16 v[84:87], v[48:51], v[124:127], v[84:87]
    s_waitcnt lgkmcnt(0)
    v_mfma_f32_16x16x32_bf16 v[56:59], v[16:19], v[128:131], v[56:59]
    ds_read_b128 v[136:139], v8 offset:0
    ds_read_b128 v[140:143], v8 offset:2048
    s_bitcmp1_b32 s20, 4
    s_cselect_b32 s12, 0x21c000, 0
    s_sub_u32 s12, s53, s12
    s_add_u32 m0, s55, 0x6000
    s_add_u32 s56, s12, 0xd8000
    buffer_load_dwordx4 v4, s[28:31], s56 offen lds
    v_mfma_f32_16x16x32_bf16 v[60:63], v[16:19], v[132:135], v[60:63]
    ds_read_b64_tr_b16 v[36:37], v9 offset:4096
    ds_read_b64_tr_b16 v[38:39], v9 offset:5120
    s_add_u32 m0, s55, 0x6400
    s_add_u32 s56, s12, 0xdb600
    buffer_load_dwordx4 v4, s[28:31], s56 offen lds
    v_mfma_f32_16x16x32_bf16 v[64:67], v[20:23], v[128:131], v[64:67]
    ds_read_b64_tr_b16 v[40:41], v10 offset:4096
    ds_read_b64_tr_b16 v[42:43], v10 offset:5120
    v_mfma_f32_16x16x32_bf16 v[68:71], v[20:23], v[132:135], v[68:71]
    ds_read_b64_tr_b16 v[44:45], v11 offset:4096
    ds_read_b64_tr_b16 v[46:47], v11 offset:5120
    v_mfma_f32_16x16x32_bf16 v[72:75], v[24:27], v[128:131], v[72:75]
    ds_read_b64_tr_b16 v[48:49], v12 offset:4096
    ds_read_b64_tr_b16 v[50:51], v12 offset:5120
    v_mfma_f32_16x16x32_bf16 v[76:79], v[24:27], v[132:135], v[76:79]
    v_mfma_f32_16x16x32_bf16 v[80:83], v[28:31], v[128:131], v[80:83]
    v_mfma_f32_16x16x32_bf16 v[84:87], v[28:31], v[132:135], v[84:87]
    s_waitcnt lgkmcnt(0)
    s_waitcnt vmcnt(4)
    s_barrier
    v_mfma_f32_16x16x32_bf16 v[56:59], v[36:39], v[136:139], v[56:59]
    ds_read_b128 v[144:147], v7 offset:32768
    ds_read_b128 v[148:151], v7 offset:34816
    s_bitcmp1_b32 s20, 5
    s_cselect_b32 s21, 0x500, 0
    s_sub_u32 s21, s52, s21
    s_add_u32 m0, s54, 0x8000
    s_add_u32 s56, s21, 0x280
    buffer_load_dwordx4 v3, s[24:27], s56 offen lds
    v_mfma_f32_16x16x32_bf16 v[60:63], v[36:39], v[140:143], v[60:63]
    ds_read_b64_tr_b16 v[16:17], v9 offset:32768
    ds_read_b64_tr_b16 v[18:19], v9 offset:33792
    s_add_u32 m0, s54, 0xa000
    s_add_u32 s56, s21, 0x14280
    buffer_load_dwordx4 v3, s[24:27], s56 offen lds
    v_mfma_f32_16x16x32_bf16 v[64:67], v[40:43], v[136:139], v[64:67]
    ds_read_b64_tr_b16 v[20:21], v10 offset:32768
    ds_read_b64_tr_b16 v[22:23], v10 offset:33792
    v_mfma_f32_16x16x32_bf16 v[68:71], v[40:43], v[140:143], v[68:71]
    ds_read_b64_tr_b16 v[24:25], v11 offset:32768
    ds_read_b64_tr_b16 v[26:27], v11 offset:33792
    v_mfma_f32_16x16x32_bf16 v[72:75], v[44:47], v[136:139], v[72:75]
    ds_read_b64_tr_b16 v[28:29], v12 offset:32768
    ds_read_b64_tr_b16 v[30:31], v12 offset:33792
    v_mfma_f32_16x16x32_bf16 v[76:79], v[44:47], v[140:143], v[76:79]
    v_mfma_f32_16x16x32_bf16 v[80:83], v[48:51], v[136:139], v[80:83]
    v_mfma_f32_16x16x32_bf16 v[84:87], v[48:51], v[140:143], v[84:87]
    s_waitcnt lgkmcnt(0)
    v_mfma_f32_16x16x32_bf16 v[56:59], v[16:19], v[144:147], v[56:59]
    ds_read_b128 v[152:155], v8 offset:32768
    ds_read_b128 v[156:159], v8 offset:34816
    s_bitcmp1_b32 s20, 5
    s_cselect_b32 s12, 0x21c000, 0
    s_sub_u32 s12, s53, s12
    s_add_u32 m0, s55, 0xe000
    s_add_u32 s56, s12, 0x10e000
    buffer_load_dwordx4 v4, s[28:31], s56 offen lds
    v_mfma_f32_16x16x32_bf16 v[60:63], v[16:19], v[148:151], v[60:63]
    ds_read_b64_tr_b16 v[36:37], v9 offset:36864
    ds_read_b64_tr_b16 v[38:39], v9 offset:37888
    s_add_u32 m0, s55, 0xe400
    s_add_u32 s56, s12, 0x111600
    buffer_load_dwordx4 v4, s[28:31], s56 offen lds
    v_mfma_f32_16x16x32_bf16 v[64:67], v[20:23], v[144:147], v[64:67]
    ds_read_b64_tr_b16 v[40:41], v10 offset:36864
    ds_read_b64_tr_b16 v[42:43], v10 offset:37888
    v_mfma_f32_16x16x32_bf16 v[68:71], v[20:23], v[148:151], v[68:71]
    ds_read_b64_tr_b16 v[44:45], v11 offset:36864
    ds_read_b64_tr_b16 v[46:47], v11 offset:37888
    v_mfma_f32_16x16x32_bf16 v[72:75], v[24:27], v[144:147], v[72:75]
    ds_read_b64_tr_b16 v[48:49], v12 offset:36864
    ds_read_b64_tr_b16 v[50:51], v12 offset:37888
    v_mfma_f32_16x16x32_bf16 v[76:79], v[24:27], v[148:151], v[76:79]
    v_mfma_f32_16x16x32_bf16 v[80:83], v[28:31], v[144:147], v[80:83]
    v_mfma_f32_16x16x32_bf16 v[84:87], v[28:31], v[148:151], v[84:87]
    s_waitcnt lgkmcnt(0)
    s_waitcnt vmcnt(4)
    s_barrier
    v_mfma_f32_16x16x32_bf16 v[56:59], v[36:39], v[152:155], v[56:59]
    v_add_u32 v7, 0xffff0000, v7
    v_add_u32 v8, 0xffff0000, v8
    ds_read_b128 v[160:163], v7 offset:0
    ds_read_b128 v[164:167], v7 offset:2048
    s_bitcmp1_b32 s20, 6
    s_cselect_b32 s21, 0x500, 0
    s_sub_u32 s21, s52, s21
    s_add_u32 m0, s54, 0x10000
    s_add_u32 s56, s21, 0x300
    buffer_load_dwordx4 v3, s[24:27], s56 offen lds
    v_mfma_f32_16x16x32_bf16 v[60:63], v[36:39], v[156:159], v[60:63]
    v_add_u32 v9, 0xffff0000, v9
    v_add_u32 v10, 0xffff0000, v10
    v_add_u32 v11, 0xffff0000, v11
    v_add_u32 v12, 0xffff0000, v12
    ds_read_b64_tr_b16 v[16:17], v9 offset:0
    ds_read_b64_tr_b16 v[18:19], v9 offset:1024
    s_add_u32 m0, s54, 0x12000
    s_add_u32 s56, s21, 0x14300
    buffer_load_dwordx4 v3, s[24:27], s56 offen lds
    v_mfma_f32_16x16x32_bf16 v[64:67], v[40:43], v[152:155], v[64:67]
    ds_read_b64_tr_b16 v[20:21], v10 offset:0
    ds_read_b64_tr_b16 v[22:23], v10 offset:1024
    v_mfma_f32_16x16x32_bf16 v[68:71], v[40:43], v[156:159], v[68:71]
    ds_read_b64_tr_b16 v[24:25], v11 offset:0
    ds_read_b64_tr_b16 v[26:27], v11 offset:1024
    v_mfma_f32_16x16x32_bf16 v[72:75], v[44:47], v[152:155], v[72:75]
    ds_read_b64_tr_b16 v[28:29], v12 offset:0
    ds_read_b64_tr_b16 v[30:31], v12 offset:1024
    v_mfma_f32_16x16x32_bf16 v[76:79], v[44:47], v[156:159], v[76:79]
    v_mfma_f32_16x16x32_bf16 v[80:83], v[48:51], v[152:155], v[80:83]
    v_mfma_f32_16x16x32_bf16 v[84:87], v[48:51], v[156:159], v[84:87]
    s_waitcnt lgkmcnt(0)
    v_mfma_f32_16x16x32_bf16 v[56:59], v[16:19], v[160:163], v[56:59]
    ds_read_b128 v[168:171], v8 offset:0
    ds_read_b128 v[172:175], v8 offset:2048
    s_bitcmp1_b32 s20, 6
    s_cselect_b32 s12, 0x21c000, 0
    s_sub_u32 s12, s53, s12
    s_add_u32 m0, s55, 0x16000
    s_add_u32 s56, s12, 0x144000
    buffer_load_dwordx4 v4, s[28:31], s56 offen lds
    v_mfma_f32_16x16x32_bf16 v[60:63], v[16:19], v[164:167], v[60:63]
    ds_read_b64_tr_b16 v[36:37], v9 offset:4096
    ds_read_b64_tr_b16 v[38:39], v9 offset:5120
    s_add_u32 m0, s55, 0x16400
    s_add_u32 s56, s12, 0x147600
    buffer_load_dwordx4 v4, s[28:31], s56 offen lds
    v_mfma_f32_16x16x32_bf16 v[64:67], v[20:23], v[160:163], v[64:67]
    ds_read_b64_tr_b16 v[40:41], v10 offset:4096
    ds_read_b64_tr_b16 v[42:43], v10 offset:5120
    v_mfma_f32_16x16x32_bf16 v[68:71], v[20:23], v[164:167], v[68:71]
    ds_read_b64_tr_b16 v[44:45], v11 offset:4096
    ds_read_b64_tr_b16 v[46:47], v11 offset:5120
    v_mfma_f32_16x16x32_bf16 v[72:75], v[24:27], v[160:163], v[72:75]
    ds_read_b64_tr_b16 v[48:49], v12 offset:4096
    ds_read_b64_tr_b16 v[50:51], v12 offset:5120
    v_mfma_f32_16x16x32_bf16 v[76:79], v[24:27], v[164:167], v[76:79]
    v_mfma_f32_16x16x32_bf16 v[80:83], v[28:31], v[160:163], v[80:83]
    v_mfma_f32_16x16x32_bf16 v[84:87], v[28:31], v[164:167], v[84:87]
    s_waitcnt lgkmcnt(0)
    s_waitcnt vmcnt(4)
    s_barrier
    v_mfma_f32_16x16x32_bf16 v[56:59], v[36:39], v[168:171], v[56:59]
    ds_read_b128 v[176:179], v7 offset:32768
    ds_read_b128 v[180:183], v7 offset:34816
    s_bitcmp1_b32 s20, 7
    s_cselect_b32 s21, 0x500, 0
    s_sub_u32 s21, s52, s21
    s_add_u32 m0, s54, 0x18000
    s_add_u32 s56, s21, 0x380
    buffer_load_dwordx4 v3, s[24:27], s56 offen lds
    v_mfma_f32_16x16x32_bf16 v[60:63], v[36:39], v[172:175], v[60:63]
    ds_read_b64_tr_b16 v[16:17], v9 offset:32768
    ds_read_b64_tr_b16 v[18:19], v9 offset:33792
    s_add_u32 m0, s54, 0x1a000
    s_add_u32 s56, s21, 0x14380
    buffer_load_dwordx4 v3, s[24:27], s56 offen lds
    v_mfma_f32_16x16x32_bf16 v[64:67], v[40:43], v[168:171], v[64:67]
    ds_read_b64_tr_b16 v[20:21], v10 offset:32768
    ds_read_b64_tr_b16 v[22:23], v10 offset:33792
    v_mfma_f32_16x16x32_bf16 v[68:71], v[40:43], v[172:175], v[68:71]
    ds_read_b64_tr_b16 v[24:25], v11 offset:32768
    ds_read_b64_tr_b16 v[26:27], v11 offset:33792
    v_mfma_f32_16x16x32_bf16 v[72:75], v[44:47], v[168:171], v[72:75]
    ds_read_b64_tr_b16 v[28:29], v12 offset:32768
    ds_read_b64_tr_b16 v[30:31], v12 offset:33792
    v_mfma_f32_16x16x32_bf16 v[76:79], v[44:47], v[172:175], v[76:79]
    v_mfma_f32_16x16x32_bf16 v[80:83], v[48:51], v[168:171], v[80:83]
    v_mfma_f32_16x16x32_bf16 v[84:87], v[48:51], v[172:175], v[84:87]
    s_waitcnt lgkmcnt(0)
    v_mfma_f32_16x16x32_bf16 v[56:59], v[16:19], v[176:179], v[56:59]
    ds_read_b128 v[184:187], v8 offset:32768
    ds_read_b128 v[188:191], v8 offset:34816
    s_bitcmp1_b32 s20, 7
    s_cselect_b32 s12, 0x21c000, 0
    s_sub_u32 s12, s53, s12
    s_add_u32 m0, s55, 0x1e000
    s_add_u32 s56, s12, 0x17a000
    buffer_load_dwordx4 v4, s[28:31], s56 offen lds
    v_mfma_f32_16x16x32_bf16 v[60:63], v[16:19], v[180:183], v[60:63]
    ds_read_b64_tr_b16 v[36:37], v9 offset:36864
    ds_read_b64_tr_b16 v[38:39], v9 offset:37888
    s_add_u32 m0, s55, 0x1e400
    s_add_u32 s56, s12, 0x17d600
    buffer_load_dwordx4 v4, s[28:31], s56 offen lds
    v_mfma_f32_16x16x32_bf16 v[64:67], v[20:23], v[176:179], v[64:67]
    ds_read_b64_tr_b16 v[40:41], v10 offset:36864
    ds_read_b64_tr_b16 v[42:43], v10 offset:37888
    v_mfma_f32_16x16x32_bf16 v[68:71], v[20:23], v[180:183], v[68:71]
    ds_read_b64_tr_b16 v[44:45], v11 offset:36864
    ds_read_b64_tr_b16 v[46:47], v11 offset:37888
    v_mfma_f32_16x16x32_bf16 v[72:75], v[24:27], v[176:179], v[72:75]
    ds_read_b64_tr_b16 v[48:49], v12 offset:36864
    ds_read_b64_tr_b16 v[50:51], v12 offset:37888
    v_mfma_f32_16x16x32_bf16 v[76:79], v[24:27], v[180:183], v[76:79]
    v_mfma_f32_16x16x32_bf16 v[80:83], v[28:31], v[176:179], v[80:83]
    v_mfma_f32_16x16x32_bf16 v[84:87], v[28:31], v[180:183], v[84:87]
    s_waitcnt lgkmcnt(0)
    s_waitcnt vmcnt(4)
    s_barrier
    v_mfma_f32_16x16x32_bf16 v[56:59], v[36:39], v[184:187], v[56:59]
    v_add_u32 v7, 0x10000, v7
    v_add_u32 v8, 0x10000, v8
    ds_read_b128 v[192:195], v7 offset:0
    ds_read_b128 v[196:199], v7 offset:2048
    s_bitcmp1_b32 s20, 8
    s_cselect_b32 s21, 0x500, 0
    s_sub_u32 s21, s52, s21
    s_add_u32 m0, s54, 0x0
    s_add_u32 s56, s21, 0x400
    buffer_load_dwordx4 v3, s[24:27], s56 offen lds
    v_mfma_f32_16x16x32_bf16 v[60:63], v[36:39], v[188:191], v[60:63]
    v_add_u32 v9, 0x10000, v9
    v_add_u32 v10, 0x10000, v10
    v_add_u32 v11, 0x10000, v11
    v_add_u32 v12, 0x10000, v12
    ds_read_b64_tr_b16 v[16:17], v9 offset:0
    ds_read_b64_tr_b16 v[18:19], v9 offset:1024
    s_add_u32 m0, s54, 0x2000
    s_add_u32 s56, s21, 0x14400
    buffer_load_dwordx4 v3, s[24:27], s56 offen lds
    v_mfma_f32_16x16x32_bf16 v[64:67], v[40:43], v[184:187], v[64:67]
    ds_read_b64_tr_b16 v[20:21], v10 offset:0
    ds_read_b64_tr_b16 v[22:23], v10 offset:1024
    v_mfma_f32_16x16x32_bf16 v[68:71], v[40:43], v[188:191], v[68:71]
    ds_read_b64_tr_b16 v[24:25], v11 offset:0
    ds_read_b64_tr_b16 v[26:27], v11 offset:1024
    v_mfma_f32_16x16x32_bf16 v[72:75], v[44:47], v[184:187], v[72:75]
    ds_read_b64_tr_b16 v[28:29], v12 offset:0
    ds_read_b64_tr_b16 v[30:31], v12 offset:1024
    v_mfma_f32_16x16x32_bf16 v[76:79], v[44:47], v[188:191], v[76:79]
    v_mfma_f32_16x16x32_bf16 v[80:83], v[48:51], v[184:187], v[80:83]
    v_mfma_f32_16x16x32_bf16 v[84:87], v[48:51], v[188:191], v[84:87]
    s_waitcnt lgkmcnt(0)
    v_mfma_f32_16x16x32_bf16 v[56:59], v[16:19], v[192:195], v[56:59]
    ds_read_b128 v[200:203], v8 offset:0
    ds_read_b128 v[204:207], v8 offset:2048
    s_bitcmp1_b32 s20, 8
    s_cselect_b32 s12, 0x21c000, 0
    s_sub_u32 s12, s53, s12
    s_add_u32 m0, s55, 0x6000
    s_add_u32 s56, s12, 0x1b0000
    buffer_load_dwordx4 v4, s[28:31], s56 offen lds
    v_mfma_f32_16x16x32_bf16 v[60:63], v[16:19], v[196:199], v[60:63]
    ds_read_b64_tr_b16 v[36:37], v9 offset:4096
    ds_read_b64_tr_b16 v[38:39], v9 offset:5120
    s_add_u32 m0, s55, 0x6400
    s_add_u32 s56, s12, 0x1b3600
    buffer_load_dwordx4 v4, s[28:31], s56 offen lds
    v_mfma_f32_16x16x32_bf16 v[64:67], v[20:23], v[192:195], v[64:67]
    ds_read_b64_tr_b16 v[40:41], v10 offset:4096
    ds_read_b64_tr_b16 v[42:43], v10 offset:5120
    v_mfma_f32_16x16x32_bf16 v[68:71], v[20:23], v[196:199], v[68:71]
    ds_read_b64_tr_b16 v[44:45], v11 offset:4096
    ds_read_b64_tr_b16 v[46:47], v11 offset:5120
    v_mfma_f32_16x16x32_bf16 v[72:75], v[24:27], v[192:195], v[72:75]
    ds_read_b64_tr_b16 v[48:49], v12 offset:4096
    ds_read_b64_tr_b16 v[50:51], v12 offset:5120
    v_mfma_f32_16x16x32_bf16 v[76:79], v[24:27], v[196:199], v[76:79]
    v_mfma_f32_16x16x32_bf16 v[80:83], v[28:31], v[192:195], v[80:83]
    v_mfma_f32_16x16x32_bf16 v[84:87], v[28:31], v[196:199], v[84:87]
    s_waitcnt lgkmcnt(0)
    s_waitcnt vmcnt(4)
    s_barrier
    v_mfma_f32_16x16x32_bf16 v[56:59], v[36:39], v[200:203], v[56:59]
    ds_read_b128 v[208:211], v7 offset:32768
    ds_read_b128 v[212:215], v7 offset:34816
    s_bitcmp1_b32 s20, 9
    s_cselect_b32 s21, 0x500, 0
    s_sub_u32 s21, s52, s21
    s_add_u32 m0, s54, 0x8000
    s_add_u32 s56, s21, 0x480
    buffer_load_dwordx4 v3, s[24:27], s56 offen lds
    v_mfma_f32_16x16x32_bf16 v[60:63], v[36:39], v[204:207], v[60:63]
    ds_read_b64_tr_b16 v[16:17], v9 offset:32768
    ds_read_b64_tr_b16 v[18:19], v9 offset:33792
    s_add_u32 m0, s54, 0xa000
    s_add_u32 s56, s21, 0x14480
    buffer_load_dwordx4 v3, s[24:27], s56 offen lds
    v_mfma_f32_16x16x32_bf16 v[64:67], v[40:43], v[200:203], v[64:67]
    ds_read_b64_tr_b16 v[20:21], v10 offset:32768
    ds_read_b64_tr_b16 v[22:23], v10 offset:33792
    v_mfma_f32_16x16x32_bf16 v[68:71], v[40:43], v[204:207], v[68:71]
    ds_read_b64_tr_b16 v[24:25], v11 offset:32768
    ds_read_b64_tr_b16 v[26:27], v11 offset:33792
    v_mfma_f32_16x16x32_bf16 v[72:75], v[44:47], v[200:203], v[72:75]
    ds_read_b64_tr_b16 v[28:29], v12 offset:32768
    ds_read_b64_tr_b16 v[30:31], v12 offset:33792
    v_mfma_f32_16x16x32_bf16 v[76:79], v[44:47], v[204:207], v[76:79]
    v_mfma_f32_16x16x32_bf16 v[80:83], v[48:51], v[200:203], v[80:83]
    v_mfma_f32_16x16x32_bf16 v[84:87], v[48:51], v[204:207], v[84:87]
    s_waitcnt lgkmcnt(0)
    v_mfma_f32_16x16x32_bf16 v[56:59], v[16:19], v[208:211], v[56:59]
    ds_read_b128 v[216:219], v8 offset:32768
    ds_read_b128 v[220:223], v8 offset:34816
    s_bitcmp1_b32 s20, 9
    s_cselect_b32 s12, 0x21c000, 0
    s_sub_u32 s12, s53, s12
    s_add_u32 m0, s55, 0xe000
    s_add_u32 s56, s12, 0x1e6000
    buffer_load_dwordx4 v4, s[28:31], s56 offen lds
    v_mfma_f32_16x16x32_bf16 v[60:63], v[16:19], v[212:215], v[60:63]
    ds_read_b64_tr_b16 v[36:37], v9 offset:36864
    ds_read_b64_tr_b16 v[38:39], v9 offset:37888
    s_add_u32 m0, s55, 0xe400
    s_add_u32 s56, s12, 0x1e9600
    buffer_load_dwordx4 v4, s[28:31], s56 offen lds
    v_mfma_f32_16x16x32_bf16 v[64:67], v[20:23], v[208:211], v[64:67]
    ds_read_b64_tr_b16 v[40:41], v10 offset:36864
    ds_read_b64_tr_b16 v[42:43], v10 offset:37888
    s_bitcmp1_b32 s20, 0
    s_cselect_b32 s12, 0x258000, 0
    s_sub_u32 s12, s64, s12
    s_add_u32 m0, s65, 0x10000
    s_add_u32 s56, s12, 0x0
    buffer_load_dwordx4 v88, s[36:39], s56 offen lds
    v_mfma_f32_16x16x32_bf16 v[68:71], v[20:23], v[212:215], v[68:71]
    ds_read_b64_tr_b16 v[44:45], v11 offset:36864
    ds_read_b64_tr_b16 v[46:47], v11 offset:37888
    s_add_u32 m0, s65, 0x10400
    s_add_u32 s56, s12, 0x0
    buffer_load_dwordx4 v89, s[36:39], s56 offen lds
    v_mfma_f32_16x16x32_bf16 v[72:75], v[24:27], v[208:211], v[72:75]
    ds_read_b64_tr_b16 v[48:49], v12 offset:36864
    ds_read_b64_tr_b16 v[50:51], v12 offset:37888
    s_add_u32 m0, s65, 0x10800
    s_add_u32 s56, s12, 0x0
    s_mov_b32 exec_hi, 0
    buffer_load_dwordx4 v90, s[36:39], s56 offen lds
    s_mov_b32 exec_hi, -1
    v_mfma_f32_16x16x32_bf16 v[76:79], v[24:27], v[212:215], v[76:79]
    v_mfma_f32_16x16x32_bf16 v[80:83], v[28:31], v[208:211], v[80:83]
    v_mfma_f32_16x16x32_bf16 v[84:87], v[28:31], v[212:215], v[84:87]
    s_waitcnt lgkmcnt(0)
    s_waitcnt vmcnt(7)
    s_barrier
    v_mfma_f32_16x16x32_bf16 v[56:59], v[36:39], v[216:219], v[56:59]
    v_add_u32 v7, 0xffff0000, v7
    v_add_u32 v8, 0xffff0000, v8
    ds_read_b128 v[224:227], v7 offset:0
    ds_read_b128 v[228:231], v7 offset:2048
    s_bitcmp1_b32 s20, 1
    s_cselect_b32 s12, 0x258000, 0
    s_sub_u32 s12, s64, s12
    s_add_u32 m0, s65, 0x12800
    s_add_u32 s56, s12, 0x3c000
    buffer_load_dwordx4 v88, s[36:39], s56 offen lds
    v_mfma_f32_16x16x32_bf16 v[60:63], v[36:39], v[220:223], v[60:63]
    v_add_u32 v9, 0xffff0000, v9
    v_add_u32 v10, 0xffff0000, v10
    v_add_u32 v11, 0xffff0000, v11
    v_add_u32 v12, 0xffff0000, v12
    ds_read_b64_tr_b16 v[16:17], v9 offset:0
    ds_read_b64_tr_b16 v[18:19], v9 offset:1024
    s_add_u32 m0, s65, 0x12c00
    s_add_u32 s56, s12, 0x3c000
    buffer_load_dwordx4 v89, s[36:39], s56 offen lds
    v_mfma_f32_16x16x32_bf16 v[64:67], v[40:43], v[216:219], v[64:67]
    ds_read_b64_tr_b16 v[20:21], v10 offset:0
    ds_read_b64_tr_b16 v[22:23], v10 offset:1024
    s_add_u32 m0, s65, 0x13000
    s_add_u32 s56, s12, 0x3c000
    s_mov_b32 exec_hi, 0
    buffer_load_dwordx4 v90, s[36:39], s56 offen lds
    s_mov_b32 exec_hi, -1
    v_mfma_f32_16x16x32_bf16 v[68:71], v[40:43], v[220:223], v[68:71]
    ds_read_b64_tr_b16 v[24:25], v11 offset:0
    ds_read_b64_tr_b16 v[26:27], v11 offset:1024
    v_mfma_f32_16x16x32_bf16 v[72:75], v[44:47], v[216:219], v[72:75]
    ds_read_b64_tr_b16 v[28:29], v12 offset:0
    ds_read_b64_tr_b16 v[30:31], v12 offset:1024
    v_mfma_f32_16x16x32_bf16 v[76:79], v[44:47], v[220:223], v[76:79]
    v_mfma_f32_16x16x32_bf16 v[80:83], v[48:51], v[216:219], v[80:83]
    v_mfma_f32_16x16x32_bf16 v[84:87], v[48:51], v[220:223], v[84:87]
    s_waitcnt lgkmcnt(0)
    v_mfma_f32_16x16x32_bf16 v[56:59], v[16:19], v[224:227], v[56:59]
    ds_read_b128 v[232:235], v8 offset:0
    ds_read_b128 v[236:239], v8 offset:2048
    s_bitcmp1_b32 s20, 2
    s_cselect_b32 s12, 0x258000, 0
    s_sub_u32 s12, s64, s12
    s_add_u32 m0, s65, 0x15000
    s_add_u32 s56, s12, 0x78000
    buffer_load_dwordx4 v88, s[36:39], s56 offen lds
    v_mfma_f32_16x16x32_bf16 v[60:63], v[16:19], v[228:231], v[60:63]
    ds_read_b64_tr_b16 v[36:37], v9 offset:4096
    ds_read_b64_tr_b16 v[38:39], v9 offset:5120
    s_add_u32 m0, s65, 0x15400
    s_add_u32 s56, s12, 0x78000
    buffer_load_dwordx4 v89, s[36:39], s56 offen lds
    v_mfma_f32_16x16x32_bf16 v[64:67], v[20:23], v[224:227], v[64:67]
    ds_read_b64_tr_b16 v[40:41], v10 offset:4096
    ds_read_b64_tr_b16 v[42:43], v10 offset:5120
    s_add_u32 m0, s65, 0x15800
    s_add_u32 s56, s12, 0x78000
    s_mov_b32 exec_hi, 0
    buffer_load_dwordx4 v90, s[36:39], s56 offen lds
    s_mov_b32 exec_hi, -1
    v_mfma_f32_16x16x32_bf16 v[68:71], v[20:23], v[228:231], v[68:71]
    ds_read_b64_tr_b16 v[44:45], v11 offset:4096
    ds_read_b64_tr_b16 v[46:47], v11 offset:5120
    v_mfma_f32_16x16x32_bf16 v[72:75], v[24:27], v[224:227], v[72:75]
    ds_read_b64_tr_b16 v[48:49], v12 offset:4096
    ds_read_b64_tr_b16 v[50:51], v12 offset:5120
    v_mfma_f32_16x16x32_bf16 v[76:79], v[24:27], v[228:231], v[76:79]
    v_mfma_f32_16x16x32_bf16 v[80:83], v[28:31], v[224:227], v[80:83]
    v_mfma_f32_16x16x32_bf16 v[84:87], v[28:31], v[228:231], v[84:87]
    s_waitcnt lgkmcnt(0)
    s_waitcnt vmcnt(9)
    s_barrier
    v_mfma_f32_16x16x32_bf16 v[56:59], v[36:39], v[232:235], v[56:59]
    ds_read_b128 v[240:243], v7 offset:32768
    ds_read_b128 v[244:247], v7 offset:34816
    s_bitcmp1_b32 s20, 3
    s_cselect_b32 s12, 0x258000, 0
    s_sub_u32 s12, s64, s12
    s_add_u32 m0, s65, 0x18000
    s_add_u32 s56, s12, 0xb4000
    buffer_load_dwordx4 v88, s[36:39], s56 offen lds
    v_mfma_f32_16x16x32_bf16 v[60:63], v[36:39], v[236:239], v[60:63]
    ds_read_b64_tr_b16 v[16:17], v9 offset:32768
    ds_read_b64_tr_b16 v[18:19], v9 offset:33792
    s_add_u32 m0, s65, 0x18400
    s_add_u32 s56, s12, 0xb4000
    buffer_load_dwordx4 v89, s[36:39], s56 offen lds
    v_mfma_f32_16x16x32_bf16 v[64:67], v[40:43], v[232:235], v[64:67]
    ds_read_b64_tr_b16 v[20:21], v10 offset:32768
    ds_read_b64_tr_b16 v[22:23], v10 offset:33792
    s_add_u32 m0, s65, 0x18800
    s_add_u32 s56, s12, 0xb4000
    s_mov_b32 exec_hi, 0
    buffer_load_dwordx4 v90, s[36:39], s56 offen lds
    s_mov_b32 exec_hi, -1
    v_mfma_f32_16x16x32_bf16 v[68:71], v[40:43], v[236:239], v[68:71]
    ds_read_b64_tr_b16 v[24:25], v11 offset:32768
    ds_read_b64_tr_b16 v[26:27], v11 offset:33792
    v_mfma_f32_16x16x32_bf16 v[72:75], v[44:47], v[232:235], v[72:75]
    ds_read_b64_tr_b16 v[28:29], v12 offset:32768
    ds_read_b64_tr_b16 v[30:31], v12 offset:33792
    v_mfma_f32_16x16x32_bf16 v[76:79], v[44:47], v[236:239], v[76:79]
    v_mfma_f32_16x16x32_bf16 v[80:83], v[48:51], v[232:235], v[80:83]
    v_mfma_f32_16x16x32_bf16 v[84:87], v[48:51], v[236:239], v[84:87]
    s_waitcnt lgkmcnt(0)
    v_mfma_f32_16x16x32_bf16 v[56:59], v[16:19], v[240:243], v[56:59]
    ds_read_b128 v[248:251], v8 offset:32768
    ds_read_b128 v[252:255], v8 offset:34816
    s_bitcmp1_b32 s20, 4
    s_cselect_b32 s12, 0x258000, 0
    s_sub_u32 s12, s64, s12
    s_add_u32 m0, s65, 0x1a800
    s_add_u32 s56, s12, 0xf0000
    buffer_load_dwordx4 v88, s[36:39], s56 offen lds
    v_mfma_f32_16x16x32_bf16 v[60:63], v[16:19], v[244:247], v[60:63]
    ds_read_b64_tr_b16 v[36:37], v9 offset:36864
    ds_read_b64_tr_b16 v[38:39], v9 offset:37888
    s_add_u32 m0, s65, 0x1ac00
    s_add_u32 s56, s12, 0xf0000
    buffer_load_dwordx4 v89, s[36:39], s56 offen lds
    v_mfma_f32_16x16x32_bf16 v[64:67], v[20:23], v[240:243], v[64:67]
    ds_read_b64_tr_b16 v[40:41], v10 offset:36864
    ds_read_b64_tr_b16 v[42:43], v10 offset:37888
    s_add_u32 m0, s65, 0x1b000
    s_add_u32 s56, s12, 0xf0000
    s_mov_b32 exec_hi, 0
    buffer_load_dwordx4 v90, s[36:39], s56 offen lds
    s_mov_b32 exec_hi, -1
    v_mfma_f32_16x16x32_bf16 v[68:71], v[20:23], v[244:247], v[68:71]
    ds_read_b64_tr_b16 v[44:45], v11 offset:36864
    ds_read_b64_tr_b16 v[46:47], v11 offset:37888
    v_mfma_f32_16x16x32_bf16 v[72:75], v[24:27], v[240:243], v[72:75]
    ds_read_b64_tr_b16 v[48:49], v12 offset:36864
    ds_read_b64_tr_b16 v[50:51], v12 offset:37888
    v_mfma_f32_16x16x32_bf16 v[76:79], v[24:27], v[244:247], v[76:79]
    v_mfma_f32_16x16x32_bf16 v[80:83], v[28:31], v[240:243], v[80:83]
    v_mfma_f32_16x16x32_bf16 v[84:87], v[28:31], v[244:247], v[84:87]
    s_waitcnt lgkmcnt(0)
    s_barrier
    v_mfma_f32_16x16x32_bf16 v[56:59], v[36:39], v[248:251], v[56:59]
    s_bitcmp1_b32 s20, 5
    s_cselect_b32 s12, 0x258000, 0
    s_sub_u32 s12, s64, s12
    s_add_u32 m0, s65, 0x1d000
    s_add_u32 s56, s12, 0x12c000
    buffer_load_dwordx4 v88, s[36:39], s56 offen lds
    v_mfma_f32_16x16x32_bf16 v[60:63], v[36:39], v[252:255], v[60:63]
    s_add_u32 m0, s65, 0x1d400
    s_add_u32 s56, s12, 0x12c000
    buffer_load_dwordx4 v89, s[36:39], s56 offen lds
    v_mfma_f32_16x16x32_bf16 v[64:67], v[40:43], v[248:251], v[64:67]
    s_add_u32 m0, s65, 0x1d800
    s_add_u32 s56, s12, 0x12c000
    s_mov_b32 exec_hi, 0
    buffer_load_dwordx4 v90, s[36:39], s56 offen lds
    s_mov_b32 exec_hi, -1
    v_mfma_f32_16x16x32_bf16 v[68:71], v[40:43], v[252:255], v[68:71]
    v_mfma_f32_16x16x32_bf16 v[72:75], v[44:47], v[248:251], v[72:75]
    v_mfma_f32_16x16x32_bf16 v[76:79], v[44:47], v[252:255], v[76:79]
    v_mfma_f32_16x16x32_bf16 v[80:83], v[48:51], v[248:251], v[80:83]
    v_mfma_f32_16x16x32_bf16 v[84:87], v[48:51], v[252:255], v[84:87]
    s_setprio 2
    v_mov_b32 v5, 0x26000
    v_mov_b32 v6, 1
    s_mul_i32 s56, s45, 5120
    v_add_u32 v7, s56, v2
    v_mov_b32 v10, v88
    v_mov_b32 v11, v89
    v_mov_b32 v12, v90
    v_lshrrev_b32 v13, 5, v1
    v_lshlrev_b32 v13, 4, v13
    v_bfe_u32 v14, v1, 2, 3
    v_add_u32 v13, v13, v14
    v_mul_u32_u24 v13, 160, v13
    v_add_u32 v13, 0x0, v13
    v_and_b32 v14, 3, v1
    v_mul_u32_u24 v14, 40, v14
    v_add_u32 v9, v13, v14
    v_cvt_pk_bf16_f32 v16, v56, v57
    v_cvt_pk_bf16_f32 v17, v58, v59
    v_cvt_pk_bf16_f32 v18, v64, v65
    v_cvt_pk_bf16_f32 v19, v66, v67
    ds_write_b128 v7, v[16:19] offset:43008
    v_cvt_pk_bf16_f32 v20, v60, v61
    v_cvt_pk_bf16_f32 v21, v62, v63
    v_cvt_pk_bf16_f32 v22, v68, v69
    v_cvt_pk_bf16_f32 v23, v70, v71
    ds_write_b128 v7, v[20:23] offset:44032
    v_cvt_pk_bf16_f32 v24, v72, v73
    v_cvt_pk_bf16_f32 v25, v74, v75
    v_cvt_pk_bf16_f32 v26, v80, v81
    v_cvt_pk_bf16_f32 v27, v82, v83
    ds_write_b128 v7, v[24:27] offset:45056
    v_cvt_pk_bf16_f32 v28, v76, v77
    v_cvt_pk_bf16_f32 v29, v78, v79
    v_cvt_pk_bf16_f32 v30, v84, v85
    v_cvt_pk_bf16_f32 v31, v86, v87
    ds_write_b128 v7, v[28:31] offset:46080
    s_mov_b64 exec, 1
    ds_add_u32 v5, v6 offset:56
    s_mov_b64 exec, -1
    s_waitcnt vmcnt(12)
    s_mov_b64 exec, 1
    ds_add_u32 v5, v6 offset:4
    s_mov_b64 exec, -1
    s_mov_b32 s60, 160000
LW_33:
    ds_read_b32 v13, v5 offset:4
    s_waitcnt lgkmcnt(0)
    v_readfirstlane_b32 s58, v13
    s_nop 1
    s_cmp_ge_u32 s58, 4
    s_nop 0
    s_cbranch_scc1 LW_33_OK
    s_sub_u32 s60, s60, 1
    s_cmp_lg_u32 s60, 0
    s_cbranch_scc1 LW_33
LW_33_OK:
    v_add_u32 v9, 0x10000, v9
    ds_read_b64_tr_b16 v[16:17], v9 offset:0
    ds_read_b64_tr_b16 v[18:19], v9 offset:1280
    ds_read_b64_tr_b16 v[20:21], v9 offset:8
    ds_read_b64_tr_b16 v[22:23], v9 offset:1288
    ds_read_b64_tr_b16 v[24:25], v9 offset:16
    ds_read_b64_tr_b16 v[26:27], v9 offset:1296
    ds_read_b64_tr_b16 v[28:29], v9 offset:24
    ds_read_b64_tr_b16 v[30:31], v9 offset:1304
    ds_read_b64_tr_b16 v[32:33], v9 offset:32
    ds_read_b64_tr_b16 v[34:35], v9 offset:1312
    s_waitcnt lgkmcnt(8)
    v_mfma_f32_16x16x32_bf16 v[56:59], v[16:19], v[96:99], 0
    ds_read_b64_tr_b16 v[36:37], v9 offset:5120
    s_bitcmp1_b32 s20, 6
    s_cselect_b32 s12, 0x258000, 0
    s_sub_u32 s12, s64, s12
    v_mfma_f32_16x16x32_bf16 v[60:63], v[16:19], v[100:103], 0
    ds_read_b64_tr_b16 v[38:39], v9 offset:6400
    s_add_u32 m0, s65, 0x0
    s_waitcnt lgkmcnt(8)
    v_mfma_f32_16x16x32_bf16 v[64:67], v[20:23], v[96:99], 0
    ds_read_b64_tr_b16 v[40:41], v9 offset:5128
    s_add_u32 s56, s12, 0x168000
    v_mfma_f32_16x16x32_bf16 v[68:71], v[20:23], v[100:103], 0
    ds_read_b64_tr_b16 v[42:43], v9 offset:6408
    buffer_load_dwordx4 v10, s[36:39], s56 offen lds
    s_add_u32 m0, s65, 0x400
    s_waitcnt lgkmcnt(8)
    v_mfma_f32_16x16x32_bf16 v[72:75], v[24:27], v[96:99], 0
    ds_read_b64_tr_b16 v[44:45], v9 offset:5136
    s_add_u32 s56, s12, 0x168000
    v_mfma_f32_16x16x32_bf16 v[76:79], v[24:27], v[100:103], 0
    ds_read_b64_tr_b16 v[46:47], v9 offset:6416
    buffer_load_dwordx4 v11, s[36:39], s56 offen lds
    s_add_u32 m0, s65, 0x800
    s_waitcnt lgkmcnt(8)
    v_mfma_f32_16x16x32_bf16 v[80:83], v[28:31], v[96:99], 0
    ds_read_b64_tr_b16 v[48:49], v9 offset:5144
    s_add_u32 s56, s12, 0x168000
    v_mfma_f32_16x16x32_bf16 v[84:87], v[28:31], v[100:103], 0
    ds_read_b64_tr_b16 v[50:51], v9 offset:6424
    s_waitcnt lgkmcnt(8)
    v_mfma_f32_16x16x32_bf16 v[88:91], v[32:35], v[96:99], 0
    ds_read_b64_tr_b16 v[52:53], v9 offset:5152
    s_mov_b32 exec_hi, 0
    buffer_load_dwordx4 v12, s[36:39], s56 offen lds
    s_mov_b32 exec_hi, -1
    s_bitcmp1_b32 s20, 7
    v_mfma_f32_16x16x32_bf16 v[92:95], v[32:35], v[100:103], 0
    ds_read_b64_tr_b16 v[54:55], v9 offset:6432
    s_cselect_b32 s12, 0x258000, 0
    s_sub_u32 s12, s64, s12
    s_add_u32 m0, s65, 0x2800
    s_add_u32 s56, s12, 0x1a4000
    buffer_load_dwordx4 v10, s[36:39], s56 offen lds
    s_waitcnt lgkmcnt(8)
    v_mfma_f32_16x16x32_bf16 v[56:59], v[36:39], v[104:107], v[56:59]
    ds_read_b64_tr_b16 v[16:17], v9 offset:10240
    s_add_u32 m0, s65, 0x2c00
    s_add_u32 s56, s12, 0x1a4000
    v_mfma_f32_16x16x32_bf16 v[60:63], v[36:39], v[108:111], v[60:63]
    ds_read_b64_tr_b16 v[18:19], v9 offset:11520
    s_waitcnt lgkmcnt(8)
    v_mfma_f32_16x16x32_bf16 v[64:67], v[40:43], v[104:107], v[64:67]
    ds_read_b64_tr_b16 v[20:21], v9 offset:10248
    buffer_load_dwordx4 v11, s[36:39], s56 offen lds
    s_add_u32 m0, s65, 0x3000
    v_mfma_f32_16x16x32_bf16 v[68:71], v[40:43], v[108:111], v[68:71]
    ds_read_b64_tr_b16 v[22:23], v9 offset:11528
    s_add_u32 s56, s12, 0x1a4000
    s_waitcnt lgkmcnt(8)
    v_mfma_f32_16x16x32_bf16 v[72:75], v[44:47], v[104:107], v[72:75]
    ds_read_b64_tr_b16 v[24:25], v9 offset:10256
    v_mfma_f32_16x16x32_bf16 v[76:79], v[44:47], v[108:111], v[76:79]
    ds_read_b64_tr_b16 v[26:27], v9 offset:11536
    s_mov_b32 exec_hi, 0
    buffer_load_dwordx4 v12, s[36:39], s56 offen lds
    s_mov_b32 exec_hi, -1
    s_waitcnt lgkmcnt(8)
    v_mfma_f32_16x16x32_bf16 v[80:83], v[48:51], v[104:107], v[80:83]
    ds_read_b64_tr_b16 v[28:29], v9 offset:10264
    s_bitcmp1_b32 s20, 8
    s_cselect_b32 s12, 0x258000, 0
    v_mfma_f32_16x16x32_bf16 v[84:87], v[48:51], v[108:111], v[84:87]
    ds_read_b64_tr_b16 v[30:31], v9 offset:11544
    s_sub_u32 s12, s64, s12
    s_waitcnt lgkmcnt(8)
    v_mfma_f32_16x16x32_bf16 v[88:91], v[52:55], v[104:107], v[88:91]
    ds_read_b64_tr_b16 v[32:33], v9 offset:10272
    s_add_u32 m0, s65, 0x5000
    s_add_u32 s56, s12, 0x1e0000
    v_mfma_f32_16x16x32_bf16 v[92:95], v[52:55], v[108:111], v[92:95]
    ds_read_b64_tr_b16 v[34:35], v9 offset:11552
    buffer_load_dwordx4 v10, s[36:39], s56 offen lds
    s_add_u32 m0, s65, 0x5400
    s_add_u32 s56, s12, 0x1e0000
    buffer_load_dwordx4 v11, s[36:39], s56 offen lds
    s_waitcnt lgkmcnt(0)
    s_waitcnt vmcnt(14)
    s_mov_b64 exec, 1
    ds_add_u32 v5, v6 offset:84
    s_mov_b64 exec, -1
    v_mfma_f32_16x16x32_bf16 v[56:59], v[16:19], v[112:115], v[56:59]
    ds_read_b64_tr_b16 v[36:37], v9 offset:15360
    s_add_u32 m0, s65, 0x5800
    s_add_u32 s56, s12, 0x1e0000
    v_mfma_f32_16x16x32_bf16 v[60:63], v[16:19], v[116:119], v[60:63]
    ds_read_b64_tr_b16 v[38:39], v9 offset:16640
    v_mfma_f32_16x16x32_bf16 v[64:67], v[20:23], v[112:115], v[64:67]
    ds_read_b64_tr_b16 v[40:41], v9 offset:15368
    s_mov_b32 exec_hi, 0
    buffer_load_dwordx4 v12, s[36:39], s56 offen lds
    s_mov_b32 exec_hi, -1
    v_mfma_f32_16x16x32_bf16 v[68:71], v[20:23], v[116:119], v[68:71]
    ds_read_b64_tr_b16 v[42:43], v9 offset:16648
    s_bitcmp1_b32 s20, 9
    v_mfma_f32_16x16x32_bf16 v[72:75], v[24:27], v[112:115], v[72:75]
    ds_read_b64_tr_b16 v[44:45], v9 offset:15376
    s_cselect_b32 s12, 0x258000, 0
    s_sub_u32 s12, s64, s12
    s_add_u32 m0, s65, 0x8000
    v_mfma_f32_16x16x32_bf16 v[76:79], v[24:27], v[116:119], v[76:79]
    ds_read_b64_tr_b16 v[46:47], v9 offset:16656
    s_add_u32 s56, s12, 0x21c000
    v_mfma_f32_16x16x32_bf16 v[80:83], v[28:31], v[112:115], v[80:83]
    ds_read_b64_tr_b16 v[48:49], v9 offset:15384
    buffer_load_dwordx4 v10, s[36:39], s56 offen lds
    v_mfma_f32_16x16x32_bf16 v[84:87], v[28:31], v[116:119], v[84:87]
    ds_read_b64_tr_b16 v[50:51], v9 offset:16664
    s_add_u32 m0, s65, 0x8400
    s_add_u32 s56, s12, 0x21c000
    v_mfma_f32_16x16x32_bf16 v[88:91], v[32:35], v[112:115], v[88:91]
    ds_read_b64_tr_b16 v[52:53], v9 offset:15392
    buffer_load_dwordx4 v11, s[36:39], s56 offen lds
    v_mfma_f32_16x16x32_bf16 v[92:95], v[32:35], v[116:119], v[92:95]
    ds_read_b64_tr_b16 v[54:55], v9 offset:16672
    s_add_u32 m0, s65, 0x8800
    s_add_u32 s56, s12, 0x21c000
    s_mov_b32 exec_hi, 0
    buffer_load_dwordx4 v12, s[36:39], s56 offen lds
    s_mov_b32 exec_hi, -1
    s_waitcnt lgkmcnt(0)
    s_mov_b32 s60, 160000
LW_34:
    ds_read_b32 v13, v5 offset:84
    s_waitcnt lgkmcnt(0)
    v_readfirstlane_b32 s58, v13
    s_nop 1
    s_cmp_ge_u32 s58, 4
    s_nop 0
    s_cbranch_scc1 LW_34_OK
    s_sub_u32 s60, s60, 1
    s_cmp_lg_u32 s60, 0
    s_cbranch_scc1 LW_34
LW_34_OK:
    v_mfma_f32_16x16x32_bf16 v[56:59], v[36:39], v[120:123], v[56:59]
    ds_read_b64_tr_b16 v[16:17], v9 offset:20480
    v_mfma_f32_16x16x32_bf16 v[60:63], v[36:39], v[124:127], v[60:63]
    ds_read_b64_tr_b16 v[18:19], v9 offset:21760
    v_mfma_f32_16x16x32_bf16 v[64:67], v[40:43], v[120:123], v[64:67]
    ds_read_b64_tr_b16 v[20:21], v9 offset:20488
    v_mfma_f32_16x16x32_bf16 v[68:71], v[40:43], v[124:127], v[68:71]
    ds_read_b64_tr_b16 v[22:23], v9 offset:21768
    v_mfma_f32_16x16x32_bf16 v[72:75], v[44:47], v[120:123], v[72:75]
    ds_read_b64_tr_b16 v[24:25], v9 offset:20496
    v_mfma_f32_16x16x32_bf16 v[76:79], v[44:47], v[124:127], v[76:79]
    ds_read_b64_tr_b16 v[26:27], v9 offset:21776
    v_mfma_f32_16x16x32_bf16 v[80:83], v[48:51], v[120:123], v[80:83]
    ds_read_b64_tr_b16 v[28:29], v9 offset:20504
    v_mfma_f32_16x16x32_bf16 v[84:87], v[48:51], v[124:127], v[84:87]
    ds_read_b64_tr_b16 v[30:31], v9 offset:21784
    v_mfma_f32_16x16x32_bf16 v[88:91], v[52:55], v[120:123], v[88:91]
    ds_read_b64_tr_b16 v[32:33], v9 offset:20512
    v_mfma_f32_16x16x32_bf16 v[92:95], v[52:55], v[124:127], v[92:95]
    ds_read_b64_tr_b16 v[34:35], v9 offset:21792
    s_waitcnt lgkmcnt(8)
    v_mfma_f32_16x16x32_bf16 v[56:59], v[16:19], v[128:131], v[56:59]
    ds_read_b64_tr_b16 v[36:37], v9 offset:25600
    v_mfma_f32_16x16x32_bf16 v[60:63], v[16:19], v[132:135], v[60:63]
    ds_read_b64_tr_b16 v[38:39], v9 offset:26880
    s_waitcnt lgkmcnt(8)
    v_mfma_f32_16x16x32_bf16 v[64:67], v[20:23], v[128:131], v[64:67]
    ds_read_b64_tr_b16 v[40:41], v9 offset:25608
    v_mfma_f32_16x16x32_bf16 v[68:71], v[20:23], v[132:135], v[68:71]
    ds_read_b64_tr_b16 v[42:43], v9 offset:26888
    s_waitcnt lgkmcnt(8)
    v_mfma_f32_16x16x32_bf16 v[72:75], v[24:27], v[128:131], v[72:75]
    ds_read_b64_tr_b16 v[44:45], v9 offset:25616
    v_mfma_f32_16x16x32_bf16 v[76:79], v[24:27], v[132:135], v[76:79]
    ds_read_b64_tr_b16 v[46:47], v9 offset:26896
    s_waitcnt lgkmcnt(8)
    v_mfma_f32_16x16x32_bf16 v[80:83], v[28:31], v[128:131], v[80:83]
    ds_read_b64_tr_b16 v[48:49], v9 offset:25624
    v_mfma_f32_16x16x32_bf16 v[84:87], v[28:31], v[132:135], v[84:87]
    ds_read_b64_tr_b16 v[50:51], v9 offset:26904
    s_waitcnt lgkmcnt(8)
    v_mfma_f32_16x16x32_bf16 v[88:91], v[32:35], v[128:131], v[88:91]
    ds_read_b64_tr_b16 v[52:53], v9 offset:25632
    v_mfma_f32_16x16x32_bf16 v[92:95], v[32:35], v[132:135], v[92:95]
    ds_read_b64_tr_b16 v[54:55], v9 offset:26912
    s_waitcnt lgkmcnt(8)
    v_mfma_f32_16x16x32_bf16 v[56:59], v[36:39], v[136:139], v[56:59]
    ds_read_b64_tr_b16 v[16:17], v9 offset:32768
    v_mfma_f32_16x16x32_bf16 v[60:63], v[36:39], v[140:143], v[60:63]
    ds_read_b64_tr_b16 v[18:19], v9 offset:34048
    s_waitcnt lgkmcnt(8)
    v_mfma_f32_16x16x32_bf16 v[64:67], v[40:43], v[136:139], v[64:67]
    ds_read_b64_tr_b16 v[20:21], v9 offset:32776
    v_mfma_f32_16x16x32_bf16 v[68:71], v[40:43], v[140:143], v[68:71]
    ds_read_b64_tr_b16 v[22:23], v9 offset:34056
    s_waitcnt lgkmcnt(8)
    v_mfma_f32_16x16x32_bf16 v[72:75], v[44:47], v[136:139], v[72:75]
    ds_read_b64_tr_b16 v[24:25], v9 offset:32784
    v_mfma_f32_16x16x32_bf16 v[76:79], v[44:47], v[140:143], v[76:79]
    ds_read_b64_tr_b16 v[26:27], v9 offset:34064
    s_waitcnt lgkmcnt(8)
    v_mfma_f32_16x16x32_bf16 v[80:83], v[48:51], v[136:139], v[80:83]
    ds_read_b64_tr_b16 v[28:29], v9 offset:32792
    v_mfma_f32_16x16x32_bf16 v[84:87], v[48:51], v[140:143], v[84:87]
    ds_read_b64_tr_b16 v[30:31], v9 offset:34072
    s_waitcnt lgkmcnt(8)
    v_mfma_f32_16x16x32_bf16 v[88:91], v[52:55], v[136:139], v[88:91]
    ds_read_b64_tr_b16 v[32:33], v9 offset:32800
    v_mfma_f32_16x16x32_bf16 v[92:95], v[52:55], v[140:143], v[92:95]
    ds_read_b64_tr_b16 v[34:35], v9 offset:34080
    s_waitcnt lgkmcnt(0)
    s_waitcnt vmcnt(12)
    s_mov_b64 exec, 1
    ds_add_u32 v5, v6 offset:60
    s_mov_b64 exec, -1
    v_mfma_f32_16x16x32_bf16 v[56:59], v[16:19], v[144:147], v[56:59]
    ds_read_b64_tr_b16 v[36:37], v9 offset:37888
    v_mfma_f32_16x16x32_bf16 v[60:63], v[16:19], v[148:151], v[60:63]
    ds_read_b64_tr_b16 v[38:39], v9 offset:39168
    v_mfma_f32_16x16x32_bf16 v[64:67], v[20:23], v[144:147], v[64:67]
    ds_read_b64_tr_b16 v[40:41], v9 offset:37896
    v_mfma_f32_16x16x32_bf16 v[68:71], v[20:23], v[148:151], v[68:71]
    ds_read_b64_tr_b16 v[42:43], v9 offset:39176
    v_mfma_f32_16x16x32_bf16 v[72:75], v[24:27], v[144:147], v[72:75]
    ds_read_b64_tr_b16 v[44:45], v9 offset:37904
    v_mfma_f32_16x16x32_bf16 v[76:79], v[24:27], v[148:151], v[76:79]
    ds_read_b64_tr_b16 v[46:47], v9 offset:39184
    v_mfma_f32_16x16x32_bf16 v[80:83], v[28:31], v[144:147], v[80:83]
    ds_read_b64_tr_b16 v[48:49], v9 offset:37912
    v_mfma_f32_16x16x32_bf16 v[84:87], v[28:31], v[148:151], v[84:87]
    ds_read_b64_tr_b16 v[50:51], v9 offset:39192
    v_mfma_f32_16x16x32_bf16 v[88:91], v[32:35], v[144:147], v[88:91]
    ds_read_b64_tr_b16 v[52:53], v9 offset:37920
    v_mfma_f32_16x16x32_bf16 v[92:95], v[32:35], v[148:151], v[92:95]
    ds_read_b64_tr_b16 v[54:55], v9 offset:39200
    s_waitcnt lgkmcnt(0)
    s_mov_b32 s60, 160000
LW_35:
    ds_read_b32 v13, v5 offset:60
    s_waitcnt lgkmcnt(0)
    v_readfirstlane_b32 s58, v13
    s_nop 1
    s_cmp_ge_u32 s58, 4
    s_nop 0
    s_cbranch_scc1 LW_35_OK
    s_sub_u32 s60, s60, 1
    s_cmp_lg_u32 s60, 0
    s_cbranch_scc1 LW_35
LW_35_OK:
    v_mfma_f32_16x16x32_bf16 v[56:59], v[36:39], v[152:155], v[56:59]
    ds_read_b64_tr_b16 v[16:17], v9 offset:43008
    v_mfma_f32_16x16x32_bf16 v[60:63], v[36:39], v[156:159], v[60:63]
    ds_read_b64_tr_b16 v[18:19], v9 offset:44288
    v_mfma_f32_16x16x32_bf16 v[64:67], v[40:43], v[152:155], v[64:67]
    ds_read_b64_tr_b16 v[20:21], v9 offset:43016
    v_mfma_f32_16x16x32_bf16 v[68:71], v[40:43], v[156:159], v[68:71]
    ds_read_b64_tr_b16 v[22:23], v9 offset:44296
    v_mfma_f32_16x16x32_bf16 v[72:75], v[44:47], v[152:155], v[72:75]
    ds_read_b64_tr_b16 v[24:25], v9 offset:43024
    v_mfma_f32_16x16x32_bf16 v[76:79], v[44:47], v[156:159], v[76:79]
    ds_read_b64_tr_b16 v[26:27], v9 offset:44304
    v_mfma_f32_16x16x32_bf16 v[80:83], v[48:51], v[152:155], v[80:83]
    ds_read_b64_tr_b16 v[28:29], v9 offset:43032
    v_mfma_f32_16x16x32_bf16 v[84:87], v[48:51], v[156:159], v[84:87]
    ds_read_b64_tr_b16 v[30:31], v9 offset:44312
    v_mfma_f32_16x16x32_bf16 v[88:91], v[52:55], v[152:155], v[88:91]
    ds_read_b64_tr_b16 v[32:33], v9 offset:43040
    v_mfma_f32_16x16x32_bf16 v[92:95], v[52:55], v[156:159], v[92:95]
    ds_read_b64_tr_b16 v[34:35], v9 offset:44320
    v_and_b32 v14, 3, v1
    v_lshrrev_b32 v15, 4, v1
    v_cmp_eq_u32 vcc, v14, v15
    v_mul_u32_u24 v14, 800, v14
    v_bfe_u32 v15, v1, 2, 2
    v_mul_u32_u24 v15, 40, v15
    v_add_u32 v14, v14, v15
    v_add_u32 v14, 0x26400, v14
    v_mov_b32 v15, 0x27400
    v_cndmask_b32 v0, v15, v14, vcc
    s_waitcnt lgkmcnt(8)
    v_mfma_f32_16x16x32_bf16 v[56:59], v[16:19], v[160:163], v[56:59]
    ds_read_b64_tr_b16 v[36:37], v9 offset:48128
    s_lshr_b32 s70, s45, 1
    v_mfma_f32_16x16x32_bf16 v[60:63], v[16:19], v[164:167], v[60:63]
    ds_read_b64_tr_b16 v[38:39], v9 offset:49408
    s_waitcnt lgkmcnt(8)
    v_mfma_f32_16x16x32_bf16 v[64:67], v[20:23], v[160:163], v[64:67]
    ds_read_b64_tr_b16 v[40:41], v9 offset:48136
    s_lshl1_add_u32 s70, s46, s70
    v_mfma_f32_16x16x32_bf16 v[68:71], v[20:23], v[164:167], v[68:71]
    ds_read_b64_tr_b16 v[42:43], v9 offset:49416
    s_waitcnt lgkmcnt(8)
    v_mfma_f32_16x16x32_bf16 v[72:75], v[24:27], v[160:163], v[72:75]
    ds_read_b64_tr_b16 v[44:45], v9 offset:48144
    s_lshl_b32 s70, s70, 9
    v_mfma_f32_16x16x32_bf16 v[76:79], v[24:27], v[164:167], v[76:79]
    ds_read_b64_tr_b16 v[46:47], v9 offset:49424
    s_waitcnt lgkmcnt(8)
    v_mfma_f32_16x16x32_bf16 v[80:83], v[28:31], v[160:163], v[80:83]
    ds_read_b64_tr_b16 v[48:49], v9 offset:48152
    s_and_b32 s77, s45, 1
    v_mfma_f32_16x16x32_bf16 v[84:87], v[28:31], v[164:167], v[84:87]
    ds_read_b64_tr_b16 v[50:51], v9 offset:49432
    s_waitcnt lgkmcnt(8)
    v_mfma_f32_16x16x32_bf16 v[88:91], v[32:35], v[160:163], v[88:91]
    ds_read_b64_tr_b16 v[52:53], v9 offset:48160
    s_lshl_b32 s77, s77, 5
    v_mfma_f32_16x16x32_bf16 v[92:95], v[32:35], v[164:167], v[92:95]
    ds_read_b64_tr_b16 v[54:55], v9 offset:49440
    s_add_u32 s70, s70, s77
    s_add_u32 s70, s70, 0xd29140
    v_and_b32 v7, 15, v1
    v_lshlrev_b32 v7, 2, v7
    s_waitcnt lgkmcnt(8)
    v_mfma_f32_16x16x32_bf16 v[56:59], v[36:39], v[168:171], v[56:59]
    ds_read_b64_tr_b16 v[16:17], v9 offset:53248
    v_mfma_f32_16x16x32_bf16 v[60:63], v[36:39], v[172:175], v[60:63]
    ds_read_b64_tr_b16 v[18:19], v9 offset:54528
    s_waitcnt lgkmcnt(8)
    v_mfma_f32_16x16x32_bf16 v[64:67], v[40:43], v[168:171], v[64:67]
    ds_read_b64_tr_b16 v[20:21], v9 offset:53256
    v_mfma_f32_16x16x32_bf16 v[68:71], v[40:43], v[172:175], v[68:71]
    ds_read_b64_tr_b16 v[22:23], v9 offset:54536
    s_waitcnt lgkmcnt(8)
    v_mfma_f32_16x16x32_bf16 v[72:75], v[44:47], v[168:171], v[72:75]
    ds_read_b64_tr_b16 v[24:25], v9 offset:53264
    v_mfma_f32_16x16x32_bf16 v[76:79], v[44:47], v[172:175], v[76:79]
    ds_read_b64_tr_b16 v[26:27], v9 offset:54544
    s_waitcnt lgkmcnt(8)
    v_mfma_f32_16x16x32_bf16 v[80:83], v[48:51], v[168:171], v[80:83]
    ds_read_b64_tr_b16 v[28:29], v9 offset:53272
    v_mfma_f32_16x16x32_bf16 v[84:87], v[48:51], v[172:175], v[84:87]
    ds_read_b64_tr_b16 v[30:31], v9 offset:54552
    s_waitcnt lgkmcnt(8)
    v_mfma_f32_16x16x32_bf16 v[88:91], v[52:55], v[168:171], v[88:91]
    ds_read_b64_tr_b16 v[32:33], v9 offset:53280
    v_mfma_f32_16x16x32_bf16 v[92:95], v[52:55], v[172:175], v[92:95]
    ds_read_b64_tr_b16 v[34:35], v9 offset:54560
    ds_read_b64_tr_b16 v[96:97], v0 offset:0
    ds_read_b64_tr_b16 v[98:99], v0 offset:160
    ds_read_b64_tr_b16 v[100:101], v0 offset:320
    s_waitcnt lgkmcnt(3)
    s_waitcnt vmcnt(6)
    s_mov_b64 exec, 1
    ds_add_u32 v5, v6 offset:64
    s_mov_b64 exec, -1
    v_mfma_f32_16x16x32_bf16 v[56:59], v[16:19], v[176:179], v[56:59]
    ds_read_b64_tr_b16 v[36:37], v9 offset:58368
    v_mfma_f32_16x16x32_bf16 v[60:63], v[16:19], v[180:183], v[60:63]
    ds_read_b64_tr_b16 v[38:39], v9 offset:59648
    v_mfma_f32_16x16x32_bf16 v[64:67], v[20:23], v[176:179], v[64:67]
    ds_read_b64_tr_b16 v[40:41], v9 offset:58376
    v_mfma_f32_16x16x32_bf16 v[68:71], v[20:23], v[180:183], v[68:71]
    ds_read_b64_tr_b16 v[42:43], v9 offset:59656
    v_mfma_f32_16x16x32_bf16 v[72:75], v[24:27], v[176:179], v[72:75]
    ds_read_b64_tr_b16 v[44:45], v9 offset:58384
    v_mfma_f32_16x16x32_bf16 v[76:79], v[24:27], v[180:183], v[76:79]
    ds_read_b64_tr_b16 v[46:47], v9 offset:59664
    v_mfma_f32_16x16x32_bf16 v[80:83], v[28:31], v[176:179], v[80:83]
    ds_read_b64_tr_b16 v[48:49], v9 offset:58392
    v_mfma_f32_16x16x32_bf16 v[84:87], v[28:31], v[180:183], v[84:87]
    ds_read_b64_tr_b16 v[50:51], v9 offset:59672
    v_mfma_f32_16x16x32_bf16 v[88:91], v[32:35], v[176:179], v[88:91]
    ds_read_b64_tr_b16 v[52:53], v9 offset:58400
    v_mfma_f32_16x16x32_bf16 v[92:95], v[32:35], v[180:183], v[92:95]
    ds_read_b64_tr_b16 v[54:55], v9 offset:59680
    ds_read_b64_tr_b16 v[102:103], v0 offset:480
    ds_read_b64_tr_b16 v[104:105], v0 offset:640
    v_mov_b32 v106, 0
    v_mov_b32 v107, 0
    s_waitcnt lgkmcnt(2)
    s_mov_b32 s60, 160000
LW_36:
    ds_read_b32 v13, v5 offset:64
    s_waitcnt lgkmcnt(0)
    v_readfirstlane_b32 s58, v13
    s_nop 1
    s_cmp_ge_u32 s58, 4
    s_nop 0
    s_cbranch_scc1 LW_36_OK
    s_sub_u32 s60, s60, 1
    s_cmp_lg_u32 s60, 0
    s_cbranch_scc1 LW_36
LW_36_OK:
    v_mfma_f32_16x16x32_bf16 v[56:59], v[36:39], v[184:187], v[56:59]
    v_add_u32 v9, 0xffff0000, v9
    ds_read_b64_tr_b16 v[16:17], v9 offset:0
    v_mfma_f32_16x16x32_bf16 v[60:63], v[36:39], v[188:191], v[60:63]
    ds_read_b64_tr_b16 v[18:19], v9 offset:1280
    v_mfma_f32_16x16x32_bf16 v[64:67], v[40:43], v[184:187], v[64:67]
    ds_read_b64_tr_b16 v[20:21], v9 offset:8
    v_mfma_f32_16x16x32_bf16 v[68:71], v[40:43], v[188:191], v[68:71]
    ds_read_b64_tr_b16 v[22:23], v9 offset:1288
    v_mfma_f32_16x16x32_bf16 v[72:75], v[44:47], v[184:187], v[72:75]
    ds_read_b64_tr_b16 v[24:25], v9 offset:16
    v_mfma_f32_16x16x32_bf16 v[76:79], v[44:47], v[188:191], v[76:79]
    ds_read_b64_tr_b16 v[26:27], v9 offset:1296
    v_mfma_f32_16x16x32_bf16 v[80:83], v[48:51], v[184:187], v[80:83]
    ds_read_b64_tr_b16 v[28:29], v9 offset:24
    v_mfma_f32_16x16x32_bf16 v[84:87], v[48:51], v[188:191], v[84:87]
    ds_read_b64_tr_b16 v[30:31], v9 offset:1304
    v_mfma_f32_16x16x32_bf16 v[88:91], v[52:55], v[184:187], v[88:91]
    ds_read_b64_tr_b16 v[32:33], v9 offset:32
    v_mfma_f32_16x16x32_bf16 v[92:95], v[52:55], v[188:191], v[92:95]
    ds_read_b64_tr_b16 v[34:35], v9 offset:1312
    ds_read_b64_tr_b16 v[108:109], v0 offset:8
    ds_read_b64_tr_b16 v[110:111], v0 offset:168
    ds_read_b64_tr_b16 v[112:113], v0 offset:328
    s_waitcnt lgkmcnt(11)
    v_mfma_f32_16x16x32_bf16 v[56:59], v[16:19], v[192:195], v[56:59]
    ds_read_b64_tr_b16 v[36:37], v9 offset:5120
    v_mfma_f32_16x16x32_bf16 v[60:63], v[16:19], v[196:199], v[60:63]
    ds_read_b64_tr_b16 v[38:39], v9 offset:6400
    s_waitcnt lgkmcnt(11)
    v_mfma_f32_16x16x32_bf16 v[64:67], v[20:23], v[192:195], v[64:67]
    ds_read_b64_tr_b16 v[40:41], v9 offset:5128
    v_mfma_f32_16x16x32_bf16 v[68:71], v[20:23], v[196:199], v[68:71]
    ds_read_b64_tr_b16 v[42:43], v9 offset:6408
    s_waitcnt lgkmcnt(11)
    v_mfma_f32_16x16x32_bf16 v[72:75], v[24:27], v[192:195], v[72:75]
    ds_read_b64_tr_b16 v[44:45], v9 offset:5136
    v_mfma_f32_16x16x32_bf16 v[76:79], v[24:27], v[196:199], v[76:79]
    ds_read_b64_tr_b16 v[46:47], v9 offset:6416
    s_waitcnt lgkmcnt(11)
    v_mfma_f32_16x16x32_bf16 v[80:83], v[28:31], v[192:195], v[80:83]
    ds_read_b64_tr_b16 v[48:49], v9 offset:5144
    v_mfma_f32_16x16x32_bf16 v[84:87], v[28:31], v[196:199], v[84:87]
    ds_read_b64_tr_b16 v[50:51], v9 offset:6424
    s_waitcnt lgkmcnt(11)
    v_mfma_f32_16x16x32_bf16 v[88:91], v[32:35], v[192:195], v[88:91]
    ds_read_b64_tr_b16 v[52:53], v9 offset:5152
    v_mfma_f32_16x16x32_bf16 v[92:95], v[32:35], v[196:199], v[92:95]
    ds_read_b64_tr_b16 v[54:55], v9 offset:6432
    ds_read_b64_tr_b16 v[114:115], v0 offset:488
    ds_read_b64_tr_b16 v[116:117], v0 offset:648
    v_mov_b32 v118, 0
    v_mov_b32 v119, 0
    s_waitcnt lgkmcnt(10)
    v_mfma_f32_16x16x32_bf16 v[56:59], v[36:39], v[200:203], v[56:59]
    ds_read_b64_tr_b16 v[16:17], v9 offset:10240
    v_mfma_f32_16x16x32_bf16 v[60:63], v[36:39], v[204:207], v[60:63]
    ds_read_b64_tr_b16 v[18:19], v9 offset:11520
    s_waitcnt lgkmcnt(10)
    v_mfma_f32_16x16x32_bf16 v[64:67], v[40:43], v[200:203], v[64:67]
    ds_read_b64_tr_b16 v[20:21], v9 offset:10248
    v_mfma_f32_16x16x32_bf16 v[68:71], v[40:43], v[204:207], v[68:71]
    ds_read_b64_tr_b16 v[22:23], v9 offset:11528
    s_waitcnt lgkmcnt(10)
    v_mfma_f32_16x16x32_bf16 v[72:75], v[44:47], v[200:203], v[72:75]
    ds_read_b64_tr_b16 v[24:25], v9 offset:10256
    v_mfma_f32_16x16x32_bf16 v[76:79], v[44:47], v[204:207], v[76:79]
    ds_read_b64_tr_b16 v[26:27], v9 offset:11536
    s_waitcnt lgkmcnt(10)
    v_mfma_f32_16x16x32_bf16 v[80:83], v[48:51], v[200:203], v[80:83]
    ds_read_b64_tr_b16 v[28:29], v9 offset:10264
    v_mfma_f32_16x16x32_bf16 v[84:87], v[48:51], v[204:207], v[84:87]
    ds_read_b64_tr_b16 v[30:31], v9 offset:11544
    s_waitcnt lgkmcnt(10)
    v_mfma_f32_16x16x32_bf16 v[88:91], v[52:55], v[200:203], v[88:91]
    ds_read_b64_tr_b16 v[32:33], v9 offset:10272
    v_mfma_f32_16x16x32_bf16 v[92:95], v[52:55], v[204:207], v[92:95]
    ds_read_b64_tr_b16 v[34:35], v9 offset:11552
    ds_read_b64_tr_b16 v[120:121], v0 offset:16
    ds_read_b64_tr_b16 v[122:123], v0 offset:176
    ds_read_b64_tr_b16 v[124:125], v0 offset:336
    s_waitcnt lgkmcnt(3)
    s_waitcnt vmcnt(0)
    s_mov_b64 exec, 1
    ds_add_u32 v5, v6 offset:88
    s_mov_b64 exec, -1
    v_mfma_f32_16x16x32_bf16 v[56:59], v[16:19], v[208:211], v[56:59]
    ds_read_b64_tr_b16 v[36:37], v9 offset:15360
    v_mfma_f32_16x16x32_bf16 v[60:63], v[16:19], v[212:215], v[60:63]
    ds_read_b64_tr_b16 v[38:39], v9 offset:16640
    v_mfma_f32_16x16x32_bf16 v[64:67], v[20:23], v[208:211], v[64:67]
    ds_read_b64_tr_b16 v[40:41], v9 offset:15368
    v_mfma_f32_16x16x32_bf16 v[68:71], v[20:23], v[212:215], v[68:71]
    ds_read_b64_tr_b16 v[42:43], v9 offset:16648
    v_mfma_f32_16x16x32_bf16 v[72:75], v[24:27], v[208:211], v[72:75]
    ds_read_b64_tr_b16 v[44:45], v9 offset:15376
    v_mfma_f32_16x16x32_bf16 v[76:79], v[24:27], v[212:215], v[76:79]
    ds_read_b64_tr_b16 v[46:47], v9 offset:16656
    v_mfma_f32_16x16x32_bf16 v[80:83], v[28:31], v[208:211], v[80:83]
    ds_read_b64_tr_b16 v[48:49], v9 offset:15384
    v_mfma_f32_16x16x32_bf16 v[84:87], v[28:31], v[212:215], v[84:87]
    ds_read_b64_tr_b16 v[50:51], v9 offset:16664
    v_mfma_f32_16x16x32_bf16 v[88:91], v[32:35], v[208:211], v[88:91]
    ds_read_b64_tr_b16 v[52:53], v9 offset:15392
    v_mfma_f32_16x16x32_bf16 v[92:95], v[32:35], v[212:215], v[92:95]
    ds_read_b64_tr_b16 v[54:55], v9 offset:16672
    ds_read_b64_tr_b16 v[126:127], v0 offset:496
    ds_read_b64_tr_b16 v[128:129], v0 offset:656
    v_mov_b32 v130, 0
    v_mov_b32 v131, 0
    s_waitcnt lgkmcnt(2)
    s_mov_b32 s60, 160000
LW_37:
    ds_read_b32 v13, v5 offset:88
    s_waitcnt lgkmcnt(0)
    v_readfirstlane_b32 s58, v13
    s_nop 1
    s_cmp_ge_u32 s58, 4
    s_nop 0
    s_cbranch_scc1 LW_37_OK
    s_sub_u32 s60, s60, 1
    s_cmp_lg_u32 s60, 0
    s_cbranch_scc1 LW_37
LW_37_OK:
    v_mfma_f32_16x16x32_bf16 v[56:59], v[36:39], v[216:219], v[56:59]
    ds_read_b64_tr_b16 v[16:17], v9 offset:20480
    v_mfma_f32_16x16x32_bf16 v[60:63], v[36:39], v[220:223], v[60:63]
    ds_read_b64_tr_b16 v[18:19], v9 offset:21760
    v_mfma_f32_16x16x32_bf16 v[64:67], v[40:43], v[216:219], v[64:67]
    ds_read_b64_tr_b16 v[20:21], v9 offset:20488
    v_mfma_f32_16x16x32_bf16 v[68:71], v[40:43], v[220:223], v[68:71]
    ds_read_b64_tr_b16 v[22:23], v9 offset:21768
    v_mfma_f32_16x16x32_bf16 v[72:75], v[44:47], v[216:219], v[72:75]
    ds_read_b64_tr_b16 v[24:25], v9 offset:20496
    v_mfma_f32_16x16x32_bf16 v[76:79], v[44:47], v[220:223], v[76:79]
    ds_read_b64_tr_b16 v[26:27], v9 offset:21776
    v_mfma_f32_16x16x32_bf16 v[80:83], v[48:51], v[216:219], v[80:83]
    ds_read_b64_tr_b16 v[28:29], v9 offset:20504
    v_mfma_f32_16x16x32_bf16 v[84:87], v[48:51], v[220:223], v[84:87]
    ds_read_b64_tr_b16 v[30:31], v9 offset:21784
    v_mfma_f32_16x16x32_bf16 v[88:91], v[52:55], v[216:219], v[88:91]
    ds_read_b64_tr_b16 v[32:33], v9 offset:20512
    v_mfma_f32_16x16x32_bf16 v[92:95], v[52:55], v[220:223], v[92:95]
    ds_read_b64_tr_b16 v[34:35], v9 offset:21792
    ds_read_b64_tr_b16 v[132:133], v0 offset:24
    ds_read_b64_tr_b16 v[134:135], v0 offset:184
    ds_read_b64_tr_b16 v[136:137], v0 offset:344
    s_waitcnt lgkmcnt(11)
    v_mfma_f32_16x16x32_bf16 v[56:59], v[16:19], v[224:227], v[56:59]
    ds_read_b64_tr_b16 v[36:37], v9 offset:25600
    v_mfma_f32_16x16x32_bf16 v[60:63], v[16:19], v[228:231], v[60:63]
    ds_read_b64_tr_b16 v[38:39], v9 offset:26880
    s_waitcnt lgkmcnt(11)
    v_mfma_f32_16x16x32_bf16 v[64:67], v[20:23], v[224:227], v[64:67]
    ds_read_b64_tr_b16 v[40:41], v9 offset:25608
    v_mfma_f32_16x16x32_bf16 v[68:71], v[20:23], v[228:231], v[68:71]
    ds_read_b64_tr_b16 v[42:43], v9 offset:26888
    s_waitcnt lgkmcnt(11)
    v_mfma_f32_16x16x32_bf16 v[72:75], v[24:27], v[224:227], v[72:75]
    ds_read_b64_tr_b16 v[44:45], v9 offset:25616
    v_mfma_f32_16x16x32_bf16 v[76:79], v[24:27], v[228:231], v[76:79]
    ds_read_b64_tr_b16 v[46:47], v9 offset:26896
    s_waitcnt lgkmcnt(11)
    v_mfma_f32_16x16x32_bf16 v[80:83], v[28:31], v[224:227], v[80:83]
    ds_read_b64_tr_b16 v[48:49], v9 offset:25624
    v_mfma_f32_16x16x32_bf16 v[84:87], v[28:31], v[228:231], v[84:87]
    ds_read_b64_tr_b16 v[50:51], v9 offset:26904
    s_waitcnt lgkmcnt(11)
    v_mfma_f32_16x16x32_bf16 v[88:91], v[32:35], v[224:227], v[88:91]
    ds_read_b64_tr_b16 v[52:53], v9 offset:25632
    v_mfma_f32_16x16x32_bf16 v[92:95], v[32:35], v[228:231], v[92:95]
    ds_read_b64_tr_b16 v[54:55], v9 offset:26912
    ds_read_b64_tr_b16 v[138:139], v0 offset:504
    ds_read_b64_tr_b16 v[140:141], v0 offset:664
    v_mov_b32 v142, 0
    v_mov_b32 v143, 0
    s_waitcnt lgkmcnt(10)
    v_mfma_f32_16x16x32_bf16 v[56:59], v[36:39], v[232:235], v[56:59]
    ds_read_b64_tr_b16 v[16:17], v9 offset:32768
    v_mfma_f32_16x16x32_bf16 v[60:63], v[36:39], v[236:239], v[60:63]
    ds_read_b64_tr_b16 v[18:19], v9 offset:34048
    s_waitcnt lgkmcnt(10)
    v_mfma_f32_16x16x32_bf16 v[64:67], v[40:43], v[232:235], v[64:67]
    ds_read_b64_tr_b16 v[20:21], v9 offset:32776
    v_mfma_f32_16x16x32_bf16 v[68:71], v[40:43], v[236:239], v[68:71]
    ds_read_b64_tr_b16 v[22:23], v9 offset:34056
    s_waitcnt lgkmcnt(10)
    v_mfma_f32_16x16x32_bf16 v[72:75], v[44:47], v[232:235], v[72:75]
    ds_read_b64_tr_b16 v[24:25], v9 offset:32784
    v_mfma_f32_16x16x32_bf16 v[76:79], v[44:47], v[236:239], v[76:79]
    ds_read_b64_tr_b16 v[26:27], v9 offset:34064
    s_waitcnt lgkmcnt(10)
    v_mfma_f32_16x16x32_bf16 v[80:83], v[48:51], v[232:235], v[80:83]
    ds_read_b64_tr_b16 v[28:29], v9 offset:32792
    v_mfma_f32_16x16x32_bf16 v[84:87], v[48:51], v[236:239], v[84:87]
    ds_read_b64_tr_b16 v[30:31], v9 offset:34072
    s_waitcnt lgkmcnt(10)
    v_mfma_f32_16x16x32_bf16 v[88:91], v[52:55], v[232:235], v[88:91]
    ds_read_b64_tr_b16 v[32:33], v9 offset:32800
    v_mfma_f32_16x16x32_bf16 v[92:95], v[52:55], v[236:239], v[92:95]
    ds_read_b64_tr_b16 v[34:35], v9 offset:34080
    ds_read_b64_tr_b16 v[144:145], v0 offset:32
    ds_read_b64_tr_b16 v[146:147], v0 offset:192
    ds_read_b64_tr_b16 v[148:149], v0 offset:352
    s_waitcnt lgkmcnt(11)
    v_mfma_f32_16x16x32_bf16 v[56:59], v[16:19], v[240:243], v[56:59]
    ds_read_b64_tr_b16 v[36:37], v9 offset:37888
    v_mfma_f32_16x16x32_bf16 v[60:63], v[16:19], v[244:247], v[60:63]
    ds_read_b64_tr_b16 v[38:39], v9 offset:39168
    s_waitcnt lgkmcnt(11)
    v_mfma_f32_16x16x32_bf16 v[64:67], v[20:23], v[240:243], v[64:67]
    ds_read_b64_tr_b16 v[40:41], v9 offset:37896
    v_mfma_f32_16x16x32_bf16 v[68:71], v[20:23], v[244:247], v[68:71]
    ds_read_b64_tr_b16 v[42:43], v9 offset:39176
    s_waitcnt lgkmcnt(11)
    v_mfma_f32_16x16x32_bf16 v[72:75], v[24:27], v[240:243], v[72:75]
    ds_read_b64_tr_b16 v[44:45], v9 offset:37904
    v_mfma_f32_16x16x32_bf16 v[76:79], v[24:27], v[244:247], v[76:79]
    ds_read_b64_tr_b16 v[46:47], v9 offset:39184
    s_waitcnt lgkmcnt(11)
    v_mfma_f32_16x16x32_bf16 v[80:83], v[28:31], v[240:243], v[80:83]
    ds_read_b64_tr_b16 v[48:49], v9 offset:37912
    v_mfma_f32_16x16x32_bf16 v[84:87], v[28:31], v[244:247], v[84:87]
    ds_read_b64_tr_b16 v[50:51], v9 offset:39192
    s_waitcnt lgkmcnt(11)
    v_mfma_f32_16x16x32_bf16 v[88:91], v[32:35], v[240:243], v[88:91]
    ds_read_b64_tr_b16 v[52:53], v9 offset:37920
    v_mfma_f32_16x16x32_bf16 v[92:95], v[32:35], v[244:247], v[92:95]
    ds_read_b64_tr_b16 v[54:55], v9 offset:39200
    ds_read_b64_tr_b16 v[150:151], v0 offset:512
    ds_read_b64_tr_b16 v[152:153], v0 offset:672
    v_mov_b32 v154, 0
    v_mov_b32 v155, 0
    s_waitcnt lgkmcnt(2)
    s_mov_b64 exec, 1
    ds_add_u32 v5, v6 offset:52
    s_mov_b64 exec, -1
    v_mfma_f32_16x16x32_bf16 v[56:59], v[36:39], v[248:251], v[56:59]
    v_mfma_f32_16x16x32_bf16 v[60:63], v[36:39], v[252:255], v[60:63]
    v_mfma_f32_16x16x32_bf16 v[64:67], v[40:43], v[248:251], v[64:67]
    v_mfma_f32_16x16x32_bf16 v[68:71], v[40:43], v[252:255], v[68:71]
    v_mfma_f32_16x16x32_bf16 v[72:75], v[44:47], v[248:251], v[72:75]
    v_mfma_f32_16x16x32_bf16 v[76:79], v[44:47], v[252:255], v[76:79]
    v_mfma_f32_16x16x32_bf16 v[80:83], v[48:51], v[248:251], v[80:83]
    v_mfma_f32_16x16x32_bf16 v[84:87], v[48:51], v[252:255], v[84:87]
    v_mfma_f32_16x16x32_bf16 v[88:91], v[52:55], v[248:251], v[88:91]
    v_mfma_f32_16x16x32_bf16 v[92:95], v[52:55], v[252:255], v[92:95]
    v_cvt_pk_bf16_f32 v16, v56, v57
    v_cvt_pk_bf16_f32 v17, v58, v59
    v_cvt_pk_bf16_f32 v18, v64, v65
    v_cvt_pk_bf16_f32 v19, v66, v67
    v_cvt_pk_bf16_f32 v20, v72, v73
    v_cvt_pk_bf16_f32 v21, v74, v75
    v_cvt_pk_bf16_f32 v22, v80, v81
    v_cvt_pk_bf16_f32 v23, v82, v83
    v_cvt_pk_bf16_f32 v24, v88, v89
    v_cvt_pk_bf16_f32 v25, v90, v91
    v_mov_b32 v26, 0
    v_mov_b32 v27, 0
    v_cvt_pk_bf16_f32 v28, v60, v61
    v_cvt_pk_bf16_f32 v29, v62, v63
    v_cvt_pk_bf16_f32 v30, v68, v69
    v_cvt_pk_bf16_f32 v31, v70, v71
    v_cvt_pk_bf16_f32 v32, v76, v77
    v_cvt_pk_bf16_f32 v33, v78, v79
    v_cvt_pk_bf16_f32 v34, v84, v85
    v_cvt_pk_bf16_f32 v35, v86, v87
    v_cvt_pk_bf16_f32 v36, v92, v93
    v_cvt_pk_bf16_f32 v37, v94, v95
    v_mov_b32 v38, 0
    v_mov_b32 v39, 0
    s_waitcnt lgkmcnt(0)
    v_mfma_f32_16x16x32_bf16 v[160:163], v[96:99], v[16:19], 0
    v_and_b32 v81, 15, v1
    v_mfma_f32_16x16x32_bf16 v[164:167], v[108:111], v[16:19], 0
    v_lshrrev_b32 v82, 4, v1
    v_mfma_f32_16x16x32_bf16 v[168:171], v[120:123], v[16:19], 0
    v_lshlrev_b32 v83, 4, v81
    v_mfma_f32_16x16x32_bf16 v[172:175], v[132:135], v[16:19], 0
    v_lshl_add_u32 v72, v82, 11, v83
    v_mfma_f32_16x16x32_bf16 v[176:179], v[144:147], v[16:19], 0
    v_mov_b32 v84, 0x7ff00000
    v_mfma_f32_16x16x32_bf16 v[160:163], v[100:103], v[20:23], v[160:163]
    v_cmp_gt_u32 vcc, 9, v81
    s_nop 1
    v_cndmask_b32 v73, v84, v72, vcc
    v_mfma_f32_16x16x32_bf16 v[164:167], v[112:115], v[20:23], v[164:167]
    s_mul_i32 s56, s45, 1920
    s_add_u32 s56, s56, 0x5000
    v_lshl_add_u32 v74, v82, 3, v83
    v_add_u32 v74, s56, v74
    v_mfma_f32_16x16x32_bf16 v[168:171], v[124:127], v[20:23], v[168:171]
    v_and_b32 v82, 1, v1
    v_mfma_f32_16x16x32_bf16 v[172:175], v[136:139], v[20:23], v[172:175]
    v_lshlrev_b32 v82, 4, v82
    v_mfma_f32_16x16x32_bf16 v[176:179], v[148:151], v[20:23], v[176:179]
    v_mov_b32 v83, 0x3f80
    v_mfma_f32_16x16x32_bf16 v[160:163], v[104:107], v[24:27], v[160:163]
    v_lshlrev_b32 v83, v82, v83
    v_mfma_f32_16x16x32_bf16 v[164:167], v[116:119], v[24:27], v[164:167]
    v_lshrrev_b32 v81, 1, v81
    v_mfma_f32_16x16x32_bf16 v[168:171], v[128:131], v[24:27], v[168:171]
    v_cmp_eq_u32 vcc, 0, v81
    s_nop 1
    v_cndmask_b32 v76, 0, v83, vcc
    v_mfma_f32_16x16x32_bf16 v[172:175], v[140:143], v[24:27], v[172:175]
    v_cmp_eq_u32 vcc, 1, v81
    s_nop 1
    v_cndmask_b32 v77, 0, v83, vcc
    v_mfma_f32_16x16x32_bf16 v[176:179], v[152:155], v[24:27], v[176:179]
    v_cmp_eq_u32 vcc, 2, v81
    s_nop 1
    v_cndmask_b32 v78, 0, v83, vcc
    v_mfma_f32_16x16x32_bf16 v[180:183], v[96:99], v[28:31], 0
    v_cmp_eq_u32 vcc, 3, v81
    s_nop 1
    v_cndmask_b32 v79, 0, v83, vcc
    v_mfma_f32_16x16x32_bf16 v[184:187], v[108:111], v[28:31], 0
    v_bfe_u32 v81, v1, 2, 2
    v_lshrrev_b32 v82, 4, v1
    v_cmp_eq_u32 vcc, v81, v82
    v_mul_u32_u24 v82, 1920, v82
    v_and_b32 v81, 3, v1
    v_mul_u32_u24 v81, 80, v81
    v_add_u32 v81, v81, v82
    v_add_u32 v81, 0x5000, v81
    v_mov_b32 v82, 0x27400
    v_cndmask_b32 v75, v82, v81, vcc
    v_mfma_f32_16x16x32_bf16 v[188:191], v[120:123], v[28:31], 0
    s_lshl_b32 s78, s47, 2
    s_add_u32 s78, s78, s45
    s_lshl_b32 s77, s78, 6
    s_add_u32 s77, s77, 0xd2d000
    s_lshl_b32 s78, s78, 15
    s_add_u32 s78, s78, 0xc24000
    s_add_u32 s79, s78, 8192
    s_add_u32 s80, s78, 16384
    s_add_u32 s81, s78, 24576
    v_mfma_f32_16x16x32_bf16 v[192:195], v[132:135], v[28:31], 0
    v_mfma_f32_16x16x32_bf16 v[196:199], v[144:147], v[28:31], 0
    v_mfma_f32_16x16x32_bf16 v[180:183], v[100:103], v[32:35], v[180:183]
    v_mfma_f32_16x16x32_bf16 v[184:187], v[112:115], v[32:35], v[184:187]
    v_mfma_f32_16x16x32_bf16 v[188:191], v[124:127], v[32:35], v[188:191]
    v_mfma_f32_16x16x32_bf16 v[192:195], v[136:139], v[32:35], v[192:195]
    v_mfma_f32_16x16x32_bf16 v[196:199], v[148:151], v[32:35], v[196:199]
    v_mfma_f32_16x16x32_bf16 v[180:183], v[104:107], v[36:39], v[180:183]
    v_mfma_f32_16x16x32_bf16 v[184:187], v[116:119], v[36:39], v[184:187]
    v_mfma_f32_16x16x32_bf16 v[188:191], v[128:131], v[36:39], v[188:191]
    v_mfma_f32_16x16x32_bf16 v[192:195], v[140:143], v[36:39], v[192:195]
    v_mfma_f32_16x16x32_bf16 v[196:199], v[152:155], v[36:39], v[196:199]
    v_max3_f32 v36, v160, v161, v162
    v_max3_f32 v37, v163, v164, v165
    v_max3_f32 v36, v36, v166, v167
    v_max3_f32 v37, v37, v168, v169
    v_max3_f32 v36, v36, v170, v171
    v_max3_f32 v37, v37, v172, v173
    v_max3_f32 v36, v36, v174, v175
    v_max3_f32 v37, v37, v176, v177
    v_max3_f32 v36, v36, v178, v179
    v_max_f32 v36, v36, v37
    v_min3_f32 v38, v160, v161, v162
    v_min3_f32 v39, v163, v164, v165
    v_min3_f32 v38, v38, v166, v167
    v_min3_f32 v39, v39, v168, v169
    v_min3_f32 v38, v38, v170, v171
    v_min3_f32 v39, v39, v172, v173
    v_min3_f32 v38, v38, v174, v175
    v_min3_f32 v39, v39, v176, v177
    v_min3_f32 v38, v38, v178, v179
    v_min_f32 v38, v38, v39
    v_mul_f32 v36, s63, v36
    v_mul_f32 v38, s62, v38
    v_pk_fma_f32 v[16:17], v[160:161], s[62:63], v[38:39] op_sel_hi:[1,0,0] neg_lo:[0,1,0] neg_hi:[0,1,0]
    v_pk_fma_f32 v[160:161], v[160:161], s[62:63], v[36:37] op_sel_hi:[1,0,0]
    v_pk_fma_f32 v[18:19], v[162:163], s[62:63], v[38:39] op_sel_hi:[1,0,0] neg_lo:[0,1,0] neg_hi:[0,1,0]
    v_pk_fma_f32 v[162:163], v[162:163], s[62:63], v[36:37] op_sel_hi:[1,0,0]
    v_pk_fma_f32 v[20:21], v[164:165], s[62:63], v[38:39] op_sel_hi:[1,0,0] neg_lo:[0,1,0] neg_hi:[0,1,0]
    v_pk_fma_f32 v[164:165], v[164:165], s[62:63], v[36:37] op_sel_hi:[1,0,0]
    v_pk_fma_f32 v[22:23], v[166:167], s[62:63], v[38:39] op_sel_hi:[1,0,0] neg_lo:[0,1,0] neg_hi:[0,1,0]
    v_pk_fma_f32 v[166:167], v[166:167], s[62:63], v[36:37] op_sel_hi:[1,0,0]
    v_pk_fma_f32 v[24:25], v[168:169], s[62:63], v[38:39] op_sel_hi:[1,0,0] neg_lo:[0,1,0] neg_hi:[0,1,0]
    v_pk_fma_f32 v[168:169], v[168:169], s[62:63], v[36:37] op_sel_hi:[1,0,0]
    v_pk_fma_f32 v[26:27], v[170:171], s[62:63], v[38:39] op_sel_hi:[1,0,0] neg_lo:[0,1,0] neg_hi:[0,1,0]
    v_pk_fma_f32 v[170:171], v[170:171], s[62:63], v[36:37] op_sel_hi:[1,0,0]
    v_pk_fma_f32 v[28:29], v[172:173], s[62:63], v[38:39] op_sel_hi:[1,0,0] neg_lo:[0,1,0] neg_hi:[0,1,0]
    v_pk_fma_f32 v[172:173], v[172:173], s[62:63], v[36:37] op_sel_hi:[1,0,0]
    v_pk_fma_f32 v[30:31], v[174:175], s[62:63], v[38:39] op_sel_hi:[1,0,0] neg_lo:[0,1,0] neg_hi:[0,1,0]
    v_pk_fma_f32 v[174:175], v[174:175], s[62:63], v[36:37] op_sel_hi:[1,0,0]
    v_pk_fma_f32 v[32:33], v[176:177], s[62:63], v[38:39] op_sel_hi:[1,0,0] neg_lo:[0,1,0] neg_hi:[0,1,0]
    v_pk_fma_f32 v[176:177], v[176:177], s[62:63], v[36:37] op_sel_hi:[1,0,0]
    v_pk_fma_f32 v[34:35], v[178:179], s[62:63], v[38:39] op_sel_hi:[1,0,0] neg_lo:[0,1,0] neg_hi:[0,1,0]
    v_pk_fma_f32 v[178:179], v[178:179], s[62:63], v[36:37] op_sel_hi:[1,0,0]
    v_exp_f32 v160, v160
    v_exp_f32 v16, v16
    v_exp_f32 v161, v161
    v_exp_f32 v17, v17
    v_exp_f32 v162, v162
    v_exp_f32 v18, v18
    v_exp_f32 v163, v163
    v_exp_f32 v19, v19
    v_exp_f32 v164, v164
    v_exp_f32 v20, v20
    v_exp_f32 v165, v165
    v_exp_f32 v21, v21
    v_exp_f32 v166, v166
    v_exp_f32 v22, v22
    v_exp_f32 v167, v167
    v_exp_f32 v23, v23
    v_exp_f32 v168, v168
    v_exp_f32 v24, v24
    v_exp_f32 v169, v169
    v_exp_f32 v25, v25
    v_exp_f32 v170, v170
    v_exp_f32 v26, v26
    v_exp_f32 v171, v171
    v_exp_f32 v27, v27
    v_exp_f32 v172, v172
    v_exp_f32 v28, v28
    v_exp_f32 v173, v173
    v_exp_f32 v29, v29
    v_exp_f32 v174, v174
    v_exp_f32 v30, v30
    v_exp_f32 v175, v175
    v_exp_f32 v31, v31
    v_exp_f32 v176, v176
    v_exp_f32 v32, v32
    v_exp_f32 v177, v177
    v_exp_f32 v33, v33
    v_exp_f32 v178, v178
    v_exp_f32 v34, v34
    v_exp_f32 v179, v179
    v_exp_f32 v35, v35
    v_pk_add_f32 v[40:41], v[160:161], v[162:163]
    v_pk_add_f32 v[42:43], v[16:17], v[18:19]
    v_pk_add_f32 v[40:41], v[40:41], v[164:165]
    v_pk_add_f32 v[42:43], v[42:43], v[20:21]
    v_pk_add_f32 v[40:41], v[40:41], v[166:167]
    v_pk_add_f32 v[42:43], v[42:43], v[22:23]
    v_pk_add_f32 v[40:41], v[40:41], v[168:169]
    v_pk_add_f32 v[42:43], v[42:43], v[24:25]
    v_pk_add_f32 v[40:41], v[40:41], v[170:171]
    v_pk_add_f32 v[42:43], v[42:43], v[26:27]
    v_pk_add_f32 v[40:41], v[40:41], v[172:173]
    v_pk_add_f32 v[42:43], v[42:43], v[28:29]
    v_pk_add_f32 v[40:41], v[40:41], v[174:175]
    v_pk_add_f32 v[42:43], v[42:43], v[30:31]
    v_pk_add_f32 v[40:41], v[40:41], v[176:177]
    v_pk_add_f32 v[42:43], v[42:43], v[32:33]
    v_pk_add_f32 v[40:41], v[40:41], v[178:179]
    v_pk_add_f32 v[42:43], v[42:43], v[34:35]
    v_add_f32 v40, v40, v41
    v_add_f32 v42, v42, v43
    v_rcp_f32 v40, v40
    v_rcp_f32 v42, v42
    v_pk_mul_f32 v[160:161], v[160:161], v[40:41] op_sel_hi:[1,0]
    v_pk_mul_f32 v[16:17], v[16:17], v[42:43] op_sel_hi:[1,0]
    v_pk_mul_f32 v[162:163], v[162:163], v[40:41] op_sel_hi:[1,0]
    v_pk_mul_f32 v[18:19], v[18:19], v[42:43] op_sel_hi:[1,0]
    v_pk_mul_f32 v[164:165], v[164:165], v[40:41] op_sel_hi:[1,0]
    v_pk_mul_f32 v[20:21], v[20:21], v[42:43] op_sel_hi:[1,0]
    v_pk_mul_f32 v[166:167], v[166:167], v[40:41] op_sel_hi:[1,0]
    v_pk_mul_f32 v[22:23], v[22:23], v[42:43] op_sel_hi:[1,0]
    v_pk_mul_f32 v[168:169], v[168:169], v[40:41] op_sel_hi:[1,0]
    v_pk_mul_f32 v[24:25], v[24:25], v[42:43] op_sel_hi:[1,0]
    v_pk_mul_f32 v[170:171], v[170:171], v[40:41] op_sel_hi:[1,0]
    v_pk_mul_f32 v[26:27], v[26:27], v[42:43] op_sel_hi:[1,0]
    v_pk_mul_f32 v[172:173], v[172:173], v[40:41] op_sel_hi:[1,0]
    v_pk_mul_f32 v[28:29], v[28:29], v[42:43] op_sel_hi:[1,0]
    v_pk_mul_f32 v[174:175], v[174:175], v[40:41] op_sel_hi:[1,0]
    v_pk_mul_f32 v[30:31], v[30:31], v[42:43] op_sel_hi:[1,0]
    v_pk_mul_f32 v[176:177], v[176:177], v[40:41] op_sel_hi:[1,0]
    v_pk_mul_f32 v[32:33], v[32:33], v[42:43] op_sel_hi:[1,0]
    v_pk_mul_f32 v[178:179], v[178:179], v[40:41] op_sel_hi:[1,0]
    v_pk_mul_f32 v[34:35], v[34:35], v[42:43] op_sel_hi:[1,0]
    v_cvt_pk_bf16_f32 v160, v160, v161
    v_cvt_pk_bf16_f32 v161, v162, v163
    v_cvt_pk_bf16_f32 v162, v164, v165
    v_cvt_pk_bf16_f32 v163, v166, v167
    v_cvt_pk_bf16_f32 v164, v168, v169
    v_cvt_pk_bf16_f32 v165, v170, v171
    v_cvt_pk_bf16_f32 v166, v172, v173
    v_cvt_pk_bf16_f32 v167, v174, v175
    v_cvt_pk_bf16_f32 v168, v176, v177
    v_cvt_pk_bf16_f32 v169, v178, v179
    v_cvt_pk_bf16_f32 v170, v16, v17
    v_cvt_pk_bf16_f32 v171, v18, v19
    v_cvt_pk_bf16_f32 v172, v20, v21
    v_cvt_pk_bf16_f32 v173, v22, v23
    v_cvt_pk_bf16_f32 v174, v24, v25
    v_cvt_pk_bf16_f32 v175, v26, v27
    v_cvt_pk_bf16_f32 v176, v28, v29
    v_cvt_pk_bf16_f32 v177, v30, v31
    v_cvt_pk_bf16_f32 v178, v32, v33
    v_cvt_pk_bf16_f32 v179, v34, v35
    s_buffer_load_dwordx16 s[4:19], s[32:35], s77 offset:0 glc
    v_max3_f32 v36, v180, v181, v182
    v_max3_f32 v37, v183, v184, v185
    v_max3_f32 v36, v36, v186, v187
    v_max3_f32 v37, v37, v188, v189
    v_max3_f32 v36, v36, v190, v191
    v_max3_f32 v37, v37, v192, v193
    v_max3_f32 v36, v36, v194, v195
    v_max3_f32 v37, v37, v196, v197
    v_max3_f32 v36, v36, v198, v199
    v_max_f32 v36, v36, v37
    v_min3_f32 v38, v180, v181, v182
    v_min3_f32 v39, v183, v184, v185
    v_min3_f32 v38, v38, v186, v187
    v_min3_f32 v39, v39, v188, v189
    v_min3_f32 v38, v38, v190, v191
    v_min3_f32 v39, v39, v192, v193
    v_min3_f32 v38, v38, v194, v195
    v_min3_f32 v39, v39, v196, v197
    v_min3_f32 v38, v38, v198, v199
    v_min_f32 v38, v38, v39
    v_mul_f32 v36, s63, v36
    v_mul_f32 v38, s62, v38
    v_pk_fma_f32 v[16:17], v[180:181], s[62:63], v[38:39] op_sel_hi:[1,0,0] neg_lo:[0,1,0] neg_hi:[0,1,0]
    v_pk_fma_f32 v[180:181], v[180:181], s[62:63], v[36:37] op_sel_hi:[1,0,0]
    v_pk_fma_f32 v[18:19], v[182:183], s[62:63], v[38:39] op_sel_hi:[1,0,0] neg_lo:[0,1,0] neg_hi:[0,1,0]
    v_pk_fma_f32 v[182:183], v[182:183], s[62:63], v[36:37] op_sel_hi:[1,0,0]
    v_pk_fma_f32 v[20:21], v[184:185], s[62:63], v[38:39] op_sel_hi:[1,0,0] neg_lo:[0,1,0] neg_hi:[0,1,0]
    v_pk_fma_f32 v[184:185], v[184:185], s[62:63], v[36:37] op_sel_hi:[1,0,0]
    v_pk_fma_f32 v[22:23], v[186:187], s[62:63], v[38:39] op_sel_hi:[1,0,0] neg_lo:[0,1,0] neg_hi:[0,1,0]
    v_pk_fma_f32 v[186:187], v[186:187], s[62:63], v[36:37] op_sel_hi:[1,0,0]
    v_pk_fma_f32 v[24:25], v[188:189], s[62:63], v[38:39] op_sel_hi:[1,0,0] neg_lo:[0,1,0] neg_hi:[0,1,0]
    v_pk_fma_f32 v[188:189], v[188:189], s[62:63], v[36:37] op_sel_hi:[1,0,0]
    v_pk_fma_f32 v[26:27], v[190:191], s[62:63], v[38:39] op_sel_hi:[1,0,0] neg_lo:[0,1,0] neg_hi:[0,1,0]
    v_pk_fma_f32 v[190:191], v[190:191], s[62:63], v[36:37] op_sel_hi:[1,0,0]
    v_pk_fma_f32 v[28:29], v[192:193], s[62:63], v[38:39] op_sel_hi:[1,0,0] neg_lo:[0,1,0] neg_hi:[0,1,0]
    v_pk_fma_f32 v[192:193], v[192:193], s[62:63], v[36:37] op_sel_hi:[1,0,0]
    v_pk_fma_f32 v[30:31], v[194:195], s[62:63], v[38:39] op_sel_hi:[1,0,0] neg_lo:[0,1,0] neg_hi:[0,1,0]
    v_pk_fma_f32 v[194:195], v[194:195], s[62:63], v[36:37] op_sel_hi:[1,0,0]
    v_pk_fma_f32 v[32:33], v[196:197], s[62:63], v[38:39] op_sel_hi:[1,0,0] neg_lo:[0,1,0] neg_hi:[0,1,0]
    v_pk_fma_f32 v[196:197], v[196:197], s[62:63], v[36:37] op_sel_hi:[1,0,0]
    v_pk_fma_f32 v[34:35], v[198:199], s[62:63], v[38:39] op_sel_hi:[1,0,0] neg_lo:[0,1,0] neg_hi:[0,1,0]
    v_pk_fma_f32 v[198:199], v[198:199], s[62:63], v[36:37] op_sel_hi:[1,0,0]
    v_exp_f32 v180, v180
    v_exp_f32 v16, v16
    v_exp_f32 v181, v181
    v_exp_f32 v17, v17
    v_exp_f32 v182, v182
    v_exp_f32 v18, v18
    v_exp_f32 v183, v183
    v_exp_f32 v19, v19
    v_exp_f32 v184, v184
    v_exp_f32 v20, v20
    v_exp_f32 v185, v185
    v_exp_f32 v21, v21
    v_exp_f32 v186, v186
    v_exp_f32 v22, v22
    v_exp_f32 v187, v187
    v_exp_f32 v23, v23
    v_exp_f32 v188, v188
    v_exp_f32 v24, v24
    v_exp_f32 v189, v189
    v_exp_f32 v25, v25
    v_exp_f32 v190, v190
    v_exp_f32 v26, v26
    v_exp_f32 v191, v191
    v_exp_f32 v27, v27
    v_exp_f32 v192, v192
    v_exp_f32 v28, v28
    v_exp_f32 v193, v193
    v_exp_f32 v29, v29
    v_exp_f32 v194, v194
    v_exp_f32 v30, v30
    v_exp_f32 v195, v195
    v_exp_f32 v31, v31
    v_exp_f32 v196, v196
    v_exp_f32 v32, v32
    v_exp_f32 v197, v197
    v_exp_f32 v33, v33
    v_exp_f32 v198, v198
    v_exp_f32 v34, v34
    v_exp_f32 v199, v199
    v_exp_f32 v35, v35
    v_pk_add_f32 v[40:41], v[180:181], v[182:183]
    v_pk_add_f32 v[42:43], v[16:17], v[18:19]
    v_pk_add_f32 v[40:41], v[40:41], v[184:185]
    v_pk_add_f32 v[42:43], v[42:43], v[20:21]
    v_pk_add_f32 v[40:41], v[40:41], v[186:187]
    v_pk_add_f32 v[42:43], v[42:43], v[22:23]
    v_pk_add_f32 v[40:41], v[40:41], v[188:189]
    v_pk_add_f32 v[42:43], v[42:43], v[24:25]
    v_pk_add_f32 v[40:41], v[40:41], v[190:191]
    v_pk_add_f32 v[42:43], v[42:43], v[26:27]
    v_pk_add_f32 v[40:41], v[40:41], v[192:193]
    v_pk_add_f32 v[42:43], v[42:43], v[28:29]
    v_pk_add_f32 v[40:41], v[40:41], v[194:195]
    v_pk_add_f32 v[42:43], v[42:43], v[30:31]
    v_pk_add_f32 v[40:41], v[40:41], v[196:197]
    v_pk_add_f32 v[42:43], v[42:43], v[32:33]
    v_pk_add_f32 v[40:41], v[40:41], v[198:199]
    v_pk_add_f32 v[42:43], v[42:43], v[34:35]
    v_add_f32 v40, v40, v41
    v_add_f32 v42, v42, v43
    v_rcp_f32 v40, v40
    v_rcp_f32 v42, v42
    v_pk_mul_f32 v[180:181], v[180:181], v[40:41] op_sel_hi:[1,0]
    v_pk_mul_f32 v[16:17], v[16:17], v[42:43] op_sel_hi:[1,0]
    v_pk_mul_f32 v[182:183], v[182:183], v[40:41] op_sel_hi:[1,0]
    v_pk_mul_f32 v[18:19], v[18:19], v[42:43] op_sel_hi:[1,0]
    v_pk_mul_f32 v[184:185], v[184:185], v[40:41] op_sel_hi:[1,0]
    v_pk_mul_f32 v[20:21], v[20:21], v[42:43] op_sel_hi:[1,0]
    v_pk_mul_f32 v[186:187], v[186:187], v[40:41] op_sel_hi:[1,0]
    v_pk_mul_f32 v[22:23], v[22:23], v[42:43] op_sel_hi:[1,0]
    v_pk_mul_f32 v[188:189], v[188:189], v[40:41] op_sel_hi:[1,0]
    v_pk_mul_f32 v[24:25], v[24:25], v[42:43] op_sel_hi:[1,0]
    v_pk_mul_f32 v[190:191], v[190:191], v[40:41] op_sel_hi:[1,0]
    v_pk_mul_f32 v[26:27], v[26:27], v[42:43] op_sel_hi:[1,0]
    v_pk_mul_f32 v[192:193], v[192:193], v[40:41] op_sel_hi:[1,0]
    v_pk_mul_f32 v[28:29], v[28:29], v[42:43] op_sel_hi:[1,0]
    v_pk_mul_f32 v[194:195], v[194:195], v[40:41] op_sel_hi:[1,0]
    v_pk_mul_f32 v[30:31], v[30:31], v[42:43] op_sel_hi:[1,0]
    v_pk_mul_f32 v[196:197], v[196:197], v[40:41] op_sel_hi:[1,0]
    v_pk_mul_f32 v[32:33], v[32:33], v[42:43] op_sel_hi:[1,0]
    v_pk_mul_f32 v[198:199], v[198:199], v[40:41] op_sel_hi:[1,0]
    v_pk_mul_f32 v[34:35], v[34:35], v[42:43] op_sel_hi:[1,0]
    v_cvt_pk_bf16_f32 v180, v180, v181
    v_cvt_pk_bf16_f32 v181, v182, v183
    v_cvt_pk_bf16_f32 v182, v184, v185
    v_cvt_pk_bf16_f32 v183, v186, v187
    v_cvt_pk_bf16_f32 v184, v188, v189
    v_cvt_pk_bf16_f32 v185, v190, v191
    v_cvt_pk_bf16_f32 v186, v192, v193
    v_cvt_pk_bf16_f32 v187, v194, v195
    v_cvt_pk_bf16_f32 v188, v196, v197
    v_cvt_pk_bf16_f32 v189, v198, v199
    v_cvt_pk_bf16_f32 v190, v16, v17
    v_cvt_pk_bf16_f32 v191, v18, v19
    v_cvt_pk_bf16_f32 v192, v20, v21
    v_cvt_pk_bf16_f32 v193, v22, v23
    v_cvt_pk_bf16_f32 v194, v24, v25
    v_cvt_pk_bf16_f32 v195, v26, v27
    v_cvt_pk_bf16_f32 v196, v28, v29
    v_cvt_pk_bf16_f32 v197, v30, v31
    v_cvt_pk_bf16_f32 v198, v32, v33
    v_cvt_pk_bf16_f32 v199, v34, v35
    s_mov_b64 exec, 1
    ds_add_u32 v5, v6 offset:68
    s_mov_b64 exec, -1
    s_mov_b32 s60, 20000
SP_38:
    s_waitcnt lgkmcnt(0)
    s_xor_b64 s[4:5], s[4:5], s[50:51]
    s_xor_b64 s[6:7], s[6:7], s[50:51]
    s_xor_b64 s[8:9], s[8:9], s[50:51]
    s_xor_b64 s[10:11], s[10:11], s[50:51]
    s_xor_b64 s[12:13], s[12:13], s[50:51]
    s_xor_b64 s[14:15], s[14:15], s[50:51]
    s_xor_b64 s[16:17], s[16:17], s[50:51]
    s_xor_b64 s[18:19], s[18:19], s[50:51]
    s_or_b64 s[4:5], s[4:5], s[6:7]
    s_or_b64 s[4:5], s[4:5], s[8:9]
    s_or_b64 s[4:5], s[4:5], s[10:11]
    s_or_b64 s[4:5], s[4:5], s[12:13]
    s_or_b64 s[4:5], s[4:5], s[14:15]
    s_or_b64 s[4:5], s[4:5], s[16:17]
    s_or_b64 s[4:5], s[4:5], s[18:19]
    s_cbranch_scc0 SP_38_OK
    s_sub_u32 s60, s60, 1
    s_cbranch_scc1 SP_38_OK
    s_buffer_load_dwordx16 s[4:19], s[32:35], s77 offset:0 glc
    s_branch SP_38
SP_38_OK:
    buffer_load_dwordx4 v[96:99], v72, s[32:35], s78 offen offset:0
    buffer_load_dwordx4 v[100:103], v72, s[32:35], s79 offen offset:0
    buffer_load_dwordx4 v[104:107], v72, s[32:35], s80 offen offset:0
    buffer_load_dwordx4 v[108:111], v72, s[32:35], s81 offen offset:0
    buffer_load_dwordx4 v[112:115], v72, s[32:35], s78 offen offset:256
    buffer_load_dwordx4 v[116:119], v72, s[32:35], s79 offen offset:256
    buffer_load_dwordx4 v[120:123], v72, s[32:35], s80 offen offset:256
    buffer_load_dwordx4 v[124:127], v72, s[32:35], s81 offen offset:256
    buffer_load_dwordx4 v[128:131], v72, s[32:35], s78 offen offset:512
    buffer_load_dwordx4 v[132:135], v72, s[32:35], s79 offen offset:512
    buffer_load_dwordx4 v[136:139], v72, s[32:35], s80 offen offset:512
    buffer_load_dwordx4 v[140:143], v72, s[32:35], s81 offen offset:512
    buffer_load_dwordx4 v[144:147], v72, s[32:35], s78 offen offset:768
    buffer_load_dwordx4 v[148:151], v72, s[32:35], s79 offen offset:768
    buffer_load_dwordx4 v[152:155], v72, s[32:35], s80 offen offset:768
    buffer_load_dwordx4 v[156:159], v72, s[32:35], s81 offen offset:768
    buffer_load_dwordx4 v[200:203], v72, s[32:35], s78 offen offset:1024
    buffer_load_dwordx4 v[204:207], v72, s[32:35], s79 offen offset:1024
    buffer_load_dwordx4 v[208:211], v72, s[32:35], s80 offen offset:1024
    buffer_load_dwordx4 v[212:215], v72, s[32:35], s81 offen offset:1024
    buffer_load_dwordx4 v[216:219], v72, s[32:35], s78 offen offset:1280
    buffer_load_dwordx4 v[220:223], v72, s[32:35], s79 offen offset:1280
    buffer_load_dwordx4 v[224:227], v72, s[32:35], s80 offen offset:1280
    buffer_load_dwordx4 v[228:231], v72, s[32:35], s81 offen offset:1280
    buffer_load_dwordx4 v[232:235], v73, s[32:35], s78 offen offset:1536
    buffer_load_dwordx4 v[236:239], v73, s[32:35], s79 offen offset:1536
    buffer_load_dwordx4 v[240:243], v73, s[32:35], s80 offen offset:1536
    buffer_load_dwordx4 v[244:247], v73, s[32:35], s81 offen offset:1536
    s_mov_b32 s60, 160000
LW_39:
    ds_read_b32 v9, v5 offset:52
    s_waitcnt lgkmcnt(0)
    v_readfirstlane_b32 s58, v9
    s_nop 1
    s_cmp_ge_u32 s58, 4
    s_nop 0
    s_cbranch_scc1 LW_39_OK
    s_sub_u32 s60, s60, 1
    s_cmp_lg_u32 s60, 0
    s_cbranch_scc1 LW_39
LW_39_OK:
    s_waitcnt vmcnt(24)
    v_mfma_f32_16x16x32_bf16 v[44:47], v[76:79], v[96:99], 0
    v_mfma_f32_16x16x32_bf16 v[44:47], v[76:79], v[100:103], v[44:47]
    v_mfma_f32_16x16x32_bf16 v[44:47], v[76:79], v[104:107], v[44:47]
    v_mfma_f32_16x16x32_bf16 v[44:47], v[76:79], v[108:111], v[44:47]
    s_waitcnt vmcnt(20)
    v_mfma_f32_16x16x32_bf16 v[48:51], v[76:79], v[112:115], 0
    v_mfma_f32_16x16x32_bf16 v[48:51], v[76:79], v[116:119], v[48:51]
    v_mfma_f32_16x16x32_bf16 v[48:51], v[76:79], v[120:123], v[48:51]
    v_mfma_f32_16x16x32_bf16 v[48:51], v[76:79], v[124:127], v[48:51]
    s_waitcnt vmcnt(16)
    v_mfma_f32_16x16x32_bf16 v[52:55], v[76:79], v[128:131], 0
    v_mfma_f32_16x16x32_bf16 v[52:55], v[76:79], v[132:135], v[52:55]
    v_mfma_f32_16x16x32_bf16 v[52:55], v[76:79], v[136:139], v[52:55]
    v_mfma_f32_16x16x32_bf16 v[52:55], v[76:79], v[140:143], v[52:55]
    s_waitcnt vmcnt(12)
    v_mfma_f32_16x16x32_bf16 v[56:59], v[76:79], v[144:147], 0
    v_mfma_f32_16x16x32_bf16 v[56:59], v[76:79], v[148:151], v[56:59]
    v_mfma_f32_16x16x32_bf16 v[56:59], v[76:79], v[152:155], v[56:59]
    v_mfma_f32_16x16x32_bf16 v[56:59], v[76:79], v[156:159], v[56:59]
    s_waitcnt vmcnt(8)
    v_mfma_f32_16x16x32_bf16 v[60:63], v[76:79], v[200:203], 0
    v_mfma_f32_16x16x32_bf16 v[60:63], v[76:79], v[204:207], v[60:63]
    v_mfma_f32_16x16x32_bf16 v[60:63], v[76:79], v[208:211], v[60:63]
    v_mfma_f32_16x16x32_bf16 v[60:63], v[76:79], v[212:215], v[60:63]
    s_waitcnt vmcnt(4)
    v_mfma_f32_16x16x32_bf16 v[64:67], v[76:79], v[216:219], 0
    v_mfma_f32_16x16x32_bf16 v[64:67], v[76:79], v[220:223], v[64:67]
    v_mfma_f32_16x16x32_bf16 v[64:67], v[76:79], v[224:227], v[64:67]
    v_mfma_f32_16x16x32_bf16 v[64:67], v[76:79], v[228:231], v[64:67]
    s_waitcnt vmcnt(0)
    v_mfma_f32_16x16x32_bf16 v[68:71], v[76:79], v[232:235], 0
    v_mfma_f32_16x16x32_bf16 v[68:71], v[76:79], v[236:239], v[68:71]
    v_mfma_f32_16x16x32_bf16 v[68:71], v[76:79], v[240:243], v[68:71]
    v_mfma_f32_16x16x32_bf16 v[68:71], v[76:79], v[244:247], v[68:71]
    s_mov_b32 exec_hi, 0
    v_cvt_pk_bf16_f32 v44, v44, v45
    v_cvt_pk_bf16_f32 v45, v46, v47
    ds_write_b64 v74, v[44:45] offset:0
    v_cvt_pk_bf16_f32 v48, v48, v49
    v_cvt_pk_bf16_f32 v49, v50, v51
    ds_write_b64 v74, v[48:49] offset:256
    v_cmp_u_f32 s[56:57], v47, v51
    v_cvt_pk_bf16_f32 v52, v52, v53
    v_cvt_pk_bf16_f32 v53, v54, v55
    ds_write_b64 v74, v[52:53] offset:512
    v_cvt_pk_bf16_f32 v56, v56, v57
    v_cvt_pk_bf16_f32 v57, v58, v59
    ds_write_b64 v74, v[56:57] offset:768
    v_cmp_u_f32 s[58:59], v55, v59
    v_cvt_pk_bf16_f32 v60, v60, v61
    v_cvt_pk_bf16_f32 v61, v62, v63
    ds_write_b64 v74, v[60:61] offset:1024
    v_cvt_pk_bf16_f32 v64, v64, v65
    v_cvt_pk_bf16_f32 v65, v66, v67
    ds_write_b64 v74, v[64:65] offset:1280
    v_cmp_u_f32 s[60:61], v63, v67
    v_cvt_pk_bf16_f32 v68, v68, v69
    v_cvt_pk_bf16_f32 v69, v70, v71
    ds_write_b64 v74, v[68:69] offset:1536
    v_cmp_u_f32 vcc, v71, v71
    s_or_b64 s[56:57], s[56:57], s[58:59]
    s_or_b64 s[56:57], s[56:57], s[60:61]
    s_mov_b32 exec_hi, -1
    s_or_b64 vcc, vcc, s[56:57]
    s_cbranch_scc1 KC_40_S
KC_40:
    s_mov_b64 exec, 1
    ds_add_u32 v5, v6 offset:12
    s_mov_b64 exec, -1
    s_mov_b32 s60, 160000
LW_41:
    ds_read_b32 v4, v5 offset:12
    s_waitcnt lgkmcnt(0)
    v_readfirstlane_b32 s58, v4
    s_nop 1
    s_cmp_ge_u32 s58, 4
    s_nop 0
    s_cbranch_scc1 LW_41_OK
    s_sub_u32 s60, s60, 1
    s_cmp_lg_u32 s60, 0
    s_cbranch_scc1 LW_41
LW_41_OK:
    ds_read_b128 v[136:139], v75 offset:1600
    ds_read_b128 v[140:143], v75 offset:1616
    ds_read_b128 v[144:147], v75 offset:1632
    ds_read_b128 v[148:151], v75 offset:1648
    ds_read_b128 v[152:155], v75 offset:1664
    ds_read_b128 v[96:99], v75 offset:0
    ds_read_b128 v[100:103], v75 offset:16
    ds_read_b128 v[104:107], v75 offset:32
    ds_read_b128 v[108:111], v75 offset:48
    ds_read_b128 v[112:115], v75 offset:64
    s_waitcnt lgkmcnt(5)
    ds_read_b128 v[116:119], v75 offset:320
    ds_read_b128 v[120:123], v75 offset:336
    ds_read_b128 v[124:127], v75 offset:352
    ds_read_b128 v[128:131], v75 offset:368
    ds_read_b128 v[132:135], v75 offset:384
    v_mfma_f32_16x16x32_bf16 v[240:243], v[136:139], v[160:163], 0
    v_mfma_f32_16x16x32_bf16 v[244:247], v[136:139], v[180:183], 0
    v_mfma_f32_16x16x32_bf16 v[240:243], v[140:143], v[164:167], v[240:243]
    v_mfma_f32_16x16x32_bf16 v[244:247], v[140:143], v[184:187], v[244:247]
    v_mfma_f32_16x16x32_bf16 v[240:243], v[144:147], v[168:171], v[240:243]
    v_mfma_f32_16x16x32_bf16 v[244:247], v[144:147], v[188:191], v[244:247]
    v_mfma_f32_16x16x32_bf16 v[240:243], v[148:151], v[172:175], v[240:243]
    v_mfma_f32_16x16x32_bf16 v[244:247], v[148:151], v[192:195], v[244:247]
    v_mfma_f32_16x16x32_bf16 v[240:243], v[152:155], v[176:179], v[240:243]
    v_mfma_f32_16x16x32_bf16 v[244:247], v[152:155], v[196:199], v[244:247]
    s_waitcnt lgkmcnt(5)
    ds_read_b128 v[136:139], v75 offset:640
    ds_read_b128 v[140:143], v75 offset:656
    ds_read_b128 v[144:147], v75 offset:672
    ds_read_b128 v[148:151], v75 offset:688
    ds_read_b128 v[152:155], v75 offset:704
    v_mfma_f32_16x16x32_bf16 v[200:203], v[96:99], v[160:163], 0
    v_mfma_f32_16x16x32_bf16 v[204:207], v[96:99], v[180:183], 0
    v_mfma_f32_16x16x32_bf16 v[200:203], v[100:103], v[164:167], v[200:203]
    v_mfma_f32_16x16x32_bf16 v[204:207], v[100:103], v[184:187], v[204:207]
    v_mfma_f32_16x16x32_bf16 v[200:203], v[104:107], v[168:171], v[200:203]
    v_mfma_f32_16x16x32_bf16 v[204:207], v[104:107], v[188:191], v[204:207]
    v_mfma_f32_16x16x32_bf16 v[200:203], v[108:111], v[172:175], v[200:203]
    v_mfma_f32_16x16x32_bf16 v[204:207], v[108:111], v[192:195], v[204:207]
    v_mfma_f32_16x16x32_bf16 v[200:203], v[112:115], v[176:179], v[200:203]
    v_mfma_f32_16x16x32_bf16 v[204:207], v[112:115], v[196:199], v[204:207]
    s_waitcnt lgkmcnt(5)
    ds_read_b128 v[96:99], v75 offset:960
    ds_read_b128 v[100:103], v75 offset:976
    ds_read_b128 v[104:107], v75 offset:992
    ds_read_b128 v[108:111], v75 offset:1008
    ds_read_b128 v[112:115], v75 offset:1024
    v_mfma_f32_16x16x32_bf16 v[208:211], v[116:119], v[160:163], 0
    v_mfma_f32_16x16x32_bf16 v[212:215], v[116:119], v[180:183], 0
    v_mfma_f32_16x16x32_bf16 v[208:211], v[120:123], v[164:167], v[208:211]
    v_mfma_f32_16x16x32_bf16 v[212:215], v[120:123], v[184:187], v[212:215]
    v_mfma_f32_16x16x32_bf16 v[208:211], v[124:127], v[168:171], v[208:211]
    v_mfma_f32_16x16x32_bf16 v[212:215], v[124:127], v[188:191], v[212:215]
    v_mfma_f32_16x16x32_bf16 v[208:211], v[128:131], v[172:175], v[208:211]
    v_mfma_f32_16x16x32_bf16 v[212:215], v[128:131], v[192:195], v[212:215]
    v_mfma_f32_16x16x32_bf16 v[208:211], v[132:135], v[176:179], v[208:211]
    v_mfma_f32_16x16x32_bf16 v[212:215], v[132:135], v[196:199], v[212:215]
    s_waitcnt lgkmcnt(5)
    ds_read_b128 v[116:119], v75 offset:1280
    ds_read_b128 v[120:123], v75 offset:1296
    ds_read_b128 v[124:127], v75 offset:1312
    ds_read_b128 v[128:131], v75 offset:1328
    ds_read_b128 v[132:135], v75 offset:1344
    v_mfma_f32_16x16x32_bf16 v[216:219], v[136:139], v[160:163], 0
    v_mfma_f32_16x16x32_bf16 v[220:223], v[136:139], v[180:183], 0
    v_mfma_f32_16x16x32_bf16 v[216:219], v[140:143], v[164:167], v[216:219]
    v_mfma_f32_16x16x32_bf16 v[220:223], v[140:143], v[184:187], v[220:223]
    v_mfma_f32_16x16x32_bf16 v[216:219], v[144:147], v[168:171], v[216:219]
    v_mfma_f32_16x16x32_bf16 v[220:223], v[144:147], v[188:191], v[220:223]
    v_mfma_f32_16x16x32_bf16 v[216:219], v[148:151], v[172:175], v[216:219]
    v_mfma_f32_16x16x32_bf16 v[220:223], v[148:151], v[192:195], v[220:223]
    v_mfma_f32_16x16x32_bf16 v[216:219], v[152:155], v[176:179], v[216:219]
    v_mfma_f32_16x16x32_bf16 v[220:223], v[152:155], v[196:199], v[220:223]
    s_waitcnt lgkmcnt(5)
    v_mfma_f32_16x16x32_bf16 v[224:227], v[96:99], v[160:163], 0
    v_mfma_f32_16x16x32_bf16 v[228:231], v[96:99], v[180:183], 0
    v_mfma_f32_16x16x32_bf16 v[224:227], v[100:103], v[164:167], v[224:227]
    v_mfma_f32_16x16x32_bf16 v[228:231], v[100:103], v[184:187], v[228:231]
    v_mfma_f32_16x16x32_bf16 v[224:227], v[104:107], v[168:171], v[224:227]
    v_mfma_f32_16x16x32_bf16 v[228:231], v[104:107], v[188:191], v[228:231]
    v_mfma_f32_16x16x32_bf16 v[224:227], v[108:111], v[172:175], v[224:227]
    v_mfma_f32_16x16x32_bf16 v[228:231], v[108:111], v[192:195], v[228:231]
    v_mfma_f32_16x16x32_bf16 v[224:227], v[112:115], v[176:179], v[224:227]
    v_mfma_f32_16x16x32_bf16 v[228:231], v[112:115], v[196:199], v[228:231]
    s_waitcnt lgkmcnt(0)
    v_mfma_f32_16x16x32_bf16 v[232:235], v[116:119], v[160:163], 0
    v_mfma_f32_16x16x32_bf16 v[236:239], v[116:119], v[180:183], 0
    v_mfma_f32_16x16x32_bf16 v[232:235], v[120:123], v[164:167], v[232:235]
    v_mfma_f32_16x16x32_bf16 v[236:239], v[120:123], v[184:187], v[236:239]
    v_mfma_f32_16x16x32_bf16 v[232:235], v[124:127], v[168:171], v[232:235]
    v_mfma_f32_16x16x32_bf16 v[236:239], v[124:127], v[188:191], v[236:239]
    v_mfma_f32_16x16x32_bf16 v[232:235], v[128:131], v[172:175], v[232:235]
    v_mfma_f32_16x16x32_bf16 v[236:239], v[128:131], v[192:195], v[236:239]
    v_mfma_f32_16x16x32_bf16 v[232:235], v[132:135], v[176:179], v[232:235]
    v_mfma_f32_16x16x32_bf16 v[236:239], v[132:135], v[196:199], v[236:239]
    s_and_b32 s56, s45, 1
    s_lshl_b32 s56, s56, 10
    s_sub_u32 s75, s72, s56
    s_add_u32 s75, s75, 65536
    s_mul_i32 s56, s47, 6144
    s_sub_u32 s75, s75, s56
    s_add_u32 s76, s72, 4096
    v_lshlrev_b32 v3, 3, v1
    v_add_f32 v40, 0x358637bd, v240
    v_rcp_f32 v40, v40
    s_nop 0
    v_mul_f32 v200, v200, v40
    v_mul_f32 v201, v201, v40
    v_mul_f32 v202, v202, v40
    v_mul_f32 v203, v203, v40
    v_cvt_pk_bf16_f32 v16, v200, v201
    v_cvt_pk_bf16_f32 v17, v202, v203
    v_mul_f32 v208, v208, v40
    v_mul_f32 v209, v209, v40
    v_mul_f32 v210, v210, v40
    v_mul_f32 v211, v211, v40
    v_cvt_pk_bf16_f32 v18, v208, v209
    v_cvt_pk_bf16_f32 v19, v210, v211
    v_mul_f32 v216, v216, v40
    v_mul_f32 v217, v217, v40
    v_mul_f32 v218, v218, v40
    v_mul_f32 v219, v219, v40
    v_cvt_pk_bf16_f32 v20, v216, v217
    v_cvt_pk_bf16_f32 v21, v218, v219
    v_mul_f32 v224, v224, v40
    v_mul_f32 v225, v225, v40
    v_mul_f32 v226, v226, v40
    v_mul_f32 v227, v227, v40
    v_cvt_pk_bf16_f32 v22, v224, v225
    v_cvt_pk_bf16_f32 v23, v226, v227
    v_mul_f32 v232, v232, v40
    v_mul_f32 v233, v233, v40
    v_mul_f32 v234, v234, v40
    v_mul_f32 v235, v235, v40
    v_cvt_pk_bf16_f32 v24, v232, v233
    v_cvt_pk_bf16_f32 v25, v234, v235
    buffer_store_dwordx4 v[16:19], v2, s[32:35], s72 offen offset:0 sc1
    buffer_store_dwordx4 v[20:23], v2, s[32:35], s76 offen offset:0 sc1
    buffer_store_dwordx2 v[24:25], v3, s[32:35], s75 offen offset:0 sc1
    v_add_f32 v42, 0x358637bd, v244
    v_rcp_f32 v42, v42
    s_nop 0
    v_mul_f32 v204, v204, v42
    v_mul_f32 v205, v205, v42
    v_mul_f32 v206, v206, v42
    v_mul_f32 v207, v207, v42
    v_cvt_pk_bf16_f32 v28, v204, v205
    v_cvt_pk_bf16_f32 v29, v206, v207
    v_mul_f32 v212, v212, v42
    v_mul_f32 v213, v213, v42
    v_mul_f32 v214, v214, v42
    v_mul_f32 v215, v215, v42
    v_cvt_pk_bf16_f32 v30, v212, v213
    v_cvt_pk_bf16_f32 v31, v214, v215
    v_mul_f32 v220, v220, v42
    v_mul_f32 v221, v221, v42
    v_mul_f32 v222, v222, v42
    v_mul_f32 v223, v223, v42
    v_cvt_pk_bf16_f32 v32, v220, v221
    v_cvt_pk_bf16_f32 v33, v222, v223
    v_mul_f32 v228, v228, v42
    v_mul_f32 v229, v229, v42
    v_mul_f32 v230, v230, v42
    v_mul_f32 v231, v231, v42
    v_cvt_pk_bf16_f32 v34, v228, v229
    v_cvt_pk_bf16_f32 v35, v230, v231
    v_mul_f32 v236, v236, v42
    v_mul_f32 v237, v237, v42
    v_mul_f32 v238, v238, v42
    v_mul_f32 v239, v239, v42
    v_cvt_pk_bf16_f32 v36, v236, v237
    v_cvt_pk_bf16_f32 v37, v238, v239
    buffer_store_dwordx4 v[28:31], v2, s[32:35], s72 offen offset:1024 sc1
    buffer_store_dwordx4 v[32:35], v2, s[32:35], s76 offen offset:1024 sc1
    buffer_store_dwordx2 v[36:37], v3, s[32:35], s75 offen offset:512 sc1
    v_mov_b32 v44, s50
    v_mov_b32 v45, 0
    s_waitcnt vmcnt(0)
    s_mov_b64 exec, 1
    buffer_store_dword v44, v45, s[32:35], s73 offen sc1
    s_mov_b64 exec, -1
    s_nop 0
    s_branch L_END
KC_40_S:
    s_mov_b32 s70, 200
KC_40_L:
    buffer_load_dwordx4 v[96:99], v72, s[32:35], s78 offen offset:0 sc1
    buffer_load_dwordx4 v[100:103], v72, s[32:35], s79 offen offset:0 sc1
    buffer_load_dwordx4 v[104:107], v72, s[32:35], s80 offen offset:0 sc1
    buffer_load_dwordx4 v[108:111], v72, s[32:35], s81 offen offset:0 sc1
    buffer_load_dwordx4 v[112:115], v72, s[32:35], s78 offen offset:256 sc1
    buffer_load_dwordx4 v[116:119], v72, s[32:35], s79 offen offset:256 sc1
    buffer_load_dwordx4 v[120:123], v72, s[32:35], s80 offen offset:256 sc1
    buffer_load_dwordx4 v[124:127], v72, s[32:35], s81 offen offset:256 sc1
    buffer_load_dwordx4 v[128:131], v72, s[32:35], s78 offen offset:512 sc1
    buffer_load_dwordx4 v[132:135], v72, s[32:35], s79 offen offset:512 sc1
    buffer_load_dwordx4 v[136:139], v72, s[32:35], s80 offen offset:512 sc1
    buffer_load_dwordx4 v[140:143], v72, s[32:35], s81 offen offset:512 sc1
    buffer_load_dwordx4 v[144:147], v72, s[32:35], s78 offen offset:768 sc1
    buffer_load_dwordx4 v[148:151], v72, s[32:35], s79 offen offset:768 sc1
    buffer_load_dwordx4 v[152:155], v72, s[32:35], s80 offen offset:768 sc1
    buffer_load_dwordx4 v[156:159], v72, s[32:35], s81 offen offset:768 sc1
    buffer_load_dwordx4 v[200:203], v72, s[32:35], s78 offen offset:1024 sc1
    buffer_load_dwordx4 v[204:207], v72, s[32:35], s79 offen offset:1024 sc1
    buffer_load_dwordx4 v[208:211], v72, s[32:35], s80 offen offset:1024 sc1
    buffer_load_dwordx4 v[212:215], v72, s[32:35], s81 offen offset:1024 sc1
    buffer_load_dwordx4 v[216:219], v72, s[32:35], s78 offen offset:1280 sc1
    buffer_load_dwordx4 v[220:223], v72, s[32:35], s79 offen offset:1280 sc1
    buffer_load_dwordx4 v[224:227], v72, s[32:35], s80 offen offset:1280 sc1
    buffer_load_dwordx4 v[228:231], v72, s[32:35], s81 offen offset:1280 sc1
    buffer_load_dwordx4 v[232:235], v73, s[32:35], s78 offen offset:1536 sc1
    buffer_load_dwordx4 v[236:239], v73, s[32:35], s79 offen offset:1536 sc1
    buffer_load_dwordx4 v[240:243], v73, s[32:35], s80 offen offset:1536 sc1
    buffer_load_dwordx4 v[244:247], v73, s[32:35], s81 offen offset:1536 sc1
    s_waitcnt vmcnt(0)
    v_mfma_f32_16x16x32_bf16 v[44:47], v[76:79], v[96:99], 0
    v_mfma_f32_16x16x32_bf16 v[44:47], v[76:79], v[100:103], v[44:47]
    v_mfma_f32_16x16x32_bf16 v[44:47], v[76:79], v[104:107], v[44:47]
    v_mfma_f32_16x16x32_bf16 v[44:47], v[76:79], v[108:111], v[44:47]
    v_mfma_f32_16x16x32_bf16 v[48:51], v[76:79], v[112:115], 0
    v_mfma_f32_16x16x32_bf16 v[48:51], v[76:79], v[116:119], v[48:51]
    v_mfma_f32_16x16x32_bf16 v[48:51], v[76:79], v[120:123], v[48:51]
    v_mfma_f32_16x16x32_bf16 v[48:51], v[76:79], v[124:127], v[48:51]
    v_mfma_f32_16x16x32_bf16 v[52:55], v[76:79], v[128:131], 0
    v_mfma_f32_16x16x32_bf16 v[52:55], v[76:79], v[132:135], v[52:55]
    v_mfma_f32_16x16x32_bf16 v[52:55], v[76:79], v[136:139], v[52:55]
    v_mfma_f32_16x16x32_bf16 v[52:55], v[76:79], v[140:143], v[52:55]
    v_mfma_f32_16x16x32_bf16 v[56:59], v[76:79], v[144:147], 0
    v_mfma_f32_16x16x32_bf16 v[56:59], v[76:79], v[148:151], v[56:59]
    v_mfma_f32_16x16x32_bf16 v[56:59], v[76:79], v[152:155], v[56:59]
    v_mfma_f32_16x16x32_bf16 v[56:59], v[76:79], v[156:159], v[56:59]
    v_mfma_f32_16x16x32_bf16 v[60:63], v[76:79], v[200:203], 0
    v_mfma_f32_16x16x32_bf16 v[60:63], v[76:79], v[204:207], v[60:63]
    v_mfma_f32_16x16x32_bf16 v[60:63], v[76:79], v[208:211], v[60:63]
    v_mfma_f32_16x16x32_bf16 v[60:63], v[76:79], v[212:215], v[60:63]
    v_mfma_f32_16x16x32_bf16 v[64:67], v[76:79], v[216:219], 0
    v_mfma_f32_16x16x32_bf16 v[64:67], v[76:79], v[220:223], v[64:67]
    v_mfma_f32_16x16x32_bf16 v[64:67], v[76:79], v[224:227], v[64:67]
    v_mfma_f32_16x16x32_bf16 v[64:67], v[76:79], v[228:231], v[64:67]
    v_mfma_f32_16x16x32_bf16 v[68:71], v[76:79], v[232:235], 0
    v_mfma_f32_16x16x32_bf16 v[68:71], v[76:79], v[236:239], v[68:71]
    v_mfma_f32_16x16x32_bf16 v[68:71], v[76:79], v[240:243], v[68:71]
    v_mfma_f32_16x16x32_bf16 v[68:71], v[76:79], v[244:247], v[68:71]
    s_mov_b32 exec_hi, 0
    v_cvt_pk_bf16_f32 v44, v44, v45
    v_cvt_pk_bf16_f32 v45, v46, v47
    ds_write_b64 v74, v[44:45] offset:0
    v_cvt_pk_bf16_f32 v48, v48, v49
    v_cvt_pk_bf16_f32 v49, v50, v51
    ds_write_b64 v74, v[48:49] offset:256
    v_cmp_u_f32 s[56:57], v47, v51
    v_cvt_pk_bf16_f32 v52, v52, v53
    v_cvt_pk_bf16_f32 v53, v54, v55
    ds_write_b64 v74, v[52:53] offset:512
    v_cvt_pk_bf16_f32 v56, v56, v57
    v_cvt_pk_bf16_f32 v57, v58, v59
    ds_write_b64 v74, v[56:57] offset:768
    v_cmp_u_f32 s[58:59], v55, v59
    v_cvt_pk_bf16_f32 v60, v60, v61
    v_cvt_pk_bf16_f32 v61, v62, v63
    ds_write_b64 v74, v[60:61] offset:1024
    v_cvt_pk_bf16_f32 v64, v64, v65
    v_cvt_pk_bf16_f32 v65, v66, v67
    ds_write_b64 v74, v[64:65] offset:1280
    v_cmp_u_f32 s[60:61], v63, v67
    v_cvt_pk_bf16_f32 v68, v68, v69
    v_cvt_pk_bf16_f32 v69, v70, v71
    ds_write_b64 v74, v[68:69] offset:1536
    v_cmp_u_f32 vcc, v71, v71
    s_or_b64 s[56:57], s[56:57], s[58:59]
    s_or_b64 s[56:57], s[56:57], s[60:61]
    s_mov_b32 exec_hi, -1
    s_or_b64 vcc, vcc, s[56:57]
    s_cbranch_scc0 KC_40
    s_sub_u32 s70, s70, 1
    s_cbranch_scc0 KC_40_L
    s_branch KC_40
L_END:
L_EXIT:
    s_endpgm
.section .rodata,"a"
.p2align 6
.amdhsa_kernel gated_mix__linear_kernel_hedgehog__dense_activation_silu__prompt_kernel
  .amdhsa_next_free_vgpr 256
  .amdhsa_next_free_sgpr 102
  .amdhsa_accum_offset 256
  .amdhsa_group_segment_fixed_size 0
  .amdhsa_kernarg_size 88
  .amdhsa_user_sgpr_count 2
  .amdhsa_user_sgpr_kernarg_segment_ptr 1
  .amdhsa_system_sgpr_workgroup_id_x 1
.end_amdhsa_kernel
```
